```python
import torch

def _softmax(x, axis=-1):
    return torch.softmax(x, dim=axis)
def _gelu(x):
    return torch.nn.functional.gelu(x, approximate="tanh")
def _silu(x):
    return torch.nn.functional.silu(x)
def _sigmoid(x):
    return torch.sigmoid(x)
def _layernorm(x, axis=-1, eps=1e-5):
    m = x.mean(dim=axis, keepdim=True)
    v = x.var(dim=axis, keepdim=True, unbiased=False)
    return (x - m) / torch.sqrt(v + eps)
def _scatter_add(tgt, idx, src, axis=0):
    return tgt.clone().index_add_(axis, idx, src)
def _segment_sum(src, seg, n):
    out = torch.zeros((n,) + src.shape[1:], dtype=src.dtype)
    return out.index_add_(0, seg, src)
def _pad(x, pw):
    flat = tuple(v for pair in reversed(pw) for v in pair)
    return torch.nn.functional.pad(x, flat)

kernel_name = 'recurrent_scan__linear_kernel_hedgehog__dense_activation_mish__prompt'

def setup_inputs():

    _w = (lambda a: (lambda t: t.to(torch.bfloat16) if t.is_floating_point() else t)(torch.as_tensor(a)))
    def _A_setup():
        B, S, D, H = 1, 2048, 576, 32
        Dh = D // H
        return {
            "x": _w((lambda *s: torch.randn(*s, dtype=torch.bfloat16) * 0.05)(B, S, D)),
            "wqkv": _w((lambda *s: torch.randn(*s, dtype=torch.bfloat16) * 0.4)(D, 3 * D)),
            "w_phi": _w((lambda *s: torch.randn(*s, dtype=torch.bfloat16) * 0.4)(H, Dh, Dh) * (Dh ** -0.5)),
            "wo": _w((lambda *s: torch.randn(*s, dtype=torch.bfloat16) * 0.2)(D, D)),
        }
    _A_in = _A_setup()

    def _B_setup():
        B, S, D, F = 1, 2048, 576, 4608
        return {
            "x": _w((lambda *s: torch.randn(*s, dtype=torch.bfloat16) * 0.05)(B, S, D)),
            "w1": _w((lambda *s: torch.randn(*s, dtype=torch.bfloat16) * 0.4)(D, F) * (D ** -0.5)),
            "b1": _w((lambda *s: torch.randn(*s, dtype=torch.bfloat16) * 0.4)(F)),
            "w2": _w((lambda *s: torch.randn(*s, dtype=torch.bfloat16) * 0.1)(F, D) * (F ** -0.5)),
        }
    _B_in = _B_setup()

    return {
        "A_x": _A_in["x"],
        "A_wqkv": _A_in["wqkv"],
        "A_w_phi": _A_in["w_phi"],
        "A_wo": _A_in["wo"],
        "B_x": _B_in["x"],
        "B_w1": _B_in["w1"],
        "B_b1": _B_in["b1"],
        "B_w2": _B_in["w2"],
    }

def reference(A_x, A_wqkv, A_w_phi, A_wo, B_x, B_w1, B_b1, B_w2):
    def _A_ref(x, wqkv, w_phi, wo):
        B, S, D = x.shape
        H = 32; Dh = D // H
        qkv = (lambda x, *d: x.permute(*d))((x @ wqkv).reshape(B, S, 3, H, Dh), 2, 0, 3, 1, 4)
        q, k, v = qkv[0], qkv[1], qkv[2]
        pq = torch.einsum("bhsd,hdf->bhsf", q, w_phi)
        pk = torch.einsum("bhsd,hdf->bhsf", k, w_phi)
        phi_q = torch.concatenate([_softmax(pq, axis=-1), _softmax(-pq, axis=-1)], axis=-1)
        phi_k = torch.concatenate([_softmax(pk, axis=-1), _softmax(-pk, axis=-1)], axis=-1)
        kv = torch.einsum("bhsf,bhsd->bhfd", phi_k, v)
        z  = torch.einsum("bhsf->bhf", phi_k)
        num = torch.einsum("bhqf,bhfd->bhqd", phi_q, kv)
        den = torch.einsum("bhqf,bhf->bhq", phi_q, z)[..., None] + 1e-6
        o = num / den
        return (lambda x, *d: x.permute(*d))(o, 0, 2, 1, 3).reshape(B, S, D) @ wo

    def _B_ref(x, w1, b1, w2):
        h = torch.einsum("bsd,df->bsf", x, w1) + b1
        sp = torch.log1p(torch.exp(-torch.abs(h))) + torch.where(h > 0, h, torch.zeros_like(h))
        act = h * torch.tanh(sp)
        return torch.einsum("bsf,fd->bsd", act, w2)

    x = A_x
    xn = _layernorm(x, axis=-1)
    s = _A_ref(xn, A_wqkv, A_w_phi, A_wo)
    g = _silu(_B_ref(xn, B_w1, B_b1, B_w2))
    return x + s * g
```

```asm
; @launch grid=(256,1,1) block=(256,1,1) lds=163840
.amdgcn_target "amdgcn-amd-amdhsa--gfx950"
.text
.globl recurrent_scan__linear_kernel_hedgehog__dense_activation_mish__prompt_kernel
.p2align 12
.p2align 8
.type recurrent_scan__linear_kernel_hedgehog__dense_activation_mish__prompt_kernel,@function
recurrent_scan__linear_kernel_hedgehog__dense_activation_mish__prompt_kernel:
s_cmp_ge_u32 s2, 256
s_cbranch_scc1 L_end
s_load_dwordx16 s[64:79], s[0:1], 0
s_load_dwordx4 s[80:83], s[0:1], 64
s_load_dwordx2 s[84:85], s[0:1], 80
v_lshrrev_b32 v3, 6, v0
s_getpc_b64 s[6:7]
s_lshr_b32 s4, s2, 3
s_lshl_b32 s4, s4, 12
v_and_b32 v4, 7, v0
v_lshl_add_u32 v4, v3, 3, v4
v_lshl_add_u32 v4, v4, 7, s4
v_min_u32 v4, L_end-recurrent_scan__linear_kernel_hedgehog__dense_activation_mish__prompt_kernel-256, v4
s_mov_b64 exec, 0xff
global_load_dword a255, v4, s[6:7]
s_mov_b64 exec, -1
v_and_b32 v1, 63, v0
v_readfirstlane_b32 s32, v3
v_lshrrev_b32 v2, 5, v1
s_and_b32 s3, s2, 7
s_lshr_b32 s63, s2, 3
s_and_b32 s33, s63, 7
s_and_b32 s5, s3, 1
s_lshl_b32 s5, s5, 3
s_add_u32 s33, s33, s5
s_lshr_b32 s63, s63, 3
s_lshr_b32 s3, s3, 1
s_mul_i32 s35, s32, 36864
s_lshl_b32 s5, s33, 2
s_add_u32 s5, s5, s32
s_mul_i32 s36, s5, 36864
s_add_u32 s37, s36, 18432
s_mul_i32 s43, s5, 36864
s_lshl_b32 s4, s33, 7
s_add_u32 s4, s4, 47185920
v_lshrrev_b32 v3, 3, v1
v_mul_u32_u24 v3, 1152, v3
v_lshrrev_b32 v4, 4, v1
v_and_b32 v5, 7, v1
v_xor_b32 v4, v4, v5
v_lshl_add_u32 v7, v4, 4, v3
v_xor_b32 v4, 4, v4
v_lshl_add_u32 v8, v4, 4, v3
v_add_u32 v8, 9216, v8
s_cmp_eq_u32 s63, 0
s_cbranch_scc1 L_attn
s_mul_i32 s34, s3, 3
s_add_u32 s34, s34, s63
s_sub_u32 s34, s34, 1
s_sub_u32 s6, s63, 1
s_cmp_ge_u32 s6, 3
s_cselect_b32 s7, 3, 0
s_sub_u32 s60, s6, s7
s_mul_i32 s6, s60, 384
s_add_u32 s54, s36, s6
s_add_u32 s55, s37, s6
s_add_u32 s6, s63, 0
s_cmp_ge_u32 s6, 3
s_cselect_b32 s7, 3, 0
s_sub_u32 s61, s6, s7
s_mul_i32 s6, s61, 384
s_add_u32 s56, s36, s6
s_add_u32 s57, s37, s6
s_add_u32 s6, s63, 1
s_cmp_ge_u32 s6, 3
s_cselect_b32 s7, 3, 0
s_sub_u32 s62, s6, s7
s_mul_i32 s6, s62, 384
s_add_u32 s58, s36, s6
s_add_u32 s59, s37, s6
s_lshl_b32 s5, s34, 2
s_add_u32 s5, s5, s4
s_lshl_b32 s1, s33, 2
s_cmp_eq_u32 s34, 0
s_cselect_b32 s100, s4, 0x7f000000
s_cselect_b32 s101, s1, 0x7f000000
s_waitcnt lgkmcnt(0)
s_mov_b32 s8, s64
s_and_b32 s9, s65, 0xffff
s_mov_b32 s10, 2359296
s_mov_b32 s11, 0x20000
s_add_u32 m0, s35, 16384
s_nop 0
buffer_load_dwordx4 v7, s[8:11], s54 offen offset:0 lds
s_add_u32 m0, s35, 17408
s_nop 0
buffer_load_dwordx4 v8, s[8:11], s54 offen offset:0 lds
s_add_u32 m0, s35, 18432
s_nop 0
buffer_load_dwordx4 v7, s[8:11], s55 offen offset:0 lds
s_add_u32 m0, s35, 19456
s_nop 0
buffer_load_dwordx4 v8, s[8:11], s55 offen offset:0 lds
s_add_u32 m0, s35, 20352
s_nop 0
buffer_load_dwordx4 v7, s[8:11], s54 offen offset:128 lds
s_add_u32 m0, s35, 21376
s_nop 0
buffer_load_dwordx4 v8, s[8:11], s54 offen offset:128 lds
s_add_u32 m0, s35, 22400
s_nop 0
buffer_load_dwordx4 v7, s[8:11], s55 offen offset:128 lds
s_add_u32 m0, s35, 23424
s_nop 0
buffer_load_dwordx4 v8, s[8:11], s55 offen offset:128 lds
s_add_u32 m0, s35, 24320
s_nop 0
buffer_load_dwordx4 v7, s[8:11], s54 offen offset:256 lds
s_add_u32 m0, s35, 25344
s_nop 0
buffer_load_dwordx4 v8, s[8:11], s54 offen offset:256 lds
s_add_u32 m0, s35, 26368
s_nop 0
buffer_load_dwordx4 v7, s[8:11], s55 offen offset:256 lds
s_add_u32 m0, s35, 27392
s_nop 0
buffer_load_dwordx4 v8, s[8:11], s55 offen offset:256 lds
s_mov_b32 s20, s84
s_and_b32 s21, s85, 0xffff
s_mov_b32 s22, 50331648
s_mov_b32 s23, 0x20000
s_mov_b32 s28, s82
s_and_b32 s29, s83, 0xffff
s_mov_b32 s30, 256
s_mov_b32 s31, 0x20000
s_mov_b32 s44, 0x00003f80
s_mov_b32 s45, 0x3f800000
s_mov_b32 s46, 0x3f803f80
s_mov_b32 s47, 0xffff0000
s_mov_b32 s48, 0x3fb8aa3b
s_mov_b32 s49, 0xbfb17218
v_mov_b32 v3, 0x7f000000
v_lshlrev_b32 v13, 2, v0
v_cmp_gt_u32 vcc, 16, v0
v_mov_b32 v14, 0
s_nop 0
v_cndmask_b32 v13, v3, v13, vcc
buffer_store_dword v14, v13, s[20:23], s100 offen sc1
v_mov_b32 v3, 0x7f000000
v_cmp_eq_u32 vcc, 0, v0
s_nop 1
v_cndmask_b32 v13, v3, v0, vcc
v_and_b32 v3, 31, v1
v_lshrrev_b32 v4, 3, v3
v_lshlrev_b32 v4, 10, v4
v_and_b32 v5, 7, v3
v_lshl_add_u32 v4, v5, 7, v4
v_add_u32 v4, s35, v4
v_bfe_u32 v5, v3, 1, 3
v_xor_b32 v5, v5, v2
v_xor_b32 v6, 0, v5
v_lshl_add_u32 v9, v6, 4, v4
v_xor_b32 v6, 2, v5
v_lshl_add_u32 v10, v6, 4, v4
v_xor_b32 v6, 4, v5
v_lshl_add_u32 v11, v6, 4, v4
v_xor_b32 v6, 6, v5
v_lshl_add_u32 v12, v6, 4, v4
v_lshlrev_b32 v19, 4, v1
s_mov_b32 s12, s74
s_and_b32 s13, s75, 0xffff
s_mov_b32 s14, 5308416
s_mov_b32 s15, 0x20000
s_mov_b32 s16, s78
s_and_b32 s17, s79, 0xffff
s_mov_b32 s18, 5308416
s_mov_b32 s19, 0x20000
s_mov_b32 s24, s76
s_and_b32 s25, s77, 0xffff
s_mov_b32 s26, 9216
s_mov_b32 s27, 0x20000
s_mul_i32 s50, s34, 768
v_lshlrev_b32 v3, 2, v0
v_min_u32 v3, 764, v3
buffer_load_dword v32, v3, s[24:27], s50 offen
v_lshlrev_b32 v33, 1, v3
v_lshlrev_b32 v4, 2, v2
v_bfe_u32 v5, v1, 2, 2
v_add_u32 v4, v4, v5
v_bfe_u32 v5, v1, 4, 1
v_lshlrev_b32 v5, 6, v5
v_and_b32 v6, 3, v1
v_lshl_add_u32 v5, v6, 4, v5
v_mul_u32_u24 v20, 9216, v4
v_add_u32 v20, v20, v5
v_add_u32 v21, 72704, v20
v_add_u32 v22, 145408, v20
v_mul_u32_u24 v23, 1152, v4
v_add_u32 v23, v23, v5
v_add_u32 v24, 8192, v23
v_add_u32 v25, 16384, v23
s_mul_i32 s38, s32, 442368
s_add_u32 s38, s38, s50
s_mul_i32 s60, s60, 1769472
s_add_u32 s60, s60, s38
s_mul_i32 s61, s61, 1769472
s_add_u32 s61, s61, s38
s_mul_i32 s62, s62, 1769472
s_add_u32 s62, s62, s38
s_mul_i32 s51, s34, 442368
s_mul_i32 s39, s32, 55296
s_add_u32 s39, s39, s51
s_mul_i32 s40, s34, 2359296
s_add_u32 s40, s40, s43
s_lshr_b32 s6, s34, 2
s_and_b32 s7, s34, 3
s_lshl_b32 s52, s6, 12
s_add_u32 s52, s52, s43
s_lshl_b32 s53, s7, 7
s_add_u32 s52, s52, s53
s_mul_i32 s53, s7, 9216
s_lshl_b32 s6, s6, 7
s_add_u32 s53, s53, s6
s_add_u32 s53, s53, s36
v_bfe_u32 v26, v1, 2, 2
v_lshlrev_b32 v26, 6, v26
v_bfe_u32 v6, v1, 4, 1
v_lshl_add_u32 v26, v6, 5, v26
v_and_b32 v6, 3, v1
v_lshl_add_u32 v26, v6, 3, v26
v_mul_u32_u24 v6, 1024, v2
v_add_u32 v26, v26, v6
v_bfe_u32 v240, v1, 2, 2
v_lshlrev_b32 v240, 6, v240
v_bfe_u32 v6, v1, 4, 1
v_lshl_add_u32 v240, v6, 5, v240
v_and_b32 v6, 1, v1
v_lshl_add_u32 v240, v6, 4, v240
v_bfe_u32 v6, v1, 1, 1
v_lshl_add_u32 v240, v6, 3, v240
v_mul_u32_u24 v6, 512, v2
v_add_u32 v240, v240, v6
v_add_u32 v27, 36864, v26
v_add_u32 v241, 36864, v240
v_add_u32 v28, 73728, v26
v_add_u32 v242, 73728, v240
v_add_u32 v29, 110592, v26
v_add_u32 v243, 110592, v240
v_lshlrev_b32 v30, 4, v2
v_add_u32 v30, 147456, v30
v_mov_b32 v31, 0x3f317218
s_mov_b32 s64, s66
s_and_b32 s65, s67, 0xffff
s_mov_b32 s66, 1990656
s_mov_b32 s67, 0x20000
s_mov_b32 s68, s70
s_and_b32 s69, s71, 0xffff
s_mov_b32 s70, 663552
s_mov_b32 s71, 0x20000
s_and_b32 s6, s33, 7
s_lshl_b32 s6, s6, 2
s_add_u32 s6, s6, s32
s_lshl_b32 s7, s63, 5
s_add_u32 s7, s7, s6
s_sub_u32 s7, s7, 32
v_mov_b32 v6, 0x7f000000
s_mul_i32 s41, s7, 24
v_add_u32 v3, s41, v1
v_lshrrev_b32 v4, 2, v3
v_mul_u32_u24 v4, 3456, v4
v_and_b32 v3, 3, v3
v_lshl_add_u32 v3, v3, 7, v4
v_cmp_gt_u32 vcc, 24, v1
s_nop 1
v_cndmask_b32 v244, v6, v3, vcc
s_mul_i32 s41, s7, 14
v_add_u32 v3, s41, v1
v_lshlrev_b32 v3, 7, v3
v_cmp_gt_u32 vcc, 14, v1
s_nop 1
v_cndmask_b32 v245, v6, v3, vcc
s_mul_i32 s41, s6, 18
v_add_u32 v3, s41, v1
v_lshlrev_b32 v3, 7, v3
v_cmp_gt_u32 vcc, 18, v1
s_nop 1
v_cndmask_b32 v246, v6, v3, vcc
s_and_b32 s6, s33, 7
s_mul_i32 s6, s6, 55296
v_lshrrev_b32 v3, 1, v1
v_mul_u32_u24 v4, 43, v3
v_lshrrev_b32 v4, 8, v4
v_mul_u32_u24 v4, 1714176, v4
v_mul_u32_u24 v3, 9216, v3
v_add3_u32 v3, v3, v4, s6
v_and_b32 v4, 1, v1
v_lshl_add_u32 v3, v4, 7, v3
v_cmp_gt_u32 vcc, 36, v1
s_nop 1
v_cndmask_b32 v247, v6, v3, vcc
s_mul_i32 s72, s3, 288
s_and_b32 s72, s72, 0xffffff80
s_mul_i32 s73, s3, 165888
v_and_b32 v248, 7, v1
v_lshrrev_b32 v3, 3, v1
v_lshlrev_b32 v249, 4, v248
v_lshl_add_u32 v249, v3, 9, v249
v_mul_u32_u24 v248, 1152, v248
v_lshl_add_u32 v248, v3, 4, v248
v_mov_b32 v15, 0
v_mov_b32 v16, 0
v_mov_b32 v17, 0
v_mov_b32 v18, 0
s_add_u32 m0, s35, 28672
s_nop 0
buffer_load_dwordx4 v7, s[8:11], s56 offen offset:0 lds
s_add_u32 m0, s35, 29696
s_nop 0
buffer_load_dwordx4 v8, s[8:11], s56 offen offset:0 lds
s_add_u32 m0, s35, 30720
s_nop 0
buffer_load_dwordx4 v7, s[8:11], s57 offen offset:0 lds
s_add_u32 m0, s35, 31744
s_nop 0
buffer_load_dwordx4 v8, s[8:11], s57 offen offset:0 lds
s_mov_b64 exec, 0
s_cmp_eq_u32 s32, 0
s_cbranch_scc1 L_pad_f0_0
s_cmp_eq_u32 s32, 1
s_cbranch_scc1 L_pad_f1_0
s_cmp_eq_u32 s32, 2
s_cbranch_scc1 L_pad_f2_0
s_branch L_pad_f3_0
L_warm_f:
s_mov_b64 exec, -1
s_waitcnt vmcnt(14)
s_add_u32 m0, s35, 32640
s_nop 0
buffer_load_dwordx4 v7, s[8:11], s56 offen offset:128 lds
s_add_u32 m0, s35, 33664
s_nop 0
buffer_load_dwordx4 v8, s[8:11], s56 offen offset:128 lds
s_add_u32 m0, s35, 34688
s_nop 0
buffer_load_dwordx4 v7, s[8:11], s57 offen offset:128 lds
s_add_u32 m0, s35, 35712
s_nop 0
buffer_load_dwordx4 v8, s[8:11], s57 offen offset:128 lds
ds_read_b128 v[64:67], v9 offset:16384
ds_read_b128 v[68:71], v10 offset:16384
ds_read_b128 v[72:75], v11 offset:16384
ds_read_b128 v[76:79], v12 offset:16384
s_waitcnt vmcnt(14)
s_waitcnt lgkmcnt(0)
s_add_u32 m0, s35, 16128
s_nop 0
buffer_load_dwordx4 v7, s[8:11], s56 offen offset:256 lds
s_add_u32 m0, s35, 17152
s_nop 0
buffer_load_dwordx4 v8, s[8:11], s56 offen offset:256 lds
s_add_u32 m0, s35, 18176
s_nop 0
buffer_load_dwordx4 v7, s[8:11], s57 offen offset:256 lds
s_add_u32 m0, s35, 19200
s_nop 0
buffer_load_dwordx4 v8, s[8:11], s57 offen offset:256 lds
ds_read_b128 v[80:83], v9 offset:20480
ds_read_b128 v[84:87], v10 offset:20480
ds_read_b128 v[88:91], v11 offset:20480
ds_read_b128 v[92:95], v12 offset:20480
v_dot2c_f32_bf16 v15, s46, v64
v_dot2c_f32_bf16 v17, v64, v64
v_dot2c_f32_bf16 v16, s46, v65
v_dot2c_f32_bf16 v18, v65, v65
v_dot2c_f32_bf16 v15, s46, v66
v_dot2c_f32_bf16 v17, v66, v66
v_dot2c_f32_bf16 v16, s46, v67
v_dot2c_f32_bf16 v18, v67, v67
v_dot2c_f32_bf16 v15, s46, v68
v_dot2c_f32_bf16 v17, v68, v68
v_dot2c_f32_bf16 v16, s46, v69
v_dot2c_f32_bf16 v18, v69, v69
v_dot2c_f32_bf16 v15, s46, v70
v_dot2c_f32_bf16 v17, v70, v70
v_dot2c_f32_bf16 v16, s46, v71
v_dot2c_f32_bf16 v18, v71, v71
v_dot2c_f32_bf16 v15, s46, v72
v_dot2c_f32_bf16 v17, v72, v72
v_dot2c_f32_bf16 v16, s46, v73
v_dot2c_f32_bf16 v18, v73, v73
v_dot2c_f32_bf16 v15, s46, v74
v_dot2c_f32_bf16 v17, v74, v74
v_dot2c_f32_bf16 v16, s46, v75
v_dot2c_f32_bf16 v18, v75, v75
v_dot2c_f32_bf16 v15, s46, v76
v_dot2c_f32_bf16 v17, v76, v76
v_dot2c_f32_bf16 v16, s46, v77
v_dot2c_f32_bf16 v18, v77, v77
v_dot2c_f32_bf16 v15, s46, v78
v_dot2c_f32_bf16 v17, v78, v78
v_dot2c_f32_bf16 v16, s46, v79
v_dot2c_f32_bf16 v18, v79, v79
s_waitcnt vmcnt(14)
s_waitcnt lgkmcnt(0)
s_add_u32 m0, s35, 20480
s_nop 0
buffer_load_dwordx4 v7, s[8:11], s58 offen offset:0 lds
s_add_u32 m0, s35, 21504
s_nop 0
buffer_load_dwordx4 v8, s[8:11], s58 offen offset:0 lds
s_add_u32 m0, s35, 22528
s_nop 0
buffer_load_dwordx4 v7, s[8:11], s59 offen offset:0 lds
s_add_u32 m0, s35, 23552
s_nop 0
buffer_load_dwordx4 v8, s[8:11], s59 offen offset:0 lds
ds_read_b128 v[96:99], v9 offset:24576
ds_read_b128 v[100:103], v10 offset:24576
ds_read_b128 v[104:107], v11 offset:24576
ds_read_b128 v[108:111], v12 offset:24576
v_dot2c_f32_bf16 v15, s46, v80
v_dot2c_f32_bf16 v17, v80, v80
v_dot2c_f32_bf16 v16, s46, v81
v_dot2c_f32_bf16 v18, v81, v81
v_dot2c_f32_bf16 v15, s46, v82
v_dot2c_f32_bf16 v17, v82, v82
v_dot2c_f32_bf16 v16, s46, v83
v_dot2c_f32_bf16 v18, v83, v83
v_dot2c_f32_bf16 v15, s46, v84
v_dot2c_f32_bf16 v17, v84, v84
v_dot2c_f32_bf16 v16, s46, v85
v_dot2c_f32_bf16 v18, v85, v85
v_dot2c_f32_bf16 v15, s46, v86
v_dot2c_f32_bf16 v17, v86, v86
v_dot2c_f32_bf16 v16, s46, v87
v_dot2c_f32_bf16 v18, v87, v87
v_dot2c_f32_bf16 v15, s46, v88
v_dot2c_f32_bf16 v17, v88, v88
v_dot2c_f32_bf16 v16, s46, v89
v_dot2c_f32_bf16 v18, v89, v89
v_dot2c_f32_bf16 v15, s46, v90
v_dot2c_f32_bf16 v17, v90, v90
v_dot2c_f32_bf16 v16, s46, v91
v_dot2c_f32_bf16 v18, v91, v91
v_dot2c_f32_bf16 v15, s46, v92
v_dot2c_f32_bf16 v17, v92, v92
v_dot2c_f32_bf16 v16, s46, v93
v_dot2c_f32_bf16 v18, v93, v93
v_dot2c_f32_bf16 v15, s46, v94
v_dot2c_f32_bf16 v17, v94, v94
v_dot2c_f32_bf16 v16, s46, v95
v_dot2c_f32_bf16 v18, v95, v95
s_waitcnt vmcnt(12)
s_waitcnt lgkmcnt(0)
s_add_u32 m0, s35, 24448
s_nop 0
buffer_load_dwordx4 v7, s[8:11], s58 offen offset:128 lds
s_add_u32 m0, s35, 25472
s_nop 0
buffer_load_dwordx4 v8, s[8:11], s58 offen offset:128 lds
s_add_u32 m0, s35, 26496
s_nop 0
buffer_load_dwordx4 v7, s[8:11], s59 offen offset:128 lds
s_add_u32 m0, s35, 27520
s_nop 0
buffer_load_dwordx4 v8, s[8:11], s59 offen offset:128 lds
ds_read_b128 v[112:115], v9 offset:28672
ds_read_b128 v[116:119], v10 offset:28672
ds_read_b128 v[120:123], v11 offset:28672
ds_read_b128 v[124:127], v12 offset:28672
v_dot2c_f32_bf16 v15, s46, v96
v_dot2c_f32_bf16 v17, v96, v96
v_dot2c_f32_bf16 v16, s46, v97
v_dot2c_f32_bf16 v18, v97, v97
v_dot2c_f32_bf16 v15, s46, v98
v_dot2c_f32_bf16 v17, v98, v98
v_dot2c_f32_bf16 v16, s46, v99
v_dot2c_f32_bf16 v18, v99, v99
v_dot2c_f32_bf16 v15, s46, v100
v_dot2c_f32_bf16 v17, v100, v100
v_dot2c_f32_bf16 v16, s46, v101
v_dot2c_f32_bf16 v18, v101, v101
v_dot2c_f32_bf16 v15, s46, v102
v_dot2c_f32_bf16 v17, v102, v102
v_dot2c_f32_bf16 v16, s46, v103
v_dot2c_f32_bf16 v18, v103, v103
v_dot2c_f32_bf16 v15, s46, v104
v_dot2c_f32_bf16 v17, v104, v104
v_dot2c_f32_bf16 v16, s46, v105
v_dot2c_f32_bf16 v18, v105, v105
v_dot2c_f32_bf16 v15, s46, v106
v_dot2c_f32_bf16 v17, v106, v106
v_dot2c_f32_bf16 v16, s46, v107
v_dot2c_f32_bf16 v18, v107, v107
v_dot2c_f32_bf16 v15, s46, v108
v_dot2c_f32_bf16 v17, v108, v108
v_dot2c_f32_bf16 v16, s46, v109
v_dot2c_f32_bf16 v18, v109, v109
v_dot2c_f32_bf16 v15, s46, v110
v_dot2c_f32_bf16 v17, v110, v110
v_dot2c_f32_bf16 v16, s46, v111
v_dot2c_f32_bf16 v18, v111, v111
s_waitcnt vmcnt(12)
s_waitcnt lgkmcnt(0)
s_add_u32 m0, s35, 28416
s_nop 0
buffer_load_dwordx4 v7, s[8:11], s58 offen offset:256 lds
s_add_u32 m0, s35, 29440
s_nop 0
buffer_load_dwordx4 v8, s[8:11], s58 offen offset:256 lds
s_add_u32 m0, s35, 30464
s_nop 0
buffer_load_dwordx4 v7, s[8:11], s59 offen offset:256 lds
s_add_u32 m0, s35, 31488
s_nop 0
buffer_load_dwordx4 v8, s[8:11], s59 offen offset:256 lds
ds_read_b128 v[128:131], v9 offset:32768
ds_read_b128 v[132:135], v10 offset:32768
ds_read_b128 v[136:139], v11 offset:32768
ds_read_b128 v[140:143], v12 offset:32768
s_add_u32 m0, s35, 0
s_add_u32 s41, s60, 0
buffer_load_dwordx4 v20, s[12:15], s41 offen offset:0 lds
buffer_load_dwordx4 v21, s[12:15], s41 offen offset:1024 lds
buffer_load_dwordx4 v22, s[12:15], s41 offen offset:2048 lds
s_add_u32 m0, s35, 3072
s_add_u32 s41, s60, 221184
buffer_load_dwordx4 v20, s[12:15], s41 offen offset:0 lds
buffer_load_dwordx4 v21, s[12:15], s41 offen offset:1024 lds
buffer_load_dwordx4 v22, s[12:15], s41 offen offset:2048 lds
v_dot2c_f32_bf16 v15, s46, v112
v_dot2c_f32_bf16 v17, v112, v112
v_dot2c_f32_bf16 v16, s46, v113
v_dot2c_f32_bf16 v18, v113, v113
v_dot2c_f32_bf16 v15, s46, v114
v_dot2c_f32_bf16 v17, v114, v114
v_dot2c_f32_bf16 v16, s46, v115
v_dot2c_f32_bf16 v18, v115, v115
v_dot2c_f32_bf16 v15, s46, v116
v_dot2c_f32_bf16 v17, v116, v116
v_dot2c_f32_bf16 v16, s46, v117
v_dot2c_f32_bf16 v18, v117, v117
v_dot2c_f32_bf16 v15, s46, v118
v_dot2c_f32_bf16 v17, v118, v118
v_dot2c_f32_bf16 v16, s46, v119
v_dot2c_f32_bf16 v18, v119, v119
v_dot2c_f32_bf16 v15, s46, v120
v_dot2c_f32_bf16 v17, v120, v120
v_dot2c_f32_bf16 v16, s46, v121
v_dot2c_f32_bf16 v18, v121, v121
v_dot2c_f32_bf16 v15, s46, v122
v_dot2c_f32_bf16 v17, v122, v122
v_dot2c_f32_bf16 v16, s46, v123
v_dot2c_f32_bf16 v18, v123, v123
v_dot2c_f32_bf16 v15, s46, v124
v_dot2c_f32_bf16 v17, v124, v124
v_dot2c_f32_bf16 v16, s46, v125
v_dot2c_f32_bf16 v18, v125, v125
v_dot2c_f32_bf16 v15, s46, v126
v_dot2c_f32_bf16 v17, v126, v126
v_dot2c_f32_bf16 v16, s46, v127
v_dot2c_f32_bf16 v18, v127, v127
s_waitcnt vmcnt(18)
ds_read_b128 v[144:147], v9 offset:16384
ds_read_b128 v[148:151], v10 offset:16384
ds_read_b128 v[152:155], v11 offset:16384
ds_read_b128 v[156:159], v12 offset:16384
s_add_u32 m0, s35, 6144
s_add_u32 s41, s61, 0
buffer_load_dwordx4 v20, s[12:15], s41 offen offset:0 lds
buffer_load_dwordx4 v21, s[12:15], s41 offen offset:1024 lds
buffer_load_dwordx4 v22, s[12:15], s41 offen offset:2048 lds
s_add_u32 m0, s35, 9216
s_add_u32 s41, s61, 221184
buffer_load_dwordx4 v20, s[12:15], s41 offen offset:0 lds
buffer_load_dwordx4 v21, s[12:15], s41 offen offset:1024 lds
buffer_load_dwordx4 v22, s[12:15], s41 offen offset:2048 lds
s_waitcnt lgkmcnt(7)
v_dot2c_f32_bf16 v15, s46, v128
v_dot2c_f32_bf16 v17, v128, v128
v_dot2c_f32_bf16 v16, s46, v129
v_dot2c_f32_bf16 v18, v129, v129
v_dot2c_f32_bf16 v15, s46, v130
v_dot2c_f32_bf16 v17, v130, v130
v_dot2c_f32_bf16 v16, s46, v131
v_dot2c_f32_bf16 v18, v131, v131
s_waitcnt lgkmcnt(6)
v_dot2c_f32_bf16 v15, s46, v132
v_dot2c_f32_bf16 v17, v132, v132
v_dot2c_f32_bf16 v16, s46, v133
v_dot2c_f32_bf16 v18, v133, v133
v_dot2c_f32_bf16 v15, s46, v134
v_dot2c_f32_bf16 v17, v134, v134
v_dot2c_f32_bf16 v16, s46, v135
v_dot2c_f32_bf16 v18, v135, v135
s_waitcnt lgkmcnt(5)
v_dot2c_f32_bf16 v15, s46, v136
v_dot2c_f32_bf16 v17, v136, v136
v_dot2c_f32_bf16 v16, s46, v137
v_dot2c_f32_bf16 v18, v137, v137
v_dot2c_f32_bf16 v15, s46, v138
v_dot2c_f32_bf16 v17, v138, v138
v_dot2c_f32_bf16 v16, s46, v139
v_dot2c_f32_bf16 v18, v139, v139
s_waitcnt lgkmcnt(4)
v_dot2c_f32_bf16 v15, s46, v140
v_dot2c_f32_bf16 v17, v140, v140
v_dot2c_f32_bf16 v16, s46, v141
v_dot2c_f32_bf16 v18, v141, v141
v_dot2c_f32_bf16 v15, s46, v142
v_dot2c_f32_bf16 v17, v142, v142
v_dot2c_f32_bf16 v16, s46, v143
v_dot2c_f32_bf16 v18, v143, v143
s_waitcnt vmcnt(20)
ds_read_b128 v[160:163], v9 offset:20480
ds_read_b128 v[164:167], v10 offset:20480
ds_read_b128 v[168:171], v11 offset:20480
ds_read_b128 v[172:175], v12 offset:20480
s_waitcnt lgkmcnt(7)
v_dot2c_f32_bf16 v15, s46, v144
v_dot2c_f32_bf16 v17, v144, v144
v_dot2c_f32_bf16 v16, s46, v145
v_dot2c_f32_bf16 v18, v145, v145
v_dot2c_f32_bf16 v15, s46, v146
v_dot2c_f32_bf16 v17, v146, v146
v_dot2c_f32_bf16 v16, s46, v147
v_dot2c_f32_bf16 v18, v147, v147
s_waitcnt lgkmcnt(6)
v_dot2c_f32_bf16 v15, s46, v148
v_dot2c_f32_bf16 v17, v148, v148
v_dot2c_f32_bf16 v16, s46, v149
v_dot2c_f32_bf16 v18, v149, v149
v_dot2c_f32_bf16 v15, s46, v150
v_dot2c_f32_bf16 v17, v150, v150
v_dot2c_f32_bf16 v16, s46, v151
v_dot2c_f32_bf16 v18, v151, v151
s_waitcnt lgkmcnt(5)
v_dot2c_f32_bf16 v15, s46, v152
v_dot2c_f32_bf16 v17, v152, v152
v_dot2c_f32_bf16 v16, s46, v153
v_dot2c_f32_bf16 v18, v153, v153
v_dot2c_f32_bf16 v15, s46, v154
v_dot2c_f32_bf16 v17, v154, v154
v_dot2c_f32_bf16 v16, s46, v155
v_dot2c_f32_bf16 v18, v155, v155
s_waitcnt lgkmcnt(4)
v_dot2c_f32_bf16 v15, s46, v156
v_dot2c_f32_bf16 v17, v156, v156
v_dot2c_f32_bf16 v16, s46, v157
v_dot2c_f32_bf16 v18, v157, v157
v_dot2c_f32_bf16 v15, s46, v158
v_dot2c_f32_bf16 v17, v158, v158
v_dot2c_f32_bf16 v16, s46, v159
v_dot2c_f32_bf16 v18, v159, v159
s_waitcnt vmcnt(16)
ds_read_b128 v[176:179], v9 offset:24576
ds_read_b128 v[180:183], v10 offset:24576
ds_read_b128 v[184:187], v11 offset:24576
ds_read_b128 v[188:191], v12 offset:24576
s_waitcnt lgkmcnt(7)
v_dot2c_f32_bf16 v15, s46, v160
v_dot2c_f32_bf16 v17, v160, v160
v_dot2c_f32_bf16 v16, s46, v161
v_dot2c_f32_bf16 v18, v161, v161
v_dot2c_f32_bf16 v15, s46, v162
v_dot2c_f32_bf16 v17, v162, v162
v_dot2c_f32_bf16 v16, s46, v163
v_dot2c_f32_bf16 v18, v163, v163
s_waitcnt lgkmcnt(6)
v_dot2c_f32_bf16 v15, s46, v164
v_dot2c_f32_bf16 v17, v164, v164
v_dot2c_f32_bf16 v16, s46, v165
v_dot2c_f32_bf16 v18, v165, v165
v_dot2c_f32_bf16 v15, s46, v166
v_dot2c_f32_bf16 v17, v166, v166
v_dot2c_f32_bf16 v16, s46, v167
v_dot2c_f32_bf16 v18, v167, v167
s_waitcnt lgkmcnt(5)
v_dot2c_f32_bf16 v15, s46, v168
v_dot2c_f32_bf16 v17, v168, v168
v_dot2c_f32_bf16 v16, s46, v169
v_dot2c_f32_bf16 v18, v169, v169
v_dot2c_f32_bf16 v15, s46, v170
v_dot2c_f32_bf16 v17, v170, v170
v_dot2c_f32_bf16 v16, s46, v171
v_dot2c_f32_bf16 v18, v171, v171
s_waitcnt lgkmcnt(4)
v_dot2c_f32_bf16 v15, s46, v172
v_dot2c_f32_bf16 v17, v172, v172
v_dot2c_f32_bf16 v16, s46, v173
v_dot2c_f32_bf16 v18, v173, v173
v_dot2c_f32_bf16 v15, s46, v174
v_dot2c_f32_bf16 v17, v174, v174
v_dot2c_f32_bf16 v16, s46, v175
v_dot2c_f32_bf16 v18, v175, v175
s_waitcnt vmcnt(12)
ds_read_b128 v[192:195], v9 offset:28672
ds_read_b128 v[196:199], v10 offset:28672
ds_read_b128 v[200:203], v11 offset:28672
ds_read_b128 v[204:207], v12 offset:28672
v_mov_b32 v14, 1
buffer_store_dword v14, v13, s[28:31], s101 offen sc1
s_waitcnt lgkmcnt(7)
v_dot2c_f32_bf16 v15, s46, v176
v_dot2c_f32_bf16 v17, v176, v176
v_dot2c_f32_bf16 v16, s46, v177
v_dot2c_f32_bf16 v18, v177, v177
v_dot2c_f32_bf16 v15, s46, v178
v_dot2c_f32_bf16 v17, v178, v178
v_dot2c_f32_bf16 v16, s46, v179
v_dot2c_f32_bf16 v18, v179, v179
s_waitcnt lgkmcnt(6)
v_dot2c_f32_bf16 v15, s46, v180
v_dot2c_f32_bf16 v17, v180, v180
v_dot2c_f32_bf16 v16, s46, v181
v_dot2c_f32_bf16 v18, v181, v181
v_dot2c_f32_bf16 v15, s46, v182
v_dot2c_f32_bf16 v17, v182, v182
v_dot2c_f32_bf16 v16, s46, v183
v_dot2c_f32_bf16 v18, v183, v183
s_waitcnt lgkmcnt(5)
v_dot2c_f32_bf16 v15, s46, v184
v_dot2c_f32_bf16 v17, v184, v184
v_dot2c_f32_bf16 v16, s46, v185
v_dot2c_f32_bf16 v18, v185, v185
v_dot2c_f32_bf16 v15, s46, v186
v_dot2c_f32_bf16 v17, v186, v186
v_dot2c_f32_bf16 v16, s46, v187
v_dot2c_f32_bf16 v18, v187, v187
s_waitcnt lgkmcnt(4)
v_dot2c_f32_bf16 v15, s46, v188
v_dot2c_f32_bf16 v17, v188, v188
v_dot2c_f32_bf16 v16, s46, v189
v_dot2c_f32_bf16 v18, v189, v189
v_dot2c_f32_bf16 v15, s46, v190
v_dot2c_f32_bf16 v17, v190, v190
v_dot2c_f32_bf16 v16, s46, v191
v_dot2c_f32_bf16 v18, v191, v191
s_waitcnt lgkmcnt(3)
v_dot2c_f32_bf16 v15, s46, v192
v_dot2c_f32_bf16 v17, v192, v192
v_dot2c_f32_bf16 v16, s46, v193
v_dot2c_f32_bf16 v18, v193, v193
v_dot2c_f32_bf16 v15, s46, v194
v_dot2c_f32_bf16 v17, v194, v194
v_dot2c_f32_bf16 v16, s46, v195
v_dot2c_f32_bf16 v18, v195, v195
s_waitcnt lgkmcnt(2)
v_dot2c_f32_bf16 v15, s46, v196
v_dot2c_f32_bf16 v17, v196, v196
v_dot2c_f32_bf16 v16, s46, v197
v_dot2c_f32_bf16 v18, v197, v197
v_dot2c_f32_bf16 v15, s46, v198
v_dot2c_f32_bf16 v17, v198, v198
v_dot2c_f32_bf16 v16, s46, v199
v_dot2c_f32_bf16 v18, v199, v199
s_waitcnt lgkmcnt(1)
v_dot2c_f32_bf16 v15, s46, v200
v_dot2c_f32_bf16 v17, v200, v200
v_dot2c_f32_bf16 v16, s46, v201
v_dot2c_f32_bf16 v18, v201, v201
v_dot2c_f32_bf16 v15, s46, v202
v_dot2c_f32_bf16 v17, v202, v202
v_dot2c_f32_bf16 v16, s46, v203
v_dot2c_f32_bf16 v18, v203, v203
s_waitcnt lgkmcnt(0)
v_dot2c_f32_bf16 v15, s46, v204
v_dot2c_f32_bf16 v17, v204, v204
v_dot2c_f32_bf16 v16, s46, v205
v_dot2c_f32_bf16 v18, v205, v205
v_dot2c_f32_bf16 v15, s46, v206
v_dot2c_f32_bf16 v17, v206, v206
v_dot2c_f32_bf16 v16, s46, v207
v_dot2c_f32_bf16 v18, v207, v207
v_lshlrev_b32 v34, 16, v32
v_and_b32 v35, s47, v32
v_mul_f32 v34, s48, v34
v_mul_f32 v35, s48, v35
v_add_u32 v33, 147456, v33
ds_write_b64 v33, v[34:35]
v_add_f32 v15, v15, v16
v_add_f32 v17, v17, v18
v_mov_b32 v16, v15
s_nop 1
v_permlane32_swap_b32 v15, v16
v_add_f32 v15, v15, v16
v_mov_b32 v18, v17
s_nop 1
v_permlane32_swap_b32 v17, v18
v_add_f32 v17, v17, v18
v_mul_f32 v15, 0x3ae38e39, v15
L_pad_f0_0:
s_cbranch_execz L_pad_f0_1
v_mul_f32 v17, 0x3ae38e39, v17
v_mov_b32 v13, v15
v_cvt_pk_bf16_f32 v13, v13, v13
v_and_b32 v13, s47, v13
v_sub_f32 v16, v15, v13
v_sub_f32 v13, 0, v13
v_mul_f32 v18, v15, v15
v_sub_f32 v14, v17, v18
v_dot2_f32_bf16 v32, v64, s44, v13
v_dot2_f32_bf16 v33, v64, s45, v13
v_dot2_f32_bf16 v34, v65, s44, v13
v_dot2_f32_bf16 v35, v65, s45, v13
v_dot2_f32_bf16 v36, v66, s44, v13
v_dot2_f32_bf16 v37, v66, s45, v13
v_dot2_f32_bf16 v38, v67, s44, v13
v_dot2_f32_bf16 v39, v67, s45, v13
v_dot2_f32_bf16 v40, v68, s44, v13
v_dot2_f32_bf16 v41, v68, s45, v13
v_dot2_f32_bf16 v42, v69, s44, v13
v_dot2_f32_bf16 v43, v69, s45, v13
v_dot2_f32_bf16 v44, v70, s44, v13
v_dot2_f32_bf16 v45, v70, s45, v13
v_dot2_f32_bf16 v46, v71, s44, v13
v_dot2_f32_bf16 v47, v71, s45, v13
s_add_u32 m0, s35, 12288
s_add_u32 s41, s62, 0
buffer_load_dwordx4 v20, s[12:15], s41 offen offset:0 lds
v_cvt_pk_bf16_f32 v64, v32, v33
v_cvt_pk_bf16_f32 v65, v34, v35
v_cvt_pk_bf16_f32 v66, v36, v37
v_cvt_pk_bf16_f32 v67, v38, v39
v_cvt_pk_bf16_f32 v68, v40, v41
v_cvt_pk_bf16_f32 v69, v42, v43
v_cvt_pk_bf16_f32 v70, v44, v45
v_cvt_pk_bf16_f32 v71, v46, v47
v_dot2_f32_bf16 v32, v72, s44, v13
v_dot2_f32_bf16 v33, v72, s45, v13
v_dot2_f32_bf16 v34, v73, s44, v13
v_dot2_f32_bf16 v35, v73, s45, v13
v_dot2_f32_bf16 v36, v74, s44, v13
v_dot2_f32_bf16 v37, v74, s45, v13
v_dot2_f32_bf16 v38, v75, s44, v13
v_dot2_f32_bf16 v39, v75, s45, v13
v_dot2_f32_bf16 v40, v76, s44, v13
v_dot2_f32_bf16 v41, v76, s45, v13
v_dot2_f32_bf16 v42, v77, s44, v13
v_dot2_f32_bf16 v43, v77, s45, v13
v_dot2_f32_bf16 v44, v78, s44, v13
v_dot2_f32_bf16 v45, v78, s45, v13
v_dot2_f32_bf16 v46, v79, s44, v13
v_dot2_f32_bf16 v47, v79, s45, v13
buffer_load_dwordx4 v21, s[12:15], s41 offen offset:1024 lds
v_cvt_pk_bf16_f32 v72, v32, v33
v_cvt_pk_bf16_f32 v73, v34, v35
v_cvt_pk_bf16_f32 v74, v36, v37
v_cvt_pk_bf16_f32 v75, v38, v39
v_cvt_pk_bf16_f32 v76, v40, v41
v_cvt_pk_bf16_f32 v77, v42, v43
v_cvt_pk_bf16_f32 v78, v44, v45
v_cvt_pk_bf16_f32 v79, v46, v47
v_dot2_f32_bf16 v32, v80, s44, v13
v_dot2_f32_bf16 v33, v80, s45, v13
v_dot2_f32_bf16 v34, v81, s44, v13
v_dot2_f32_bf16 v35, v81, s45, v13
v_dot2_f32_bf16 v36, v82, s44, v13
v_dot2_f32_bf16 v37, v82, s45, v13
v_dot2_f32_bf16 v38, v83, s44, v13
v_dot2_f32_bf16 v39, v83, s45, v13
v_dot2_f32_bf16 v40, v84, s44, v13
v_dot2_f32_bf16 v41, v84, s45, v13
v_dot2_f32_bf16 v42, v85, s44, v13
v_dot2_f32_bf16 v43, v85, s45, v13
v_dot2_f32_bf16 v44, v86, s44, v13
v_dot2_f32_bf16 v45, v86, s45, v13
v_dot2_f32_bf16 v46, v87, s44, v13
v_dot2_f32_bf16 v47, v87, s45, v13
buffer_load_dwordx4 v22, s[12:15], s41 offen offset:2048 lds
v_cvt_pk_bf16_f32 v80, v32, v33
v_cvt_pk_bf16_f32 v81, v34, v35
v_cvt_pk_bf16_f32 v82, v36, v37
v_cvt_pk_bf16_f32 v83, v38, v39
v_cvt_pk_bf16_f32 v84, v40, v41
v_cvt_pk_bf16_f32 v85, v42, v43
v_cvt_pk_bf16_f32 v86, v44, v45
v_cvt_pk_bf16_f32 v87, v46, v47
v_dot2_f32_bf16 v32, v88, s44, v13
v_dot2_f32_bf16 v33, v88, s45, v13
v_dot2_f32_bf16 v34, v89, s44, v13
v_dot2_f32_bf16 v35, v89, s45, v13
v_dot2_f32_bf16 v36, v90, s44, v13
v_dot2_f32_bf16 v37, v90, s45, v13
v_dot2_f32_bf16 v38, v91, s44, v13
v_dot2_f32_bf16 v39, v91, s45, v13
v_dot2_f32_bf16 v40, v92, s44, v13
v_dot2_f32_bf16 v41, v92, s45, v13
v_dot2_f32_bf16 v42, v93, s44, v13
v_dot2_f32_bf16 v43, v93, s45, v13
v_dot2_f32_bf16 v44, v94, s44, v13
v_dot2_f32_bf16 v45, v94, s45, v13
v_dot2_f32_bf16 v46, v95, s44, v13
v_dot2_f32_bf16 v47, v95, s45, v13
s_add_u32 m0, s35, 15360
s_add_u32 s41, s62, 221184
buffer_load_dwordx4 v20, s[12:15], s41 offen offset:0 lds
v_cvt_pk_bf16_f32 v88, v32, v33
v_cvt_pk_bf16_f32 v89, v34, v35
v_cvt_pk_bf16_f32 v90, v36, v37
v_cvt_pk_bf16_f32 v91, v38, v39
v_cvt_pk_bf16_f32 v92, v40, v41
v_cvt_pk_bf16_f32 v93, v42, v43
v_cvt_pk_bf16_f32 v94, v44, v45
v_cvt_pk_bf16_f32 v95, v46, v47
v_dot2_f32_bf16 v32, v96, s44, v13
v_dot2_f32_bf16 v33, v96, s45, v13
v_dot2_f32_bf16 v34, v97, s44, v13
v_dot2_f32_bf16 v35, v97, s45, v13
v_dot2_f32_bf16 v36, v98, s44, v13
v_dot2_f32_bf16 v37, v98, s45, v13
v_dot2_f32_bf16 v38, v99, s44, v13
v_dot2_f32_bf16 v39, v99, s45, v13
v_dot2_f32_bf16 v40, v100, s44, v13
v_dot2_f32_bf16 v41, v100, s45, v13
v_dot2_f32_bf16 v42, v101, s44, v13
v_dot2_f32_bf16 v43, v101, s45, v13
v_dot2_f32_bf16 v44, v102, s44, v13
v_dot2_f32_bf16 v45, v102, s45, v13
v_dot2_f32_bf16 v46, v103, s44, v13
v_dot2_f32_bf16 v47, v103, s45, v13
buffer_load_dwordx4 v21, s[12:15], s41 offen offset:1024 lds
v_cvt_pk_bf16_f32 v96, v32, v33
v_cvt_pk_bf16_f32 v97, v34, v35
v_cvt_pk_bf16_f32 v98, v36, v37
v_cvt_pk_bf16_f32 v99, v38, v39
v_cvt_pk_bf16_f32 v100, v40, v41
v_cvt_pk_bf16_f32 v101, v42, v43
v_cvt_pk_bf16_f32 v102, v44, v45
v_cvt_pk_bf16_f32 v103, v46, v47
v_dot2_f32_bf16 v32, v104, s44, v13
v_dot2_f32_bf16 v33, v104, s45, v13
v_dot2_f32_bf16 v34, v105, s44, v13
v_dot2_f32_bf16 v35, v105, s45, v13
v_dot2_f32_bf16 v36, v106, s44, v13
v_dot2_f32_bf16 v37, v106, s45, v13
v_dot2_f32_bf16 v38, v107, s44, v13
v_dot2_f32_bf16 v39, v107, s45, v13
v_dot2_f32_bf16 v40, v108, s44, v13
v_dot2_f32_bf16 v41, v108, s45, v13
v_dot2_f32_bf16 v42, v109, s44, v13
v_dot2_f32_bf16 v43, v109, s45, v13
v_dot2_f32_bf16 v44, v110, s44, v13
v_dot2_f32_bf16 v45, v110, s45, v13
v_dot2_f32_bf16 v46, v111, s44, v13
v_dot2_f32_bf16 v47, v111, s45, v13
buffer_load_dword a250, v244, s[64:67], s72 offen offset:1152
v_cvt_pk_bf16_f32 v104, v32, v33
v_cvt_pk_bf16_f32 v105, v34, v35
v_cvt_pk_bf16_f32 v106, v36, v37
v_cvt_pk_bf16_f32 v107, v38, v39
v_cvt_pk_bf16_f32 v108, v40, v41
v_cvt_pk_bf16_f32 v109, v42, v43
v_cvt_pk_bf16_f32 v110, v44, v45
v_cvt_pk_bf16_f32 v111, v46, v47
v_dot2_f32_bf16 v32, v112, s44, v13
v_dot2_f32_bf16 v33, v112, s45, v13
v_dot2_f32_bf16 v34, v113, s44, v13
v_dot2_f32_bf16 v35, v113, s45, v13
v_dot2_f32_bf16 v36, v114, s44, v13
v_dot2_f32_bf16 v37, v114, s45, v13
v_dot2_f32_bf16 v38, v115, s44, v13
v_dot2_f32_bf16 v39, v115, s45, v13
v_dot2_f32_bf16 v40, v116, s44, v13
v_dot2_f32_bf16 v41, v116, s45, v13
v_dot2_f32_bf16 v42, v117, s44, v13
v_dot2_f32_bf16 v43, v117, s45, v13
v_dot2_f32_bf16 v44, v118, s44, v13
v_dot2_f32_bf16 v45, v118, s45, v13
v_dot2_f32_bf16 v46, v119, s44, v13
v_dot2_f32_bf16 v47, v119, s45, v13
buffer_load_dwordx4 v22, s[12:15], s41 offen offset:2048 lds
v_cvt_pk_bf16_f32 v112, v32, v33
v_cvt_pk_bf16_f32 v113, v34, v35
v_cvt_pk_bf16_f32 v114, v36, v37
v_cvt_pk_bf16_f32 v115, v38, v39
v_cvt_pk_bf16_f32 v116, v40, v41
v_cvt_pk_bf16_f32 v117, v42, v43
v_cvt_pk_bf16_f32 v118, v44, v45
v_cvt_pk_bf16_f32 v119, v46, v47
v_dot2_f32_bf16 v32, v120, s44, v13
v_dot2_f32_bf16 v33, v120, s45, v13
v_dot2_f32_bf16 v34, v121, s44, v13
v_dot2_f32_bf16 v35, v121, s45, v13
v_dot2_f32_bf16 v36, v122, s44, v13
v_dot2_f32_bf16 v37, v122, s45, v13
v_dot2_f32_bf16 v38, v123, s44, v13
v_dot2_f32_bf16 v39, v123, s45, v13
v_dot2_f32_bf16 v40, v124, s44, v13
v_dot2_f32_bf16 v41, v124, s45, v13
v_dot2_f32_bf16 v42, v125, s44, v13
v_dot2_f32_bf16 v43, v125, s45, v13
v_dot2_f32_bf16 v44, v126, s44, v13
v_dot2_f32_bf16 v45, v126, s45, v13
v_dot2_f32_bf16 v46, v127, s44, v13
v_dot2_f32_bf16 v47, v127, s45, v13
s_add_u32 m0, s35, 18432
s_add_u32 s41, s60, 128
buffer_load_dwordx4 v20, s[12:15], s41 offen offset:0 lds
v_cvt_pk_bf16_f32 v120, v32, v33
v_cvt_pk_bf16_f32 v121, v34, v35
v_cvt_pk_bf16_f32 v122, v36, v37
v_cvt_pk_bf16_f32 v123, v38, v39
v_cvt_pk_bf16_f32 v124, v40, v41
v_cvt_pk_bf16_f32 v125, v42, v43
v_cvt_pk_bf16_f32 v126, v44, v45
v_cvt_pk_bf16_f32 v127, v46, v47
v_dot2_f32_bf16 v32, v128, s44, v13
v_dot2_f32_bf16 v33, v128, s45, v13
v_dot2_f32_bf16 v34, v129, s44, v13
v_dot2_f32_bf16 v35, v129, s45, v13
v_dot2_f32_bf16 v36, v130, s44, v13
v_dot2_f32_bf16 v37, v130, s45, v13
v_dot2_f32_bf16 v38, v131, s44, v13
v_dot2_f32_bf16 v39, v131, s45, v13
v_dot2_f32_bf16 v40, v132, s44, v13
v_dot2_f32_bf16 v41, v132, s45, v13
v_dot2_f32_bf16 v42, v133, s44, v13
v_dot2_f32_bf16 v43, v133, s45, v13
v_dot2_f32_bf16 v44, v134, s44, v13
v_dot2_f32_bf16 v45, v134, s45, v13
v_dot2_f32_bf16 v46, v135, s44, v13
v_dot2_f32_bf16 v47, v135, s45, v13
buffer_load_dwordx4 v21, s[12:15], s41 offen offset:1024 lds
v_cvt_pk_bf16_f32 v128, v32, v33
v_cvt_pk_bf16_f32 v129, v34, v35
v_cvt_pk_bf16_f32 v130, v36, v37
v_cvt_pk_bf16_f32 v131, v38, v39
v_cvt_pk_bf16_f32 v132, v40, v41
v_cvt_pk_bf16_f32 v133, v42, v43
v_cvt_pk_bf16_f32 v134, v44, v45
v_cvt_pk_bf16_f32 v135, v46, v47
v_dot2_f32_bf16 v32, v136, s44, v13
v_dot2_f32_bf16 v33, v136, s45, v13
v_dot2_f32_bf16 v34, v137, s44, v13
v_dot2_f32_bf16 v35, v137, s45, v13
v_dot2_f32_bf16 v36, v138, s44, v13
v_dot2_f32_bf16 v37, v138, s45, v13
v_dot2_f32_bf16 v38, v139, s44, v13
v_dot2_f32_bf16 v39, v139, s45, v13
v_dot2_f32_bf16 v40, v140, s44, v13
v_dot2_f32_bf16 v41, v140, s45, v13
v_dot2_f32_bf16 v42, v141, s44, v13
v_dot2_f32_bf16 v43, v141, s45, v13
v_dot2_f32_bf16 v44, v142, s44, v13
v_dot2_f32_bf16 v45, v142, s45, v13
v_dot2_f32_bf16 v46, v143, s44, v13
v_dot2_f32_bf16 v47, v143, s45, v13
buffer_load_dwordx4 v22, s[12:15], s41 offen offset:2048 lds
v_cvt_pk_bf16_f32 v136, v32, v33
v_cvt_pk_bf16_f32 v137, v34, v35
v_cvt_pk_bf16_f32 v138, v36, v37
v_cvt_pk_bf16_f32 v139, v38, v39
v_cvt_pk_bf16_f32 v140, v40, v41
v_cvt_pk_bf16_f32 v141, v42, v43
v_cvt_pk_bf16_f32 v142, v44, v45
v_cvt_pk_bf16_f32 v143, v46, v47
v_dot2_f32_bf16 v32, v144, s44, v13
v_dot2_f32_bf16 v33, v144, s45, v13
v_dot2_f32_bf16 v34, v145, s44, v13
v_dot2_f32_bf16 v35, v145, s45, v13
v_dot2_f32_bf16 v36, v146, s44, v13
v_dot2_f32_bf16 v37, v146, s45, v13
v_dot2_f32_bf16 v38, v147, s44, v13
v_dot2_f32_bf16 v39, v147, s45, v13
v_dot2_f32_bf16 v40, v148, s44, v13
v_dot2_f32_bf16 v41, v148, s45, v13
v_dot2_f32_bf16 v42, v149, s44, v13
v_dot2_f32_bf16 v43, v149, s45, v13
v_dot2_f32_bf16 v44, v150, s44, v13
v_dot2_f32_bf16 v45, v150, s45, v13
v_dot2_f32_bf16 v46, v151, s44, v13
v_dot2_f32_bf16 v47, v151, s45, v13
s_add_u32 m0, s35, 21504
s_add_u32 s41, s60, 221312
buffer_load_dwordx4 v20, s[12:15], s41 offen offset:0 lds
v_cvt_pk_bf16_f32 v144, v32, v33
v_cvt_pk_bf16_f32 v145, v34, v35
v_cvt_pk_bf16_f32 v146, v36, v37
v_cvt_pk_bf16_f32 v147, v38, v39
v_cvt_pk_bf16_f32 v148, v40, v41
v_cvt_pk_bf16_f32 v149, v42, v43
v_cvt_pk_bf16_f32 v150, v44, v45
v_cvt_pk_bf16_f32 v151, v46, v47
v_dot2_f32_bf16 v32, v152, s44, v13
v_dot2_f32_bf16 v33, v152, s45, v13
v_dot2_f32_bf16 v34, v153, s44, v13
v_dot2_f32_bf16 v35, v153, s45, v13
v_dot2_f32_bf16 v36, v154, s44, v13
v_dot2_f32_bf16 v37, v154, s45, v13
v_dot2_f32_bf16 v38, v155, s44, v13
v_dot2_f32_bf16 v39, v155, s45, v13
v_dot2_f32_bf16 v40, v156, s44, v13
v_dot2_f32_bf16 v41, v156, s45, v13
v_dot2_f32_bf16 v42, v157, s44, v13
v_dot2_f32_bf16 v43, v157, s45, v13
v_dot2_f32_bf16 v44, v158, s44, v13
v_dot2_f32_bf16 v45, v158, s45, v13
v_dot2_f32_bf16 v46, v159, s44, v13
v_dot2_f32_bf16 v47, v159, s45, v13
buffer_load_dwordx4 v21, s[12:15], s41 offen offset:1024 lds
v_cvt_pk_bf16_f32 v152, v32, v33
v_cvt_pk_bf16_f32 v153, v34, v35
v_cvt_pk_bf16_f32 v154, v36, v37
v_cvt_pk_bf16_f32 v155, v38, v39
v_cvt_pk_bf16_f32 v156, v40, v41
v_cvt_pk_bf16_f32 v157, v42, v43
v_cvt_pk_bf16_f32 v158, v44, v45
v_cvt_pk_bf16_f32 v159, v46, v47
v_dot2_f32_bf16 v32, v160, s44, v13
v_dot2_f32_bf16 v33, v160, s45, v13
v_dot2_f32_bf16 v34, v161, s44, v13
v_dot2_f32_bf16 v35, v161, s45, v13
v_dot2_f32_bf16 v36, v162, s44, v13
v_dot2_f32_bf16 v37, v162, s45, v13
v_dot2_f32_bf16 v38, v163, s44, v13
v_dot2_f32_bf16 v39, v163, s45, v13
v_dot2_f32_bf16 v40, v164, s44, v13
v_dot2_f32_bf16 v41, v164, s45, v13
v_dot2_f32_bf16 v42, v165, s44, v13
v_dot2_f32_bf16 v43, v165, s45, v13
v_dot2_f32_bf16 v44, v166, s44, v13
v_dot2_f32_bf16 v45, v166, s45, v13
v_dot2_f32_bf16 v46, v167, s44, v13
v_dot2_f32_bf16 v47, v167, s45, v13
buffer_load_dwordx4 v22, s[12:15], s41 offen offset:2048 lds
v_cvt_pk_bf16_f32 v160, v32, v33
v_cvt_pk_bf16_f32 v161, v34, v35
v_cvt_pk_bf16_f32 v162, v36, v37
v_cvt_pk_bf16_f32 v163, v38, v39
v_cvt_pk_bf16_f32 v164, v40, v41
v_cvt_pk_bf16_f32 v165, v42, v43
v_cvt_pk_bf16_f32 v166, v44, v45
v_cvt_pk_bf16_f32 v167, v46, v47
v_dot2_f32_bf16 v32, v168, s44, v13
v_dot2_f32_bf16 v33, v168, s45, v13
v_dot2_f32_bf16 v34, v169, s44, v13
v_dot2_f32_bf16 v35, v169, s45, v13
v_dot2_f32_bf16 v36, v170, s44, v13
v_dot2_f32_bf16 v37, v170, s45, v13
v_dot2_f32_bf16 v38, v171, s44, v13
v_dot2_f32_bf16 v39, v171, s45, v13
v_dot2_f32_bf16 v40, v172, s44, v13
v_dot2_f32_bf16 v41, v172, s45, v13
v_dot2_f32_bf16 v42, v173, s44, v13
v_dot2_f32_bf16 v43, v173, s45, v13
v_dot2_f32_bf16 v44, v174, s44, v13
v_dot2_f32_bf16 v45, v174, s45, v13
v_dot2_f32_bf16 v46, v175, s44, v13
v_dot2_f32_bf16 v47, v175, s45, v13
buffer_load_dwordx4 a[192:195], v248, s[8:11], s53 offen offset:0
v_cvt_pk_bf16_f32 v168, v32, v33
v_cvt_pk_bf16_f32 v169, v34, v35
v_cvt_pk_bf16_f32 v170, v36, v37
v_cvt_pk_bf16_f32 v171, v38, v39
v_cvt_pk_bf16_f32 v172, v40, v41
v_cvt_pk_bf16_f32 v173, v42, v43
v_cvt_pk_bf16_f32 v174, v44, v45
v_cvt_pk_bf16_f32 v175, v46, v47
v_dot2_f32_bf16 v32, v176, s44, v13
v_dot2_f32_bf16 v33, v176, s45, v13
v_dot2_f32_bf16 v34, v177, s44, v13
v_dot2_f32_bf16 v35, v177, s45, v13
v_dot2_f32_bf16 v36, v178, s44, v13
v_dot2_f32_bf16 v37, v178, s45, v13
v_dot2_f32_bf16 v38, v179, s44, v13
v_dot2_f32_bf16 v39, v179, s45, v13
v_dot2_f32_bf16 v40, v180, s44, v13
v_dot2_f32_bf16 v41, v180, s45, v13
v_dot2_f32_bf16 v42, v181, s44, v13
v_dot2_f32_bf16 v43, v181, s45, v13
v_dot2_f32_bf16 v44, v182, s44, v13
v_dot2_f32_bf16 v45, v182, s45, v13
v_dot2_f32_bf16 v46, v183, s44, v13
v_dot2_f32_bf16 v47, v183, s45, v13
s_add_u32 m0, s35, 24576
s_add_u32 s41, s61, 128
buffer_load_dwordx4 v20, s[12:15], s41 offen offset:0 lds
v_cvt_pk_bf16_f32 v176, v32, v33
v_cvt_pk_bf16_f32 v177, v34, v35
v_cvt_pk_bf16_f32 v178, v36, v37
v_cvt_pk_bf16_f32 v179, v38, v39
v_cvt_pk_bf16_f32 v180, v40, v41
v_cvt_pk_bf16_f32 v181, v42, v43
v_cvt_pk_bf16_f32 v182, v44, v45
v_cvt_pk_bf16_f32 v183, v46, v47
v_dot2_f32_bf16 v32, v184, s44, v13
v_dot2_f32_bf16 v33, v184, s45, v13
v_dot2_f32_bf16 v34, v185, s44, v13
v_dot2_f32_bf16 v35, v185, s45, v13
v_dot2_f32_bf16 v36, v186, s44, v13
v_dot2_f32_bf16 v37, v186, s45, v13
v_dot2_f32_bf16 v38, v187, s44, v13
v_dot2_f32_bf16 v39, v187, s45, v13
v_dot2_f32_bf16 v40, v188, s44, v13
v_dot2_f32_bf16 v41, v188, s45, v13
v_dot2_f32_bf16 v42, v189, s44, v13
v_dot2_f32_bf16 v43, v189, s45, v13
v_dot2_f32_bf16 v44, v190, s44, v13
v_dot2_f32_bf16 v45, v190, s45, v13
v_dot2_f32_bf16 v46, v191, s44, v13
v_dot2_f32_bf16 v47, v191, s45, v13
buffer_load_dwordx4 a[196:199], v248, s[8:11], s53 offen offset:384
v_cvt_pk_bf16_f32 v184, v32, v33
v_cvt_pk_bf16_f32 v185, v34, v35
v_cvt_pk_bf16_f32 v186, v36, v37
v_cvt_pk_bf16_f32 v187, v38, v39
v_cvt_pk_bf16_f32 v188, v40, v41
v_cvt_pk_bf16_f32 v189, v42, v43
v_cvt_pk_bf16_f32 v190, v44, v45
v_cvt_pk_bf16_f32 v191, v46, v47
v_dot2_f32_bf16 v32, v192, s44, v13
v_dot2_f32_bf16 v33, v192, s45, v13
v_dot2_f32_bf16 v34, v193, s44, v13
v_dot2_f32_bf16 v35, v193, s45, v13
v_dot2_f32_bf16 v36, v194, s44, v13
v_dot2_f32_bf16 v37, v194, s45, v13
v_dot2_f32_bf16 v38, v195, s44, v13
v_dot2_f32_bf16 v39, v195, s45, v13
v_dot2_f32_bf16 v40, v196, s44, v13
v_dot2_f32_bf16 v41, v196, s45, v13
v_dot2_f32_bf16 v42, v197, s44, v13
v_dot2_f32_bf16 v43, v197, s45, v13
v_dot2_f32_bf16 v44, v198, s44, v13
v_dot2_f32_bf16 v45, v198, s45, v13
v_dot2_f32_bf16 v46, v199, s44, v13
v_dot2_f32_bf16 v47, v199, s45, v13
buffer_load_dwordx4 v21, s[12:15], s41 offen offset:1024 lds
v_cvt_pk_bf16_f32 v192, v32, v33
v_cvt_pk_bf16_f32 v193, v34, v35
v_cvt_pk_bf16_f32 v194, v36, v37
v_cvt_pk_bf16_f32 v195, v38, v39
v_cvt_pk_bf16_f32 v196, v40, v41
v_cvt_pk_bf16_f32 v197, v42, v43
v_cvt_pk_bf16_f32 v198, v44, v45
v_cvt_pk_bf16_f32 v199, v46, v47
v_dot2_f32_bf16 v32, v200, s44, v13
v_dot2_f32_bf16 v33, v200, s45, v13
v_dot2_f32_bf16 v34, v201, s44, v13
v_dot2_f32_bf16 v35, v201, s45, v13
v_dot2_f32_bf16 v36, v202, s44, v13
v_dot2_f32_bf16 v37, v202, s45, v13
v_dot2_f32_bf16 v38, v203, s44, v13
v_dot2_f32_bf16 v39, v203, s45, v13
v_dot2_f32_bf16 v40, v204, s44, v13
v_dot2_f32_bf16 v41, v204, s45, v13
v_dot2_f32_bf16 v42, v205, s44, v13
v_dot2_f32_bf16 v43, v205, s45, v13
v_dot2_f32_bf16 v44, v206, s44, v13
v_dot2_f32_bf16 v45, v206, s45, v13
v_dot2_f32_bf16 v46, v207, s44, v13
v_dot2_f32_bf16 v47, v207, s45, v13
buffer_load_dwordx4 a[200:203], v248, s[8:11], s53 offen offset:768
v_cvt_pk_bf16_f32 v200, v32, v33
v_cvt_pk_bf16_f32 v201, v34, v35
v_cvt_pk_bf16_f32 v202, v36, v37
v_cvt_pk_bf16_f32 v203, v38, v39
v_cvt_pk_bf16_f32 v204, v40, v41
v_cvt_pk_bf16_f32 v205, v42, v43
v_cvt_pk_bf16_f32 v206, v44, v45
v_cvt_pk_bf16_f32 v207, v46, v47
v_mul_f32 v17, 0x41800000, v14
v_cmp_nge_f32 vcc, v17, v18
s_nop 4
s_cbranch_vccz L_ffn_var
v_mov_b32 v17, 0
v_mov_b32 v18, 0
v_dot2c_f32_bf16 v17, v64, v64
v_dot2c_f32_bf16 v18, v65, v65
v_dot2c_f32_bf16 v17, v66, v66
v_dot2c_f32_bf16 v18, v67, v67
v_dot2c_f32_bf16 v17, v68, v68
v_dot2c_f32_bf16 v18, v69, v69
v_dot2c_f32_bf16 v17, v70, v70
v_dot2c_f32_bf16 v18, v71, v71
v_dot2c_f32_bf16 v17, v72, v72
v_dot2c_f32_bf16 v18, v73, v73
v_dot2c_f32_bf16 v17, v74, v74
v_dot2c_f32_bf16 v18, v75, v75
v_dot2c_f32_bf16 v17, v76, v76
v_dot2c_f32_bf16 v18, v77, v77
v_dot2c_f32_bf16 v17, v78, v78
v_dot2c_f32_bf16 v18, v79, v79
v_dot2c_f32_bf16 v17, v80, v80
v_dot2c_f32_bf16 v18, v81, v81
v_dot2c_f32_bf16 v17, v82, v82
v_dot2c_f32_bf16 v18, v83, v83
v_dot2c_f32_bf16 v17, v84, v84
v_dot2c_f32_bf16 v18, v85, v85
v_dot2c_f32_bf16 v17, v86, v86
v_dot2c_f32_bf16 v18, v87, v87
v_dot2c_f32_bf16 v17, v88, v88
v_dot2c_f32_bf16 v18, v89, v89
v_dot2c_f32_bf16 v17, v90, v90
v_dot2c_f32_bf16 v18, v91, v91
v_dot2c_f32_bf16 v17, v92, v92
v_dot2c_f32_bf16 v18, v93, v93
v_dot2c_f32_bf16 v17, v94, v94
v_dot2c_f32_bf16 v18, v95, v95
v_dot2c_f32_bf16 v17, v96, v96
v_dot2c_f32_bf16 v18, v97, v97
v_dot2c_f32_bf16 v17, v98, v98
v_dot2c_f32_bf16 v18, v99, v99
v_dot2c_f32_bf16 v17, v100, v100
v_dot2c_f32_bf16 v18, v101, v101
v_dot2c_f32_bf16 v17, v102, v102
v_dot2c_f32_bf16 v18, v103, v103
v_dot2c_f32_bf16 v17, v104, v104
v_dot2c_f32_bf16 v18, v105, v105
v_dot2c_f32_bf16 v17, v106, v106
v_dot2c_f32_bf16 v18, v107, v107
v_dot2c_f32_bf16 v17, v108, v108
v_dot2c_f32_bf16 v18, v109, v109
v_dot2c_f32_bf16 v17, v110, v110
v_dot2c_f32_bf16 v18, v111, v111
v_dot2c_f32_bf16 v17, v112, v112
v_dot2c_f32_bf16 v18, v113, v113
v_dot2c_f32_bf16 v17, v114, v114
v_dot2c_f32_bf16 v18, v115, v115
v_dot2c_f32_bf16 v17, v116, v116
v_dot2c_f32_bf16 v18, v117, v117
v_dot2c_f32_bf16 v17, v118, v118
v_dot2c_f32_bf16 v18, v119, v119
v_dot2c_f32_bf16 v17, v120, v120
v_dot2c_f32_bf16 v18, v121, v121
v_dot2c_f32_bf16 v17, v122, v122
v_dot2c_f32_bf16 v18, v123, v123
v_dot2c_f32_bf16 v17, v124, v124
v_dot2c_f32_bf16 v18, v125, v125
v_dot2c_f32_bf16 v17, v126, v126
v_dot2c_f32_bf16 v18, v127, v127
v_dot2c_f32_bf16 v17, v128, v128
v_dot2c_f32_bf16 v18, v129, v129
v_dot2c_f32_bf16 v17, v130, v130
v_dot2c_f32_bf16 v18, v131, v131
v_dot2c_f32_bf16 v17, v132, v132
v_dot2c_f32_bf16 v18, v133, v133
v_dot2c_f32_bf16 v17, v134, v134
v_dot2c_f32_bf16 v18, v135, v135
v_dot2c_f32_bf16 v17, v136, v136
v_dot2c_f32_bf16 v18, v137, v137
v_dot2c_f32_bf16 v17, v138, v138
v_dot2c_f32_bf16 v18, v139, v139
v_dot2c_f32_bf16 v17, v140, v140
v_dot2c_f32_bf16 v18, v141, v141
v_dot2c_f32_bf16 v17, v142, v142
v_dot2c_f32_bf16 v18, v143, v143
v_dot2c_f32_bf16 v17, v144, v144
v_dot2c_f32_bf16 v18, v145, v145
v_dot2c_f32_bf16 v17, v146, v146
v_dot2c_f32_bf16 v18, v147, v147
v_dot2c_f32_bf16 v17, v148, v148
v_dot2c_f32_bf16 v18, v149, v149
v_dot2c_f32_bf16 v17, v150, v150
L_pad_f1_0:
s_cbranch_execz L_pad_f1_1
v_dot2c_f32_bf16 v18, v151, v151
v_dot2c_f32_bf16 v17, v152, v152
v_dot2c_f32_bf16 v18, v153, v153
v_dot2c_f32_bf16 v17, v154, v154
v_dot2c_f32_bf16 v18, v155, v155
v_dot2c_f32_bf16 v17, v156, v156
v_dot2c_f32_bf16 v18, v157, v157
v_dot2c_f32_bf16 v17, v158, v158
v_dot2c_f32_bf16 v18, v159, v159
v_dot2c_f32_bf16 v17, v160, v160
v_dot2c_f32_bf16 v18, v161, v161
v_dot2c_f32_bf16 v17, v162, v162
v_dot2c_f32_bf16 v18, v163, v163
v_dot2c_f32_bf16 v17, v164, v164
v_dot2c_f32_bf16 v18, v165, v165
v_dot2c_f32_bf16 v17, v166, v166
v_dot2c_f32_bf16 v18, v167, v167
v_dot2c_f32_bf16 v17, v168, v168
v_dot2c_f32_bf16 v18, v169, v169
v_dot2c_f32_bf16 v17, v170, v170
v_dot2c_f32_bf16 v18, v171, v171
v_dot2c_f32_bf16 v17, v172, v172
v_dot2c_f32_bf16 v18, v173, v173
v_dot2c_f32_bf16 v17, v174, v174
v_dot2c_f32_bf16 v18, v175, v175
v_dot2c_f32_bf16 v17, v176, v176
v_dot2c_f32_bf16 v18, v177, v177
v_dot2c_f32_bf16 v17, v178, v178
v_dot2c_f32_bf16 v18, v179, v179
v_dot2c_f32_bf16 v17, v180, v180
v_dot2c_f32_bf16 v18, v181, v181
v_dot2c_f32_bf16 v17, v182, v182
v_dot2c_f32_bf16 v18, v183, v183
v_dot2c_f32_bf16 v17, v184, v184
v_dot2c_f32_bf16 v18, v185, v185
v_dot2c_f32_bf16 v17, v186, v186
v_dot2c_f32_bf16 v18, v187, v187
v_dot2c_f32_bf16 v17, v188, v188
v_dot2c_f32_bf16 v18, v189, v189
v_dot2c_f32_bf16 v17, v190, v190
v_dot2c_f32_bf16 v18, v191, v191
v_dot2c_f32_bf16 v17, v192, v192
v_dot2c_f32_bf16 v18, v193, v193
v_dot2c_f32_bf16 v17, v194, v194
v_dot2c_f32_bf16 v18, v195, v195
v_dot2c_f32_bf16 v17, v196, v196
v_dot2c_f32_bf16 v18, v197, v197
v_dot2c_f32_bf16 v17, v198, v198
v_dot2c_f32_bf16 v18, v199, v199
v_dot2c_f32_bf16 v17, v200, v200
v_dot2c_f32_bf16 v18, v201, v201
v_dot2c_f32_bf16 v17, v202, v202
v_dot2c_f32_bf16 v18, v203, v203
v_dot2c_f32_bf16 v17, v204, v204
v_dot2c_f32_bf16 v18, v205, v205
v_dot2c_f32_bf16 v17, v206, v206
v_dot2c_f32_bf16 v18, v207, v207
s_nop 2
v_add_f32 v17, v17, v18
v_mov_b32 v18, v17
s_nop 1
v_permlane32_swap_b32 v17, v18
v_add_f32 v17, v17, v18
v_mul_f32 v17, 0x3ae38e39, v17
v_mul_f32 v16, v16, v16
v_sub_f32 v14, v17, v16
s_nop 3
L_ffn_var:
v_max_f32 v14, 0, v14
v_cvt_pk_bf16_f32 v14, v14, v14
v_and_b32 v14, s47, v14
v_add_f32 v14, 0x3727c5ac, v14
v_cvt_pk_bf16_f32 v14, v14, v14
v_and_b32 v14, s47, v14
v_sqrt_f32 v14, v14
s_nop 0
v_cvt_pk_bf16_f32 v14, v14, v14
v_and_b32 v14, s47, v14
v_lshrrev_b32 v13, 16, v14
v_rcp_f32 v14, v14
v_mov_b32 v3, 0x7f000000
v_cmp_eq_u32 vcc, 0, v0
s_nop 1
v_cndmask_b32 v7, v3, v0, vcc
v_min_u32 v10, 15, v1
v_lshlrev_b32 v10, 2, v10
v_mul_f32 v14, s48, v14
v_mov_b32 v15, 0xbfb17218
v_mov_b32 v16, 2.0
s_mov_b32 s24, s80
s_and_b32 s25, s81, 0xffff
s_mov_b32 s26, 2359296
s_mov_b32 s27, 0x20000
v_mov_b32 v11, v248
v_mov_b32 v12, v249
s_waitcnt lgkmcnt(0)
s_waitcnt vmcnt(25)
s_barrier
ds_read_b64_tr_b16 a[144:145], v26 offset:0
ds_read_b64_tr_b16 a[146:147], v26 offset:512
ds_read_b64_tr_b16 a[148:149], v26 offset:256
ds_read_b64_tr_b16 a[150:151], v26 offset:768
ds_read_b64_tr_b16 a[152:153], v26 offset:2048
ds_read_b64_tr_b16 a[154:155], v26 offset:2560
ds_read_b64_tr_b16 a[156:157], v26 offset:2304
ds_read_b64_tr_b16 a[158:159], v26 offset:2816
ds_read_b64_tr_b16 a[160:161], v26 offset:4096
ds_read_b64_tr_b16 a[162:163], v26 offset:4608
ds_read_b64_tr_b16 a[164:165], v26 offset:4352
ds_read_b64_tr_b16 a[166:167], v26 offset:4864
s_waitcnt lgkmcnt(10)
v_mfma_f32_32x32x16_bf16 v[208:223], a[144:147], v[64:67], 0
ds_read_b64_tr_b16 a[168:169], v27 offset:0
ds_read_b64_tr_b16 a[170:171], v27 offset:512
v_accvgpr_write_b32 a0, v64
v_accvgpr_write_b32 a1, v65
v_accvgpr_write_b32 a2, v66
s_waitcnt lgkmcnt(10)
v_mfma_f32_32x32x16_bf16 v[224:239], a[148:151], v[64:67], 0
s_waitcnt lgkmcnt(6)
ds_read_b64_tr_b16 a[172:173], v27 offset:256
ds_read_b64_tr_b16 a[174:175], v27 offset:768
v_accvgpr_write_b32 a3, v67
v_accvgpr_write_b32 a4, v68
v_accvgpr_write_b32 a5, v69
v_mfma_f32_32x32x16_bf16 v[208:223], a[152:155], v[68:71], v[208:223]
buffer_load_dwordx4 v22, s[12:15], s41 offen offset:2048 lds
ds_read_b64_tr_b16 a[176:177], v27 offset:2048
ds_read_b64_tr_b16 a[178:179], v27 offset:2560
v_mfma_f32_32x32x16_bf16 v[224:239], a[156:159], v[68:71], v[224:239]
s_waitcnt lgkmcnt(6)
s_add_u32 m0, s35, 27648
ds_read_b64_tr_b16 a[180:181], v27 offset:2304
ds_read_b64_tr_b16 a[182:183], v27 offset:2816
v_accvgpr_write_b32 a6, v70
v_accvgpr_write_b32 a7, v71
v_accvgpr_write_b32 a8, v72
v_mfma_f32_32x32x16_bf16 v[208:223], a[160:163], v[72:75], v[208:223]
s_add_u32 s41, s61, 221312
ds_read_b64_tr_b16 a[184:185], v27 offset:4096
ds_read_b64_tr_b16 a[186:187], v27 offset:4608
v_accvgpr_write_b32 a9, v73
v_accvgpr_write_b32 a10, v74
v_accvgpr_write_b32 a11, v75
v_mfma_f32_32x32x16_bf16 v[224:239], a[164:167], v[72:75], v[224:239]
s_waitcnt lgkmcnt(6)
buffer_load_dwordx4 v20, s[12:15], s41 offen offset:0 lds
ds_read_b64_tr_b16 a[188:189], v27 offset:4352
ds_read_b64_tr_b16 a[190:191], v27 offset:4864
v_mfma_f32_32x32x16_bf16 v[208:223], a[168:171], v[76:79], v[208:223]
ds_read_b64_tr_b16 a[144:145], v28 offset:0
ds_read_b64_tr_b16 a[146:147], v28 offset:512
v_accvgpr_write_b32 a12, v76
v_accvgpr_write_b32 a13, v77
v_accvgpr_write_b32 a14, v78
v_mfma_f32_32x32x16_bf16 v[224:239], a[172:175], v[76:79], v[224:239]
s_waitcnt lgkmcnt(6)
ds_read_b64_tr_b16 a[148:149], v28 offset:256
ds_read_b64_tr_b16 a[150:151], v28 offset:768
v_accvgpr_write_b32 a15, v79
v_accvgpr_write_b32 a16, v80
v_accvgpr_write_b32 a17, v81
v_mfma_f32_32x32x16_bf16 v[208:223], a[176:179], v[80:83], v[208:223]
buffer_load_dwordx4 v21, s[12:15], s41 offen offset:1024 lds
ds_read_b64_tr_b16 a[152:153], v28 offset:2048
ds_read_b64_tr_b16 a[154:155], v28 offset:2560
v_mfma_f32_32x32x16_bf16 v[224:239], a[180:183], v[80:83], v[224:239]
s_waitcnt lgkmcnt(6)
ds_read_b64_tr_b16 a[156:157], v28 offset:2304
ds_read_b64_tr_b16 a[158:159], v28 offset:2816
v_accvgpr_write_b32 a18, v82
v_accvgpr_write_b32 a19, v83
v_accvgpr_write_b32 a20, v84
v_mfma_f32_32x32x16_bf16 v[208:223], a[184:187], v[84:87], v[208:223]
ds_read_b64_tr_b16 a[160:161], v28 offset:4096
ds_read_b64_tr_b16 a[162:163], v28 offset:4608
v_accvgpr_write_b32 a21, v85
v_accvgpr_write_b32 a22, v86
v_accvgpr_write_b32 a23, v87
v_mfma_f32_32x32x16_bf16 v[224:239], a[188:191], v[84:87], v[224:239]
s_waitcnt lgkmcnt(6)
buffer_load_dwordx4 v22, s[12:15], s41 offen offset:2048 lds
ds_read_b64_tr_b16 a[164:165], v28 offset:4352
ds_read_b64_tr_b16 a[166:167], v28 offset:4864
s_waitcnt vmcnt(23)
s_barrier
v_mfma_f32_32x32x16_bf16 v[208:223], a[144:147], v[88:91], v[208:223]
s_add_u32 m0, s35, 30720
ds_read_b64_tr_b16 a[168:169], v29 offset:0
ds_read_b64_tr_b16 a[170:171], v29 offset:512
v_accvgpr_write_b32 a24, v88
v_accvgpr_write_b32 a25, v89
v_accvgpr_write_b32 a26, v90
v_mfma_f32_32x32x16_bf16 v[224:239], a[148:151], v[88:91], v[224:239]
s_waitcnt lgkmcnt(6)
s_add_u32 s41, s62, 128
ds_read_b64_tr_b16 a[172:173], v29 offset:256
ds_read_b64_tr_b16 a[174:175], v29 offset:768
v_accvgpr_write_b32 a27, v91
v_accvgpr_write_b32 a28, v92
v_accvgpr_write_b32 a29, v93
v_mfma_f32_32x32x16_bf16 v[208:223], a[152:155], v[92:95], v[208:223]
buffer_load_dwordx4 v20, s[12:15], s41 offen offset:0 lds
ds_read_b64_tr_b16 a[176:177], v29 offset:2048
ds_read_b64_tr_b16 a[178:179], v29 offset:2560
v_mfma_f32_32x32x16_bf16 v[224:239], a[156:159], v[92:95], v[224:239]
s_waitcnt lgkmcnt(6)
ds_read_b64_tr_b16 a[180:181], v29 offset:2304
ds_read_b64_tr_b16 a[182:183], v29 offset:2816
v_accvgpr_write_b32 a30, v94
v_accvgpr_write_b32 a31, v95
v_accvgpr_write_b32 a32, v96
v_mfma_f32_32x32x16_bf16 v[208:223], a[160:163], v[96:99], v[208:223]
ds_read_b64_tr_b16 a[184:185], v29 offset:4096
ds_read_b64_tr_b16 a[186:187], v29 offset:4608
v_accvgpr_write_b32 a33, v97
v_accvgpr_write_b32 a34, v98
v_accvgpr_write_b32 a35, v99
v_mfma_f32_32x32x16_bf16 v[224:239], a[164:167], v[96:99], v[224:239]
s_waitcnt lgkmcnt(6)
buffer_load_dwordx4 v21, s[12:15], s41 offen offset:1024 lds
ds_read_b64_tr_b16 a[188:189], v29 offset:4352
ds_read_b64_tr_b16 a[190:191], v29 offset:4864
v_mfma_f32_32x32x16_bf16 v[208:223], a[168:171], v[100:103], v[208:223]
ds_read_b64_tr_b16 a[144:145], v26 offset:6144
ds_read_b64_tr_b16 a[146:147], v26 offset:6656
v_accvgpr_write_b32 a36, v100
v_accvgpr_write_b32 a37, v101
v_accvgpr_write_b32 a38, v102
v_mfma_f32_32x32x16_bf16 v[224:239], a[172:175], v[100:103], v[224:239]
s_waitcnt lgkmcnt(6)
ds_read_b64_tr_b16 a[148:149], v26 offset:6400
ds_read_b64_tr_b16 a[150:151], v26 offset:6912
v_accvgpr_write_b32 a39, v103
v_accvgpr_write_b32 a40, v104
v_accvgpr_write_b32 a41, v105
v_mfma_f32_32x32x16_bf16 v[208:223], a[176:179], v[104:107], v[208:223]
buffer_load_dwordx4 v22, s[12:15], s41 offen offset:2048 lds
ds_read_b64_tr_b16 a[152:153], v26 offset:8192
ds_read_b64_tr_b16 a[154:155], v26 offset:8704
v_mfma_f32_32x32x16_bf16 v[224:239], a[180:183], v[104:107], v[224:239]
s_waitcnt lgkmcnt(6)
s_add_u32 m0, s35, 33792
ds_read_b64_tr_b16 a[156:157], v26 offset:8448
ds_read_b64_tr_b16 a[158:159], v26 offset:8960
v_accvgpr_write_b32 a42, v106
v_accvgpr_write_b32 a43, v107
v_accvgpr_write_b32 a44, v108
v_mfma_f32_32x32x16_bf16 v[208:223], a[184:187], v[108:111], v[208:223]
s_add_u32 s41, s62, 221312
ds_read_b64_tr_b16 a[160:161], v26 offset:10240
ds_read_b64_tr_b16 a[162:163], v26 offset:10752
v_accvgpr_write_b32 a45, v109
v_accvgpr_write_b32 a46, v110
v_accvgpr_write_b32 a47, v111
v_mfma_f32_32x32x16_bf16 v[224:239], a[188:191], v[108:111], v[224:239]
s_waitcnt lgkmcnt(6)
buffer_load_dwordx4 v20, s[12:15], s41 offen offset:0 lds
ds_read_b64_tr_b16 a[164:165], v26 offset:10496
ds_read_b64_tr_b16 a[166:167], v26 offset:11008
v_mfma_f32_32x32x16_bf16 v[208:223], a[144:147], v[112:115], v[208:223]
ds_read_b64_tr_b16 a[168:169], v27 offset:6144
ds_read_b64_tr_b16 a[170:171], v27 offset:6656
v_accvgpr_write_b32 a48, v112
v_accvgpr_write_b32 a49, v113
v_accvgpr_write_b32 a50, v114
v_mfma_f32_32x32x16_bf16 v[224:239], a[148:151], v[112:115], v[224:239]
s_waitcnt lgkmcnt(6)
ds_read_b64_tr_b16 a[172:173], v27 offset:6400
ds_read_b64_tr_b16 a[174:175], v27 offset:6912
v_accvgpr_write_b32 a51, v115
v_accvgpr_write_b32 a52, v116
v_accvgpr_write_b32 a53, v117
v_mfma_f32_32x32x16_bf16 v[208:223], a[152:155], v[116:119], v[208:223]
buffer_load_dword a237, v247, s[12:15], s38 offen offset:256
ds_read_b64_tr_b16 a[176:177], v27 offset:8192
ds_read_b64_tr_b16 a[178:179], v27 offset:8704
v_mfma_f32_32x32x16_bf16 v[224:239], a[156:159], v[116:119], v[224:239]
s_waitcnt lgkmcnt(6)
ds_read_b64_tr_b16 a[180:181], v27 offset:8448
ds_read_b64_tr_b16 a[182:183], v27 offset:8960
v_accvgpr_write_b32 a54, v118
v_accvgpr_write_b32 a55, v119
v_accvgpr_write_b32 a56, v120
v_mfma_f32_32x32x16_bf16 v[208:223], a[160:163], v[120:123], v[208:223]
ds_read_b64_tr_b16 a[184:185], v27 offset:10240
ds_read_b64_tr_b16 a[186:187], v27 offset:10752
v_accvgpr_write_b32 a57, v121
v_accvgpr_write_b32 a58, v122
v_accvgpr_write_b32 a59, v123
v_mfma_f32_32x32x16_bf16 v[224:239], a[164:167], v[120:123], v[224:239]
s_waitcnt lgkmcnt(6)
buffer_load_dwordx4 v21, s[12:15], s41 offen offset:1024 lds
ds_read_b64_tr_b16 a[188:189], v27 offset:10496
ds_read_b64_tr_b16 a[190:191], v27 offset:11008
v_mfma_f32_32x32x16_bf16 v[208:223], a[168:171], v[124:127], v[208:223]
ds_read_b64_tr_b16 a[144:145], v28 offset:6144
ds_read_b64_tr_b16 a[146:147], v28 offset:6656
v_accvgpr_write_b32 a60, v124
v_accvgpr_write_b32 a61, v125
v_accvgpr_write_b32 a62, v126
v_mfma_f32_32x32x16_bf16 v[224:239], a[172:175], v[124:127], v[224:239]
s_waitcnt lgkmcnt(6)
ds_read_b64_tr_b16 a[148:149], v28 offset:6400
ds_read_b64_tr_b16 a[150:151], v28 offset:6912
v_accvgpr_write_b32 a63, v127
v_accvgpr_write_b32 a64, v128
v_accvgpr_write_b32 a65, v129
v_mfma_f32_32x32x16_bf16 v[208:223], a[176:179], v[128:131], v[208:223]
buffer_load_dword a249, v244, s[64:67], s72 offen offset:2304
ds_read_b64_tr_b16 a[152:153], v28 offset:8192
ds_read_b64_tr_b16 a[154:155], v28 offset:8704
v_mfma_f32_32x32x16_bf16 v[224:239], a[180:183], v[128:131], v[224:239]
s_waitcnt lgkmcnt(6)
ds_read_b64_tr_b16 a[156:157], v28 offset:8448
ds_read_b64_tr_b16 a[158:159], v28 offset:8960
v_accvgpr_write_b32 a66, v130
v_accvgpr_write_b32 a67, v131
v_accvgpr_write_b32 a68, v132
v_mfma_f32_32x32x16_bf16 v[208:223], a[184:187], v[132:135], v[208:223]
ds_read_b64_tr_b16 a[160:161], v28 offset:10240
ds_read_b64_tr_b16 a[162:163], v28 offset:10752
v_accvgpr_write_b32 a69, v133
v_accvgpr_write_b32 a70, v134
v_accvgpr_write_b32 a71, v135
v_mfma_f32_32x32x16_bf16 v[224:239], a[188:191], v[132:135], v[224:239]
s_waitcnt lgkmcnt(6)
buffer_load_dwordx4 v22, s[12:15], s41 offen offset:2048 lds
ds_read_b64_tr_b16 a[164:165], v28 offset:10496
ds_read_b64_tr_b16 a[166:167], v28 offset:11008
s_waitcnt vmcnt(23)
s_barrier
v_mfma_f32_32x32x16_bf16 v[208:223], a[144:147], v[136:139], v[208:223]
s_add_u32 m0, s35, 0
ds_read_b64_tr_b16 a[168:169], v29 offset:6144
ds_read_b64_tr_b16 a[170:171], v29 offset:6656
v_accvgpr_write_b32 a72, v136
v_accvgpr_write_b32 a73, v137
v_accvgpr_write_b32 a74, v138
v_mfma_f32_32x32x16_bf16 v[224:239], a[148:151], v[136:139], v[224:239]
s_waitcnt lgkmcnt(6)
s_add_u32 s41, s60, 256
ds_read_b64_tr_b16 a[172:173], v29 offset:6400
ds_read_b64_tr_b16 a[174:175], v29 offset:6912
v_accvgpr_write_b32 a75, v139
v_accvgpr_write_b32 a76, v140
v_accvgpr_write_b32 a77, v141
v_mfma_f32_32x32x16_bf16 v[208:223], a[152:155], v[140:143], v[208:223]
buffer_load_dwordx4 v20, s[12:15], s41 offen offset:0 lds
ds_read_b64_tr_b16 a[176:177], v29 offset:8192
ds_read_b64_tr_b16 a[178:179], v29 offset:8704
v_mfma_f32_32x32x16_bf16 v[224:239], a[156:159], v[140:143], v[224:239]
s_waitcnt lgkmcnt(6)
ds_read_b64_tr_b16 a[180:181], v29 offset:8448
ds_read_b64_tr_b16 a[182:183], v29 offset:8960
v_accvgpr_write_b32 a78, v142
v_accvgpr_write_b32 a79, v143
v_accvgpr_write_b32 a80, v144
v_mfma_f32_32x32x16_bf16 v[208:223], a[160:163], v[144:147], v[208:223]
ds_read_b64_tr_b16 a[184:185], v29 offset:10240
ds_read_b64_tr_b16 a[186:187], v29 offset:10752
v_accvgpr_write_b32 a81, v145
v_accvgpr_write_b32 a82, v146
v_accvgpr_write_b32 a83, v147
v_mfma_f32_32x32x16_bf16 v[224:239], a[164:167], v[144:147], v[224:239]
s_waitcnt lgkmcnt(6)
buffer_load_dwordx4 v21, s[12:15], s41 offen offset:1024 lds
ds_read_b64_tr_b16 a[188:189], v29 offset:10496
ds_read_b64_tr_b16 a[190:191], v29 offset:11008
v_mfma_f32_32x32x16_bf16 v[208:223], a[168:171], v[148:151], v[208:223]
ds_read_b64_tr_b16 a[144:145], v26 offset:12288
ds_read_b64_tr_b16 a[146:147], v26 offset:12800
v_accvgpr_write_b32 a84, v148
v_accvgpr_write_b32 a85, v149
v_accvgpr_write_b32 a86, v150
v_mfma_f32_32x32x16_bf16 v[224:239], a[172:175], v[148:151], v[224:239]
s_waitcnt lgkmcnt(6)
ds_read_b64_tr_b16 a[148:149], v26 offset:12544
ds_read_b64_tr_b16 a[150:151], v26 offset:13056
v_accvgpr_write_b32 a87, v151
v_accvgpr_write_b32 a88, v152
v_accvgpr_write_b32 a89, v153
v_mfma_f32_32x32x16_bf16 v[208:223], a[176:179], v[152:155], v[208:223]
buffer_load_dwordx4 v22, s[12:15], s41 offen offset:2048 lds
ds_read_b64_tr_b16 a[152:153], v26 offset:14336
ds_read_b64_tr_b16 a[154:155], v26 offset:14848
v_mfma_f32_32x32x16_bf16 v[224:239], a[180:183], v[152:155], v[224:239]
s_waitcnt lgkmcnt(6)
s_add_u32 m0, s35, 3072
ds_read_b64_tr_b16 a[156:157], v26 offset:14592
ds_read_b64_tr_b16 a[158:159], v26 offset:15104
v_accvgpr_write_b32 a90, v154
v_accvgpr_write_b32 a91, v155
v_accvgpr_write_b32 a92, v156
v_mfma_f32_32x32x16_bf16 v[208:223], a[184:187], v[156:159], v[208:223]
s_add_u32 s41, s60, 221440
ds_read_b64_tr_b16 a[160:161], v26 offset:16384
ds_read_b64_tr_b16 a[162:163], v26 offset:16896
v_accvgpr_write_b32 a93, v157
v_accvgpr_write_b32 a94, v158
v_accvgpr_write_b32 a95, v159
v_mfma_f32_32x32x16_bf16 v[224:239], a[188:191], v[156:159], v[224:239]
s_waitcnt lgkmcnt(6)
buffer_load_dwordx4 v20, s[12:15], s41 offen offset:0 lds
ds_read_b64_tr_b16 a[164:165], v26 offset:16640
ds_read_b64_tr_b16 a[166:167], v26 offset:17152
v_mfma_f32_32x32x16_bf16 v[208:223], a[144:147], v[160:163], v[208:223]
ds_read_b64_tr_b16 a[168:169], v27 offset:12288
ds_read_b64_tr_b16 a[170:171], v27 offset:12800
v_accvgpr_write_b32 a96, v160
v_accvgpr_write_b32 a97, v161
v_accvgpr_write_b32 a98, v162
v_mfma_f32_32x32x16_bf16 v[224:239], a[148:151], v[160:163], v[224:239]
s_waitcnt lgkmcnt(6)
ds_read_b64_tr_b16 a[172:173], v27 offset:12544
ds_read_b64_tr_b16 a[174:175], v27 offset:13056
v_accvgpr_write_b32 a99, v163
v_accvgpr_write_b32 a100, v164
v_accvgpr_write_b32 a101, v165
v_mfma_f32_32x32x16_bf16 v[208:223], a[152:155], v[164:167], v[208:223]
buffer_load_dwordx4 v21, s[12:15], s41 offen offset:1024 lds
ds_read_b64_tr_b16 a[176:177], v27 offset:14336
ds_read_b64_tr_b16 a[178:179], v27 offset:14848
v_mfma_f32_32x32x16_bf16 v[224:239], a[156:159], v[164:167], v[224:239]
s_waitcnt lgkmcnt(6)
ds_read_b64_tr_b16 a[180:181], v27 offset:14592
ds_read_b64_tr_b16 a[182:183], v27 offset:15104
v_accvgpr_write_b32 a102, v166
v_accvgpr_write_b32 a103, v167
v_accvgpr_write_b32 a104, v168
v_mfma_f32_32x32x16_bf16 v[208:223], a[160:163], v[168:171], v[208:223]
ds_read_b64_tr_b16 a[184:185], v27 offset:16384
ds_read_b64_tr_b16 a[186:187], v27 offset:16896
v_accvgpr_write_b32 a105, v169
v_accvgpr_write_b32 a106, v170
v_accvgpr_write_b32 a107, v171
v_mfma_f32_32x32x16_bf16 v[224:239], a[164:167], v[168:171], v[224:239]
s_waitcnt lgkmcnt(6)
buffer_load_dwordx4 v22, s[12:15], s41 offen offset:2048 lds
ds_read_b64_tr_b16 a[188:189], v27 offset:16640
ds_read_b64_tr_b16 a[190:191], v27 offset:17152
v_mfma_f32_32x32x16_bf16 v[208:223], a[168:171], v[172:175], v[208:223]
s_add_u32 m0, s35, 6144
ds_read_b64_tr_b16 a[144:145], v28 offset:12288
ds_read_b64_tr_b16 a[146:147], v28 offset:12800
v_accvgpr_write_b32 a108, v172
v_accvgpr_write_b32 a109, v173
v_accvgpr_write_b32 a110, v174
v_mfma_f32_32x32x16_bf16 v[224:239], a[172:175], v[172:175], v[224:239]
s_waitcnt lgkmcnt(6)
s_add_u32 s41, s61, 256
ds_read_b64_tr_b16 a[148:149], v28 offset:12544
ds_read_b64_tr_b16 a[150:151], v28 offset:13056
v_accvgpr_write_b32 a111, v175
v_accvgpr_write_b32 a112, v176
v_accvgpr_write_b32 a113, v177
v_mfma_f32_32x32x16_bf16 v[208:223], a[176:179], v[176:179], v[208:223]
ds_read_b64_tr_b16 a[152:153], v28 offset:14336
ds_read_b64_tr_b16 a[154:155], v28 offset:14848
v_accvgpr_write_b32 a114, v178
v_accvgpr_write_b32 a115, v179
v_accvgpr_write_b32 a116, v180
v_mfma_f32_32x32x16_bf16 v[224:239], a[180:183], v[176:179], v[224:239]
s_waitcnt lgkmcnt(6)
ds_read_b64_tr_b16 a[156:157], v28 offset:14592
ds_read_b64_tr_b16 a[158:159], v28 offset:15104
v_accvgpr_write_b32 a117, v181
v_accvgpr_write_b32 a118, v182
v_accvgpr_write_b32 a119, v183
v_mfma_f32_32x32x16_bf16 v[208:223], a[184:187], v[180:183], v[208:223]
ds_read_b64_tr_b16 a[160:161], v28 offset:16384
ds_read_b64_tr_b16 a[162:163], v28 offset:16896
v_accvgpr_write_b32 a120, v184
v_accvgpr_write_b32 a121, v185
v_accvgpr_write_b32 a122, v186
v_mfma_f32_32x32x16_bf16 v[224:239], a[188:191], v[180:183], v[224:239]
s_waitcnt lgkmcnt(6)
ds_read_b64_tr_b16 a[164:165], v28 offset:16640
ds_read_b64_tr_b16 a[166:167], v28 offset:17152
v_accvgpr_write_b32 a123, v187
v_accvgpr_write_b32 a124, v188
v_accvgpr_write_b32 a125, v189
s_waitcnt vmcnt(23)
s_barrier
v_mfma_f32_32x32x16_bf16 v[208:223], a[144:147], v[184:187], v[208:223]
buffer_load_dword a248, v244, s[64:67], s72 offen
ds_read_b64_tr_b16 a[168:169], v29 offset:12288
ds_read_b64_tr_b16 a[170:171], v29 offset:12800
v_mfma_f32_32x32x16_bf16 v[224:239], a[148:151], v[184:187], v[224:239]
s_waitcnt lgkmcnt(6)
ds_read_b64_tr_b16 a[172:173], v29 offset:12544
ds_read_b64_tr_b16 a[174:175], v29 offset:13056
v_accvgpr_write_b32 a126, v190
v_accvgpr_write_b32 a127, v191
v_accvgpr_write_b32 a128, v192
v_mfma_f32_32x32x16_bf16 v[208:223], a[152:155], v[188:191], v[208:223]
ds_read_b64_tr_b16 a[176:177], v29 offset:14336
ds_read_b64_tr_b16 a[178:179], v29 offset:14848
v_accvgpr_write_b32 a129, v193
v_accvgpr_write_b32 a130, v194
v_accvgpr_write_b32 a131, v195
v_mfma_f32_32x32x16_bf16 v[224:239], a[156:159], v[188:191], v[224:239]
s_waitcnt lgkmcnt(6)
buffer_load_dwordx4 v20, s[12:15], s41 offen offset:0 lds
ds_read_b64_tr_b16 a[180:181], v29 offset:14592
ds_read_b64_tr_b16 a[182:183], v29 offset:15104
v_mfma_f32_32x32x16_bf16 v[208:223], a[160:163], v[192:195], v[208:223]
ds_read_b64_tr_b16 a[184:185], v29 offset:16384
ds_read_b64_tr_b16 a[186:187], v29 offset:16896
v_accvgpr_write_b32 a132, v196
v_accvgpr_write_b32 a133, v197
v_accvgpr_write_b32 a134, v198
v_mfma_f32_32x32x16_bf16 v[224:239], a[164:167], v[192:195], v[224:239]
s_waitcnt lgkmcnt(6)
ds_read_b64_tr_b16 a[188:189], v29 offset:16640
ds_read_b64_tr_b16 a[190:191], v29 offset:17152
v_accvgpr_write_b32 a135, v199
v_accvgpr_write_b32 a136, v200
v_accvgpr_write_b32 a137, v201
v_mfma_f32_32x32x16_bf16 v[208:223], a[168:171], v[196:199], v[208:223]
buffer_load_dwordx4 v21, s[12:15], s41 offen offset:1024 lds
ds_read_b64_tr_b16 a[144:145], v26 offset:18432
ds_read_b64_tr_b16 a[146:147], v26 offset:18944
v_mfma_f32_32x32x16_bf16 v[224:239], a[172:175], v[196:199], v[224:239]
s_waitcnt lgkmcnt(6)
ds_read_b64_tr_b16 a[148:149], v26 offset:18688
ds_read_b64_tr_b16 a[150:151], v26 offset:19200
v_accvgpr_write_b32 a138, v202
v_accvgpr_write_b32 a139, v203
v_accvgpr_write_b32 a140, v204
v_mfma_f32_32x32x16_bf16 v[208:223], a[176:179], v[200:203], v[208:223]
ds_read_b64_tr_b16 a[152:153], v26 offset:20480
ds_read_b64_tr_b16 a[154:155], v26 offset:20992
v_accvgpr_write_b32 a141, v205
v_accvgpr_write_b32 a142, v206
v_accvgpr_write_b32 a143, v207
v_mfma_f32_32x32x16_bf16 v[224:239], a[180:183], v[200:203], v[224:239]
s_waitcnt lgkmcnt(6)
buffer_load_dwordx4 v22, s[12:15], s41 offen offset:2048 lds
ds_read_b64_tr_b16 a[156:157], v26 offset:20736
ds_read_b64_tr_b16 a[158:159], v26 offset:21248
v_mfma_f32_32x32x16_bf16 v[208:223], a[184:187], v[204:207], v[208:223]
s_add_u32 m0, s35, 9216
ds_read_b64_tr_b16 a[160:161], v26 offset:22528
ds_read_b64_tr_b16 a[162:163], v26 offset:23040
ds_read_b128 v[48:51], v30 offset:0
ds_read_b128 v[52:55], v30 offset:32
ds_read_b128 v[56:59], v30 offset:64
ds_read_b128 v[60:63], v30 offset:96
v_mfma_f32_32x32x16_bf16 v[224:239], a[188:191], v[204:207], v[224:239]
s_waitcnt lgkmcnt(10)
s_add_u32 s41, s61, 221440
ds_read_b64_tr_b16 a[164:165], v26 offset:22784
ds_read_b64_tr_b16 a[166:167], v26 offset:23296
v_mfma_f32_32x32x16_bf16 v[64:79], a[144:147], a[0:3], 0
buffer_load_dwordx4 v20, s[12:15], s41 offen offset:0 lds
ds_read_b64_tr_b16 a[168:169], v27 offset:18432
ds_read_b64_tr_b16 a[170:171], v27 offset:18944
v_mfma_f32_32x32x16_bf16 v[80:95], a[148:151], a[0:3], 0
s_waitcnt lgkmcnt(10)
ds_read_b64_tr_b16 a[172:173], v27 offset:18688
ds_read_b64_tr_b16 a[174:175], v27 offset:19200
v_mfma_f32_32x32x16_bf16 v[64:79], a[152:155], a[4:7], v[64:79]
ds_read_b64_tr_b16 a[176:177], v27 offset:20480
ds_read_b64_tr_b16 a[178:179], v27 offset:20992
s_waitcnt lgkmcnt(11)
v_pk_fma_f32 v[208:209], v[208:209], v[14:15], v[48:49] op_sel:[0,0,0] op_sel_hi:[1,0,1]
v_pk_fma_f32 v[210:211], v[210:211], v[14:15], v[50:51] op_sel:[0,0,0] op_sel_hi:[1,0,1]
s_waitcnt lgkmcnt(10)
v_pk_fma_f32 v[212:213], v[212:213], v[14:15], v[52:53] op_sel:[0,0,0] op_sel_hi:[1,0,1]
v_pk_fma_f32 v[214:215], v[214:215], v[14:15], v[54:55] op_sel:[0,0,0] op_sel_hi:[1,0,1]
s_waitcnt lgkmcnt(9)
v_pk_fma_f32 v[216:217], v[216:217], v[14:15], v[56:57] op_sel:[0,0,0] op_sel_hi:[1,0,1]
v_pk_fma_f32 v[218:219], v[218:219], v[14:15], v[58:59] op_sel:[0,0,0] op_sel_hi:[1,0,1]
s_waitcnt lgkmcnt(8)
v_pk_fma_f32 v[220:221], v[220:221], v[14:15], v[60:61] op_sel:[0,0,0] op_sel_hi:[1,0,1]
v_pk_fma_f32 v[222:223], v[222:223], v[14:15], v[62:63] op_sel:[0,0,0] op_sel_hi:[1,0,1]
v_mfma_f32_32x32x16_bf16 v[80:95], a[156:159], a[4:7], v[80:95]
s_waitcnt lgkmcnt(6)
buffer_load_dwordx4 v21, s[12:15], s41 offen offset:1024 lds
ds_read_b64_tr_b16 a[180:181], v27 offset:20736
ds_read_b64_tr_b16 a[182:183], v27 offset:21248
L_pad_f2_0:
s_cbranch_execz L_pad_f2_1
v_mfma_f32_32x32x16_bf16 v[64:79], a[160:163], a[8:11], v[64:79]
ds_read_b64_tr_b16 a[184:185], v27 offset:22528
ds_read_b64_tr_b16 a[186:187], v27 offset:23040
v_exp_f32 v32, v208
v_mfma_f32_32x32x16_bf16 v[80:95], a[164:167], a[8:11], v[80:95]
s_waitcnt lgkmcnt(6)
ds_read_b64_tr_b16 a[188:189], v27 offset:22784
ds_read_b64_tr_b16 a[190:191], v27 offset:23296
v_exp_f32 v33, v209
v_exp_f32 v34, v210
v_mfma_f32_32x32x16_bf16 v[64:79], a[168:171], a[12:15], v[64:79]
buffer_load_dwordx4 v22, s[12:15], s41 offen offset:2048 lds
ds_read_b64_tr_b16 a[144:145], v28 offset:18432
ds_read_b64_tr_b16 a[146:147], v28 offset:18944
v_mfma_f32_32x32x16_bf16 v[80:95], a[172:175], a[12:15], v[80:95]
s_waitcnt lgkmcnt(6)
s_add_u32 m0, s35, 12288
ds_read_b64_tr_b16 a[148:149], v28 offset:18688
ds_read_b64_tr_b16 a[150:151], v28 offset:19200
v_exp_f32 v35, v211
v_exp_f32 v36, v212
v_mfma_f32_32x32x16_bf16 v[64:79], a[176:179], a[16:19], v[64:79]
s_add_u32 s41, s62, 256
ds_read_b64_tr_b16 a[152:153], v28 offset:20480
ds_read_b64_tr_b16 a[154:155], v28 offset:20992
v_exp_f32 v37, v213
v_exp_f32 v38, v214
v_mfma_f32_32x32x16_bf16 v[80:95], a[180:183], a[16:19], v[80:95]
s_waitcnt lgkmcnt(6)
ds_read_b64_tr_b16 a[156:157], v28 offset:20736
ds_read_b64_tr_b16 a[158:159], v28 offset:21248
v_exp_f32 v39, v215
v_exp_f32 v40, v216
v_mfma_f32_32x32x16_bf16 v[64:79], a[184:187], a[20:23], v[64:79]
ds_read_b64_tr_b16 a[160:161], v28 offset:22528
ds_read_b64_tr_b16 a[162:163], v28 offset:23040
v_exp_f32 v41, v217
v_exp_f32 v42, v218
v_mfma_f32_32x32x16_bf16 v[80:95], a[188:191], a[20:23], v[80:95]
s_waitcnt lgkmcnt(6)
ds_read_b64_tr_b16 a[164:165], v28 offset:22784
ds_read_b64_tr_b16 a[166:167], v28 offset:23296
v_exp_f32 v43, v219
v_exp_f32 v44, v220
s_waitcnt vmcnt(21)
s_barrier
v_mfma_f32_32x32x16_bf16 v[64:79], a[144:147], a[24:27], v[64:79]
buffer_load_dwordx4 v20, s[12:15], s41 offen offset:0 lds
ds_read_b64_tr_b16 a[168:169], v29 offset:18432
ds_read_b64_tr_b16 a[170:171], v29 offset:18944
v_mfma_f32_32x32x16_bf16 v[80:95], a[148:151], a[24:27], v[80:95]
s_waitcnt lgkmcnt(6)
ds_read_b64_tr_b16 a[172:173], v29 offset:18688
ds_read_b64_tr_b16 a[174:175], v29 offset:19200
v_exp_f32 v45, v221
v_exp_f32 v46, v222
v_mfma_f32_32x32x16_bf16 v[64:79], a[152:155], a[28:31], v[64:79]
ds_read_b64_tr_b16 a[176:177], v29 offset:20480
ds_read_b64_tr_b16 a[178:179], v29 offset:20992
v_exp_f32 v47, v223
v_add_f32 v48, 2.0, v32
v_mfma_f32_32x32x16_bf16 v[80:95], a[156:159], a[28:31], v[80:95]
s_waitcnt lgkmcnt(6)
buffer_load_dwordx4 v21, s[12:15], s41 offen offset:1024 lds
ds_read_b64_tr_b16 a[180:181], v29 offset:20736
ds_read_b64_tr_b16 a[182:183], v29 offset:21248
v_mfma_f32_32x32x16_bf16 v[64:79], a[160:163], a[32:35], v[64:79]
ds_read_b64_tr_b16 a[184:185], v29 offset:22528
ds_read_b64_tr_b16 a[186:187], v29 offset:23040
v_add_f32 v49, 2.0, v33
v_add_f32 v50, 2.0, v34
v_add_f32 v51, 2.0, v35
v_add_f32 v52, 2.0, v36
v_mfma_f32_32x32x16_bf16 v[80:95], a[164:167], a[32:35], v[80:95]
s_waitcnt lgkmcnt(6)
ds_read_b64_tr_b16 a[188:189], v29 offset:22784
ds_read_b64_tr_b16 a[190:191], v29 offset:23296
v_add_f32 v53, 2.0, v37
v_add_f32 v54, 2.0, v38
v_add_f32 v55, 2.0, v39
v_add_f32 v56, 2.0, v40
v_mfma_f32_32x32x16_bf16 v[64:79], a[168:171], a[36:39], v[64:79]
buffer_load_dword a238, v247, s[12:15], s38 offen offset:512
ds_read_b64_tr_b16 a[144:145], v26 offset:24576
ds_read_b64_tr_b16 a[146:147], v26 offset:25088
v_mfma_f32_32x32x16_bf16 v[80:95], a[172:175], a[36:39], v[80:95]
s_waitcnt lgkmcnt(6)
ds_read_b64_tr_b16 a[148:149], v26 offset:24832
ds_read_b64_tr_b16 a[150:151], v26 offset:25344
v_add_f32 v57, 2.0, v41
v_add_f32 v58, 2.0, v42
v_add_f32 v59, 2.0, v43
v_add_f32 v60, 2.0, v44
v_mfma_f32_32x32x16_bf16 v[64:79], a[176:179], a[40:43], v[64:79]
ds_read_b64_tr_b16 a[152:153], v26 offset:26624
ds_read_b64_tr_b16 a[154:155], v26 offset:27136
v_add_f32 v61, 2.0, v45
v_add_f32 v62, 2.0, v46
v_add_f32 v63, 2.0, v47
v_pk_fma_f32 v[32:33], v[32:33], v[48:49], v[16:17] op_sel:[0,0,0] op_sel_hi:[1,1,0]
v_pk_fma_f32 v[34:35], v[34:35], v[50:51], v[16:17] op_sel:[0,0,0] op_sel_hi:[1,1,0]
v_pk_fma_f32 v[36:37], v[36:37], v[52:53], v[16:17] op_sel:[0,0,0] op_sel_hi:[1,1,0]
v_pk_fma_f32 v[38:39], v[38:39], v[54:55], v[16:17] op_sel:[0,0,0] op_sel_hi:[1,1,0]
v_pk_fma_f32 v[40:41], v[40:41], v[56:57], v[16:17] op_sel:[0,0,0] op_sel_hi:[1,1,0]
v_pk_fma_f32 v[42:43], v[42:43], v[58:59], v[16:17] op_sel:[0,0,0] op_sel_hi:[1,1,0]
v_pk_fma_f32 v[44:45], v[44:45], v[60:61], v[16:17] op_sel:[0,0,0] op_sel_hi:[1,1,0]
v_pk_fma_f32 v[46:47], v[46:47], v[62:63], v[16:17] op_sel:[0,0,0] op_sel_hi:[1,1,0]
v_mfma_f32_32x32x16_bf16 v[80:95], a[180:183], a[40:43], v[80:95]
s_waitcnt lgkmcnt(6)
buffer_load_dwordx4 v22, s[12:15], s41 offen offset:2048 lds
ds_read_b64_tr_b16 a[156:157], v26 offset:26880
ds_read_b64_tr_b16 a[158:159], v26 offset:27392
v_mfma_f32_32x32x16_bf16 v[64:79], a[184:187], a[44:47], v[64:79]
s_add_u32 m0, s35, 15360
ds_read_b64_tr_b16 a[160:161], v26 offset:28672
ds_read_b64_tr_b16 a[162:163], v26 offset:29184
ds_read_b128 v[48:51], v30 offset:128
ds_read_b128 v[52:55], v30 offset:160
ds_read_b128 v[56:59], v30 offset:192
ds_read_b128 v[60:63], v30 offset:224
v_mfma_f32_32x32x16_bf16 v[80:95], a[188:191], a[44:47], v[80:95]
s_waitcnt lgkmcnt(10)
s_add_u32 s41, s62, 221440
ds_read_b64_tr_b16 a[164:165], v26 offset:28928
ds_read_b64_tr_b16 a[166:167], v26 offset:29440
v_rcp_f32 v32, v32
v_rcp_f32 v33, v33
v_mfma_f32_32x32x16_bf16 v[64:79], a[144:147], a[48:51], v[64:79]
buffer_load_dwordx4 v20, s[12:15], s41 offen offset:0 lds
ds_read_b64_tr_b16 a[168:169], v27 offset:24576
ds_read_b64_tr_b16 a[170:171], v27 offset:25088
v_mfma_f32_32x32x16_bf16 v[80:95], a[148:151], a[48:51], v[80:95]
s_waitcnt lgkmcnt(10)
ds_read_b64_tr_b16 a[172:173], v27 offset:24832
ds_read_b64_tr_b16 a[174:175], v27 offset:25344
v_rcp_f32 v34, v34
v_rcp_f32 v35, v35
v_mfma_f32_32x32x16_bf16 v[64:79], a[152:155], a[52:55], v[64:79]
ds_read_b64_tr_b16 a[176:177], v27 offset:26624
ds_read_b64_tr_b16 a[178:179], v27 offset:27136
v_rcp_f32 v36, v36
v_rcp_f32 v37, v37
v_mfma_f32_32x32x16_bf16 v[80:95], a[156:159], a[52:55], v[80:95]
s_waitcnt lgkmcnt(6)
buffer_load_dwordx4 v21, s[12:15], s41 offen offset:1024 lds
ds_read_b64_tr_b16 a[180:181], v27 offset:26880
ds_read_b64_tr_b16 a[182:183], v27 offset:27392
v_mfma_f32_32x32x16_bf16 v[64:79], a[160:163], a[56:59], v[64:79]
ds_read_b64_tr_b16 a[184:185], v27 offset:28672
ds_read_b64_tr_b16 a[186:187], v27 offset:29184
v_rcp_f32 v38, v38
v_rcp_f32 v39, v39
v_mfma_f32_32x32x16_bf16 v[80:95], a[164:167], a[56:59], v[80:95]
s_waitcnt lgkmcnt(6)
ds_read_b64_tr_b16 a[188:189], v27 offset:28928
ds_read_b64_tr_b16 a[190:191], v27 offset:29440
v_rcp_f32 v40, v40
v_rcp_f32 v41, v41
v_mfma_f32_32x32x16_bf16 v[64:79], a[168:171], a[60:63], v[64:79]
buffer_load_dwordx4 v22, s[12:15], s41 offen offset:2048 lds
ds_read_b64_tr_b16 a[144:145], v28 offset:24576
ds_read_b64_tr_b16 a[146:147], v28 offset:25088
v_mfma_f32_32x32x16_bf16 v[80:95], a[172:175], a[60:63], v[80:95]
s_waitcnt lgkmcnt(6)
s_add_u32 m0, s35, 18432
ds_read_b64_tr_b16 a[148:149], v28 offset:24832
ds_read_b64_tr_b16 a[150:151], v28 offset:25344
v_rcp_f32 v42, v42
v_rcp_f32 v43, v43
v_mfma_f32_32x32x16_bf16 v[64:79], a[176:179], a[64:67], v[64:79]
s_add_u32 s41, s60, 384
ds_read_b64_tr_b16 a[152:153], v28 offset:26624
ds_read_b64_tr_b16 a[154:155], v28 offset:27136
v_rcp_f32 v44, v44
v_rcp_f32 v45, v45
v_mfma_f32_32x32x16_bf16 v[80:95], a[180:183], a[64:67], v[80:95]
s_waitcnt lgkmcnt(6)
ds_read_b64_tr_b16 a[156:157], v28 offset:26880
ds_read_b64_tr_b16 a[158:159], v28 offset:27392
v_rcp_f32 v46, v46
v_rcp_f32 v47, v47
v_pk_fma_f32 v[32:33], v[32:33], v[14:15], v[30:31] op_sel:[0,1,1] op_sel_hi:[1,1,1]
v_pk_fma_f32 v[34:35], v[34:35], v[14:15], v[30:31] op_sel:[0,1,1] op_sel_hi:[1,1,1]
v_pk_fma_f32 v[36:37], v[36:37], v[14:15], v[30:31] op_sel:[0,1,1] op_sel_hi:[1,1,1]
v_pk_fma_f32 v[38:39], v[38:39], v[14:15], v[30:31] op_sel:[0,1,1] op_sel_hi:[1,1,1]
v_pk_fma_f32 v[40:41], v[40:41], v[14:15], v[30:31] op_sel:[0,1,1] op_sel_hi:[1,1,1]
v_pk_fma_f32 v[42:43], v[42:43], v[14:15], v[30:31] op_sel:[0,1,1] op_sel_hi:[1,1,1]
v_pk_fma_f32 v[44:45], v[44:45], v[14:15], v[30:31] op_sel:[0,1,1] op_sel_hi:[1,1,1]
v_pk_fma_f32 v[46:47], v[46:47], v[14:15], v[30:31] op_sel:[0,1,1] op_sel_hi:[1,1,1]
v_pk_mul_f32 v[208:209], v[208:209], v[32:33] op_sel:[0,0] op_sel_hi:[1,1]
v_pk_mul_f32 v[210:211], v[210:211], v[34:35] op_sel:[0,0] op_sel_hi:[1,1]
v_pk_mul_f32 v[212:213], v[212:213], v[36:37] op_sel:[0,0] op_sel_hi:[1,1]
v_pk_mul_f32 v[214:215], v[214:215], v[38:39] op_sel:[0,0] op_sel_hi:[1,1]
v_pk_mul_f32 v[216:217], v[216:217], v[40:41] op_sel:[0,0] op_sel_hi:[1,1]
v_pk_mul_f32 v[218:219], v[218:219], v[42:43] op_sel:[0,0] op_sel_hi:[1,1]
v_pk_mul_f32 v[220:221], v[220:221], v[44:45] op_sel:[0,0] op_sel_hi:[1,1]
v_pk_mul_f32 v[222:223], v[222:223], v[46:47] op_sel:[0,0] op_sel_hi:[1,1]
v_pk_fma_f32 v[224:225], v[224:225], v[14:15], v[48:49] op_sel:[0,0,0] op_sel_hi:[1,0,1]
v_pk_fma_f32 v[226:227], v[226:227], v[14:15], v[50:51] op_sel:[0,0,0] op_sel_hi:[1,0,1]
v_pk_fma_f32 v[228:229], v[228:229], v[14:15], v[52:53] op_sel:[0,0,0] op_sel_hi:[1,0,1]
v_pk_fma_f32 v[230:231], v[230:231], v[14:15], v[54:55] op_sel:[0,0,0] op_sel_hi:[1,0,1]
v_pk_fma_f32 v[232:233], v[232:233], v[14:15], v[56:57] op_sel:[0,0,0] op_sel_hi:[1,0,1]
v_pk_fma_f32 v[234:235], v[234:235], v[14:15], v[58:59] op_sel:[0,0,0] op_sel_hi:[1,0,1]
v_pk_fma_f32 v[236:237], v[236:237], v[14:15], v[60:61] op_sel:[0,0,0] op_sel_hi:[1,0,1]
v_pk_fma_f32 v[238:239], v[238:239], v[14:15], v[62:63] op_sel:[0,0,0] op_sel_hi:[1,0,1]
v_mfma_f32_32x32x16_bf16 v[64:79], a[184:187], a[68:71], v[64:79]
ds_read_b64_tr_b16 a[160:161], v28 offset:28672
ds_read_b64_tr_b16 a[162:163], v28 offset:29184
v_cvt_pk_bf16_f32 v96, v208, v209
v_cvt_pk_bf16_f32 v97, v210, v211
v_cvt_pk_bf16_f32 v98, v212, v213
v_cvt_pk_bf16_f32 v99, v214, v215
v_mfma_f32_32x32x16_bf16 v[80:95], a[188:191], a[68:71], v[80:95]
s_waitcnt lgkmcnt(6)
ds_read_b64_tr_b16 a[164:165], v28 offset:28928
ds_read_b64_tr_b16 a[166:167], v28 offset:29440
v_cvt_pk_bf16_f32 v100, v216, v217
v_cvt_pk_bf16_f32 v101, v218, v219
v_cvt_pk_bf16_f32 v102, v220, v221
v_cvt_pk_bf16_f32 v103, v222, v223
s_waitcnt vmcnt(20)
s_barrier
v_mfma_f32_32x32x16_bf16 v[64:79], a[144:147], a[72:75], v[64:79]
buffer_load_dwordx4 v20, s[12:15], s41 offen offset:0 lds
ds_read_b64_tr_b16 a[168:169], v29 offset:24576
ds_read_b64_tr_b16 a[170:171], v29 offset:25088
v_mfma_f32_32x32x16_bf16 v[80:95], a[148:151], a[72:75], v[80:95]
s_waitcnt lgkmcnt(6)
ds_read_b64_tr_b16 a[172:173], v29 offset:24832
ds_read_b64_tr_b16 a[174:175], v29 offset:25344
v_exp_f32 v32, v224
v_exp_f32 v33, v225
v_mfma_f32_32x32x16_bf16 v[64:79], a[152:155], a[76:79], v[64:79]
ds_read_b64_tr_b16 a[176:177], v29 offset:26624
ds_read_b64_tr_b16 a[178:179], v29 offset:27136
v_exp_f32 v34, v226
v_exp_f32 v35, v227
v_mfma_f32_32x32x16_bf16 v[80:95], a[156:159], a[76:79], v[80:95]
s_waitcnt lgkmcnt(6)
buffer_load_dwordx4 v21, s[12:15], s41 offen offset:1024 lds
ds_read_b64_tr_b16 a[180:181], v29 offset:26880
ds_read_b64_tr_b16 a[182:183], v29 offset:27392
v_mfma_f32_32x32x16_bf16 v[64:79], a[160:163], a[80:83], v[64:79]
ds_read_b64_tr_b16 a[184:185], v29 offset:28672
ds_read_b64_tr_b16 a[186:187], v29 offset:29184
v_exp_f32 v36, v228
v_exp_f32 v37, v229
v_mfma_f32_32x32x16_bf16 v[80:95], a[164:167], a[80:83], v[80:95]
s_waitcnt lgkmcnt(6)
ds_read_b64_tr_b16 a[188:189], v29 offset:28928
ds_read_b64_tr_b16 a[190:191], v29 offset:29440
v_exp_f32 v38, v230
v_exp_f32 v39, v231
v_mfma_f32_32x32x16_bf16 v[64:79], a[168:171], a[84:87], v[64:79]
buffer_load_dwordx4 v22, s[12:15], s41 offen offset:2048 lds
ds_read_b64_tr_b16 a[144:145], v26 offset:30720
ds_read_b64_tr_b16 a[146:147], v26 offset:31232
v_mfma_f32_32x32x16_bf16 v[80:95], a[172:175], a[84:87], v[80:95]
s_waitcnt lgkmcnt(6)
s_add_u32 m0, s35, 21504
ds_read_b64_tr_b16 a[148:149], v26 offset:30976
ds_read_b64_tr_b16 a[150:151], v26 offset:31488
v_exp_f32 v40, v232
v_exp_f32 v41, v233
v_mfma_f32_32x32x16_bf16 v[64:79], a[176:179], a[88:91], v[64:79]
s_add_u32 s41, s60, 221568
ds_read_b64_tr_b16 a[152:153], v26 offset:32768
ds_read_b64_tr_b16 a[154:155], v26 offset:33280
v_exp_f32 v42, v234
v_exp_f32 v43, v235
v_mfma_f32_32x32x16_bf16 v[80:95], a[180:183], a[88:91], v[80:95]
s_waitcnt lgkmcnt(6)
buffer_load_dwordx4 v20, s[12:15], s41 offen offset:0 lds
ds_read_b64_tr_b16 a[156:157], v26 offset:33024
ds_read_b64_tr_b16 a[158:159], v26 offset:33536
v_mfma_f32_32x32x16_bf16 v[64:79], a[184:187], a[92:95], v[64:79]
ds_read_b64_tr_b16 a[160:161], v26 offset:34816
ds_read_b64_tr_b16 a[162:163], v26 offset:35328
v_exp_f32 v44, v236
v_exp_f32 v45, v237
v_mfma_f32_32x32x16_bf16 v[80:95], a[188:191], a[92:95], v[80:95]
s_waitcnt lgkmcnt(6)
ds_read_b64_tr_b16 a[164:165], v26 offset:35072
ds_read_b64_tr_b16 a[166:167], v26 offset:35584
v_exp_f32 v46, v238
v_exp_f32 v47, v239
v_mfma_f32_32x32x16_bf16 v[64:79], a[144:147], a[96:99], v[64:79]
buffer_load_dword a247, v245, s[68:71], s73 offen
ds_read_b64_tr_b16 a[168:169], v27 offset:30720
ds_read_b64_tr_b16 a[170:171], v27 offset:31232
v_mfma_f32_32x32x16_bf16 v[80:95], a[148:151], a[96:99], v[80:95]
s_waitcnt lgkmcnt(6)
ds_read_b64_tr_b16 a[172:173], v27 offset:30976
ds_read_b64_tr_b16 a[174:175], v27 offset:31488
v_add_f32 v48, 2.0, v32
v_add_f32 v49, 2.0, v33
v_add_f32 v50, 2.0, v34
v_add_f32 v51, 2.0, v35
v_mfma_f32_32x32x16_bf16 v[64:79], a[152:155], a[100:103], v[64:79]
ds_read_b64_tr_b16 a[176:177], v27 offset:32768
ds_read_b64_tr_b16 a[178:179], v27 offset:33280
v_add_f32 v52, 2.0, v36
v_add_f32 v53, 2.0, v37
v_add_f32 v54, 2.0, v38
v_add_f32 v55, 2.0, v39
v_mfma_f32_32x32x16_bf16 v[80:95], a[156:159], a[100:103], v[80:95]
s_waitcnt lgkmcnt(6)
buffer_load_dwordx4 v21, s[12:15], s41 offen offset:1024 lds
ds_read_b64_tr_b16 a[180:181], v27 offset:33024
ds_read_b64_tr_b16 a[182:183], v27 offset:33536
v_mfma_f32_32x32x16_bf16 v[64:79], a[160:163], a[104:107], v[64:79]
ds_read_b64_tr_b16 a[184:185], v27 offset:34816
ds_read_b64_tr_b16 a[186:187], v27 offset:35328
v_add_f32 v56, 2.0, v40
v_add_f32 v57, 2.0, v41
v_add_f32 v58, 2.0, v42
v_add_f32 v59, 2.0, v43
v_mfma_f32_32x32x16_bf16 v[80:95], a[164:167], a[104:107], v[80:95]
s_waitcnt lgkmcnt(6)
ds_read_b64_tr_b16 a[188:189], v27 offset:35072
ds_read_b64_tr_b16 a[190:191], v27 offset:35584
v_add_f32 v60, 2.0, v44
v_add_f32 v61, 2.0, v45
v_add_f32 v62, 2.0, v46
v_add_f32 v63, 2.0, v47
v_pk_fma_f32 v[32:33], v[32:33], v[48:49], v[16:17] op_sel:[0,0,0] op_sel_hi:[1,1,0]
v_pk_fma_f32 v[34:35], v[34:35], v[50:51], v[16:17] op_sel:[0,0,0] op_sel_hi:[1,1,0]
v_pk_fma_f32 v[36:37], v[36:37], v[52:53], v[16:17] op_sel:[0,0,0] op_sel_hi:[1,1,0]
v_pk_fma_f32 v[38:39], v[38:39], v[54:55], v[16:17] op_sel:[0,0,0] op_sel_hi:[1,1,0]
v_pk_fma_f32 v[40:41], v[40:41], v[56:57], v[16:17] op_sel:[0,0,0] op_sel_hi:[1,1,0]
v_pk_fma_f32 v[42:43], v[42:43], v[58:59], v[16:17] op_sel:[0,0,0] op_sel_hi:[1,1,0]
v_pk_fma_f32 v[44:45], v[44:45], v[60:61], v[16:17] op_sel:[0,0,0] op_sel_hi:[1,1,0]
v_pk_fma_f32 v[46:47], v[46:47], v[62:63], v[16:17] op_sel:[0,0,0] op_sel_hi:[1,1,0]
v_mfma_f32_32x32x16_bf16 v[64:79], a[168:171], a[108:111], v[64:79]
buffer_load_dwordx4 v22, s[12:15], s41 offen offset:2048 lds
ds_read_b64_tr_b16 a[144:145], v28 offset:30720
ds_read_b64_tr_b16 a[146:147], v28 offset:31232
v_mfma_f32_32x32x16_bf16 v[80:95], a[172:175], a[108:111], v[80:95]
s_waitcnt lgkmcnt(6)
s_add_u32 m0, s35, 24576
ds_read_b64_tr_b16 a[148:149], v28 offset:30976
ds_read_b64_tr_b16 a[150:151], v28 offset:31488
v_rcp_f32 v32, v32
v_rcp_f32 v33, v33
v_mfma_f32_32x32x16_bf16 v[64:79], a[176:179], a[112:115], v[64:79]
s_add_u32 s41, s61, 384
ds_read_b64_tr_b16 a[152:153], v28 offset:32768
ds_read_b64_tr_b16 a[154:155], v28 offset:33280
v_rcp_f32 v34, v34
v_rcp_f32 v35, v35
v_mfma_f32_32x32x16_bf16 v[80:95], a[180:183], a[112:115], v[80:95]
s_waitcnt lgkmcnt(6)
ds_read_b64_tr_b16 a[156:157], v28 offset:33024
ds_read_b64_tr_b16 a[158:159], v28 offset:33536
v_rcp_f32 v36, v36
v_rcp_f32 v37, v37
v_mfma_f32_32x32x16_bf16 v[64:79], a[184:187], a[116:119], v[64:79]
ds_read_b64_tr_b16 a[160:161], v28 offset:34816
ds_read_b64_tr_b16 a[162:163], v28 offset:35328
v_rcp_f32 v38, v38
v_rcp_f32 v39, v39
v_mfma_f32_32x32x16_bf16 v[80:95], a[188:191], a[116:119], v[80:95]
s_waitcnt lgkmcnt(6)
ds_read_b64_tr_b16 a[164:165], v28 offset:35072
ds_read_b64_tr_b16 a[166:167], v28 offset:35584
v_rcp_f32 v40, v40
v_rcp_f32 v41, v41
s_waitcnt vmcnt(21)
s_barrier
v_mfma_f32_32x32x16_bf16 v[64:79], a[144:147], a[120:123], v[64:79]
buffer_load_dwordx4 v20, s[12:15], s41 offen offset:0 lds
ds_read_b64_tr_b16 a[168:169], v29 offset:30720
ds_read_b64_tr_b16 a[170:171], v29 offset:31232
v_mfma_f32_32x32x16_bf16 v[80:95], a[148:151], a[120:123], v[80:95]
s_waitcnt lgkmcnt(6)
ds_read_b64_tr_b16 a[172:173], v29 offset:30976
ds_read_b64_tr_b16 a[174:175], v29 offset:31488
v_rcp_f32 v42, v42
v_rcp_f32 v43, v43
v_mfma_f32_32x32x16_bf16 v[64:79], a[152:155], a[124:127], v[64:79]
ds_read_b64_tr_b16 a[176:177], v29 offset:32768
ds_read_b64_tr_b16 a[178:179], v29 offset:33280
v_rcp_f32 v44, v44
v_rcp_f32 v45, v45
v_mfma_f32_32x32x16_bf16 v[80:95], a[156:159], a[124:127], v[80:95]
s_waitcnt lgkmcnt(6)
buffer_load_dwordx4 v21, s[12:15], s41 offen offset:1024 lds
ds_read_b64_tr_b16 a[180:181], v29 offset:33024
ds_read_b64_tr_b16 a[182:183], v29 offset:33536
v_mfma_f32_32x32x16_bf16 v[64:79], a[160:163], a[128:131], v[64:79]
ds_read_b64_tr_b16 a[184:185], v29 offset:34816
ds_read_b64_tr_b16 a[186:187], v29 offset:35328
v_rcp_f32 v46, v46
v_rcp_f32 v47, v47
v_pk_fma_f32 v[32:33], v[32:33], v[14:15], v[30:31] op_sel:[0,1,1] op_sel_hi:[1,1,1]
v_pk_fma_f32 v[34:35], v[34:35], v[14:15], v[30:31] op_sel:[0,1,1] op_sel_hi:[1,1,1]
v_pk_fma_f32 v[36:37], v[36:37], v[14:15], v[30:31] op_sel:[0,1,1] op_sel_hi:[1,1,1]
v_pk_fma_f32 v[38:39], v[38:39], v[14:15], v[30:31] op_sel:[0,1,1] op_sel_hi:[1,1,1]
v_pk_fma_f32 v[40:41], v[40:41], v[14:15], v[30:31] op_sel:[0,1,1] op_sel_hi:[1,1,1]
v_pk_fma_f32 v[42:43], v[42:43], v[14:15], v[30:31] op_sel:[0,1,1] op_sel_hi:[1,1,1]
v_pk_fma_f32 v[44:45], v[44:45], v[14:15], v[30:31] op_sel:[0,1,1] op_sel_hi:[1,1,1]
v_pk_fma_f32 v[46:47], v[46:47], v[14:15], v[30:31] op_sel:[0,1,1] op_sel_hi:[1,1,1]
v_pk_mul_f32 v[224:225], v[224:225], v[32:33] op_sel:[0,0] op_sel_hi:[1,1]
v_pk_mul_f32 v[226:227], v[226:227], v[34:35] op_sel:[0,0] op_sel_hi:[1,1]
v_pk_mul_f32 v[228:229], v[228:229], v[36:37] op_sel:[0,0] op_sel_hi:[1,1]
v_pk_mul_f32 v[230:231], v[230:231], v[38:39] op_sel:[0,0] op_sel_hi:[1,1]
v_pk_mul_f32 v[232:233], v[232:233], v[40:41] op_sel:[0,0] op_sel_hi:[1,1]
v_pk_mul_f32 v[234:235], v[234:235], v[42:43] op_sel:[0,0] op_sel_hi:[1,1]
v_pk_mul_f32 v[236:237], v[236:237], v[44:45] op_sel:[0,0] op_sel_hi:[1,1]
v_pk_mul_f32 v[238:239], v[238:239], v[46:47] op_sel:[0,0] op_sel_hi:[1,1]
v_mfma_f32_32x32x16_bf16 v[80:95], a[164:167], a[128:131], v[80:95]
s_waitcnt lgkmcnt(6)
ds_read_b64_tr_b16 a[188:189], v29 offset:35072
ds_read_b64_tr_b16 a[190:191], v29 offset:35584
v_cvt_pk_bf16_f32 v104, v224, v225
v_cvt_pk_bf16_f32 v105, v226, v227
v_cvt_pk_bf16_f32 v106, v228, v229
v_cvt_pk_bf16_f32 v107, v230, v231
v_mfma_f32_32x32x16_bf16 v[64:79], a[168:171], a[132:135], v[64:79]
buffer_load_dwordx4 v22, s[12:15], s41 offen offset:2048 lds
ds_read_b64_tr_b16 a[144:145], v26 offset:0
ds_read_b64_tr_b16 a[146:147], v26 offset:512
v_mfma_f32_32x32x16_bf16 v[80:95], a[172:175], a[132:135], v[80:95]
s_waitcnt lgkmcnt(6)
s_add_u32 m0, s35, 27648
ds_read_b64_tr_b16 a[148:149], v26 offset:256
ds_read_b64_tr_b16 a[150:151], v26 offset:768
v_cvt_pk_bf16_f32 v108, v232, v233
v_cvt_pk_bf16_f32 v109, v234, v235
v_cvt_pk_bf16_f32 v110, v236, v237
v_cvt_pk_bf16_f32 v111, v238, v239
v_mfma_f32_32x32x16_bf16 v[64:79], a[176:179], a[136:139], v[64:79]
s_add_u32 s41, s61, 221568
ds_read_b64_tr_b16 a[152:153], v26 offset:2048
ds_read_b64_tr_b16 a[154:155], v26 offset:2560
v_mfma_f32_32x32x16_bf16 v[80:95], a[180:183], a[136:139], v[80:95]
s_waitcnt lgkmcnt(6)
buffer_load_dwordx4 v20, s[12:15], s41 offen offset:0 lds
ds_read_b64_tr_b16 a[156:157], v26 offset:2304
ds_read_b64_tr_b16 a[158:159], v26 offset:2816
v_mfma_f32_32x32x16_bf16 v[64:79], a[184:187], a[140:143], v[64:79]
ds_read_b64_tr_b16 a[160:161], v26 offset:4096
ds_read_b64_tr_b16 a[162:163], v26 offset:4608
ds_read_b128 v[48:51], v30 offset:256
ds_read_b128 v[52:55], v30 offset:288
ds_read_b128 v[56:59], v30 offset:320
ds_read_b128 v[60:63], v30 offset:352
v_mfma_f32_32x32x16_bf16 v[80:95], a[188:191], a[140:143], v[80:95]
s_waitcnt lgkmcnt(10)
ds_read_b64_tr_b16 a[164:165], v26 offset:4352
ds_read_b64_tr_b16 a[166:167], v26 offset:4864
v_mfma_f32_32x32x16_bf16 v[208:223], a[144:147], a[0:3], 0
buffer_load_dwordx4 v21, s[12:15], s41 offen offset:1024 lds
ds_read_b64_tr_b16 a[168:169], v27 offset:0
ds_read_b64_tr_b16 a[170:171], v27 offset:512
v_mfma_f32_32x32x16_bf16 v[224:239], a[148:151], a[0:3], 0
s_waitcnt lgkmcnt(10)
ds_read_b64_tr_b16 a[172:173], v27 offset:256
ds_read_b64_tr_b16 a[174:175], v27 offset:768
v_mfma_f32_32x32x16_bf16 v[208:223], a[152:155], a[4:7], v[208:223]
ds_read_b64_tr_b16 a[176:177], v27 offset:2048
ds_read_b64_tr_b16 a[178:179], v27 offset:2560
s_waitcnt lgkmcnt(11)
v_pk_fma_f32 v[64:65], v[64:65], v[14:15], v[48:49] op_sel:[0,0,0] op_sel_hi:[1,0,1]
v_pk_fma_f32 v[66:67], v[66:67], v[14:15], v[50:51] op_sel:[0,0,0] op_sel_hi:[1,0,1]
s_waitcnt lgkmcnt(10)
v_pk_fma_f32 v[68:69], v[68:69], v[14:15], v[52:53] op_sel:[0,0,0] op_sel_hi:[1,0,1]
v_pk_fma_f32 v[70:71], v[70:71], v[14:15], v[54:55] op_sel:[0,0,0] op_sel_hi:[1,0,1]
s_waitcnt lgkmcnt(9)
v_pk_fma_f32 v[72:73], v[72:73], v[14:15], v[56:57] op_sel:[0,0,0] op_sel_hi:[1,0,1]
v_pk_fma_f32 v[74:75], v[74:75], v[14:15], v[58:59] op_sel:[0,0,0] op_sel_hi:[1,0,1]
s_waitcnt lgkmcnt(8)
v_pk_fma_f32 v[76:77], v[76:77], v[14:15], v[60:61] op_sel:[0,0,0] op_sel_hi:[1,0,1]
v_pk_fma_f32 v[78:79], v[78:79], v[14:15], v[62:63] op_sel:[0,0,0] op_sel_hi:[1,0,1]
v_mfma_f32_32x32x16_bf16 v[224:239], a[156:159], a[4:7], v[224:239]
s_waitcnt lgkmcnt(6)
buffer_load_dwordx4 v22, s[12:15], s41 offen offset:2048 lds
ds_read_b64_tr_b16 a[180:181], v27 offset:2304
ds_read_b64_tr_b16 a[182:183], v27 offset:2816
v_mfma_f32_32x32x16_bf16 v[208:223], a[160:163], a[8:11], v[208:223]
s_add_u32 m0, s35, 30720
ds_read_b64_tr_b16 a[184:185], v27 offset:4096
ds_read_b64_tr_b16 a[186:187], v27 offset:4608
v_exp_f32 v32, v64
v_mfma_f32_32x32x16_bf16 v[224:239], a[164:167], a[8:11], v[224:239]
s_waitcnt lgkmcnt(6)
s_add_u32 s41, s62, 384
ds_read_b64_tr_b16 a[188:189], v27 offset:4352
ds_read_b64_tr_b16 a[190:191], v27 offset:4864
v_exp_f32 v33, v65
v_exp_f32 v34, v66
v_mfma_f32_32x32x16_bf16 v[208:223], a[168:171], a[12:15], v[208:223]
s_add_u32 s63, s51, 0
buffer_load_dword a240, v246, s[16:19], s63 offen
ds_read_b64_tr_b16 a[144:145], v28 offset:0
ds_read_b64_tr_b16 a[146:147], v28 offset:512
v_mfma_f32_32x32x16_bf16 v[224:239], a[172:175], a[12:15], v[224:239]
s_waitcnt lgkmcnt(6)
ds_read_b64_tr_b16 a[148:149], v28 offset:256
ds_read_b64_tr_b16 a[150:151], v28 offset:768
v_exp_f32 v35, v67
v_exp_f32 v36, v68
v_mfma_f32_32x32x16_bf16 v[208:223], a[176:179], a[16:19], v[208:223]
ds_read_b64_tr_b16 a[152:153], v28 offset:2048
ds_read_b64_tr_b16 a[154:155], v28 offset:2560
v_exp_f32 v37, v69
v_exp_f32 v38, v70
v_mfma_f32_32x32x16_bf16 v[224:239], a[180:183], a[16:19], v[224:239]
s_waitcnt lgkmcnt(6)
ds_read_b64_tr_b16 a[156:157], v28 offset:2304
ds_read_b64_tr_b16 a[158:159], v28 offset:2816
v_exp_f32 v39, v71
v_exp_f32 v40, v72
v_mfma_f32_32x32x16_bf16 v[208:223], a[184:187], a[20:23], v[208:223]
ds_read_b64_tr_b16 a[160:161], v28 offset:4096
ds_read_b64_tr_b16 a[162:163], v28 offset:4608
v_exp_f32 v41, v73
v_exp_f32 v42, v74
v_mfma_f32_32x32x16_bf16 v[224:239], a[188:191], a[20:23], v[224:239]
s_waitcnt lgkmcnt(6)
ds_read_b64_tr_b16 a[164:165], v28 offset:4352
ds_read_b64_tr_b16 a[166:167], v28 offset:4864
v_exp_f32 v43, v75
v_exp_f32 v44, v76
s_waitcnt vmcnt(21)
s_barrier
v_mfma_f32_32x32x16_bf16 v[208:223], a[144:147], a[24:27], v[208:223]
buffer_load_dwordx4 v20, s[12:15], s41 offen offset:0 lds
ds_read_b64_tr_b16 a[168:169], v29 offset:0
ds_read_b64_tr_b16 a[170:171], v29 offset:512
v_mfma_f32_32x32x16_bf16 v[224:239], a[148:151], a[24:27], v[224:239]
s_waitcnt lgkmcnt(6)
ds_read_b64_tr_b16 a[172:173], v29 offset:256
ds_read_b64_tr_b16 a[174:175], v29 offset:768
v_exp_f32 v45, v77
v_exp_f32 v46, v78
v_mfma_f32_32x32x16_bf16 v[208:223], a[152:155], a[28:31], v[208:223]
ds_read_b64_tr_b16 a[176:177], v29 offset:2048
ds_read_b64_tr_b16 a[178:179], v29 offset:2560
v_exp_f32 v47, v79
v_add_f32 v48, 2.0, v32
v_mfma_f32_32x32x16_bf16 v[224:239], a[156:159], a[28:31], v[224:239]
s_waitcnt lgkmcnt(6)
buffer_load_dwordx4 v21, s[12:15], s41 offen offset:1024 lds
ds_read_b64_tr_b16 a[180:181], v29 offset:2304
ds_read_b64_tr_b16 a[182:183], v29 offset:2816
v_mfma_f32_32x32x16_bf16 v[208:223], a[160:163], a[32:35], v[208:223]
ds_read_b64_tr_b16 a[184:185], v29 offset:4096
ds_read_b64_tr_b16 a[186:187], v29 offset:4608
v_add_f32 v49, 2.0, v33
v_add_f32 v50, 2.0, v34
v_add_f32 v51, 2.0, v35
v_add_f32 v52, 2.0, v36
v_mfma_f32_32x32x16_bf16 v[224:239], a[164:167], a[32:35], v[224:239]
s_waitcnt lgkmcnt(6)
ds_read_b64_tr_b16 a[188:189], v29 offset:4352
ds_read_b64_tr_b16 a[190:191], v29 offset:4864
v_add_f32 v53, 2.0, v37
v_add_f32 v54, 2.0, v38
v_add_f32 v55, 2.0, v39
v_add_f32 v56, 2.0, v40
v_mfma_f32_32x32x16_bf16 v[208:223], a[168:171], a[36:39], v[208:223]
buffer_load_dwordx4 v22, s[12:15], s41 offen offset:2048 lds
ds_read_b64_tr_b16 a[144:145], v26 offset:6144
ds_read_b64_tr_b16 a[146:147], v26 offset:6656
v_mfma_f32_32x32x16_bf16 v[224:239], a[172:175], a[36:39], v[224:239]
s_waitcnt lgkmcnt(6)
s_add_u32 m0, s35, 33792
ds_read_b64_tr_b16 a[148:149], v26 offset:6400
ds_read_b64_tr_b16 a[150:151], v26 offset:6912
v_add_f32 v57, 2.0, v41
v_add_f32 v58, 2.0, v42
v_add_f32 v59, 2.0, v43
v_add_f32 v60, 2.0, v44
v_mfma_f32_32x32x16_bf16 v[208:223], a[176:179], a[40:43], v[208:223]
s_add_u32 s41, s62, 221568
ds_read_b64_tr_b16 a[152:153], v26 offset:8192
ds_read_b64_tr_b16 a[154:155], v26 offset:8704
v_add_f32 v61, 2.0, v45
v_add_f32 v62, 2.0, v46
v_add_f32 v63, 2.0, v47
v_pk_fma_f32 v[32:33], v[32:33], v[48:49], v[16:17] op_sel:[0,0,0] op_sel_hi:[1,1,0]
v_pk_fma_f32 v[34:35], v[34:35], v[50:51], v[16:17] op_sel:[0,0,0] op_sel_hi:[1,1,0]
v_pk_fma_f32 v[36:37], v[36:37], v[52:53], v[16:17] op_sel:[0,0,0] op_sel_hi:[1,1,0]
v_pk_fma_f32 v[38:39], v[38:39], v[54:55], v[16:17] op_sel:[0,0,0] op_sel_hi:[1,1,0]
v_pk_fma_f32 v[40:41], v[40:41], v[56:57], v[16:17] op_sel:[0,0,0] op_sel_hi:[1,1,0]
v_pk_fma_f32 v[42:43], v[42:43], v[58:59], v[16:17] op_sel:[0,0,0] op_sel_hi:[1,1,0]
v_pk_fma_f32 v[44:45], v[44:45], v[60:61], v[16:17] op_sel:[0,0,0] op_sel_hi:[1,1,0]
v_pk_fma_f32 v[46:47], v[46:47], v[62:63], v[16:17] op_sel:[0,0,0] op_sel_hi:[1,1,0]
v_mfma_f32_32x32x16_bf16 v[224:239], a[180:183], a[40:43], v[224:239]
s_waitcnt lgkmcnt(6)
buffer_load_dwordx4 v20, s[12:15], s41 offen offset:0 lds
ds_read_b64_tr_b16 a[156:157], v26 offset:8448
ds_read_b64_tr_b16 a[158:159], v26 offset:8960
v_mfma_f32_32x32x16_bf16 v[208:223], a[184:187], a[44:47], v[208:223]
ds_read_b64_tr_b16 a[160:161], v26 offset:10240
ds_read_b64_tr_b16 a[162:163], v26 offset:10752
ds_read_b128 v[48:51], v30 offset:384
ds_read_b128 v[52:55], v30 offset:416
ds_read_b128 v[56:59], v30 offset:448
ds_read_b128 v[60:63], v30 offset:480
v_mfma_f32_32x32x16_bf16 v[224:239], a[188:191], a[44:47], v[224:239]
s_waitcnt lgkmcnt(10)
ds_read_b64_tr_b16 a[164:165], v26 offset:10496
ds_read_b64_tr_b16 a[166:167], v26 offset:11008
L_pad_f3_0:
s_cbranch_execz L_pad_f3_1
v_rcp_f32 v32, v32
v_rcp_f32 v33, v33
v_mfma_f32_32x32x16_bf16 v[208:223], a[144:147], a[48:51], v[208:223]
buffer_load_dwordx4 v21, s[12:15], s41 offen offset:1024 lds
ds_read_b64_tr_b16 a[168:169], v27 offset:6144
ds_read_b64_tr_b16 a[170:171], v27 offset:6656
v_mfma_f32_32x32x16_bf16 v[224:239], a[148:151], a[48:51], v[224:239]
s_waitcnt lgkmcnt(10)
ds_read_b64_tr_b16 a[172:173], v27 offset:6400
ds_read_b64_tr_b16 a[174:175], v27 offset:6912
v_rcp_f32 v34, v34
v_rcp_f32 v35, v35
v_mfma_f32_32x32x16_bf16 v[208:223], a[152:155], a[52:55], v[208:223]
ds_read_b64_tr_b16 a[176:177], v27 offset:8192
ds_read_b64_tr_b16 a[178:179], v27 offset:8704
v_rcp_f32 v36, v36
v_rcp_f32 v37, v37
v_mfma_f32_32x32x16_bf16 v[224:239], a[156:159], a[52:55], v[224:239]
s_waitcnt lgkmcnt(6)
buffer_load_dwordx4 v22, s[12:15], s41 offen offset:2048 lds
ds_read_b64_tr_b16 a[180:181], v27 offset:8448
ds_read_b64_tr_b16 a[182:183], v27 offset:8960
v_mfma_f32_32x32x16_bf16 v[208:223], a[160:163], a[56:59], v[208:223]
s_add_u32 m0, s35, 0
ds_read_b64_tr_b16 a[184:185], v27 offset:10240
ds_read_b64_tr_b16 a[186:187], v27 offset:10752
v_rcp_f32 v38, v38
v_rcp_f32 v39, v39
v_mfma_f32_32x32x16_bf16 v[224:239], a[164:167], a[56:59], v[224:239]
s_waitcnt lgkmcnt(6)
s_add_u32 s41, s60, 512
ds_read_b64_tr_b16 a[188:189], v27 offset:10496
ds_read_b64_tr_b16 a[190:191], v27 offset:11008
v_rcp_f32 v40, v40
v_rcp_f32 v41, v41
v_mfma_f32_32x32x16_bf16 v[208:223], a[168:171], a[60:63], v[208:223]
ds_read_b64_tr_b16 a[144:145], v28 offset:6144
ds_read_b64_tr_b16 a[146:147], v28 offset:6656
v_rcp_f32 v42, v42
v_rcp_f32 v43, v43
v_mfma_f32_32x32x16_bf16 v[224:239], a[172:175], a[60:63], v[224:239]
s_waitcnt lgkmcnt(6)
ds_read_b64_tr_b16 a[148:149], v28 offset:6400
ds_read_b64_tr_b16 a[150:151], v28 offset:6912
v_rcp_f32 v44, v44
v_rcp_f32 v45, v45
v_mfma_f32_32x32x16_bf16 v[208:223], a[176:179], a[64:67], v[208:223]
ds_read_b64_tr_b16 a[152:153], v28 offset:8192
ds_read_b64_tr_b16 a[154:155], v28 offset:8704
v_rcp_f32 v46, v46
v_mfma_f32_32x32x16_bf16 v[224:239], a[180:183], a[64:67], v[224:239]
s_waitcnt lgkmcnt(6)
ds_read_b64_tr_b16 a[156:157], v28 offset:8448
ds_read_b64_tr_b16 a[158:159], v28 offset:8960
v_rcp_f32 v47, v47
v_pk_fma_f32 v[32:33], v[32:33], v[14:15], v[30:31] op_sel:[0,1,1] op_sel_hi:[1,1,1]
v_pk_fma_f32 v[34:35], v[34:35], v[14:15], v[30:31] op_sel:[0,1,1] op_sel_hi:[1,1,1]
v_pk_fma_f32 v[36:37], v[36:37], v[14:15], v[30:31] op_sel:[0,1,1] op_sel_hi:[1,1,1]
v_pk_fma_f32 v[38:39], v[38:39], v[14:15], v[30:31] op_sel:[0,1,1] op_sel_hi:[1,1,1]
v_pk_fma_f32 v[40:41], v[40:41], v[14:15], v[30:31] op_sel:[0,1,1] op_sel_hi:[1,1,1]
v_pk_fma_f32 v[42:43], v[42:43], v[14:15], v[30:31] op_sel:[0,1,1] op_sel_hi:[1,1,1]
v_pk_fma_f32 v[44:45], v[44:45], v[14:15], v[30:31] op_sel:[0,1,1] op_sel_hi:[1,1,1]
v_pk_fma_f32 v[46:47], v[46:47], v[14:15], v[30:31] op_sel:[0,1,1] op_sel_hi:[1,1,1]
v_pk_mul_f32 v[64:65], v[64:65], v[32:33] op_sel:[0,0] op_sel_hi:[1,1]
v_pk_mul_f32 v[66:67], v[66:67], v[34:35] op_sel:[0,0] op_sel_hi:[1,1]
v_pk_mul_f32 v[68:69], v[68:69], v[36:37] op_sel:[0,0] op_sel_hi:[1,1]
v_pk_mul_f32 v[70:71], v[70:71], v[38:39] op_sel:[0,0] op_sel_hi:[1,1]
v_pk_mul_f32 v[72:73], v[72:73], v[40:41] op_sel:[0,0] op_sel_hi:[1,1]
v_pk_mul_f32 v[74:75], v[74:75], v[42:43] op_sel:[0,0] op_sel_hi:[1,1]
v_pk_mul_f32 v[76:77], v[76:77], v[44:45] op_sel:[0,0] op_sel_hi:[1,1]
v_pk_mul_f32 v[78:79], v[78:79], v[46:47] op_sel:[0,0] op_sel_hi:[1,1]
v_pk_fma_f32 v[80:81], v[80:81], v[14:15], v[48:49] op_sel:[0,0,0] op_sel_hi:[1,0,1]
v_pk_fma_f32 v[82:83], v[82:83], v[14:15], v[50:51] op_sel:[0,0,0] op_sel_hi:[1,0,1]
v_pk_fma_f32 v[84:85], v[84:85], v[14:15], v[52:53] op_sel:[0,0,0] op_sel_hi:[1,0,1]
v_pk_fma_f32 v[86:87], v[86:87], v[14:15], v[54:55] op_sel:[0,0,0] op_sel_hi:[1,0,1]
v_pk_fma_f32 v[88:89], v[88:89], v[14:15], v[56:57] op_sel:[0,0,0] op_sel_hi:[1,0,1]
v_pk_fma_f32 v[90:91], v[90:91], v[14:15], v[58:59] op_sel:[0,0,0] op_sel_hi:[1,0,1]
v_pk_fma_f32 v[92:93], v[92:93], v[14:15], v[60:61] op_sel:[0,0,0] op_sel_hi:[1,0,1]
v_pk_fma_f32 v[94:95], v[94:95], v[14:15], v[62:63] op_sel:[0,0,0] op_sel_hi:[1,0,1]
v_mfma_f32_32x32x16_bf16 v[208:223], a[184:187], a[68:71], v[208:223]
ds_read_b64_tr_b16 a[160:161], v28 offset:10240
ds_read_b64_tr_b16 a[162:163], v28 offset:10752
v_cvt_pk_bf16_f32 v112, v64, v65
v_cvt_pk_bf16_f32 v113, v66, v67
v_cvt_pk_bf16_f32 v114, v68, v69
v_cvt_pk_bf16_f32 v115, v70, v71
v_mfma_f32_32x32x16_bf16 v[224:239], a[188:191], a[68:71], v[224:239]
s_waitcnt lgkmcnt(6)
ds_read_b64_tr_b16 a[164:165], v28 offset:10496
ds_read_b64_tr_b16 a[166:167], v28 offset:11008
v_cvt_pk_bf16_f32 v116, v72, v73
v_cvt_pk_bf16_f32 v117, v74, v75
v_cvt_pk_bf16_f32 v118, v76, v77
v_cvt_pk_bf16_f32 v119, v78, v79
s_waitcnt vmcnt(20)
s_barrier
v_mfma_f32_32x32x16_bf16 v[208:223], a[144:147], a[72:75], v[208:223]
s_add_u32 s63, s51, 73728
buffer_load_dword a241, v246, s[16:19], s63 offen
ds_read_b64_tr_b16 a[168:169], v29 offset:6144
ds_read_b64_tr_b16 a[170:171], v29 offset:6656
v_mfma_f32_32x32x16_bf16 v[224:239], a[148:151], a[72:75], v[224:239]
s_waitcnt lgkmcnt(6)
ds_read_b64_tr_b16 a[172:173], v29 offset:6400
ds_read_b64_tr_b16 a[174:175], v29 offset:6912
v_exp_f32 v32, v80
v_exp_f32 v33, v81
v_mfma_f32_32x32x16_bf16 v[208:223], a[152:155], a[76:79], v[208:223]
ds_read_b64_tr_b16 a[176:177], v29 offset:8192
ds_read_b64_tr_b16 a[178:179], v29 offset:8704
v_exp_f32 v34, v82
v_exp_f32 v35, v83
v_mfma_f32_32x32x16_bf16 v[224:239], a[156:159], a[76:79], v[224:239]
s_waitcnt lgkmcnt(6)
buffer_load_dwordx4 v20, s[12:15], s41 offen offset:0 lds
ds_read_b64_tr_b16 a[180:181], v29 offset:8448
ds_read_b64_tr_b16 a[182:183], v29 offset:8960
v_mfma_f32_32x32x16_bf16 v[208:223], a[160:163], a[80:83], v[208:223]
ds_read_b64_tr_b16 a[184:185], v29 offset:10240
ds_read_b64_tr_b16 a[186:187], v29 offset:10752
v_exp_f32 v36, v84
v_exp_f32 v37, v85
v_mfma_f32_32x32x16_bf16 v[224:239], a[164:167], a[80:83], v[224:239]
s_waitcnt lgkmcnt(6)
ds_read_b64_tr_b16 a[188:189], v29 offset:10496
ds_read_b64_tr_b16 a[190:191], v29 offset:11008
v_exp_f32 v38, v86
v_exp_f32 v39, v87
v_mfma_f32_32x32x16_bf16 v[208:223], a[168:171], a[84:87], v[208:223]
buffer_load_dwordx4 v21, s[12:15], s41 offen offset:1024 lds
ds_read_b64_tr_b16 a[144:145], v26 offset:12288
ds_read_b64_tr_b16 a[146:147], v26 offset:12800
v_mfma_f32_32x32x16_bf16 v[224:239], a[172:175], a[84:87], v[224:239]
s_waitcnt lgkmcnt(6)
ds_read_b64_tr_b16 a[148:149], v26 offset:12544
ds_read_b64_tr_b16 a[150:151], v26 offset:13056
v_exp_f32 v40, v88
v_exp_f32 v41, v89
v_mfma_f32_32x32x16_bf16 v[208:223], a[176:179], a[88:91], v[208:223]
ds_read_b64_tr_b16 a[152:153], v26 offset:14336
ds_read_b64_tr_b16 a[154:155], v26 offset:14848
v_exp_f32 v42, v90
v_exp_f32 v43, v91
v_mfma_f32_32x32x16_bf16 v[224:239], a[180:183], a[88:91], v[224:239]
s_waitcnt lgkmcnt(6)
buffer_load_dwordx4 v22, s[12:15], s41 offen offset:2048 lds
ds_read_b64_tr_b16 a[156:157], v26 offset:14592
ds_read_b64_tr_b16 a[158:159], v26 offset:15104
v_mfma_f32_32x32x16_bf16 v[208:223], a[184:187], a[92:95], v[208:223]
s_add_u32 m0, s35, 3072
ds_read_b64_tr_b16 a[160:161], v26 offset:16384
ds_read_b64_tr_b16 a[162:163], v26 offset:16896
v_exp_f32 v44, v92
v_exp_f32 v45, v93
v_mfma_f32_32x32x16_bf16 v[224:239], a[188:191], a[92:95], v[224:239]
s_waitcnt lgkmcnt(6)
s_add_u32 s41, s60, 221696
ds_read_b64_tr_b16 a[164:165], v26 offset:16640
ds_read_b64_tr_b16 a[166:167], v26 offset:17152
v_exp_f32 v46, v94
v_exp_f32 v47, v95
v_mfma_f32_32x32x16_bf16 v[208:223], a[144:147], a[96:99], v[208:223]
buffer_load_dwordx4 v20, s[12:15], s41 offen offset:0 lds
ds_read_b64_tr_b16 a[168:169], v27 offset:12288
ds_read_b64_tr_b16 a[170:171], v27 offset:12800
v_mfma_f32_32x32x16_bf16 v[224:239], a[148:151], a[96:99], v[224:239]
s_waitcnt lgkmcnt(6)
ds_read_b64_tr_b16 a[172:173], v27 offset:12544
ds_read_b64_tr_b16 a[174:175], v27 offset:13056
v_add_f32 v48, 2.0, v32
v_add_f32 v49, 2.0, v33
v_add_f32 v50, 2.0, v34
v_add_f32 v51, 2.0, v35
v_mfma_f32_32x32x16_bf16 v[208:223], a[152:155], a[100:103], v[208:223]
ds_read_b64_tr_b16 a[176:177], v27 offset:14336
ds_read_b64_tr_b16 a[178:179], v27 offset:14848
v_add_f32 v52, 2.0, v36
v_add_f32 v53, 2.0, v37
v_add_f32 v54, 2.0, v38
v_add_f32 v55, 2.0, v39
v_mfma_f32_32x32x16_bf16 v[224:239], a[156:159], a[100:103], v[224:239]
s_waitcnt lgkmcnt(6)
buffer_load_dwordx4 v21, s[12:15], s41 offen offset:1024 lds
ds_read_b64_tr_b16 a[180:181], v27 offset:14592
ds_read_b64_tr_b16 a[182:183], v27 offset:15104
v_mfma_f32_32x32x16_bf16 v[208:223], a[160:163], a[104:107], v[208:223]
ds_read_b64_tr_b16 a[184:185], v27 offset:16384
ds_read_b64_tr_b16 a[186:187], v27 offset:16896
v_add_f32 v56, 2.0, v40
v_add_f32 v57, 2.0, v41
v_add_f32 v58, 2.0, v42
v_add_f32 v59, 2.0, v43
v_mfma_f32_32x32x16_bf16 v[224:239], a[164:167], a[104:107], v[224:239]
s_waitcnt lgkmcnt(6)
ds_read_b64_tr_b16 a[188:189], v27 offset:16640
ds_read_b64_tr_b16 a[190:191], v27 offset:17152
v_add_f32 v60, 2.0, v44
v_add_f32 v61, 2.0, v45
v_add_f32 v62, 2.0, v46
v_add_f32 v63, 2.0, v47
v_pk_fma_f32 v[32:33], v[32:33], v[48:49], v[16:17] op_sel:[0,0,0] op_sel_hi:[1,1,0]
v_pk_fma_f32 v[34:35], v[34:35], v[50:51], v[16:17] op_sel:[0,0,0] op_sel_hi:[1,1,0]
v_pk_fma_f32 v[36:37], v[36:37], v[52:53], v[16:17] op_sel:[0,0,0] op_sel_hi:[1,1,0]
v_pk_fma_f32 v[38:39], v[38:39], v[54:55], v[16:17] op_sel:[0,0,0] op_sel_hi:[1,1,0]
v_pk_fma_f32 v[40:41], v[40:41], v[56:57], v[16:17] op_sel:[0,0,0] op_sel_hi:[1,1,0]
v_pk_fma_f32 v[42:43], v[42:43], v[58:59], v[16:17] op_sel:[0,0,0] op_sel_hi:[1,1,0]
v_pk_fma_f32 v[44:45], v[44:45], v[60:61], v[16:17] op_sel:[0,0,0] op_sel_hi:[1,1,0]
v_pk_fma_f32 v[46:47], v[46:47], v[62:63], v[16:17] op_sel:[0,0,0] op_sel_hi:[1,1,0]
v_mfma_f32_32x32x16_bf16 v[208:223], a[168:171], a[108:111], v[208:223]
buffer_load_dwordx4 v22, s[12:15], s41 offen offset:2048 lds
ds_read_b64_tr_b16 a[144:145], v28 offset:12288
ds_read_b64_tr_b16 a[146:147], v28 offset:12800
v_mfma_f32_32x32x16_bf16 v[224:239], a[172:175], a[108:111], v[224:239]
s_waitcnt lgkmcnt(6)
s_add_u32 m0, s35, 6144
ds_read_b64_tr_b16 a[148:149], v28 offset:12544
ds_read_b64_tr_b16 a[150:151], v28 offset:13056
v_rcp_f32 v32, v32
v_rcp_f32 v33, v33
v_mfma_f32_32x32x16_bf16 v[208:223], a[176:179], a[112:115], v[208:223]
s_add_u32 s41, s61, 512
ds_read_b64_tr_b16 a[152:153], v28 offset:14336
ds_read_b64_tr_b16 a[154:155], v28 offset:14848
v_rcp_f32 v34, v34
v_rcp_f32 v35, v35
v_mfma_f32_32x32x16_bf16 v[224:239], a[180:183], a[112:115], v[224:239]
s_waitcnt lgkmcnt(6)
ds_read_b64_tr_b16 a[156:157], v28 offset:14592
ds_read_b64_tr_b16 a[158:159], v28 offset:15104
v_rcp_f32 v36, v36
v_rcp_f32 v37, v37
v_mfma_f32_32x32x16_bf16 v[208:223], a[184:187], a[116:119], v[208:223]
ds_read_b64_tr_b16 a[160:161], v28 offset:16384
ds_read_b64_tr_b16 a[162:163], v28 offset:16896
v_rcp_f32 v38, v38
v_rcp_f32 v39, v39
v_mfma_f32_32x32x16_bf16 v[224:239], a[188:191], a[116:119], v[224:239]
s_waitcnt lgkmcnt(6)
ds_read_b64_tr_b16 a[164:165], v28 offset:16640
ds_read_b64_tr_b16 a[166:167], v28 offset:17152
v_rcp_f32 v40, v40
v_rcp_f32 v41, v41
s_waitcnt vmcnt(20)
s_barrier
v_mfma_f32_32x32x16_bf16 v[208:223], a[144:147], a[120:123], v[208:223]
buffer_load_dwordx4 v20, s[12:15], s41 offen offset:0 lds
ds_read_b64_tr_b16 a[168:169], v29 offset:12288
ds_read_b64_tr_b16 a[170:171], v29 offset:12800
v_mfma_f32_32x32x16_bf16 v[224:239], a[148:151], a[120:123], v[224:239]
s_waitcnt lgkmcnt(6)
ds_read_b64_tr_b16 a[172:173], v29 offset:12544
ds_read_b64_tr_b16 a[174:175], v29 offset:13056
v_rcp_f32 v42, v42
v_rcp_f32 v43, v43
v_mfma_f32_32x32x16_bf16 v[208:223], a[152:155], a[124:127], v[208:223]
ds_read_b64_tr_b16 a[176:177], v29 offset:14336
ds_read_b64_tr_b16 a[178:179], v29 offset:14848
v_rcp_f32 v44, v44
v_rcp_f32 v45, v45
v_mfma_f32_32x32x16_bf16 v[224:239], a[156:159], a[124:127], v[224:239]
s_waitcnt lgkmcnt(6)
buffer_load_dwordx4 v21, s[12:15], s41 offen offset:1024 lds
ds_read_b64_tr_b16 a[180:181], v29 offset:14592
ds_read_b64_tr_b16 a[182:183], v29 offset:15104
v_mfma_f32_32x32x16_bf16 v[208:223], a[160:163], a[128:131], v[208:223]
ds_read_b64_tr_b16 a[184:185], v29 offset:16384
ds_read_b64_tr_b16 a[186:187], v29 offset:16896
v_rcp_f32 v46, v46
v_rcp_f32 v47, v47
v_pk_fma_f32 v[32:33], v[32:33], v[14:15], v[30:31] op_sel:[0,1,1] op_sel_hi:[1,1,1]
v_pk_fma_f32 v[34:35], v[34:35], v[14:15], v[30:31] op_sel:[0,1,1] op_sel_hi:[1,1,1]
v_pk_fma_f32 v[36:37], v[36:37], v[14:15], v[30:31] op_sel:[0,1,1] op_sel_hi:[1,1,1]
v_pk_fma_f32 v[38:39], v[38:39], v[14:15], v[30:31] op_sel:[0,1,1] op_sel_hi:[1,1,1]
v_pk_fma_f32 v[40:41], v[40:41], v[14:15], v[30:31] op_sel:[0,1,1] op_sel_hi:[1,1,1]
v_pk_fma_f32 v[42:43], v[42:43], v[14:15], v[30:31] op_sel:[0,1,1] op_sel_hi:[1,1,1]
v_pk_fma_f32 v[44:45], v[44:45], v[14:15], v[30:31] op_sel:[0,1,1] op_sel_hi:[1,1,1]
v_pk_fma_f32 v[46:47], v[46:47], v[14:15], v[30:31] op_sel:[0,1,1] op_sel_hi:[1,1,1]
v_pk_mul_f32 v[80:81], v[80:81], v[32:33] op_sel:[0,0] op_sel_hi:[1,1]
v_pk_mul_f32 v[82:83], v[82:83], v[34:35] op_sel:[0,0] op_sel_hi:[1,1]
v_pk_mul_f32 v[84:85], v[84:85], v[36:37] op_sel:[0,0] op_sel_hi:[1,1]
v_pk_mul_f32 v[86:87], v[86:87], v[38:39] op_sel:[0,0] op_sel_hi:[1,1]
v_pk_mul_f32 v[88:89], v[88:89], v[40:41] op_sel:[0,0] op_sel_hi:[1,1]
v_pk_mul_f32 v[90:91], v[90:91], v[42:43] op_sel:[0,0] op_sel_hi:[1,1]
v_pk_mul_f32 v[92:93], v[92:93], v[44:45] op_sel:[0,0] op_sel_hi:[1,1]
v_pk_mul_f32 v[94:95], v[94:95], v[46:47] op_sel:[0,0] op_sel_hi:[1,1]
v_mfma_f32_32x32x16_bf16 v[224:239], a[164:167], a[128:131], v[224:239]
s_waitcnt lgkmcnt(6)
ds_read_b64_tr_b16 a[188:189], v29 offset:16640
ds_read_b64_tr_b16 a[190:191], v29 offset:17152
v_cvt_pk_bf16_f32 v120, v80, v81
v_cvt_pk_bf16_f32 v121, v82, v83
v_cvt_pk_bf16_f32 v122, v84, v85
v_cvt_pk_bf16_f32 v123, v86, v87
v_mfma_f32_32x32x16_bf16 v[208:223], a[168:171], a[132:135], v[208:223]
s_add_u32 s63, s51, 147456
buffer_load_dword a242, v246, s[16:19], s63 offen
ds_read_b64_tr_b16 a[144:145], v26 offset:18432
ds_read_b64_tr_b16 a[146:147], v26 offset:18944
v_mfma_f32_32x32x16_bf16 v[224:239], a[172:175], a[132:135], v[224:239]
s_waitcnt lgkmcnt(6)
ds_read_b64_tr_b16 a[148:149], v26 offset:18688
ds_read_b64_tr_b16 a[150:151], v26 offset:19200
v_cvt_pk_bf16_f32 v124, v88, v89
v_cvt_pk_bf16_f32 v125, v90, v91
v_cvt_pk_bf16_f32 v126, v92, v93
v_cvt_pk_bf16_f32 v127, v94, v95
v_mfma_f32_32x32x16_bf16 v[208:223], a[176:179], a[136:139], v[208:223]
ds_read_b64_tr_b16 a[152:153], v26 offset:20480
ds_read_b64_tr_b16 a[154:155], v26 offset:20992
v_mfma_f32_32x32x16_bf16 v[224:239], a[180:183], a[136:139], v[224:239]
s_waitcnt lgkmcnt(6)
buffer_load_dwordx4 v22, s[12:15], s41 offen offset:2048 lds
ds_read_b64_tr_b16 a[156:157], v26 offset:20736
ds_read_b64_tr_b16 a[158:159], v26 offset:21248
v_mfma_f32_32x32x16_bf16 v[208:223], a[184:187], a[140:143], v[208:223]
s_add_u32 m0, s35, 9216
ds_read_b64_tr_b16 a[160:161], v26 offset:22528
ds_read_b64_tr_b16 a[162:163], v26 offset:23040
ds_read_b128 v[48:51], v30 offset:512
ds_read_b128 v[52:55], v30 offset:544
ds_read_b128 v[56:59], v30 offset:576
ds_read_b128 v[60:63], v30 offset:608
v_mfma_f32_32x32x16_bf16 v[224:239], a[188:191], a[140:143], v[224:239]
s_waitcnt lgkmcnt(10)
s_add_u32 s41, s61, 221696
ds_read_b64_tr_b16 a[164:165], v26 offset:22784
ds_read_b64_tr_b16 a[166:167], v26 offset:23296
v_mfma_f32_32x32x16_bf16 v[64:79], a[144:147], a[0:3], 0
buffer_load_dwordx4 v20, s[12:15], s41 offen offset:0 lds
ds_read_b64_tr_b16 a[168:169], v27 offset:18432
ds_read_b64_tr_b16 a[170:171], v27 offset:18944
v_mfma_f32_32x32x16_bf16 v[80:95], a[148:151], a[0:3], 0
s_waitcnt lgkmcnt(10)
ds_read_b64_tr_b16 a[172:173], v27 offset:18688
ds_read_b64_tr_b16 a[174:175], v27 offset:19200
v_mfma_f32_32x32x16_bf16 v[64:79], a[152:155], a[4:7], v[64:79]
ds_read_b64_tr_b16 a[176:177], v27 offset:20480
ds_read_b64_tr_b16 a[178:179], v27 offset:20992
s_waitcnt lgkmcnt(11)
v_pk_fma_f32 v[208:209], v[208:209], v[14:15], v[48:49] op_sel:[0,0,0] op_sel_hi:[1,0,1]
v_pk_fma_f32 v[210:211], v[210:211], v[14:15], v[50:51] op_sel:[0,0,0] op_sel_hi:[1,0,1]
s_waitcnt lgkmcnt(10)
v_pk_fma_f32 v[212:213], v[212:213], v[14:15], v[52:53] op_sel:[0,0,0] op_sel_hi:[1,0,1]
v_pk_fma_f32 v[214:215], v[214:215], v[14:15], v[54:55] op_sel:[0,0,0] op_sel_hi:[1,0,1]
s_waitcnt lgkmcnt(9)
v_pk_fma_f32 v[216:217], v[216:217], v[14:15], v[56:57] op_sel:[0,0,0] op_sel_hi:[1,0,1]
v_pk_fma_f32 v[218:219], v[218:219], v[14:15], v[58:59] op_sel:[0,0,0] op_sel_hi:[1,0,1]
s_waitcnt lgkmcnt(8)
v_pk_fma_f32 v[220:221], v[220:221], v[14:15], v[60:61] op_sel:[0,0,0] op_sel_hi:[1,0,1]
v_pk_fma_f32 v[222:223], v[222:223], v[14:15], v[62:63] op_sel:[0,0,0] op_sel_hi:[1,0,1]
v_mfma_f32_32x32x16_bf16 v[80:95], a[156:159], a[4:7], v[80:95]
s_waitcnt lgkmcnt(6)
buffer_load_dwordx4 v21, s[12:15], s41 offen offset:1024 lds
ds_read_b64_tr_b16 a[180:181], v27 offset:20736
ds_read_b64_tr_b16 a[182:183], v27 offset:21248
v_mfma_f32_32x32x16_bf16 v[64:79], a[160:163], a[8:11], v[64:79]
ds_read_b64_tr_b16 a[184:185], v27 offset:22528
ds_read_b64_tr_b16 a[186:187], v27 offset:23040
v_exp_f32 v32, v208
v_mfma_f32_32x32x16_bf16 v[80:95], a[164:167], a[8:11], v[80:95]
s_waitcnt lgkmcnt(6)
ds_read_b64_tr_b16 a[188:189], v27 offset:22784
ds_read_b64_tr_b16 a[190:191], v27 offset:23296
v_exp_f32 v33, v209
v_exp_f32 v34, v210
v_mfma_f32_32x32x16_bf16 v[64:79], a[168:171], a[12:15], v[64:79]
buffer_load_dwordx4 v22, s[12:15], s41 offen offset:2048 lds
ds_read_b64_tr_b16 a[144:145], v28 offset:18432
ds_read_b64_tr_b16 a[146:147], v28 offset:18944
v_mfma_f32_32x32x16_bf16 v[80:95], a[172:175], a[12:15], v[80:95]
s_waitcnt lgkmcnt(6)
s_add_u32 m0, s35, 12288
ds_read_b64_tr_b16 a[148:149], v28 offset:18688
ds_read_b64_tr_b16 a[150:151], v28 offset:19200
v_exp_f32 v35, v211
v_exp_f32 v36, v212
v_mfma_f32_32x32x16_bf16 v[64:79], a[176:179], a[16:19], v[64:79]
s_add_u32 s41, s62, 512
ds_read_b64_tr_b16 a[152:153], v28 offset:20480
ds_read_b64_tr_b16 a[154:155], v28 offset:20992
v_exp_f32 v37, v213
v_exp_f32 v38, v214
v_mfma_f32_32x32x16_bf16 v[80:95], a[180:183], a[16:19], v[80:95]
s_waitcnt lgkmcnt(6)
ds_read_b64_tr_b16 a[156:157], v28 offset:20736
ds_read_b64_tr_b16 a[158:159], v28 offset:21248
v_exp_f32 v39, v215
v_exp_f32 v40, v216
v_mfma_f32_32x32x16_bf16 v[64:79], a[184:187], a[20:23], v[64:79]
ds_read_b64_tr_b16 a[160:161], v28 offset:22528
ds_read_b64_tr_b16 a[162:163], v28 offset:23040
v_exp_f32 v41, v217
v_exp_f32 v42, v218
v_mfma_f32_32x32x16_bf16 v[80:95], a[188:191], a[20:23], v[80:95]
s_waitcnt lgkmcnt(6)
ds_read_b64_tr_b16 a[164:165], v28 offset:22784
ds_read_b64_tr_b16 a[166:167], v28 offset:23296
v_exp_f32 v43, v219
v_exp_f32 v44, v220
s_waitcnt vmcnt(21)
s_barrier
v_mfma_f32_32x32x16_bf16 v[64:79], a[144:147], a[24:27], v[64:79]
buffer_load_dwordx4 v20, s[12:15], s41 offen offset:0 lds
ds_read_b64_tr_b16 a[168:169], v29 offset:18432
ds_read_b64_tr_b16 a[170:171], v29 offset:18944
v_mfma_f32_32x32x16_bf16 v[80:95], a[148:151], a[24:27], v[80:95]
s_waitcnt lgkmcnt(6)
ds_read_b64_tr_b16 a[172:173], v29 offset:18688
ds_read_b64_tr_b16 a[174:175], v29 offset:19200
v_exp_f32 v45, v221
v_exp_f32 v46, v222
v_mfma_f32_32x32x16_bf16 v[64:79], a[152:155], a[28:31], v[64:79]
ds_read_b64_tr_b16 a[176:177], v29 offset:20480
ds_read_b64_tr_b16 a[178:179], v29 offset:20992
v_exp_f32 v47, v223
v_add_f32 v48, 2.0, v32
v_mfma_f32_32x32x16_bf16 v[80:95], a[156:159], a[28:31], v[80:95]
s_waitcnt lgkmcnt(6)
buffer_load_dwordx4 v21, s[12:15], s41 offen offset:1024 lds
ds_read_b64_tr_b16 a[180:181], v29 offset:20736
ds_read_b64_tr_b16 a[182:183], v29 offset:21248
v_mfma_f32_32x32x16_bf16 v[64:79], a[160:163], a[32:35], v[64:79]
ds_read_b64_tr_b16 a[184:185], v29 offset:22528
ds_read_b64_tr_b16 a[186:187], v29 offset:23040
v_add_f32 v49, 2.0, v33
v_add_f32 v50, 2.0, v34
v_add_f32 v51, 2.0, v35
v_add_f32 v52, 2.0, v36
v_mfma_f32_32x32x16_bf16 v[80:95], a[164:167], a[32:35], v[80:95]
s_waitcnt lgkmcnt(6)
ds_read_b64_tr_b16 a[188:189], v29 offset:22784
ds_read_b64_tr_b16 a[190:191], v29 offset:23296
v_add_f32 v53, 2.0, v37
v_add_f32 v54, 2.0, v38
v_add_f32 v55, 2.0, v39
v_add_f32 v56, 2.0, v40
v_mfma_f32_32x32x16_bf16 v[64:79], a[168:171], a[36:39], v[64:79]
buffer_load_dwordx4 v22, s[12:15], s41 offen offset:2048 lds
ds_read_b64_tr_b16 a[144:145], v26 offset:24576
ds_read_b64_tr_b16 a[146:147], v26 offset:25088
v_mfma_f32_32x32x16_bf16 v[80:95], a[172:175], a[36:39], v[80:95]
s_waitcnt lgkmcnt(6)
s_add_u32 m0, s35, 15360
ds_read_b64_tr_b16 a[148:149], v26 offset:24832
ds_read_b64_tr_b16 a[150:151], v26 offset:25344
v_add_f32 v57, 2.0, v41
v_add_f32 v58, 2.0, v42
v_add_f32 v59, 2.0, v43
v_add_f32 v60, 2.0, v44
v_mfma_f32_32x32x16_bf16 v[64:79], a[176:179], a[40:43], v[64:79]
s_add_u32 s41, s62, 221696
ds_read_b64_tr_b16 a[152:153], v26 offset:26624
ds_read_b64_tr_b16 a[154:155], v26 offset:27136
v_add_f32 v61, 2.0, v45
v_add_f32 v62, 2.0, v46
v_add_f32 v63, 2.0, v47
v_pk_fma_f32 v[32:33], v[32:33], v[48:49], v[16:17] op_sel:[0,0,0] op_sel_hi:[1,1,0]
v_pk_fma_f32 v[34:35], v[34:35], v[50:51], v[16:17] op_sel:[0,0,0] op_sel_hi:[1,1,0]
v_pk_fma_f32 v[36:37], v[36:37], v[52:53], v[16:17] op_sel:[0,0,0] op_sel_hi:[1,1,0]
v_pk_fma_f32 v[38:39], v[38:39], v[54:55], v[16:17] op_sel:[0,0,0] op_sel_hi:[1,1,0]
v_pk_fma_f32 v[40:41], v[40:41], v[56:57], v[16:17] op_sel:[0,0,0] op_sel_hi:[1,1,0]
v_pk_fma_f32 v[42:43], v[42:43], v[58:59], v[16:17] op_sel:[0,0,0] op_sel_hi:[1,1,0]
v_pk_fma_f32 v[44:45], v[44:45], v[60:61], v[16:17] op_sel:[0,0,0] op_sel_hi:[1,1,0]
v_pk_fma_f32 v[46:47], v[46:47], v[62:63], v[16:17] op_sel:[0,0,0] op_sel_hi:[1,1,0]
v_mfma_f32_32x32x16_bf16 v[80:95], a[180:183], a[40:43], v[80:95]
s_waitcnt lgkmcnt(6)
buffer_load_dwordx4 v20, s[12:15], s41 offen offset:0 lds
ds_read_b64_tr_b16 a[156:157], v26 offset:26880
ds_read_b64_tr_b16 a[158:159], v26 offset:27392
v_mfma_f32_32x32x16_bf16 v[64:79], a[184:187], a[44:47], v[64:79]
ds_read_b64_tr_b16 a[160:161], v26 offset:28672
ds_read_b64_tr_b16 a[162:163], v26 offset:29184
ds_read_b128 v[48:51], v30 offset:640
ds_read_b128 v[52:55], v30 offset:672
ds_read_b128 v[56:59], v30 offset:704
ds_read_b128 v[60:63], v30 offset:736
v_mfma_f32_32x32x16_bf16 v[80:95], a[188:191], a[44:47], v[80:95]
s_waitcnt lgkmcnt(10)
ds_read_b64_tr_b16 a[164:165], v26 offset:28928
ds_read_b64_tr_b16 a[166:167], v26 offset:29440
v_rcp_f32 v32, v32
v_rcp_f32 v33, v33
v_mfma_f32_32x32x16_bf16 v[64:79], a[144:147], a[48:51], v[64:79]
s_add_u32 s63, s51, 221184
buffer_load_dword a243, v246, s[16:19], s63 offen
ds_read_b64_tr_b16 a[168:169], v27 offset:24576
ds_read_b64_tr_b16 a[170:171], v27 offset:25088
v_mfma_f32_32x32x16_bf16 v[80:95], a[148:151], a[48:51], v[80:95]
s_waitcnt lgkmcnt(10)
ds_read_b64_tr_b16 a[172:173], v27 offset:24832
ds_read_b64_tr_b16 a[174:175], v27 offset:25344
v_rcp_f32 v34, v34
v_rcp_f32 v35, v35
v_mfma_f32_32x32x16_bf16 v[64:79], a[152:155], a[52:55], v[64:79]
ds_read_b64_tr_b16 a[176:177], v27 offset:26624
ds_read_b64_tr_b16 a[178:179], v27 offset:27136
v_rcp_f32 v36, v36
v_rcp_f32 v37, v37
v_mfma_f32_32x32x16_bf16 v[80:95], a[156:159], a[52:55], v[80:95]
s_waitcnt lgkmcnt(6)
buffer_load_dwordx4 v21, s[12:15], s41 offen offset:1024 lds
ds_read_b64_tr_b16 a[180:181], v27 offset:26880
ds_read_b64_tr_b16 a[182:183], v27 offset:27392
v_mfma_f32_32x32x16_bf16 v[64:79], a[160:163], a[56:59], v[64:79]
ds_read_b64_tr_b16 a[184:185], v27 offset:28672
ds_read_b64_tr_b16 a[186:187], v27 offset:29184
v_rcp_f32 v38, v38
v_rcp_f32 v39, v39
v_mfma_f32_32x32x16_bf16 v[80:95], a[164:167], a[56:59], v[80:95]
s_waitcnt lgkmcnt(6)
ds_read_b64_tr_b16 a[188:189], v27 offset:28928
ds_read_b64_tr_b16 a[190:191], v27 offset:29440
v_rcp_f32 v40, v40
v_rcp_f32 v41, v41
v_mfma_f32_32x32x16_bf16 v[64:79], a[168:171], a[60:63], v[64:79]
buffer_load_dwordx4 v22, s[12:15], s41 offen offset:2048 lds
ds_read_b64_tr_b16 a[144:145], v28 offset:24576
ds_read_b64_tr_b16 a[146:147], v28 offset:25088
v_mfma_f32_32x32x16_bf16 v[80:95], a[172:175], a[60:63], v[80:95]
s_waitcnt lgkmcnt(6)
s_add_u32 m0, s35, 18432
ds_read_b64_tr_b16 a[148:149], v28 offset:24832
ds_read_b64_tr_b16 a[150:151], v28 offset:25344
v_rcp_f32 v42, v42
v_rcp_f32 v43, v43
v_mfma_f32_32x32x16_bf16 v[64:79], a[176:179], a[64:67], v[64:79]
s_add_u32 s41, s60, 640
ds_read_b64_tr_b16 a[152:153], v28 offset:26624
ds_read_b64_tr_b16 a[154:155], v28 offset:27136
v_rcp_f32 v44, v44
v_rcp_f32 v45, v45
v_mfma_f32_32x32x16_bf16 v[80:95], a[180:183], a[64:67], v[80:95]
s_waitcnt lgkmcnt(6)
ds_read_b64_tr_b16 a[156:157], v28 offset:26880
ds_read_b64_tr_b16 a[158:159], v28 offset:27392
v_rcp_f32 v46, v46
v_rcp_f32 v47, v47
v_pk_fma_f32 v[32:33], v[32:33], v[14:15], v[30:31] op_sel:[0,1,1] op_sel_hi:[1,1,1]
v_pk_fma_f32 v[34:35], v[34:35], v[14:15], v[30:31] op_sel:[0,1,1] op_sel_hi:[1,1,1]
v_pk_fma_f32 v[36:37], v[36:37], v[14:15], v[30:31] op_sel:[0,1,1] op_sel_hi:[1,1,1]
v_pk_fma_f32 v[38:39], v[38:39], v[14:15], v[30:31] op_sel:[0,1,1] op_sel_hi:[1,1,1]
v_pk_fma_f32 v[40:41], v[40:41], v[14:15], v[30:31] op_sel:[0,1,1] op_sel_hi:[1,1,1]
v_pk_fma_f32 v[42:43], v[42:43], v[14:15], v[30:31] op_sel:[0,1,1] op_sel_hi:[1,1,1]
v_pk_fma_f32 v[44:45], v[44:45], v[14:15], v[30:31] op_sel:[0,1,1] op_sel_hi:[1,1,1]
v_pk_fma_f32 v[46:47], v[46:47], v[14:15], v[30:31] op_sel:[0,1,1] op_sel_hi:[1,1,1]
v_pk_mul_f32 v[208:209], v[208:209], v[32:33] op_sel:[0,0] op_sel_hi:[1,1]
v_pk_mul_f32 v[210:211], v[210:211], v[34:35] op_sel:[0,0] op_sel_hi:[1,1]
v_pk_mul_f32 v[212:213], v[212:213], v[36:37] op_sel:[0,0] op_sel_hi:[1,1]
v_pk_mul_f32 v[214:215], v[214:215], v[38:39] op_sel:[0,0] op_sel_hi:[1,1]
v_pk_mul_f32 v[216:217], v[216:217], v[40:41] op_sel:[0,0] op_sel_hi:[1,1]
v_pk_mul_f32 v[218:219], v[218:219], v[42:43] op_sel:[0,0] op_sel_hi:[1,1]
v_pk_mul_f32 v[220:221], v[220:221], v[44:45] op_sel:[0,0] op_sel_hi:[1,1]
v_pk_mul_f32 v[222:223], v[222:223], v[46:47] op_sel:[0,0] op_sel_hi:[1,1]
v_pk_fma_f32 v[224:225], v[224:225], v[14:15], v[48:49] op_sel:[0,0,0] op_sel_hi:[1,0,1]
v_pk_fma_f32 v[226:227], v[226:227], v[14:15], v[50:51] op_sel:[0,0,0] op_sel_hi:[1,0,1]
v_pk_fma_f32 v[228:229], v[228:229], v[14:15], v[52:53] op_sel:[0,0,0] op_sel_hi:[1,0,1]
v_pk_fma_f32 v[230:231], v[230:231], v[14:15], v[54:55] op_sel:[0,0,0] op_sel_hi:[1,0,1]
v_pk_fma_f32 v[232:233], v[232:233], v[14:15], v[56:57] op_sel:[0,0,0] op_sel_hi:[1,0,1]
v_pk_fma_f32 v[234:235], v[234:235], v[14:15], v[58:59] op_sel:[0,0,0] op_sel_hi:[1,0,1]
v_pk_fma_f32 v[236:237], v[236:237], v[14:15], v[60:61] op_sel:[0,0,0] op_sel_hi:[1,0,1]
v_pk_fma_f32 v[238:239], v[238:239], v[14:15], v[62:63] op_sel:[0,0,0] op_sel_hi:[1,0,1]
v_mfma_f32_32x32x16_bf16 v[64:79], a[184:187], a[68:71], v[64:79]
ds_read_b64_tr_b16 a[160:161], v28 offset:28672
ds_read_b64_tr_b16 a[162:163], v28 offset:29184
v_cvt_pk_bf16_f32 v128, v208, v209
v_cvt_pk_bf16_f32 v129, v210, v211
v_cvt_pk_bf16_f32 v130, v212, v213
v_cvt_pk_bf16_f32 v131, v214, v215
v_mfma_f32_32x32x16_bf16 v[80:95], a[188:191], a[68:71], v[80:95]
s_waitcnt lgkmcnt(6)
ds_read_b64_tr_b16 a[164:165], v28 offset:28928
ds_read_b64_tr_b16 a[166:167], v28 offset:29440
v_cvt_pk_bf16_f32 v132, v216, v217
v_cvt_pk_bf16_f32 v133, v218, v219
v_cvt_pk_bf16_f32 v134, v220, v221
v_cvt_pk_bf16_f32 v135, v222, v223
s_waitcnt vmcnt(21)
s_barrier
v_mfma_f32_32x32x16_bf16 v[64:79], a[144:147], a[72:75], v[64:79]
buffer_load_dwordx4 v20, s[12:15], s41 offen offset:0 lds
ds_read_b64_tr_b16 a[168:169], v29 offset:24576
ds_read_b64_tr_b16 a[170:171], v29 offset:25088
v_mfma_f32_32x32x16_bf16 v[80:95], a[148:151], a[72:75], v[80:95]
s_waitcnt lgkmcnt(6)
ds_read_b64_tr_b16 a[172:173], v29 offset:24832
ds_read_b64_tr_b16 a[174:175], v29 offset:25344
v_exp_f32 v32, v224
v_exp_f32 v33, v225
v_mfma_f32_32x32x16_bf16 v[64:79], a[152:155], a[76:79], v[64:79]
ds_read_b64_tr_b16 a[176:177], v29 offset:26624
ds_read_b64_tr_b16 a[178:179], v29 offset:27136
v_exp_f32 v34, v226
v_exp_f32 v35, v227
v_mfma_f32_32x32x16_bf16 v[80:95], a[156:159], a[76:79], v[80:95]
s_waitcnt lgkmcnt(6)
buffer_load_dwordx4 v21, s[12:15], s41 offen offset:1024 lds
ds_read_b64_tr_b16 a[180:181], v29 offset:26880
ds_read_b64_tr_b16 a[182:183], v29 offset:27392
L_pad_f0_1:
s_cbranch_execz L_pad_f0_2
v_mfma_f32_32x32x16_bf16 v[64:79], a[160:163], a[80:83], v[64:79]
ds_read_b64_tr_b16 a[184:185], v29 offset:28672
ds_read_b64_tr_b16 a[186:187], v29 offset:29184
v_exp_f32 v36, v228
v_exp_f32 v37, v229
v_mfma_f32_32x32x16_bf16 v[80:95], a[164:167], a[80:83], v[80:95]
s_waitcnt lgkmcnt(6)
ds_read_b64_tr_b16 a[188:189], v29 offset:28928
ds_read_b64_tr_b16 a[190:191], v29 offset:29440
v_exp_f32 v38, v230
v_exp_f32 v39, v231
v_mfma_f32_32x32x16_bf16 v[64:79], a[168:171], a[84:87], v[64:79]
buffer_load_dwordx4 v22, s[12:15], s41 offen offset:2048 lds
ds_read_b64_tr_b16 a[144:145], v26 offset:30720
ds_read_b64_tr_b16 a[146:147], v26 offset:31232
v_mfma_f32_32x32x16_bf16 v[80:95], a[172:175], a[84:87], v[80:95]
s_waitcnt lgkmcnt(6)
s_add_u32 m0, s35, 21504
ds_read_b64_tr_b16 a[148:149], v26 offset:30976
ds_read_b64_tr_b16 a[150:151], v26 offset:31488
v_exp_f32 v40, v232
v_exp_f32 v41, v233
v_mfma_f32_32x32x16_bf16 v[64:79], a[176:179], a[88:91], v[64:79]
s_add_u32 s41, s60, 221824
ds_read_b64_tr_b16 a[152:153], v26 offset:32768
ds_read_b64_tr_b16 a[154:155], v26 offset:33280
v_exp_f32 v42, v234
v_exp_f32 v43, v235
v_mfma_f32_32x32x16_bf16 v[80:95], a[180:183], a[88:91], v[80:95]
s_waitcnt lgkmcnt(6)
buffer_load_dwordx4 v20, s[12:15], s41 offen offset:0 lds
ds_read_b64_tr_b16 a[156:157], v26 offset:33024
ds_read_b64_tr_b16 a[158:159], v26 offset:33536
v_mfma_f32_32x32x16_bf16 v[64:79], a[184:187], a[92:95], v[64:79]
ds_read_b64_tr_b16 a[160:161], v26 offset:34816
ds_read_b64_tr_b16 a[162:163], v26 offset:35328
v_exp_f32 v44, v236
v_exp_f32 v45, v237
v_mfma_f32_32x32x16_bf16 v[80:95], a[188:191], a[92:95], v[80:95]
s_waitcnt lgkmcnt(6)
ds_read_b64_tr_b16 a[164:165], v26 offset:35072
ds_read_b64_tr_b16 a[166:167], v26 offset:35584
v_exp_f32 v46, v238
v_exp_f32 v47, v239
v_mfma_f32_32x32x16_bf16 v[64:79], a[144:147], a[96:99], v[64:79]
buffer_load_dwordx4 v21, s[12:15], s41 offen offset:1024 lds
ds_read_b64_tr_b16 a[168:169], v27 offset:30720
ds_read_b64_tr_b16 a[170:171], v27 offset:31232
v_mfma_f32_32x32x16_bf16 v[80:95], a[148:151], a[96:99], v[80:95]
s_waitcnt lgkmcnt(6)
ds_read_b64_tr_b16 a[172:173], v27 offset:30976
ds_read_b64_tr_b16 a[174:175], v27 offset:31488
v_add_f32 v48, 2.0, v32
v_add_f32 v49, 2.0, v33
v_add_f32 v50, 2.0, v34
v_add_f32 v51, 2.0, v35
v_mfma_f32_32x32x16_bf16 v[64:79], a[152:155], a[100:103], v[64:79]
ds_read_b64_tr_b16 a[176:177], v27 offset:32768
ds_read_b64_tr_b16 a[178:179], v27 offset:33280
v_add_f32 v52, 2.0, v36
v_add_f32 v53, 2.0, v37
v_add_f32 v54, 2.0, v38
v_add_f32 v55, 2.0, v39
v_mfma_f32_32x32x16_bf16 v[80:95], a[156:159], a[100:103], v[80:95]
s_waitcnt lgkmcnt(6)
buffer_load_dwordx4 v22, s[12:15], s41 offen offset:2048 lds
ds_read_b64_tr_b16 a[180:181], v27 offset:33024
ds_read_b64_tr_b16 a[182:183], v27 offset:33536
v_mfma_f32_32x32x16_bf16 v[64:79], a[160:163], a[104:107], v[64:79]
s_add_u32 m0, s35, 24576
ds_read_b64_tr_b16 a[184:185], v27 offset:34816
ds_read_b64_tr_b16 a[186:187], v27 offset:35328
v_add_f32 v56, 2.0, v40
v_add_f32 v57, 2.0, v41
v_add_f32 v58, 2.0, v42
v_add_f32 v59, 2.0, v43
v_mfma_f32_32x32x16_bf16 v[80:95], a[164:167], a[104:107], v[80:95]
s_waitcnt lgkmcnt(6)
s_add_u32 s41, s61, 640
ds_read_b64_tr_b16 a[188:189], v27 offset:35072
ds_read_b64_tr_b16 a[190:191], v27 offset:35584
v_add_f32 v60, 2.0, v44
v_add_f32 v61, 2.0, v45
v_add_f32 v62, 2.0, v46
v_add_f32 v63, 2.0, v47
v_pk_fma_f32 v[32:33], v[32:33], v[48:49], v[16:17] op_sel:[0,0,0] op_sel_hi:[1,1,0]
v_pk_fma_f32 v[34:35], v[34:35], v[50:51], v[16:17] op_sel:[0,0,0] op_sel_hi:[1,1,0]
v_pk_fma_f32 v[36:37], v[36:37], v[52:53], v[16:17] op_sel:[0,0,0] op_sel_hi:[1,1,0]
v_pk_fma_f32 v[38:39], v[38:39], v[54:55], v[16:17] op_sel:[0,0,0] op_sel_hi:[1,1,0]
v_pk_fma_f32 v[40:41], v[40:41], v[56:57], v[16:17] op_sel:[0,0,0] op_sel_hi:[1,1,0]
v_pk_fma_f32 v[42:43], v[42:43], v[58:59], v[16:17] op_sel:[0,0,0] op_sel_hi:[1,1,0]
v_pk_fma_f32 v[44:45], v[44:45], v[60:61], v[16:17] op_sel:[0,0,0] op_sel_hi:[1,1,0]
v_pk_fma_f32 v[46:47], v[46:47], v[62:63], v[16:17] op_sel:[0,0,0] op_sel_hi:[1,1,0]
v_mfma_f32_32x32x16_bf16 v[64:79], a[168:171], a[108:111], v[64:79]
s_add_u32 s63, s51, 294912
buffer_load_dword a244, v246, s[16:19], s63 offen
ds_read_b64_tr_b16 a[144:145], v28 offset:30720
ds_read_b64_tr_b16 a[146:147], v28 offset:31232
v_mfma_f32_32x32x16_bf16 v[80:95], a[172:175], a[108:111], v[80:95]
s_waitcnt lgkmcnt(6)
ds_read_b64_tr_b16 a[148:149], v28 offset:30976
ds_read_b64_tr_b16 a[150:151], v28 offset:31488
v_rcp_f32 v32, v32
v_rcp_f32 v33, v33
v_mfma_f32_32x32x16_bf16 v[64:79], a[176:179], a[112:115], v[64:79]
ds_read_b64_tr_b16 a[152:153], v28 offset:32768
ds_read_b64_tr_b16 a[154:155], v28 offset:33280
v_rcp_f32 v34, v34
v_rcp_f32 v35, v35
v_mfma_f32_32x32x16_bf16 v[80:95], a[180:183], a[112:115], v[80:95]
s_waitcnt lgkmcnt(6)
ds_read_b64_tr_b16 a[156:157], v28 offset:33024
ds_read_b64_tr_b16 a[158:159], v28 offset:33536
v_rcp_f32 v36, v36
v_rcp_f32 v37, v37
v_mfma_f32_32x32x16_bf16 v[64:79], a[184:187], a[116:119], v[64:79]
ds_read_b64_tr_b16 a[160:161], v28 offset:34816
ds_read_b64_tr_b16 a[162:163], v28 offset:35328
v_rcp_f32 v38, v38
v_rcp_f32 v39, v39
v_mfma_f32_32x32x16_bf16 v[80:95], a[188:191], a[116:119], v[80:95]
s_waitcnt lgkmcnt(6)
ds_read_b64_tr_b16 a[164:165], v28 offset:35072
ds_read_b64_tr_b16 a[166:167], v28 offset:35584
v_rcp_f32 v40, v40
v_rcp_f32 v41, v41
s_waitcnt vmcnt(21)
s_barrier
v_mfma_f32_32x32x16_bf16 v[64:79], a[144:147], a[120:123], v[64:79]
buffer_load_dwordx4 v20, s[12:15], s41 offen offset:0 lds
ds_read_b64_tr_b16 a[168:169], v29 offset:30720
ds_read_b64_tr_b16 a[170:171], v29 offset:31232
v_mfma_f32_32x32x16_bf16 v[80:95], a[148:151], a[120:123], v[80:95]
s_waitcnt lgkmcnt(6)
ds_read_b64_tr_b16 a[172:173], v29 offset:30976
ds_read_b64_tr_b16 a[174:175], v29 offset:31488
v_rcp_f32 v42, v42
v_rcp_f32 v43, v43
v_mfma_f32_32x32x16_bf16 v[64:79], a[152:155], a[124:127], v[64:79]
ds_read_b64_tr_b16 a[176:177], v29 offset:32768
ds_read_b64_tr_b16 a[178:179], v29 offset:33280
v_rcp_f32 v44, v44
v_rcp_f32 v45, v45
v_mfma_f32_32x32x16_bf16 v[80:95], a[156:159], a[124:127], v[80:95]
s_waitcnt lgkmcnt(6)
buffer_load_dwordx4 v21, s[12:15], s41 offen offset:1024 lds
ds_read_b64_tr_b16 a[180:181], v29 offset:33024
ds_read_b64_tr_b16 a[182:183], v29 offset:33536
v_mfma_f32_32x32x16_bf16 v[64:79], a[160:163], a[128:131], v[64:79]
ds_read_b64_tr_b16 a[184:185], v29 offset:34816
ds_read_b64_tr_b16 a[186:187], v29 offset:35328
v_rcp_f32 v46, v46
v_rcp_f32 v47, v47
v_pk_fma_f32 v[32:33], v[32:33], v[14:15], v[30:31] op_sel:[0,1,1] op_sel_hi:[1,1,1]
v_pk_fma_f32 v[34:35], v[34:35], v[14:15], v[30:31] op_sel:[0,1,1] op_sel_hi:[1,1,1]
v_pk_fma_f32 v[36:37], v[36:37], v[14:15], v[30:31] op_sel:[0,1,1] op_sel_hi:[1,1,1]
v_pk_fma_f32 v[38:39], v[38:39], v[14:15], v[30:31] op_sel:[0,1,1] op_sel_hi:[1,1,1]
v_pk_fma_f32 v[40:41], v[40:41], v[14:15], v[30:31] op_sel:[0,1,1] op_sel_hi:[1,1,1]
v_pk_fma_f32 v[42:43], v[42:43], v[14:15], v[30:31] op_sel:[0,1,1] op_sel_hi:[1,1,1]
v_pk_fma_f32 v[44:45], v[44:45], v[14:15], v[30:31] op_sel:[0,1,1] op_sel_hi:[1,1,1]
v_pk_fma_f32 v[46:47], v[46:47], v[14:15], v[30:31] op_sel:[0,1,1] op_sel_hi:[1,1,1]
v_pk_mul_f32 v[224:225], v[224:225], v[32:33] op_sel:[0,0] op_sel_hi:[1,1]
v_pk_mul_f32 v[226:227], v[226:227], v[34:35] op_sel:[0,0] op_sel_hi:[1,1]
v_pk_mul_f32 v[228:229], v[228:229], v[36:37] op_sel:[0,0] op_sel_hi:[1,1]
v_pk_mul_f32 v[230:231], v[230:231], v[38:39] op_sel:[0,0] op_sel_hi:[1,1]
v_pk_mul_f32 v[232:233], v[232:233], v[40:41] op_sel:[0,0] op_sel_hi:[1,1]
v_pk_mul_f32 v[234:235], v[234:235], v[42:43] op_sel:[0,0] op_sel_hi:[1,1]
v_pk_mul_f32 v[236:237], v[236:237], v[44:45] op_sel:[0,0] op_sel_hi:[1,1]
v_pk_mul_f32 v[238:239], v[238:239], v[46:47] op_sel:[0,0] op_sel_hi:[1,1]
v_mfma_f32_32x32x16_bf16 v[80:95], a[164:167], a[128:131], v[80:95]
s_waitcnt lgkmcnt(6)
ds_read_b64_tr_b16 a[188:189], v29 offset:35072
ds_read_b64_tr_b16 a[190:191], v29 offset:35584
v_cvt_pk_bf16_f32 v136, v224, v225
v_cvt_pk_bf16_f32 v137, v226, v227
v_cvt_pk_bf16_f32 v138, v228, v229
v_cvt_pk_bf16_f32 v139, v230, v231
v_mfma_f32_32x32x16_bf16 v[64:79], a[168:171], a[132:135], v[64:79]
buffer_load_dwordx4 v22, s[12:15], s41 offen offset:2048 lds
ds_read_b64_tr_b16 a[144:145], v26 offset:0
ds_read_b64_tr_b16 a[146:147], v26 offset:512
v_mfma_f32_32x32x16_bf16 v[80:95], a[172:175], a[132:135], v[80:95]
s_waitcnt lgkmcnt(6)
s_add_u32 m0, s35, 27648
ds_read_b64_tr_b16 a[148:149], v26 offset:256
ds_read_b64_tr_b16 a[150:151], v26 offset:768
v_cvt_pk_bf16_f32 v140, v232, v233
v_cvt_pk_bf16_f32 v141, v234, v235
v_cvt_pk_bf16_f32 v142, v236, v237
v_cvt_pk_bf16_f32 v143, v238, v239
v_mfma_f32_32x32x16_bf16 v[64:79], a[176:179], a[136:139], v[64:79]
s_add_u32 s41, s61, 221824
ds_read_b64_tr_b16 a[152:153], v26 offset:2048
ds_read_b64_tr_b16 a[154:155], v26 offset:2560
v_mfma_f32_32x32x16_bf16 v[80:95], a[180:183], a[136:139], v[80:95]
s_waitcnt lgkmcnt(6)
buffer_load_dwordx4 v20, s[12:15], s41 offen offset:0 lds
ds_read_b64_tr_b16 a[156:157], v26 offset:2304
ds_read_b64_tr_b16 a[158:159], v26 offset:2816
v_mfma_f32_32x32x16_bf16 v[64:79], a[184:187], a[140:143], v[64:79]
ds_read_b64_tr_b16 a[160:161], v26 offset:4096
ds_read_b64_tr_b16 a[162:163], v26 offset:4608
ds_read_b128 v[48:51], v30 offset:768
ds_read_b128 v[52:55], v30 offset:800
ds_read_b128 v[56:59], v30 offset:832
ds_read_b128 v[60:63], v30 offset:864
v_mfma_f32_32x32x16_bf16 v[80:95], a[188:191], a[140:143], v[80:95]
s_waitcnt lgkmcnt(10)
ds_read_b64_tr_b16 a[164:165], v26 offset:4352
ds_read_b64_tr_b16 a[166:167], v26 offset:4864
v_mfma_f32_32x32x16_bf16 v[208:223], a[144:147], a[0:3], 0
buffer_load_dwordx4 v21, s[12:15], s41 offen offset:1024 lds
ds_read_b64_tr_b16 a[168:169], v27 offset:0
ds_read_b64_tr_b16 a[170:171], v27 offset:512
v_mfma_f32_32x32x16_bf16 v[224:239], a[148:151], a[0:3], 0
s_waitcnt lgkmcnt(10)
ds_read_b64_tr_b16 a[172:173], v27 offset:256
ds_read_b64_tr_b16 a[174:175], v27 offset:768
v_mfma_f32_32x32x16_bf16 v[208:223], a[152:155], a[4:7], v[208:223]
ds_read_b64_tr_b16 a[176:177], v27 offset:2048
ds_read_b64_tr_b16 a[178:179], v27 offset:2560
s_waitcnt lgkmcnt(11)
v_pk_fma_f32 v[64:65], v[64:65], v[14:15], v[48:49] op_sel:[0,0,0] op_sel_hi:[1,0,1]
v_pk_fma_f32 v[66:67], v[66:67], v[14:15], v[50:51] op_sel:[0,0,0] op_sel_hi:[1,0,1]
s_waitcnt lgkmcnt(10)
v_pk_fma_f32 v[68:69], v[68:69], v[14:15], v[52:53] op_sel:[0,0,0] op_sel_hi:[1,0,1]
v_pk_fma_f32 v[70:71], v[70:71], v[14:15], v[54:55] op_sel:[0,0,0] op_sel_hi:[1,0,1]
s_waitcnt lgkmcnt(9)
v_pk_fma_f32 v[72:73], v[72:73], v[14:15], v[56:57] op_sel:[0,0,0] op_sel_hi:[1,0,1]
v_pk_fma_f32 v[74:75], v[74:75], v[14:15], v[58:59] op_sel:[0,0,0] op_sel_hi:[1,0,1]
s_waitcnt lgkmcnt(8)
v_pk_fma_f32 v[76:77], v[76:77], v[14:15], v[60:61] op_sel:[0,0,0] op_sel_hi:[1,0,1]
v_pk_fma_f32 v[78:79], v[78:79], v[14:15], v[62:63] op_sel:[0,0,0] op_sel_hi:[1,0,1]
v_mfma_f32_32x32x16_bf16 v[224:239], a[156:159], a[4:7], v[224:239]
s_waitcnt lgkmcnt(6)
buffer_load_dwordx4 v22, s[12:15], s41 offen offset:2048 lds
ds_read_b64_tr_b16 a[180:181], v27 offset:2304
ds_read_b64_tr_b16 a[182:183], v27 offset:2816
v_mfma_f32_32x32x16_bf16 v[208:223], a[160:163], a[8:11], v[208:223]
s_add_u32 m0, s35, 30720
ds_read_b64_tr_b16 a[184:185], v27 offset:4096
ds_read_b64_tr_b16 a[186:187], v27 offset:4608
v_exp_f32 v32, v64
v_mfma_f32_32x32x16_bf16 v[224:239], a[164:167], a[8:11], v[224:239]
s_waitcnt lgkmcnt(6)
s_add_u32 s41, s62, 640
ds_read_b64_tr_b16 a[188:189], v27 offset:4352
ds_read_b64_tr_b16 a[190:191], v27 offset:4864
v_exp_f32 v33, v65
v_exp_f32 v34, v66
v_mfma_f32_32x32x16_bf16 v[208:223], a[168:171], a[12:15], v[208:223]
ds_read_b64_tr_b16 a[144:145], v28 offset:0
ds_read_b64_tr_b16 a[146:147], v28 offset:512
v_exp_f32 v35, v67
v_exp_f32 v36, v68
v_mfma_f32_32x32x16_bf16 v[224:239], a[172:175], a[12:15], v[224:239]
s_waitcnt lgkmcnt(6)
ds_read_b64_tr_b16 a[148:149], v28 offset:256
ds_read_b64_tr_b16 a[150:151], v28 offset:768
v_exp_f32 v37, v69
v_exp_f32 v38, v70
v_mfma_f32_32x32x16_bf16 v[208:223], a[176:179], a[16:19], v[208:223]
ds_read_b64_tr_b16 a[152:153], v28 offset:2048
ds_read_b64_tr_b16 a[154:155], v28 offset:2560
v_exp_f32 v39, v71
v_mfma_f32_32x32x16_bf16 v[224:239], a[180:183], a[16:19], v[224:239]
s_waitcnt lgkmcnt(6)
ds_read_b64_tr_b16 a[156:157], v28 offset:2304
ds_read_b64_tr_b16 a[158:159], v28 offset:2816
v_exp_f32 v40, v72
v_mfma_f32_32x32x16_bf16 v[208:223], a[184:187], a[20:23], v[208:223]
ds_read_b64_tr_b16 a[160:161], v28 offset:4096
ds_read_b64_tr_b16 a[162:163], v28 offset:4608
v_exp_f32 v41, v73
v_exp_f32 v42, v74
v_mfma_f32_32x32x16_bf16 v[224:239], a[188:191], a[20:23], v[224:239]
s_waitcnt lgkmcnt(6)
ds_read_b64_tr_b16 a[164:165], v28 offset:4352
ds_read_b64_tr_b16 a[166:167], v28 offset:4864
v_exp_f32 v43, v75
v_exp_f32 v44, v76
s_waitcnt vmcnt(20)
s_barrier
v_mfma_f32_32x32x16_bf16 v[208:223], a[144:147], a[24:27], v[208:223]
s_add_u32 s63, s51, 368640
buffer_load_dword a245, v246, s[16:19], s63 offen
ds_read_b64_tr_b16 a[168:169], v29 offset:0
ds_read_b64_tr_b16 a[170:171], v29 offset:512
v_mfma_f32_32x32x16_bf16 v[224:239], a[148:151], a[24:27], v[224:239]
s_waitcnt lgkmcnt(6)
ds_read_b64_tr_b16 a[172:173], v29 offset:256
ds_read_b64_tr_b16 a[174:175], v29 offset:768
v_exp_f32 v45, v77
v_exp_f32 v46, v78
v_mfma_f32_32x32x16_bf16 v[208:223], a[152:155], a[28:31], v[208:223]
ds_read_b64_tr_b16 a[176:177], v29 offset:2048
ds_read_b64_tr_b16 a[178:179], v29 offset:2560
v_exp_f32 v47, v79
v_add_f32 v48, 2.0, v32
v_mfma_f32_32x32x16_bf16 v[224:239], a[156:159], a[28:31], v[224:239]
s_waitcnt lgkmcnt(6)
buffer_load_dwordx4 v20, s[12:15], s41 offen offset:0 lds
ds_read_b64_tr_b16 a[180:181], v29 offset:2304
ds_read_b64_tr_b16 a[182:183], v29 offset:2816
v_mfma_f32_32x32x16_bf16 v[208:223], a[160:163], a[32:35], v[208:223]
ds_read_b64_tr_b16 a[184:185], v29 offset:4096
ds_read_b64_tr_b16 a[186:187], v29 offset:4608
v_add_f32 v49, 2.0, v33
v_add_f32 v50, 2.0, v34
v_add_f32 v51, 2.0, v35
v_add_f32 v52, 2.0, v36
v_mfma_f32_32x32x16_bf16 v[224:239], a[164:167], a[32:35], v[224:239]
s_waitcnt lgkmcnt(6)
ds_read_b64_tr_b16 a[188:189], v29 offset:4352
ds_read_b64_tr_b16 a[190:191], v29 offset:4864
v_add_f32 v53, 2.0, v37
v_add_f32 v54, 2.0, v38
v_add_f32 v55, 2.0, v39
v_add_f32 v56, 2.0, v40
v_mfma_f32_32x32x16_bf16 v[208:223], a[168:171], a[36:39], v[208:223]
buffer_load_dwordx4 v21, s[12:15], s41 offen offset:1024 lds
ds_read_b64_tr_b16 a[144:145], v26 offset:6144
ds_read_b64_tr_b16 a[146:147], v26 offset:6656
v_mfma_f32_32x32x16_bf16 v[224:239], a[172:175], a[36:39], v[224:239]
s_waitcnt lgkmcnt(6)
ds_read_b64_tr_b16 a[148:149], v26 offset:6400
ds_read_b64_tr_b16 a[150:151], v26 offset:6912
v_add_f32 v57, 2.0, v41
v_add_f32 v58, 2.0, v42
v_add_f32 v59, 2.0, v43
v_add_f32 v60, 2.0, v44
v_mfma_f32_32x32x16_bf16 v[208:223], a[176:179], a[40:43], v[208:223]
ds_read_b64_tr_b16 a[152:153], v26 offset:8192
ds_read_b64_tr_b16 a[154:155], v26 offset:8704
v_add_f32 v61, 2.0, v45
v_add_f32 v62, 2.0, v46
v_add_f32 v63, 2.0, v47
v_pk_fma_f32 v[32:33], v[32:33], v[48:49], v[16:17] op_sel:[0,0,0] op_sel_hi:[1,1,0]
v_pk_fma_f32 v[34:35], v[34:35], v[50:51], v[16:17] op_sel:[0,0,0] op_sel_hi:[1,1,0]
v_pk_fma_f32 v[36:37], v[36:37], v[52:53], v[16:17] op_sel:[0,0,0] op_sel_hi:[1,1,0]
v_pk_fma_f32 v[38:39], v[38:39], v[54:55], v[16:17] op_sel:[0,0,0] op_sel_hi:[1,1,0]
v_pk_fma_f32 v[40:41], v[40:41], v[56:57], v[16:17] op_sel:[0,0,0] op_sel_hi:[1,1,0]
v_pk_fma_f32 v[42:43], v[42:43], v[58:59], v[16:17] op_sel:[0,0,0] op_sel_hi:[1,1,0]
v_pk_fma_f32 v[44:45], v[44:45], v[60:61], v[16:17] op_sel:[0,0,0] op_sel_hi:[1,1,0]
v_pk_fma_f32 v[46:47], v[46:47], v[62:63], v[16:17] op_sel:[0,0,0] op_sel_hi:[1,1,0]
v_mfma_f32_32x32x16_bf16 v[224:239], a[180:183], a[40:43], v[224:239]
s_waitcnt lgkmcnt(6)
buffer_load_dwordx4 v22, s[12:15], s41 offen offset:2048 lds
ds_read_b64_tr_b16 a[156:157], v26 offset:8448
ds_read_b64_tr_b16 a[158:159], v26 offset:8960
v_mfma_f32_32x32x16_bf16 v[208:223], a[184:187], a[44:47], v[208:223]
s_add_u32 m0, s35, 33792
ds_read_b64_tr_b16 a[160:161], v26 offset:10240
ds_read_b64_tr_b16 a[162:163], v26 offset:10752
ds_read_b128 v[48:51], v30 offset:896
ds_read_b128 v[52:55], v30 offset:928
ds_read_b128 v[56:59], v30 offset:960
ds_read_b128 v[60:63], v30 offset:992
v_mfma_f32_32x32x16_bf16 v[224:239], a[188:191], a[44:47], v[224:239]
s_waitcnt lgkmcnt(10)
s_add_u32 s41, s62, 221824
ds_read_b64_tr_b16 a[164:165], v26 offset:10496
ds_read_b64_tr_b16 a[166:167], v26 offset:11008
v_rcp_f32 v32, v32
v_rcp_f32 v33, v33
v_mfma_f32_32x32x16_bf16 v[208:223], a[144:147], a[48:51], v[208:223]
buffer_load_dwordx4 v20, s[12:15], s41 offen offset:0 lds
ds_read_b64_tr_b16 a[168:169], v27 offset:6144
ds_read_b64_tr_b16 a[170:171], v27 offset:6656
v_mfma_f32_32x32x16_bf16 v[224:239], a[148:151], a[48:51], v[224:239]
s_waitcnt lgkmcnt(10)
ds_read_b64_tr_b16 a[172:173], v27 offset:6400
ds_read_b64_tr_b16 a[174:175], v27 offset:6912
v_rcp_f32 v34, v34
v_rcp_f32 v35, v35
v_mfma_f32_32x32x16_bf16 v[208:223], a[152:155], a[52:55], v[208:223]
ds_read_b64_tr_b16 a[176:177], v27 offset:8192
ds_read_b64_tr_b16 a[178:179], v27 offset:8704
v_rcp_f32 v36, v36
v_rcp_f32 v37, v37
v_mfma_f32_32x32x16_bf16 v[224:239], a[156:159], a[52:55], v[224:239]
s_waitcnt lgkmcnt(6)
buffer_load_dwordx4 v21, s[12:15], s41 offen offset:1024 lds
ds_read_b64_tr_b16 a[180:181], v27 offset:8448
ds_read_b64_tr_b16 a[182:183], v27 offset:8960
v_mfma_f32_32x32x16_bf16 v[208:223], a[160:163], a[56:59], v[208:223]
ds_read_b64_tr_b16 a[184:185], v27 offset:10240
ds_read_b64_tr_b16 a[186:187], v27 offset:10752
v_rcp_f32 v38, v38
v_rcp_f32 v39, v39
v_mfma_f32_32x32x16_bf16 v[224:239], a[164:167], a[56:59], v[224:239]
s_waitcnt lgkmcnt(6)
ds_read_b64_tr_b16 a[188:189], v27 offset:10496
ds_read_b64_tr_b16 a[190:191], v27 offset:11008
v_rcp_f32 v40, v40
v_rcp_f32 v41, v41
v_mfma_f32_32x32x16_bf16 v[208:223], a[168:171], a[60:63], v[208:223]
buffer_load_dwordx4 v22, s[12:15], s41 offen offset:2048 lds
ds_read_b64_tr_b16 a[144:145], v28 offset:6144
ds_read_b64_tr_b16 a[146:147], v28 offset:6656
v_mfma_f32_32x32x16_bf16 v[224:239], a[172:175], a[60:63], v[224:239]
s_waitcnt lgkmcnt(6)
s_add_u32 m0, s35, 0
ds_read_b64_tr_b16 a[148:149], v28 offset:6400
ds_read_b64_tr_b16 a[150:151], v28 offset:6912
v_rcp_f32 v42, v42
v_rcp_f32 v43, v43
v_mfma_f32_32x32x16_bf16 v[208:223], a[176:179], a[64:67], v[208:223]
s_add_u32 s41, s39, 0
ds_read_b64_tr_b16 a[152:153], v28 offset:8192
ds_read_b64_tr_b16 a[154:155], v28 offset:8704
v_rcp_f32 v44, v44
v_rcp_f32 v45, v45
v_mfma_f32_32x32x16_bf16 v[224:239], a[180:183], a[64:67], v[224:239]
s_waitcnt lgkmcnt(6)
ds_read_b64_tr_b16 a[156:157], v28 offset:8448
ds_read_b64_tr_b16 a[158:159], v28 offset:8960
v_rcp_f32 v46, v46
v_rcp_f32 v47, v47
v_pk_fma_f32 v[32:33], v[32:33], v[14:15], v[30:31] op_sel:[0,1,1] op_sel_hi:[1,1,1]
v_pk_fma_f32 v[34:35], v[34:35], v[14:15], v[30:31] op_sel:[0,1,1] op_sel_hi:[1,1,1]
v_pk_fma_f32 v[36:37], v[36:37], v[14:15], v[30:31] op_sel:[0,1,1] op_sel_hi:[1,1,1]
v_pk_fma_f32 v[38:39], v[38:39], v[14:15], v[30:31] op_sel:[0,1,1] op_sel_hi:[1,1,1]
v_pk_fma_f32 v[40:41], v[40:41], v[14:15], v[30:31] op_sel:[0,1,1] op_sel_hi:[1,1,1]
v_pk_fma_f32 v[42:43], v[42:43], v[14:15], v[30:31] op_sel:[0,1,1] op_sel_hi:[1,1,1]
v_pk_fma_f32 v[44:45], v[44:45], v[14:15], v[30:31] op_sel:[0,1,1] op_sel_hi:[1,1,1]
v_pk_fma_f32 v[46:47], v[46:47], v[14:15], v[30:31] op_sel:[0,1,1] op_sel_hi:[1,1,1]
v_pk_mul_f32 v[64:65], v[64:65], v[32:33] op_sel:[0,0] op_sel_hi:[1,1]
v_pk_mul_f32 v[66:67], v[66:67], v[34:35] op_sel:[0,0] op_sel_hi:[1,1]
v_pk_mul_f32 v[68:69], v[68:69], v[36:37] op_sel:[0,0] op_sel_hi:[1,1]
v_pk_mul_f32 v[70:71], v[70:71], v[38:39] op_sel:[0,0] op_sel_hi:[1,1]
v_pk_mul_f32 v[72:73], v[72:73], v[40:41] op_sel:[0,0] op_sel_hi:[1,1]
v_pk_mul_f32 v[74:75], v[74:75], v[42:43] op_sel:[0,0] op_sel_hi:[1,1]
v_pk_mul_f32 v[76:77], v[76:77], v[44:45] op_sel:[0,0] op_sel_hi:[1,1]
v_pk_mul_f32 v[78:79], v[78:79], v[46:47] op_sel:[0,0] op_sel_hi:[1,1]
v_pk_fma_f32 v[80:81], v[80:81], v[14:15], v[48:49] op_sel:[0,0,0] op_sel_hi:[1,0,1]
v_pk_fma_f32 v[82:83], v[82:83], v[14:15], v[50:51] op_sel:[0,0,0] op_sel_hi:[1,0,1]
v_pk_fma_f32 v[84:85], v[84:85], v[14:15], v[52:53] op_sel:[0,0,0] op_sel_hi:[1,0,1]
v_pk_fma_f32 v[86:87], v[86:87], v[14:15], v[54:55] op_sel:[0,0,0] op_sel_hi:[1,0,1]
v_pk_fma_f32 v[88:89], v[88:89], v[14:15], v[56:57] op_sel:[0,0,0] op_sel_hi:[1,0,1]
v_pk_fma_f32 v[90:91], v[90:91], v[14:15], v[58:59] op_sel:[0,0,0] op_sel_hi:[1,0,1]
v_pk_fma_f32 v[92:93], v[92:93], v[14:15], v[60:61] op_sel:[0,0,0] op_sel_hi:[1,0,1]
v_pk_fma_f32 v[94:95], v[94:95], v[14:15], v[62:63] op_sel:[0,0,0] op_sel_hi:[1,0,1]
v_mfma_f32_32x32x16_bf16 v[208:223], a[184:187], a[68:71], v[208:223]
ds_read_b64_tr_b16 a[160:161], v28 offset:10240
ds_read_b64_tr_b16 a[162:163], v28 offset:10752
v_cvt_pk_bf16_f32 v144, v64, v65
v_cvt_pk_bf16_f32 v145, v66, v67
v_cvt_pk_bf16_f32 v146, v68, v69
v_cvt_pk_bf16_f32 v147, v70, v71
v_mfma_f32_32x32x16_bf16 v[224:239], a[188:191], a[68:71], v[224:239]
s_waitcnt lgkmcnt(6)
ds_read_b64_tr_b16 a[164:165], v28 offset:10496
ds_read_b64_tr_b16 a[166:167], v28 offset:11008
v_cvt_pk_bf16_f32 v148, v72, v73
v_cvt_pk_bf16_f32 v149, v74, v75
v_cvt_pk_bf16_f32 v150, v76, v77
v_cvt_pk_bf16_f32 v151, v78, v79
s_waitcnt vmcnt(20)
s_barrier
v_mfma_f32_32x32x16_bf16 v[208:223], a[144:147], a[72:75], v[208:223]
buffer_load_dwordx4 v23, s[16:19], s41 offen offset:0 lds
ds_read_b64_tr_b16 a[168:169], v29 offset:6144
ds_read_b64_tr_b16 a[170:171], v29 offset:6656
v_mfma_f32_32x32x16_bf16 v[224:239], a[148:151], a[72:75], v[224:239]
s_waitcnt lgkmcnt(6)
ds_read_b64_tr_b16 a[172:173], v29 offset:6400
ds_read_b64_tr_b16 a[174:175], v29 offset:6912
v_exp_f32 v32, v80
v_exp_f32 v33, v81
v_mfma_f32_32x32x16_bf16 v[208:223], a[152:155], a[76:79], v[208:223]
ds_read_b64_tr_b16 a[176:177], v29 offset:8192
ds_read_b64_tr_b16 a[178:179], v29 offset:8704
v_exp_f32 v34, v82
v_exp_f32 v35, v83
v_mfma_f32_32x32x16_bf16 v[224:239], a[156:159], a[76:79], v[224:239]
s_waitcnt lgkmcnt(6)
buffer_load_dwordx4 v24, s[16:19], s41 offen offset:1024 lds
ds_read_b64_tr_b16 a[180:181], v29 offset:8448
ds_read_b64_tr_b16 a[182:183], v29 offset:8960
v_mfma_f32_32x32x16_bf16 v[208:223], a[160:163], a[80:83], v[208:223]
ds_read_b64_tr_b16 a[184:185], v29 offset:10240
ds_read_b64_tr_b16 a[186:187], v29 offset:10752
v_exp_f32 v36, v84
v_exp_f32 v37, v85
v_mfma_f32_32x32x16_bf16 v[224:239], a[164:167], a[80:83], v[224:239]
s_waitcnt lgkmcnt(6)
ds_read_b64_tr_b16 a[188:189], v29 offset:10496
ds_read_b64_tr_b16 a[190:191], v29 offset:11008
v_exp_f32 v38, v86
v_exp_f32 v39, v87
v_mfma_f32_32x32x16_bf16 v[208:223], a[168:171], a[84:87], v[208:223]
buffer_load_dword v8, off, s[28:31], s1 sc1
ds_read_b64_tr_b16 a[144:145], v26 offset:12288
ds_read_b64_tr_b16 a[146:147], v26 offset:12800
v_mfma_f32_32x32x16_bf16 v[224:239], a[172:175], a[84:87], v[224:239]
s_waitcnt lgkmcnt(6)
ds_read_b64_tr_b16 a[148:149], v26 offset:12544
ds_read_b64_tr_b16 a[150:151], v26 offset:13056
v_exp_f32 v40, v88
v_exp_f32 v41, v89
v_mfma_f32_32x32x16_bf16 v[208:223], a[176:179], a[88:91], v[208:223]
ds_read_b64_tr_b16 a[152:153], v26 offset:14336
ds_read_b64_tr_b16 a[154:155], v26 offset:14848
v_exp_f32 v42, v90
v_exp_f32 v43, v91
v_mfma_f32_32x32x16_bf16 v[224:239], a[180:183], a[88:91], v[224:239]
s_waitcnt lgkmcnt(6)
buffer_load_dwordx4 v25, s[16:19], s41 offen offset:2048 lds
ds_read_b64_tr_b16 a[156:157], v26 offset:14592
ds_read_b64_tr_b16 a[158:159], v26 offset:15104
v_mfma_f32_32x32x16_bf16 v[208:223], a[184:187], a[92:95], v[208:223]
s_add_u32 m0, s35, 3072
ds_read_b64_tr_b16 a[160:161], v26 offset:16384
ds_read_b64_tr_b16 a[162:163], v26 offset:16896
v_exp_f32 v44, v92
v_exp_f32 v45, v93
v_mfma_f32_32x32x16_bf16 v[224:239], a[188:191], a[92:95], v[224:239]
s_waitcnt lgkmcnt(6)
s_add_u32 s41, s39, 27648
ds_read_b64_tr_b16 a[164:165], v26 offset:16640
ds_read_b64_tr_b16 a[166:167], v26 offset:17152
v_exp_f32 v46, v94
v_exp_f32 v47, v95
v_mfma_f32_32x32x16_bf16 v[208:223], a[144:147], a[96:99], v[208:223]
buffer_load_dwordx4 v23, s[16:19], s41 offen offset:0 lds
ds_read_b64_tr_b16 a[168:169], v27 offset:12288
ds_read_b64_tr_b16 a[170:171], v27 offset:12800
v_mfma_f32_32x32x16_bf16 v[224:239], a[148:151], a[96:99], v[224:239]
s_waitcnt lgkmcnt(6)
ds_read_b64_tr_b16 a[172:173], v27 offset:12544
ds_read_b64_tr_b16 a[174:175], v27 offset:13056
v_add_f32 v48, 2.0, v32
v_add_f32 v49, 2.0, v33
v_add_f32 v50, 2.0, v34
v_add_f32 v51, 2.0, v35
v_mfma_f32_32x32x16_bf16 v[208:223], a[152:155], a[100:103], v[208:223]
ds_read_b64_tr_b16 a[176:177], v27 offset:14336
ds_read_b64_tr_b16 a[178:179], v27 offset:14848
v_add_f32 v52, 2.0, v36
v_add_f32 v53, 2.0, v37
v_add_f32 v54, 2.0, v38
v_add_f32 v55, 2.0, v39
v_mfma_f32_32x32x16_bf16 v[224:239], a[156:159], a[100:103], v[224:239]
s_waitcnt lgkmcnt(6)
buffer_load_dwordx4 v24, s[16:19], s41 offen offset:1024 lds
ds_read_b64_tr_b16 a[180:181], v27 offset:14592
ds_read_b64_tr_b16 a[182:183], v27 offset:15104
v_mfma_f32_32x32x16_bf16 v[208:223], a[160:163], a[104:107], v[208:223]
ds_read_b64_tr_b16 a[184:185], v27 offset:16384
ds_read_b64_tr_b16 a[186:187], v27 offset:16896
v_add_f32 v56, 2.0, v40
v_add_f32 v57, 2.0, v41
v_add_f32 v58, 2.0, v42
v_add_f32 v59, 2.0, v43
v_mfma_f32_32x32x16_bf16 v[224:239], a[164:167], a[104:107], v[224:239]
s_waitcnt lgkmcnt(6)
ds_read_b64_tr_b16 a[188:189], v27 offset:16640
ds_read_b64_tr_b16 a[190:191], v27 offset:17152
v_add_f32 v60, 2.0, v44
v_add_f32 v61, 2.0, v45
v_add_f32 v62, 2.0, v46
v_add_f32 v63, 2.0, v47
v_pk_fma_f32 v[32:33], v[32:33], v[48:49], v[16:17] op_sel:[0,0,0] op_sel_hi:[1,1,0]
v_pk_fma_f32 v[34:35], v[34:35], v[50:51], v[16:17] op_sel:[0,0,0] op_sel_hi:[1,1,0]
v_pk_fma_f32 v[36:37], v[36:37], v[52:53], v[16:17] op_sel:[0,0,0] op_sel_hi:[1,1,0]
v_pk_fma_f32 v[38:39], v[38:39], v[54:55], v[16:17] op_sel:[0,0,0] op_sel_hi:[1,1,0]
v_pk_fma_f32 v[40:41], v[40:41], v[56:57], v[16:17] op_sel:[0,0,0] op_sel_hi:[1,1,0]
v_pk_fma_f32 v[42:43], v[42:43], v[58:59], v[16:17] op_sel:[0,0,0] op_sel_hi:[1,1,0]
v_pk_fma_f32 v[44:45], v[44:45], v[60:61], v[16:17] op_sel:[0,0,0] op_sel_hi:[1,1,0]
v_pk_fma_f32 v[46:47], v[46:47], v[62:63], v[16:17] op_sel:[0,0,0] op_sel_hi:[1,1,0]
v_mfma_f32_32x32x16_bf16 v[208:223], a[168:171], a[108:111], v[208:223]
buffer_load_dwordx4 v25, s[16:19], s41 offen offset:2048 lds
ds_read_b64_tr_b16 a[144:145], v28 offset:12288
ds_read_b64_tr_b16 a[146:147], v28 offset:12800
v_mfma_f32_32x32x16_bf16 v[224:239], a[172:175], a[108:111], v[224:239]
s_waitcnt lgkmcnt(6)
s_add_u32 m0, s35, 6144
ds_read_b64_tr_b16 a[148:149], v28 offset:12544
ds_read_b64_tr_b16 a[150:151], v28 offset:13056
v_rcp_f32 v32, v32
v_rcp_f32 v33, v33
v_mfma_f32_32x32x16_bf16 v[208:223], a[176:179], a[112:115], v[208:223]
s_add_u32 s41, s39, 221184
ds_read_b64_tr_b16 a[152:153], v28 offset:14336
ds_read_b64_tr_b16 a[154:155], v28 offset:14848
v_rcp_f32 v34, v34
v_rcp_f32 v35, v35
v_mfma_f32_32x32x16_bf16 v[224:239], a[180:183], a[112:115], v[224:239]
s_waitcnt lgkmcnt(6)
ds_read_b64_tr_b16 a[156:157], v28 offset:14592
ds_read_b64_tr_b16 a[158:159], v28 offset:15104
v_rcp_f32 v36, v36
v_rcp_f32 v37, v37
v_mfma_f32_32x32x16_bf16 v[208:223], a[184:187], a[116:119], v[208:223]
ds_read_b64_tr_b16 a[160:161], v28 offset:16384
ds_read_b64_tr_b16 a[162:163], v28 offset:16896
v_rcp_f32 v38, v38
v_rcp_f32 v39, v39
v_mfma_f32_32x32x16_bf16 v[224:239], a[188:191], a[116:119], v[224:239]
s_waitcnt lgkmcnt(6)
ds_read_b64_tr_b16 a[164:165], v28 offset:16640
ds_read_b64_tr_b16 a[166:167], v28 offset:17152
v_rcp_f32 v40, v40
v_rcp_f32 v41, v41
s_waitcnt vmcnt(21)
s_barrier
v_mfma_f32_32x32x16_bf16 v[208:223], a[144:147], a[120:123], v[208:223]
L_pad_f1_1:
s_cbranch_execz L_pad_f1_2
buffer_load_dwordx4 v23, s[16:19], s41 offen offset:0 lds
ds_read_b64_tr_b16 a[168:169], v29 offset:12288
ds_read_b64_tr_b16 a[170:171], v29 offset:12800
v_mfma_f32_32x32x16_bf16 v[224:239], a[148:151], a[120:123], v[224:239]
s_waitcnt lgkmcnt(6)
ds_read_b64_tr_b16 a[172:173], v29 offset:12544
ds_read_b64_tr_b16 a[174:175], v29 offset:13056
v_rcp_f32 v42, v42
v_rcp_f32 v43, v43
v_mfma_f32_32x32x16_bf16 v[208:223], a[152:155], a[124:127], v[208:223]
ds_read_b64_tr_b16 a[176:177], v29 offset:14336
ds_read_b64_tr_b16 a[178:179], v29 offset:14848
v_rcp_f32 v44, v44
v_rcp_f32 v45, v45
v_mfma_f32_32x32x16_bf16 v[224:239], a[156:159], a[124:127], v[224:239]
s_waitcnt lgkmcnt(6)
buffer_load_dwordx4 v24, s[16:19], s41 offen offset:1024 lds
ds_read_b64_tr_b16 a[180:181], v29 offset:14592
ds_read_b64_tr_b16 a[182:183], v29 offset:15104
v_mfma_f32_32x32x16_bf16 v[208:223], a[160:163], a[128:131], v[208:223]
ds_read_b64_tr_b16 a[184:185], v29 offset:16384
ds_read_b64_tr_b16 a[186:187], v29 offset:16896
v_rcp_f32 v46, v46
v_rcp_f32 v47, v47
v_pk_fma_f32 v[32:33], v[32:33], v[14:15], v[30:31] op_sel:[0,1,1] op_sel_hi:[1,1,1]
v_pk_fma_f32 v[34:35], v[34:35], v[14:15], v[30:31] op_sel:[0,1,1] op_sel_hi:[1,1,1]
v_pk_fma_f32 v[36:37], v[36:37], v[14:15], v[30:31] op_sel:[0,1,1] op_sel_hi:[1,1,1]
v_pk_fma_f32 v[38:39], v[38:39], v[14:15], v[30:31] op_sel:[0,1,1] op_sel_hi:[1,1,1]
v_pk_fma_f32 v[40:41], v[40:41], v[14:15], v[30:31] op_sel:[0,1,1] op_sel_hi:[1,1,1]
v_pk_fma_f32 v[42:43], v[42:43], v[14:15], v[30:31] op_sel:[0,1,1] op_sel_hi:[1,1,1]
v_pk_fma_f32 v[44:45], v[44:45], v[14:15], v[30:31] op_sel:[0,1,1] op_sel_hi:[1,1,1]
v_pk_fma_f32 v[46:47], v[46:47], v[14:15], v[30:31] op_sel:[0,1,1] op_sel_hi:[1,1,1]
v_pk_mul_f32 v[80:81], v[80:81], v[32:33] op_sel:[0,0] op_sel_hi:[1,1]
v_pk_mul_f32 v[82:83], v[82:83], v[34:35] op_sel:[0,0] op_sel_hi:[1,1]
v_pk_mul_f32 v[84:85], v[84:85], v[36:37] op_sel:[0,0] op_sel_hi:[1,1]
v_pk_mul_f32 v[86:87], v[86:87], v[38:39] op_sel:[0,0] op_sel_hi:[1,1]
v_pk_mul_f32 v[88:89], v[88:89], v[40:41] op_sel:[0,0] op_sel_hi:[1,1]
v_pk_mul_f32 v[90:91], v[90:91], v[42:43] op_sel:[0,0] op_sel_hi:[1,1]
v_pk_mul_f32 v[92:93], v[92:93], v[44:45] op_sel:[0,0] op_sel_hi:[1,1]
v_pk_mul_f32 v[94:95], v[94:95], v[46:47] op_sel:[0,0] op_sel_hi:[1,1]
v_mfma_f32_32x32x16_bf16 v[224:239], a[164:167], a[128:131], v[224:239]
s_waitcnt lgkmcnt(6)
ds_read_b64_tr_b16 a[188:189], v29 offset:16640
ds_read_b64_tr_b16 a[190:191], v29 offset:17152
v_cvt_pk_bf16_f32 v152, v80, v81
v_cvt_pk_bf16_f32 v153, v82, v83
v_cvt_pk_bf16_f32 v154, v84, v85
v_cvt_pk_bf16_f32 v155, v86, v87
v_mfma_f32_32x32x16_bf16 v[208:223], a[168:171], a[132:135], v[208:223]
buffer_load_dwordx4 v25, s[16:19], s41 offen offset:2048 lds
ds_read_b64_tr_b16 a[144:145], v26 offset:18432
ds_read_b64_tr_b16 a[146:147], v26 offset:18944
v_mfma_f32_32x32x16_bf16 v[224:239], a[172:175], a[132:135], v[224:239]
s_waitcnt lgkmcnt(6)
s_add_u32 m0, s35, 9216
ds_read_b64_tr_b16 a[148:149], v26 offset:18688
ds_read_b64_tr_b16 a[150:151], v26 offset:19200
v_cvt_pk_bf16_f32 v156, v88, v89
v_cvt_pk_bf16_f32 v157, v90, v91
v_cvt_pk_bf16_f32 v158, v92, v93
v_cvt_pk_bf16_f32 v159, v94, v95
v_mfma_f32_32x32x16_bf16 v[208:223], a[176:179], a[136:139], v[208:223]
s_add_u32 s41, s39, 248832
ds_read_b64_tr_b16 a[152:153], v26 offset:20480
ds_read_b64_tr_b16 a[154:155], v26 offset:20992
v_mfma_f32_32x32x16_bf16 v[224:239], a[180:183], a[136:139], v[224:239]
s_waitcnt lgkmcnt(6)
buffer_load_dwordx4 v23, s[16:19], s41 offen offset:0 lds
ds_read_b64_tr_b16 a[156:157], v26 offset:20736
ds_read_b64_tr_b16 a[158:159], v26 offset:21248
v_mfma_f32_32x32x16_bf16 v[208:223], a[184:187], a[140:143], v[208:223]
ds_read_b64_tr_b16 a[160:161], v26 offset:22528
ds_read_b64_tr_b16 a[162:163], v26 offset:23040
ds_read_b128 v[48:51], v30 offset:1024
ds_read_b128 v[52:55], v30 offset:1056
ds_read_b128 v[56:59], v30 offset:1088
ds_read_b128 v[60:63], v30 offset:1120
v_mfma_f32_32x32x16_bf16 v[224:239], a[188:191], a[140:143], v[224:239]
s_waitcnt lgkmcnt(10)
ds_read_b64_tr_b16 a[164:165], v26 offset:22784
ds_read_b64_tr_b16 a[166:167], v26 offset:23296
v_mfma_f32_32x32x16_bf16 v[64:79], a[144:147], a[0:3], 0
buffer_load_dwordx4 v24, s[16:19], s41 offen offset:1024 lds
ds_read_b64_tr_b16 a[168:169], v27 offset:18432
ds_read_b64_tr_b16 a[170:171], v27 offset:18944
v_mfma_f32_32x32x16_bf16 v[80:95], a[148:151], a[0:3], 0
s_waitcnt lgkmcnt(10)
ds_read_b64_tr_b16 a[172:173], v27 offset:18688
ds_read_b64_tr_b16 a[174:175], v27 offset:19200
v_mfma_f32_32x32x16_bf16 v[64:79], a[152:155], a[4:7], v[64:79]
ds_read_b64_tr_b16 a[176:177], v27 offset:20480
ds_read_b64_tr_b16 a[178:179], v27 offset:20992
s_waitcnt lgkmcnt(11)
v_pk_fma_f32 v[208:209], v[208:209], v[14:15], v[48:49] op_sel:[0,0,0] op_sel_hi:[1,0,1]
v_pk_fma_f32 v[210:211], v[210:211], v[14:15], v[50:51] op_sel:[0,0,0] op_sel_hi:[1,0,1]
s_waitcnt lgkmcnt(10)
v_pk_fma_f32 v[212:213], v[212:213], v[14:15], v[52:53] op_sel:[0,0,0] op_sel_hi:[1,0,1]
v_pk_fma_f32 v[214:215], v[214:215], v[14:15], v[54:55] op_sel:[0,0,0] op_sel_hi:[1,0,1]
s_waitcnt lgkmcnt(9)
v_pk_fma_f32 v[216:217], v[216:217], v[14:15], v[56:57] op_sel:[0,0,0] op_sel_hi:[1,0,1]
v_pk_fma_f32 v[218:219], v[218:219], v[14:15], v[58:59] op_sel:[0,0,0] op_sel_hi:[1,0,1]
s_waitcnt lgkmcnt(8)
v_pk_fma_f32 v[220:221], v[220:221], v[14:15], v[60:61] op_sel:[0,0,0] op_sel_hi:[1,0,1]
v_pk_fma_f32 v[222:223], v[222:223], v[14:15], v[62:63] op_sel:[0,0,0] op_sel_hi:[1,0,1]
v_mfma_f32_32x32x16_bf16 v[80:95], a[156:159], a[4:7], v[80:95]
s_waitcnt lgkmcnt(6)
buffer_load_dwordx4 v25, s[16:19], s41 offen offset:2048 lds
ds_read_b64_tr_b16 a[180:181], v27 offset:20736
ds_read_b64_tr_b16 a[182:183], v27 offset:21248
v_mfma_f32_32x32x16_bf16 v[64:79], a[160:163], a[8:11], v[64:79]
s_add_u32 m0, s35, 12288
ds_read_b64_tr_b16 a[184:185], v27 offset:22528
ds_read_b64_tr_b16 a[186:187], v27 offset:23040
v_exp_f32 v32, v208
v_mfma_f32_32x32x16_bf16 v[80:95], a[164:167], a[8:11], v[80:95]
s_waitcnt lgkmcnt(6)
s_add_u32 s41, s39, 128
ds_read_b64_tr_b16 a[188:189], v27 offset:22784
ds_read_b64_tr_b16 a[190:191], v27 offset:23296
v_exp_f32 v33, v209
v_exp_f32 v34, v210
v_mfma_f32_32x32x16_bf16 v[64:79], a[168:171], a[12:15], v[64:79]
ds_read_b64_tr_b16 a[144:145], v28 offset:18432
ds_read_b64_tr_b16 a[146:147], v28 offset:18944
v_exp_f32 v35, v211
v_exp_f32 v36, v212
v_mfma_f32_32x32x16_bf16 v[80:95], a[172:175], a[12:15], v[80:95]
s_waitcnt lgkmcnt(6)
ds_read_b64_tr_b16 a[148:149], v28 offset:18688
ds_read_b64_tr_b16 a[150:151], v28 offset:19200
v_exp_f32 v37, v213
v_exp_f32 v38, v214
v_mfma_f32_32x32x16_bf16 v[64:79], a[176:179], a[16:19], v[64:79]
ds_read_b64_tr_b16 a[152:153], v28 offset:20480
ds_read_b64_tr_b16 a[154:155], v28 offset:20992
v_exp_f32 v39, v215
v_mfma_f32_32x32x16_bf16 v[80:95], a[180:183], a[16:19], v[80:95]
s_waitcnt lgkmcnt(6)
ds_read_b64_tr_b16 a[156:157], v28 offset:20736
ds_read_b64_tr_b16 a[158:159], v28 offset:21248
v_exp_f32 v40, v216
v_mfma_f32_32x32x16_bf16 v[64:79], a[184:187], a[20:23], v[64:79]
ds_read_b64_tr_b16 a[160:161], v28 offset:22528
ds_read_b64_tr_b16 a[162:163], v28 offset:23040
v_exp_f32 v41, v217
v_exp_f32 v42, v218
v_mfma_f32_32x32x16_bf16 v[80:95], a[188:191], a[20:23], v[80:95]
s_waitcnt lgkmcnt(6)
ds_read_b64_tr_b16 a[164:165], v28 offset:22784
ds_read_b64_tr_b16 a[166:167], v28 offset:23296
v_exp_f32 v43, v219
v_exp_f32 v44, v220
s_waitcnt vmcnt(20)
s_barrier
v_mfma_f32_32x32x16_bf16 v[64:79], a[144:147], a[24:27], v[64:79]
buffer_load_dwordx4 v23, s[16:19], s41 offen offset:0 lds
ds_read_b64_tr_b16 a[168:169], v29 offset:18432
ds_read_b64_tr_b16 a[170:171], v29 offset:18944
v_mfma_f32_32x32x16_bf16 v[80:95], a[148:151], a[24:27], v[80:95]
s_waitcnt lgkmcnt(6)
ds_read_b64_tr_b16 a[172:173], v29 offset:18688
ds_read_b64_tr_b16 a[174:175], v29 offset:19200
v_exp_f32 v45, v221
v_exp_f32 v46, v222
v_mfma_f32_32x32x16_bf16 v[64:79], a[152:155], a[28:31], v[64:79]
ds_read_b64_tr_b16 a[176:177], v29 offset:20480
ds_read_b64_tr_b16 a[178:179], v29 offset:20992
v_exp_f32 v47, v223
v_add_f32 v48, 2.0, v32
v_mfma_f32_32x32x16_bf16 v[80:95], a[156:159], a[28:31], v[80:95]
s_waitcnt lgkmcnt(6)
buffer_load_dwordx4 v24, s[16:19], s41 offen offset:1024 lds
ds_read_b64_tr_b16 a[180:181], v29 offset:20736
ds_read_b64_tr_b16 a[182:183], v29 offset:21248
v_mfma_f32_32x32x16_bf16 v[64:79], a[160:163], a[32:35], v[64:79]
ds_read_b64_tr_b16 a[184:185], v29 offset:22528
ds_read_b64_tr_b16 a[186:187], v29 offset:23040
v_add_f32 v49, 2.0, v33
v_add_f32 v50, 2.0, v34
v_add_f32 v51, 2.0, v35
v_add_f32 v52, 2.0, v36
v_mfma_f32_32x32x16_bf16 v[80:95], a[164:167], a[32:35], v[80:95]
s_waitcnt lgkmcnt(6)
ds_read_b64_tr_b16 a[188:189], v29 offset:22784
ds_read_b64_tr_b16 a[190:191], v29 offset:23296
v_add_f32 v53, 2.0, v37
v_add_f32 v54, 2.0, v38
v_add_f32 v55, 2.0, v39
v_add_f32 v56, 2.0, v40
v_mfma_f32_32x32x16_bf16 v[64:79], a[168:171], a[36:39], v[64:79]
buffer_load_dwordx4 v25, s[16:19], s41 offen offset:2048 lds
ds_read_b64_tr_b16 a[144:145], v26 offset:24576
ds_read_b64_tr_b16 a[146:147], v26 offset:25088
v_mfma_f32_32x32x16_bf16 v[80:95], a[172:175], a[36:39], v[80:95]
s_waitcnt lgkmcnt(6)
s_add_u32 m0, s35, 15360
ds_read_b64_tr_b16 a[148:149], v26 offset:24832
ds_read_b64_tr_b16 a[150:151], v26 offset:25344
v_add_f32 v57, 2.0, v41
v_add_f32 v58, 2.0, v42
v_add_f32 v59, 2.0, v43
v_add_f32 v60, 2.0, v44
s_waitcnt vmcnt(13)
v_cmp_le_u32 vcc, 1, v8
s_nop 1
s_andn2_b32 s7, 0x1, vcc_lo
s_cbranch_scc1 L_spin_fi
L_back_fi:
v_mfma_f32_32x32x16_bf16 v[64:79], a[176:179], a[40:43], v[64:79]
s_add_u32 s41, s39, 27776
ds_read_b64_tr_b16 a[152:153], v26 offset:26624
ds_read_b64_tr_b16 a[154:155], v26 offset:27136
v_add_f32 v61, 2.0, v45
v_add_f32 v62, 2.0, v46
v_add_f32 v63, 2.0, v47
v_pk_fma_f32 v[32:33], v[32:33], v[48:49], v[16:17] op_sel:[0,0,0] op_sel_hi:[1,1,0]
v_pk_fma_f32 v[34:35], v[34:35], v[50:51], v[16:17] op_sel:[0,0,0] op_sel_hi:[1,1,0]
v_pk_fma_f32 v[36:37], v[36:37], v[52:53], v[16:17] op_sel:[0,0,0] op_sel_hi:[1,1,0]
v_pk_fma_f32 v[38:39], v[38:39], v[54:55], v[16:17] op_sel:[0,0,0] op_sel_hi:[1,1,0]
v_pk_fma_f32 v[40:41], v[40:41], v[56:57], v[16:17] op_sel:[0,0,0] op_sel_hi:[1,1,0]
v_pk_fma_f32 v[42:43], v[42:43], v[58:59], v[16:17] op_sel:[0,0,0] op_sel_hi:[1,1,0]
v_pk_fma_f32 v[44:45], v[44:45], v[60:61], v[16:17] op_sel:[0,0,0] op_sel_hi:[1,1,0]
v_pk_fma_f32 v[46:47], v[46:47], v[62:63], v[16:17] op_sel:[0,0,0] op_sel_hi:[1,1,0]
v_mfma_f32_32x32x16_bf16 v[80:95], a[180:183], a[40:43], v[80:95]
s_waitcnt lgkmcnt(6)
buffer_load_dwordx4 v23, s[16:19], s41 offen offset:0 lds
ds_read_b64_tr_b16 a[156:157], v26 offset:26880
ds_read_b64_tr_b16 a[158:159], v26 offset:27392
v_mfma_f32_32x32x16_bf16 v[64:79], a[184:187], a[44:47], v[64:79]
ds_read_b64_tr_b16 a[160:161], v26 offset:28672
ds_read_b64_tr_b16 a[162:163], v26 offset:29184
ds_read_b128 v[48:51], v30 offset:1152
ds_read_b128 v[52:55], v30 offset:1184
ds_read_b128 v[56:59], v30 offset:1216
ds_read_b128 v[60:63], v30 offset:1248
v_mfma_f32_32x32x16_bf16 v[80:95], a[188:191], a[44:47], v[80:95]
s_waitcnt lgkmcnt(10)
ds_read_b64_tr_b16 a[164:165], v26 offset:28928
ds_read_b64_tr_b16 a[166:167], v26 offset:29440
v_rcp_f32 v32, v32
v_rcp_f32 v33, v33
v_mfma_f32_32x32x16_bf16 v[64:79], a[144:147], a[48:51], v[64:79]
buffer_load_dwordx4 v24, s[16:19], s41 offen offset:1024 lds
ds_read_b64_tr_b16 a[168:169], v27 offset:24576
ds_read_b64_tr_b16 a[170:171], v27 offset:25088
v_mfma_f32_32x32x16_bf16 v[80:95], a[148:151], a[48:51], v[80:95]
s_waitcnt lgkmcnt(10)
ds_read_b64_tr_b16 a[172:173], v27 offset:24832
ds_read_b64_tr_b16 a[174:175], v27 offset:25344
v_rcp_f32 v34, v34
v_rcp_f32 v35, v35
v_mfma_f32_32x32x16_bf16 v[64:79], a[152:155], a[52:55], v[64:79]
ds_read_b64_tr_b16 a[176:177], v27 offset:26624
ds_read_b64_tr_b16 a[178:179], v27 offset:27136
v_rcp_f32 v36, v36
v_rcp_f32 v37, v37
v_mfma_f32_32x32x16_bf16 v[80:95], a[156:159], a[52:55], v[80:95]
s_waitcnt lgkmcnt(6)
buffer_load_dwordx4 v25, s[16:19], s41 offen offset:2048 lds
ds_read_b64_tr_b16 a[180:181], v27 offset:26880
ds_read_b64_tr_b16 a[182:183], v27 offset:27392
v_mfma_f32_32x32x16_bf16 v[64:79], a[160:163], a[56:59], v[64:79]
s_add_u32 m0, s35, 18432
ds_read_b64_tr_b16 a[184:185], v27 offset:28672
ds_read_b64_tr_b16 a[186:187], v27 offset:29184
v_rcp_f32 v38, v38
v_rcp_f32 v39, v39
v_mfma_f32_32x32x16_bf16 v[80:95], a[164:167], a[56:59], v[80:95]
s_waitcnt lgkmcnt(6)
s_add_u32 s41, s39, 221312
ds_read_b64_tr_b16 a[188:189], v27 offset:28928
ds_read_b64_tr_b16 a[190:191], v27 offset:29440
v_rcp_f32 v40, v40
v_rcp_f32 v41, v41
v_mfma_f32_32x32x16_bf16 v[64:79], a[168:171], a[60:63], v[64:79]
ds_read_b64_tr_b16 a[144:145], v28 offset:24576
ds_read_b64_tr_b16 a[146:147], v28 offset:25088
v_rcp_f32 v42, v42
v_rcp_f32 v43, v43
v_mfma_f32_32x32x16_bf16 v[80:95], a[172:175], a[60:63], v[80:95]
s_waitcnt lgkmcnt(6)
ds_read_b64_tr_b16 a[148:149], v28 offset:24832
ds_read_b64_tr_b16 a[150:151], v28 offset:25344
v_rcp_f32 v44, v44
v_rcp_f32 v45, v45
v_mfma_f32_32x32x16_bf16 v[64:79], a[176:179], a[64:67], v[64:79]
ds_read_b64_tr_b16 a[152:153], v28 offset:26624
ds_read_b64_tr_b16 a[154:155], v28 offset:27136
v_rcp_f32 v46, v46
v_mfma_f32_32x32x16_bf16 v[80:95], a[180:183], a[64:67], v[80:95]
s_waitcnt lgkmcnt(6)
ds_read_b64_tr_b16 a[156:157], v28 offset:26880
ds_read_b64_tr_b16 a[158:159], v28 offset:27392
v_rcp_f32 v47, v47
v_pk_fma_f32 v[32:33], v[32:33], v[14:15], v[30:31] op_sel:[0,1,1] op_sel_hi:[1,1,1]
v_pk_fma_f32 v[34:35], v[34:35], v[14:15], v[30:31] op_sel:[0,1,1] op_sel_hi:[1,1,1]
v_pk_fma_f32 v[36:37], v[36:37], v[14:15], v[30:31] op_sel:[0,1,1] op_sel_hi:[1,1,1]
v_pk_fma_f32 v[38:39], v[38:39], v[14:15], v[30:31] op_sel:[0,1,1] op_sel_hi:[1,1,1]
v_pk_fma_f32 v[40:41], v[40:41], v[14:15], v[30:31] op_sel:[0,1,1] op_sel_hi:[1,1,1]
v_pk_fma_f32 v[42:43], v[42:43], v[14:15], v[30:31] op_sel:[0,1,1] op_sel_hi:[1,1,1]
v_pk_fma_f32 v[44:45], v[44:45], v[14:15], v[30:31] op_sel:[0,1,1] op_sel_hi:[1,1,1]
v_pk_fma_f32 v[46:47], v[46:47], v[14:15], v[30:31] op_sel:[0,1,1] op_sel_hi:[1,1,1]
v_pk_mul_f32 v[208:209], v[208:209], v[32:33] op_sel:[0,0] op_sel_hi:[1,1]
v_pk_mul_f32 v[210:211], v[210:211], v[34:35] op_sel:[0,0] op_sel_hi:[1,1]
v_pk_mul_f32 v[212:213], v[212:213], v[36:37] op_sel:[0,0] op_sel_hi:[1,1]
v_pk_mul_f32 v[214:215], v[214:215], v[38:39] op_sel:[0,0] op_sel_hi:[1,1]
v_pk_mul_f32 v[216:217], v[216:217], v[40:41] op_sel:[0,0] op_sel_hi:[1,1]
v_pk_mul_f32 v[218:219], v[218:219], v[42:43] op_sel:[0,0] op_sel_hi:[1,1]
v_pk_mul_f32 v[220:221], v[220:221], v[44:45] op_sel:[0,0] op_sel_hi:[1,1]
v_pk_mul_f32 v[222:223], v[222:223], v[46:47] op_sel:[0,0] op_sel_hi:[1,1]
v_pk_fma_f32 v[224:225], v[224:225], v[14:15], v[48:49] op_sel:[0,0,0] op_sel_hi:[1,0,1]
v_pk_fma_f32 v[226:227], v[226:227], v[14:15], v[50:51] op_sel:[0,0,0] op_sel_hi:[1,0,1]
v_pk_fma_f32 v[228:229], v[228:229], v[14:15], v[52:53] op_sel:[0,0,0] op_sel_hi:[1,0,1]
v_pk_fma_f32 v[230:231], v[230:231], v[14:15], v[54:55] op_sel:[0,0,0] op_sel_hi:[1,0,1]
v_pk_fma_f32 v[232:233], v[232:233], v[14:15], v[56:57] op_sel:[0,0,0] op_sel_hi:[1,0,1]
v_pk_fma_f32 v[234:235], v[234:235], v[14:15], v[58:59] op_sel:[0,0,0] op_sel_hi:[1,0,1]
v_pk_fma_f32 v[236:237], v[236:237], v[14:15], v[60:61] op_sel:[0,0,0] op_sel_hi:[1,0,1]
v_pk_fma_f32 v[238:239], v[238:239], v[14:15], v[62:63] op_sel:[0,0,0] op_sel_hi:[1,0,1]
v_mfma_f32_32x32x16_bf16 v[64:79], a[184:187], a[68:71], v[64:79]
ds_read_b64_tr_b16 a[160:161], v28 offset:28672
ds_read_b64_tr_b16 a[162:163], v28 offset:29184
v_cvt_pk_bf16_f32 v160, v208, v209
v_cvt_pk_bf16_f32 v161, v210, v211
v_cvt_pk_bf16_f32 v162, v212, v213
v_cvt_pk_bf16_f32 v163, v214, v215
v_mfma_f32_32x32x16_bf16 v[80:95], a[188:191], a[68:71], v[80:95]
s_waitcnt lgkmcnt(6)
ds_read_b64_tr_b16 a[164:165], v28 offset:28928
ds_read_b64_tr_b16 a[166:167], v28 offset:29440
v_cvt_pk_bf16_f32 v164, v216, v217
v_cvt_pk_bf16_f32 v165, v218, v219
v_cvt_pk_bf16_f32 v166, v220, v221
v_cvt_pk_bf16_f32 v167, v222, v223
s_barrier
v_mfma_f32_32x32x16_bf16 v[64:79], a[144:147], a[72:75], v[64:79]
buffer_load_dwordx4 v23, s[16:19], s41 offen offset:0 lds
ds_read_b64_tr_b16 a[168:169], v29 offset:24576
ds_read_b64_tr_b16 a[170:171], v29 offset:25088
v_mfma_f32_32x32x16_bf16 v[80:95], a[148:151], a[72:75], v[80:95]
s_waitcnt lgkmcnt(6)
ds_read_b64_tr_b16 a[172:173], v29 offset:24832
ds_read_b64_tr_b16 a[174:175], v29 offset:25344
v_exp_f32 v32, v224
v_exp_f32 v33, v225
v_mfma_f32_32x32x16_bf16 v[64:79], a[152:155], a[76:79], v[64:79]
ds_read_b64_tr_b16 a[176:177], v29 offset:26624
ds_read_b64_tr_b16 a[178:179], v29 offset:27136
v_exp_f32 v34, v226
v_exp_f32 v35, v227
v_mfma_f32_32x32x16_bf16 v[80:95], a[156:159], a[76:79], v[80:95]
s_waitcnt lgkmcnt(6)
buffer_load_dwordx4 v24, s[16:19], s41 offen offset:1024 lds
ds_read_b64_tr_b16 a[180:181], v29 offset:26880
ds_read_b64_tr_b16 a[182:183], v29 offset:27392
v_mfma_f32_32x32x16_bf16 v[64:79], a[160:163], a[80:83], v[64:79]
ds_read_b64_tr_b16 a[184:185], v29 offset:28672
ds_read_b64_tr_b16 a[186:187], v29 offset:29184
v_exp_f32 v36, v228
v_exp_f32 v37, v229
v_mfma_f32_32x32x16_bf16 v[80:95], a[164:167], a[80:83], v[80:95]
s_waitcnt lgkmcnt(6)
ds_read_b64_tr_b16 a[188:189], v29 offset:28928
ds_read_b64_tr_b16 a[190:191], v29 offset:29440
v_exp_f32 v38, v230
v_exp_f32 v39, v231
v_mfma_f32_32x32x16_bf16 v[64:79], a[168:171], a[84:87], v[64:79]
buffer_load_dwordx4 v25, s[16:19], s41 offen offset:2048 lds
ds_read_b64_tr_b16 a[144:145], v26 offset:30720
ds_read_b64_tr_b16 a[146:147], v26 offset:31232
v_mfma_f32_32x32x16_bf16 v[80:95], a[172:175], a[84:87], v[80:95]
s_waitcnt lgkmcnt(6)
s_add_u32 m0, s35, 21504
ds_read_b64_tr_b16 a[148:149], v26 offset:30976
ds_read_b64_tr_b16 a[150:151], v26 offset:31488
v_exp_f32 v40, v232
v_exp_f32 v41, v233
v_mfma_f32_32x32x16_bf16 v[64:79], a[176:179], a[88:91], v[64:79]
s_add_u32 s41, s39, 248960
ds_read_b64_tr_b16 a[152:153], v26 offset:32768
ds_read_b64_tr_b16 a[154:155], v26 offset:33280
v_exp_f32 v42, v234
v_exp_f32 v43, v235
v_mfma_f32_32x32x16_bf16 v[80:95], a[180:183], a[88:91], v[80:95]
s_waitcnt lgkmcnt(6)
buffer_load_dwordx4 v23, s[16:19], s41 offen offset:0 lds
ds_read_b64_tr_b16 a[156:157], v26 offset:33024
ds_read_b64_tr_b16 a[158:159], v26 offset:33536
v_mfma_f32_32x32x16_bf16 v[64:79], a[184:187], a[92:95], v[64:79]
ds_read_b64_tr_b16 a[160:161], v26 offset:34816
ds_read_b64_tr_b16 a[162:163], v26 offset:35328
v_exp_f32 v44, v236
v_exp_f32 v45, v237
v_mfma_f32_32x32x16_bf16 v[80:95], a[188:191], a[92:95], v[80:95]
s_waitcnt lgkmcnt(6)
ds_read_b64_tr_b16 a[164:165], v26 offset:35072
ds_read_b64_tr_b16 a[166:167], v26 offset:35584
v_exp_f32 v46, v238
v_exp_f32 v47, v239
v_mfma_f32_32x32x16_bf16 v[64:79], a[144:147], a[96:99], v[64:79]
buffer_load_dwordx4 v24, s[16:19], s41 offen offset:1024 lds
ds_read_b64_tr_b16 a[168:169], v27 offset:30720
ds_read_b64_tr_b16 a[170:171], v27 offset:31232
v_mfma_f32_32x32x16_bf16 v[80:95], a[148:151], a[96:99], v[80:95]
s_waitcnt lgkmcnt(6)
ds_read_b64_tr_b16 a[172:173], v27 offset:30976
ds_read_b64_tr_b16 a[174:175], v27 offset:31488
v_add_f32 v48, 2.0, v32
v_add_f32 v49, 2.0, v33
v_add_f32 v50, 2.0, v34
v_add_f32 v51, 2.0, v35
v_mfma_f32_32x32x16_bf16 v[64:79], a[152:155], a[100:103], v[64:79]
ds_read_b64_tr_b16 a[176:177], v27 offset:32768
ds_read_b64_tr_b16 a[178:179], v27 offset:33280
v_add_f32 v52, 2.0, v36
v_add_f32 v53, 2.0, v37
v_add_f32 v54, 2.0, v38
v_add_f32 v55, 2.0, v39
v_mfma_f32_32x32x16_bf16 v[80:95], a[156:159], a[100:103], v[80:95]
s_waitcnt lgkmcnt(6)
buffer_load_dwordx4 v25, s[16:19], s41 offen offset:2048 lds
ds_read_b64_tr_b16 a[180:181], v27 offset:33024
ds_read_b64_tr_b16 a[182:183], v27 offset:33536
v_mfma_f32_32x32x16_bf16 v[64:79], a[160:163], a[104:107], v[64:79]
s_add_u32 m0, s35, 24576
ds_read_b64_tr_b16 a[184:185], v27 offset:34816
ds_read_b64_tr_b16 a[186:187], v27 offset:35328
v_add_f32 v56, 2.0, v40
v_add_f32 v57, 2.0, v41
v_add_f32 v58, 2.0, v42
v_add_f32 v59, 2.0, v43
v_mfma_f32_32x32x16_bf16 v[80:95], a[164:167], a[104:107], v[80:95]
s_waitcnt lgkmcnt(6)
s_add_u32 s41, s39, 256
ds_read_b64_tr_b16 a[188:189], v27 offset:35072
ds_read_b64_tr_b16 a[190:191], v27 offset:35584
v_add_f32 v60, 2.0, v44
v_add_f32 v61, 2.0, v45
v_add_f32 v62, 2.0, v46
v_add_f32 v63, 2.0, v47
v_pk_fma_f32 v[32:33], v[32:33], v[48:49], v[16:17] op_sel:[0,0,0] op_sel_hi:[1,1,0]
v_pk_fma_f32 v[34:35], v[34:35], v[50:51], v[16:17] op_sel:[0,0,0] op_sel_hi:[1,1,0]
v_pk_fma_f32 v[36:37], v[36:37], v[52:53], v[16:17] op_sel:[0,0,0] op_sel_hi:[1,1,0]
v_pk_fma_f32 v[38:39], v[38:39], v[54:55], v[16:17] op_sel:[0,0,0] op_sel_hi:[1,1,0]
v_pk_fma_f32 v[40:41], v[40:41], v[56:57], v[16:17] op_sel:[0,0,0] op_sel_hi:[1,1,0]
v_pk_fma_f32 v[42:43], v[42:43], v[58:59], v[16:17] op_sel:[0,0,0] op_sel_hi:[1,1,0]
v_pk_fma_f32 v[44:45], v[44:45], v[60:61], v[16:17] op_sel:[0,0,0] op_sel_hi:[1,1,0]
v_pk_fma_f32 v[46:47], v[46:47], v[62:63], v[16:17] op_sel:[0,0,0] op_sel_hi:[1,1,0]
v_mfma_f32_32x32x16_bf16 v[64:79], a[168:171], a[108:111], v[64:79]
ds_read_b64_tr_b16 a[144:145], v28 offset:30720
ds_read_b64_tr_b16 a[146:147], v28 offset:31232
v_rcp_f32 v32, v32
v_rcp_f32 v33, v33
v_mfma_f32_32x32x16_bf16 v[80:95], a[172:175], a[108:111], v[80:95]
s_waitcnt lgkmcnt(6)
ds_read_b64_tr_b16 a[148:149], v28 offset:30976
ds_read_b64_tr_b16 a[150:151], v28 offset:31488
v_rcp_f32 v34, v34
v_rcp_f32 v35, v35
v_mfma_f32_32x32x16_bf16 v[64:79], a[176:179], a[112:115], v[64:79]
ds_read_b64_tr_b16 a[152:153], v28 offset:32768
ds_read_b64_tr_b16 a[154:155], v28 offset:33280
v_rcp_f32 v36, v36
v_mfma_f32_32x32x16_bf16 v[80:95], a[180:183], a[112:115], v[80:95]
s_waitcnt lgkmcnt(6)
ds_read_b64_tr_b16 a[156:157], v28 offset:33024
ds_read_b64_tr_b16 a[158:159], v28 offset:33536
v_rcp_f32 v37, v37
v_mfma_f32_32x32x16_bf16 v[64:79], a[184:187], a[116:119], v[64:79]
ds_read_b64_tr_b16 a[160:161], v28 offset:34816
ds_read_b64_tr_b16 a[162:163], v28 offset:35328
v_rcp_f32 v38, v38
v_rcp_f32 v39, v39
v_mfma_f32_32x32x16_bf16 v[80:95], a[188:191], a[116:119], v[80:95]
s_waitcnt lgkmcnt(6)
ds_read_b64_tr_b16 a[164:165], v28 offset:35072
ds_read_b64_tr_b16 a[166:167], v28 offset:35584
v_rcp_f32 v40, v40
v_rcp_f32 v41, v41
s_waitcnt vmcnt(18)
s_barrier
v_mfma_f32_32x32x16_bf16 v[64:79], a[144:147], a[120:123], v[64:79]
buffer_load_dwordx4 v23, s[16:19], s41 offen offset:0 lds
ds_read_b64_tr_b16 a[168:169], v29 offset:30720
ds_read_b64_tr_b16 a[170:171], v29 offset:31232
v_mfma_f32_32x32x16_bf16 v[80:95], a[148:151], a[120:123], v[80:95]
s_waitcnt lgkmcnt(6)
ds_read_b64_tr_b16 a[172:173], v29 offset:30976
ds_read_b64_tr_b16 a[174:175], v29 offset:31488
v_rcp_f32 v42, v42
v_rcp_f32 v43, v43
v_mfma_f32_32x32x16_bf16 v[64:79], a[152:155], a[124:127], v[64:79]
ds_read_b64_tr_b16 a[176:177], v29 offset:32768
ds_read_b64_tr_b16 a[178:179], v29 offset:33280
v_rcp_f32 v44, v44
v_rcp_f32 v45, v45
v_mfma_f32_32x32x16_bf16 v[80:95], a[156:159], a[124:127], v[80:95]
s_waitcnt lgkmcnt(6)
buffer_load_dwordx4 v24, s[16:19], s41 offen offset:1024 lds
ds_read_b64_tr_b16 a[180:181], v29 offset:33024
ds_read_b64_tr_b16 a[182:183], v29 offset:33536
v_mfma_f32_32x32x16_bf16 v[64:79], a[160:163], a[128:131], v[64:79]
ds_read_b64_tr_b16 a[184:185], v29 offset:34816
ds_read_b64_tr_b16 a[186:187], v29 offset:35328
v_rcp_f32 v46, v46
v_rcp_f32 v47, v47
v_pk_fma_f32 v[32:33], v[32:33], v[14:15], v[30:31] op_sel:[0,1,1] op_sel_hi:[1,1,1]
v_pk_fma_f32 v[34:35], v[34:35], v[14:15], v[30:31] op_sel:[0,1,1] op_sel_hi:[1,1,1]
v_pk_fma_f32 v[36:37], v[36:37], v[14:15], v[30:31] op_sel:[0,1,1] op_sel_hi:[1,1,1]
v_pk_fma_f32 v[38:39], v[38:39], v[14:15], v[30:31] op_sel:[0,1,1] op_sel_hi:[1,1,1]
v_pk_fma_f32 v[40:41], v[40:41], v[14:15], v[30:31] op_sel:[0,1,1] op_sel_hi:[1,1,1]
v_pk_fma_f32 v[42:43], v[42:43], v[14:15], v[30:31] op_sel:[0,1,1] op_sel_hi:[1,1,1]
v_pk_fma_f32 v[44:45], v[44:45], v[14:15], v[30:31] op_sel:[0,1,1] op_sel_hi:[1,1,1]
v_pk_fma_f32 v[46:47], v[46:47], v[14:15], v[30:31] op_sel:[0,1,1] op_sel_hi:[1,1,1]
v_pk_mul_f32 v[224:225], v[224:225], v[32:33] op_sel:[0,0] op_sel_hi:[1,1]
v_pk_mul_f32 v[226:227], v[226:227], v[34:35] op_sel:[0,0] op_sel_hi:[1,1]
v_pk_mul_f32 v[228:229], v[228:229], v[36:37] op_sel:[0,0] op_sel_hi:[1,1]
v_pk_mul_f32 v[230:231], v[230:231], v[38:39] op_sel:[0,0] op_sel_hi:[1,1]
v_pk_mul_f32 v[232:233], v[232:233], v[40:41] op_sel:[0,0] op_sel_hi:[1,1]
v_pk_mul_f32 v[234:235], v[234:235], v[42:43] op_sel:[0,0] op_sel_hi:[1,1]
v_pk_mul_f32 v[236:237], v[236:237], v[44:45] op_sel:[0,0] op_sel_hi:[1,1]
v_pk_mul_f32 v[238:239], v[238:239], v[46:47] op_sel:[0,0] op_sel_hi:[1,1]
v_mfma_f32_32x32x16_bf16 v[80:95], a[164:167], a[128:131], v[80:95]
s_waitcnt lgkmcnt(6)
ds_read_b64_tr_b16 a[188:189], v29 offset:35072
ds_read_b64_tr_b16 a[190:191], v29 offset:35584
v_cvt_pk_bf16_f32 v168, v224, v225
v_cvt_pk_bf16_f32 v169, v226, v227
v_cvt_pk_bf16_f32 v170, v228, v229
v_cvt_pk_bf16_f32 v171, v230, v231
v_mfma_f32_32x32x16_bf16 v[64:79], a[168:171], a[132:135], v[64:79]
buffer_load_dwordx4 v25, s[16:19], s41 offen offset:2048 lds
ds_read_b64_tr_b16 a[144:145], v240 offset:0
ds_read_b64_tr_b16 a[146:147], v240 offset:1024
v_mfma_f32_32x32x16_bf16 v[80:95], a[172:175], a[132:135], v[80:95]
s_waitcnt lgkmcnt(6)
s_add_u32 m0, s35, 27648
ds_read_b64_tr_b16 a[148:149], v240 offset:256
ds_read_b64_tr_b16 a[150:151], v240 offset:1280
v_cvt_pk_bf16_f32 v172, v232, v233
v_cvt_pk_bf16_f32 v173, v234, v235
v_cvt_pk_bf16_f32 v174, v236, v237
v_cvt_pk_bf16_f32 v175, v238, v239
v_mfma_f32_32x32x16_bf16 v[64:79], a[176:179], a[136:139], v[64:79]
s_add_u32 s41, s39, 27904
ds_read_b64_tr_b16 a[152:153], v240 offset:2048
ds_read_b64_tr_b16 a[154:155], v240 offset:3072
v_mfma_f32_32x32x16_bf16 v[80:95], a[180:183], a[136:139], v[80:95]
s_waitcnt lgkmcnt(6)
buffer_load_dwordx4 v23, s[16:19], s41 offen offset:0 lds
ds_read_b64_tr_b16 a[156:157], v240 offset:2304
ds_read_b64_tr_b16 a[158:159], v240 offset:3328
v_mfma_f32_32x32x16_bf16 v[64:79], a[184:187], a[140:143], v[64:79]
ds_read_b64_tr_b16 a[160:161], v240 offset:4096
ds_read_b64_tr_b16 a[162:163], v240 offset:5120
ds_read_b128 v[48:51], v30 offset:1280
ds_read_b128 v[52:55], v30 offset:1312
ds_read_b128 v[56:59], v30 offset:1344
ds_read_b128 v[60:63], v30 offset:1376
v_mfma_f32_32x32x16_bf16 v[80:95], a[188:191], a[140:143], v[80:95]
s_waitcnt lgkmcnt(10)
ds_read_b64_tr_b16 a[164:165], v240 offset:4352
ds_read_b64_tr_b16 a[166:167], v240 offset:5376
v_mfma_f32_32x32x16_bf16 v[208:223], a[144:147], v[96:99], 0
buffer_load_dwordx4 v24, s[16:19], s41 offen offset:1024 lds
ds_read_b64_tr_b16 a[168:169], v241 offset:0
ds_read_b64_tr_b16 a[170:171], v241 offset:1024
v_mfma_f32_32x32x16_bf16 v[224:239], a[148:151], v[96:99], 0
s_waitcnt lgkmcnt(10)
ds_read_b64_tr_b16 a[172:173], v241 offset:256
ds_read_b64_tr_b16 a[174:175], v241 offset:1280
v_mfma_f32_32x32x16_bf16 v[208:223], a[152:155], v[100:103], v[208:223]
ds_read_b64_tr_b16 a[176:177], v241 offset:2048
ds_read_b64_tr_b16 a[178:179], v241 offset:3072
s_waitcnt lgkmcnt(11)
v_pk_fma_f32 v[64:65], v[64:65], v[14:15], v[48:49] op_sel:[0,0,0] op_sel_hi:[1,0,1]
v_pk_fma_f32 v[66:67], v[66:67], v[14:15], v[50:51] op_sel:[0,0,0] op_sel_hi:[1,0,1]
s_waitcnt lgkmcnt(10)
v_pk_fma_f32 v[68:69], v[68:69], v[14:15], v[52:53] op_sel:[0,0,0] op_sel_hi:[1,0,1]
v_pk_fma_f32 v[70:71], v[70:71], v[14:15], v[54:55] op_sel:[0,0,0] op_sel_hi:[1,0,1]
s_waitcnt lgkmcnt(9)
v_pk_fma_f32 v[72:73], v[72:73], v[14:15], v[56:57] op_sel:[0,0,0] op_sel_hi:[1,0,1]
v_pk_fma_f32 v[74:75], v[74:75], v[14:15], v[58:59] op_sel:[0,0,0] op_sel_hi:[1,0,1]
s_waitcnt lgkmcnt(8)
v_pk_fma_f32 v[76:77], v[76:77], v[14:15], v[60:61] op_sel:[0,0,0] op_sel_hi:[1,0,1]
v_pk_fma_f32 v[78:79], v[78:79], v[14:15], v[62:63] op_sel:[0,0,0] op_sel_hi:[1,0,1]
v_mfma_f32_32x32x16_bf16 v[224:239], a[156:159], v[100:103], v[224:239]
s_waitcnt lgkmcnt(6)
buffer_load_dwordx4 v25, s[16:19], s41 offen offset:2048 lds
ds_read_b64_tr_b16 a[180:181], v241 offset:2304
ds_read_b64_tr_b16 a[182:183], v241 offset:3328
v_mfma_f32_32x32x16_bf16 v[208:223], a[160:163], v[104:107], v[208:223]
s_add_u32 m0, s35, 30720
ds_read_b64_tr_b16 a[184:185], v241 offset:4096
ds_read_b64_tr_b16 a[186:187], v241 offset:5120
v_exp_f32 v32, v64
L_pad_f2_1:
s_cbranch_execz L_pad_f2_2
v_exp_f32 v33, v65
v_exp_f32 v34, v66
v_mfma_f32_32x32x16_bf16 v[224:239], a[164:167], v[104:107], v[224:239]
s_waitcnt lgkmcnt(6)
s_add_u32 s41, s39, 221440
ds_read_b64_tr_b16 a[188:189], v241 offset:4352
ds_read_b64_tr_b16 a[190:191], v241 offset:5376
v_exp_f32 v35, v67
v_exp_f32 v36, v68
v_exp_f32 v37, v69
v_mfma_f32_32x32x16_bf16 v[208:223], a[168:171], v[108:111], v[208:223]
ds_read_b64_tr_b16 a[144:145], v242 offset:0
ds_read_b64_tr_b16 a[146:147], v242 offset:1024
v_exp_f32 v38, v70
v_exp_f32 v39, v71
v_exp_f32 v40, v72
v_mfma_f32_32x32x16_bf16 v[224:239], a[172:175], v[108:111], v[224:239]
s_waitcnt lgkmcnt(6)
ds_read_b64_tr_b16 a[148:149], v242 offset:256
ds_read_b64_tr_b16 a[150:151], v242 offset:1280
v_exp_f32 v41, v73
v_exp_f32 v42, v74
v_exp_f32 v43, v75
v_mfma_f32_32x32x16_bf16 v[208:223], a[176:179], v[112:115], v[208:223]
ds_read_b64_tr_b16 a[152:153], v242 offset:2048
ds_read_b64_tr_b16 a[154:155], v242 offset:3072
v_exp_f32 v44, v76
v_exp_f32 v45, v77
v_exp_f32 v46, v78
v_mfma_f32_32x32x16_bf16 v[224:239], a[180:183], v[112:115], v[224:239]
s_waitcnt lgkmcnt(6)
ds_read_b64_tr_b16 a[156:157], v242 offset:2304
ds_read_b64_tr_b16 a[158:159], v242 offset:3328
v_exp_f32 v47, v79
v_add_f32 v48, 2.0, v32
v_add_f32 v49, 2.0, v33
v_add_f32 v50, 2.0, v34
v_add_f32 v51, 2.0, v35
v_add_f32 v52, 2.0, v36
v_mfma_f32_32x32x16_bf16 v[208:223], a[184:187], v[116:119], v[208:223]
ds_read_b64_tr_b16 a[160:161], v242 offset:4096
ds_read_b64_tr_b16 a[162:163], v242 offset:5120
v_add_f32 v53, 2.0, v37
v_add_f32 v54, 2.0, v38
v_add_f32 v55, 2.0, v39
v_add_f32 v56, 2.0, v40
v_add_f32 v57, 2.0, v41
v_add_f32 v58, 2.0, v42
v_add_f32 v59, 2.0, v43
v_mfma_f32_32x32x16_bf16 v[224:239], a[188:191], v[116:119], v[224:239]
s_waitcnt lgkmcnt(6)
ds_read_b64_tr_b16 a[164:165], v242 offset:4352
ds_read_b64_tr_b16 a[166:167], v242 offset:5376
v_add_f32 v60, 2.0, v44
v_add_f32 v61, 2.0, v45
v_add_f32 v62, 2.0, v46
v_add_f32 v63, 2.0, v47
v_pk_fma_f32 v[32:33], v[32:33], v[48:49], v[16:17] op_sel:[0,0,0] op_sel_hi:[1,1,0]
v_pk_fma_f32 v[34:35], v[34:35], v[50:51], v[16:17] op_sel:[0,0,0] op_sel_hi:[1,1,0]
v_pk_fma_f32 v[36:37], v[36:37], v[52:53], v[16:17] op_sel:[0,0,0] op_sel_hi:[1,1,0]
v_pk_fma_f32 v[38:39], v[38:39], v[54:55], v[16:17] op_sel:[0,0,0] op_sel_hi:[1,1,0]
v_pk_fma_f32 v[40:41], v[40:41], v[56:57], v[16:17] op_sel:[0,0,0] op_sel_hi:[1,1,0]
v_pk_fma_f32 v[42:43], v[42:43], v[58:59], v[16:17] op_sel:[0,0,0] op_sel_hi:[1,1,0]
v_pk_fma_f32 v[44:45], v[44:45], v[60:61], v[16:17] op_sel:[0,0,0] op_sel_hi:[1,1,0]
v_pk_fma_f32 v[46:47], v[46:47], v[62:63], v[16:17] op_sel:[0,0,0] op_sel_hi:[1,1,0]
s_waitcnt vmcnt(18)
s_barrier
v_mfma_f32_32x32x16_bf16 v[208:223], a[144:147], v[120:123], v[208:223]
buffer_load_dwordx4 v23, s[16:19], s41 offen offset:0 lds
ds_read_b64_tr_b16 a[168:169], v243 offset:0
ds_read_b64_tr_b16 a[170:171], v243 offset:1024
v_mfma_f32_32x32x16_bf16 v[224:239], a[148:151], v[120:123], v[224:239]
s_waitcnt lgkmcnt(6)
ds_read_b64_tr_b16 a[172:173], v243 offset:256
ds_read_b64_tr_b16 a[174:175], v243 offset:1280
ds_read_b128 v[48:51], v30 offset:1408
ds_read_b128 v[52:55], v30 offset:1440
ds_read_b128 v[56:59], v30 offset:1472
ds_read_b128 v[60:63], v30 offset:1504
v_rcp_f32 v32, v32
v_mfma_f32_32x32x16_bf16 v[208:223], a[152:155], v[124:127], v[208:223]
ds_read_b64_tr_b16 a[176:177], v243 offset:2048
ds_read_b64_tr_b16 a[178:179], v243 offset:3072
v_rcp_f32 v33, v33
v_rcp_f32 v34, v34
v_rcp_f32 v35, v35
v_mfma_f32_32x32x16_bf16 v[224:239], a[156:159], v[124:127], v[224:239]
s_waitcnt lgkmcnt(10)
buffer_load_dwordx4 v24, s[16:19], s41 offen offset:1024 lds
ds_read_b64_tr_b16 a[180:181], v243 offset:2304
ds_read_b64_tr_b16 a[182:183], v243 offset:3328
v_mfma_f32_32x32x16_bf16 v[208:223], a[160:163], v[128:131], v[208:223]
ds_read_b64_tr_b16 a[184:185], v243 offset:4096
ds_read_b64_tr_b16 a[186:187], v243 offset:5120
v_rcp_f32 v36, v36
v_rcp_f32 v37, v37
v_rcp_f32 v38, v38
v_mfma_f32_32x32x16_bf16 v[224:239], a[164:167], v[128:131], v[224:239]
s_waitcnt lgkmcnt(10)
ds_read_b64_tr_b16 a[188:189], v243 offset:4352
ds_read_b64_tr_b16 a[190:191], v243 offset:5376
v_rcp_f32 v39, v39
v_rcp_f32 v40, v40
v_rcp_f32 v41, v41
v_mfma_f32_32x32x16_bf16 v[208:223], a[168:171], v[132:135], v[208:223]
buffer_load_dwordx4 v25, s[16:19], s41 offen offset:2048 lds
ds_read_b64_tr_b16 a[144:145], v240 offset:6144
ds_read_b64_tr_b16 a[146:147], v240 offset:7168
v_mfma_f32_32x32x16_bf16 v[224:239], a[172:175], v[132:135], v[224:239]
s_waitcnt lgkmcnt(6)
s_add_u32 m0, s35, 33792
ds_read_b64_tr_b16 a[148:149], v240 offset:6400
ds_read_b64_tr_b16 a[150:151], v240 offset:7424
v_rcp_f32 v42, v42
v_rcp_f32 v43, v43
v_rcp_f32 v44, v44
v_mfma_f32_32x32x16_bf16 v[208:223], a[176:179], v[136:139], v[208:223]
s_add_u32 s41, s39, 249088
ds_read_b64_tr_b16 a[152:153], v240 offset:8192
ds_read_b64_tr_b16 a[154:155], v240 offset:9216
v_rcp_f32 v45, v45
v_rcp_f32 v46, v46
v_rcp_f32 v47, v47
v_pk_fma_f32 v[32:33], v[32:33], v[14:15], v[30:31] op_sel:[0,1,1] op_sel_hi:[1,1,1]
v_pk_fma_f32 v[34:35], v[34:35], v[14:15], v[30:31] op_sel:[0,1,1] op_sel_hi:[1,1,1]
v_pk_fma_f32 v[36:37], v[36:37], v[14:15], v[30:31] op_sel:[0,1,1] op_sel_hi:[1,1,1]
v_pk_fma_f32 v[38:39], v[38:39], v[14:15], v[30:31] op_sel:[0,1,1] op_sel_hi:[1,1,1]
v_pk_fma_f32 v[40:41], v[40:41], v[14:15], v[30:31] op_sel:[0,1,1] op_sel_hi:[1,1,1]
v_pk_fma_f32 v[42:43], v[42:43], v[14:15], v[30:31] op_sel:[0,1,1] op_sel_hi:[1,1,1]
v_pk_fma_f32 v[44:45], v[44:45], v[14:15], v[30:31] op_sel:[0,1,1] op_sel_hi:[1,1,1]
v_pk_fma_f32 v[46:47], v[46:47], v[14:15], v[30:31] op_sel:[0,1,1] op_sel_hi:[1,1,1]
v_pk_mul_f32 v[64:65], v[64:65], v[32:33] op_sel:[0,0] op_sel_hi:[1,1]
v_pk_mul_f32 v[66:67], v[66:67], v[34:35] op_sel:[0,0] op_sel_hi:[1,1]
v_pk_mul_f32 v[68:69], v[68:69], v[36:37] op_sel:[0,0] op_sel_hi:[1,1]
v_pk_mul_f32 v[70:71], v[70:71], v[38:39] op_sel:[0,0] op_sel_hi:[1,1]
v_pk_mul_f32 v[72:73], v[72:73], v[40:41] op_sel:[0,0] op_sel_hi:[1,1]
v_pk_mul_f32 v[74:75], v[74:75], v[42:43] op_sel:[0,0] op_sel_hi:[1,1]
v_pk_mul_f32 v[76:77], v[76:77], v[44:45] op_sel:[0,0] op_sel_hi:[1,1]
v_pk_mul_f32 v[78:79], v[78:79], v[46:47] op_sel:[0,0] op_sel_hi:[1,1]
v_pk_fma_f32 v[80:81], v[80:81], v[14:15], v[48:49] op_sel:[0,0,0] op_sel_hi:[1,0,1]
v_pk_fma_f32 v[82:83], v[82:83], v[14:15], v[50:51] op_sel:[0,0,0] op_sel_hi:[1,0,1]
v_pk_fma_f32 v[84:85], v[84:85], v[14:15], v[52:53] op_sel:[0,0,0] op_sel_hi:[1,0,1]
v_pk_fma_f32 v[86:87], v[86:87], v[14:15], v[54:55] op_sel:[0,0,0] op_sel_hi:[1,0,1]
v_pk_fma_f32 v[88:89], v[88:89], v[14:15], v[56:57] op_sel:[0,0,0] op_sel_hi:[1,0,1]
v_pk_fma_f32 v[90:91], v[90:91], v[14:15], v[58:59] op_sel:[0,0,0] op_sel_hi:[1,0,1]
v_pk_fma_f32 v[92:93], v[92:93], v[14:15], v[60:61] op_sel:[0,0,0] op_sel_hi:[1,0,1]
v_pk_fma_f32 v[94:95], v[94:95], v[14:15], v[62:63] op_sel:[0,0,0] op_sel_hi:[1,0,1]
v_mfma_f32_32x32x16_bf16 v[224:239], a[180:183], v[136:139], v[224:239]
s_waitcnt lgkmcnt(6)
buffer_load_dwordx4 v23, s[16:19], s41 offen offset:0 lds
ds_read_b64_tr_b16 a[156:157], v240 offset:8448
ds_read_b64_tr_b16 a[158:159], v240 offset:9472
v_mfma_f32_32x32x16_bf16 v[208:223], a[184:187], v[140:143], v[208:223]
ds_read_b64_tr_b16 a[160:161], v240 offset:10240
ds_read_b64_tr_b16 a[162:163], v240 offset:11264
v_cvt_pk_bf16_f32 v176, v64, v65
v_cvt_pk_bf16_f32 v177, v66, v67
v_cvt_pk_bf16_f32 v178, v68, v69
v_cvt_pk_bf16_f32 v179, v70, v71
v_cvt_pk_bf16_f32 v180, v72, v73
v_cvt_pk_bf16_f32 v181, v74, v75
v_cvt_pk_bf16_f32 v182, v76, v77
v_cvt_pk_bf16_f32 v183, v78, v79
v_mfma_f32_32x32x16_bf16 v[224:239], a[188:191], v[140:143], v[224:239]
s_waitcnt lgkmcnt(6)
ds_read_b64_tr_b16 a[164:165], v240 offset:10496
ds_read_b64_tr_b16 a[166:167], v240 offset:11520
v_exp_f32 v32, v80
v_exp_f32 v33, v81
v_exp_f32 v34, v82
v_exp_f32 v35, v83
v_mfma_f32_32x32x16_bf16 v[208:223], a[144:147], v[144:147], v[208:223]
buffer_load_dwordx4 v24, s[16:19], s41 offen offset:1024 lds
ds_read_b64_tr_b16 a[168:169], v241 offset:6144
ds_read_b64_tr_b16 a[170:171], v241 offset:7168
v_mfma_f32_32x32x16_bf16 v[224:239], a[148:151], v[144:147], v[224:239]
s_waitcnt lgkmcnt(6)
ds_read_b64_tr_b16 a[172:173], v241 offset:6400
ds_read_b64_tr_b16 a[174:175], v241 offset:7424
v_exp_f32 v36, v84
v_exp_f32 v37, v85
v_exp_f32 v38, v86
v_exp_f32 v39, v87
v_mfma_f32_32x32x16_bf16 v[208:223], a[152:155], v[148:151], v[208:223]
ds_read_b64_tr_b16 a[176:177], v241 offset:8192
ds_read_b64_tr_b16 a[178:179], v241 offset:9216
v_exp_f32 v40, v88
v_exp_f32 v41, v89
v_exp_f32 v42, v90
v_exp_f32 v43, v91
v_mfma_f32_32x32x16_bf16 v[224:239], a[156:159], v[148:151], v[224:239]
s_waitcnt lgkmcnt(6)
buffer_load_dwordx4 v25, s[16:19], s41 offen offset:2048 lds
ds_read_b64_tr_b16 a[180:181], v241 offset:8448
ds_read_b64_tr_b16 a[182:183], v241 offset:9472
v_mfma_f32_32x32x16_bf16 v[208:223], a[160:163], v[152:155], v[208:223]
s_add_u32 m0, s35, 0
ds_read_b64_tr_b16 a[184:185], v241 offset:10240
ds_read_b64_tr_b16 a[186:187], v241 offset:11264
v_exp_f32 v44, v92
v_exp_f32 v45, v93
v_exp_f32 v46, v94
v_exp_f32 v47, v95
v_add_f32 v48, 2.0, v32
v_mfma_f32_32x32x16_bf16 v[224:239], a[164:167], v[152:155], v[224:239]
s_waitcnt lgkmcnt(6)
s_add_u32 s41, s39, 384
ds_read_b64_tr_b16 a[188:189], v241 offset:10496
ds_read_b64_tr_b16 a[190:191], v241 offset:11520
v_add_f32 v49, 2.0, v33
v_add_f32 v50, 2.0, v34
v_add_f32 v51, 2.0, v35
v_add_f32 v52, 2.0, v36
v_add_f32 v53, 2.0, v37
v_add_f32 v54, 2.0, v38
v_add_f32 v55, 2.0, v39
v_add_f32 v56, 2.0, v40
v_add_f32 v57, 2.0, v41
v_mfma_f32_32x32x16_bf16 v[208:223], a[168:171], v[156:159], v[208:223]
ds_read_b64_tr_b16 a[144:145], v242 offset:6144
ds_read_b64_tr_b16 a[146:147], v242 offset:7168
v_add_f32 v58, 2.0, v42
v_add_f32 v59, 2.0, v43
v_add_f32 v60, 2.0, v44
v_add_f32 v61, 2.0, v45
v_add_f32 v62, 2.0, v46
v_add_f32 v63, 2.0, v47
v_pk_fma_f32 v[32:33], v[32:33], v[48:49], v[16:17] op_sel:[0,0,0] op_sel_hi:[1,1,0]
v_pk_fma_f32 v[34:35], v[34:35], v[50:51], v[16:17] op_sel:[0,0,0] op_sel_hi:[1,1,0]
v_pk_fma_f32 v[36:37], v[36:37], v[52:53], v[16:17] op_sel:[0,0,0] op_sel_hi:[1,1,0]
v_pk_fma_f32 v[38:39], v[38:39], v[54:55], v[16:17] op_sel:[0,0,0] op_sel_hi:[1,1,0]
v_pk_fma_f32 v[40:41], v[40:41], v[56:57], v[16:17] op_sel:[0,0,0] op_sel_hi:[1,1,0]
v_pk_fma_f32 v[42:43], v[42:43], v[58:59], v[16:17] op_sel:[0,0,0] op_sel_hi:[1,1,0]
v_pk_fma_f32 v[44:45], v[44:45], v[60:61], v[16:17] op_sel:[0,0,0] op_sel_hi:[1,1,0]
v_pk_fma_f32 v[46:47], v[46:47], v[62:63], v[16:17] op_sel:[0,0,0] op_sel_hi:[1,1,0]
v_mfma_f32_32x32x16_bf16 v[224:239], a[172:175], v[156:159], v[224:239]
s_waitcnt lgkmcnt(6)
ds_read_b64_tr_b16 a[148:149], v242 offset:6400
ds_read_b64_tr_b16 a[150:151], v242 offset:7424
v_rcp_f32 v32, v32
v_rcp_f32 v33, v33
v_rcp_f32 v34, v34
v_rcp_f32 v35, v35
v_mfma_f32_32x32x16_bf16 v[208:223], a[176:179], v[160:163], v[208:223]
ds_read_b64_tr_b16 a[152:153], v242 offset:8192
ds_read_b64_tr_b16 a[154:155], v242 offset:9216
v_rcp_f32 v36, v36
v_rcp_f32 v37, v37
v_rcp_f32 v38, v38
v_rcp_f32 v39, v39
v_mfma_f32_32x32x16_bf16 v[224:239], a[180:183], v[160:163], v[224:239]
s_waitcnt lgkmcnt(6)
ds_read_b64_tr_b16 a[156:157], v242 offset:8448
ds_read_b64_tr_b16 a[158:159], v242 offset:9472
v_rcp_f32 v40, v40
v_rcp_f32 v41, v41
v_rcp_f32 v42, v42
v_rcp_f32 v43, v43
v_mfma_f32_32x32x16_bf16 v[208:223], a[184:187], v[164:167], v[208:223]
ds_read_b64_tr_b16 a[160:161], v242 offset:10240
ds_read_b64_tr_b16 a[162:163], v242 offset:11264
v_rcp_f32 v44, v44
v_rcp_f32 v45, v45
v_mfma_f32_32x32x16_bf16 v[224:239], a[188:191], v[164:167], v[224:239]
s_waitcnt lgkmcnt(6)
ds_read_b64_tr_b16 a[164:165], v242 offset:10496
ds_read_b64_tr_b16 a[166:167], v242 offset:11520
v_rcp_f32 v46, v46
v_rcp_f32 v47, v47
v_pk_fma_f32 v[32:33], v[32:33], v[14:15], v[30:31] op_sel:[0,1,1] op_sel_hi:[1,1,1]
v_pk_fma_f32 v[34:35], v[34:35], v[14:15], v[30:31] op_sel:[0,1,1] op_sel_hi:[1,1,1]
v_pk_fma_f32 v[36:37], v[36:37], v[14:15], v[30:31] op_sel:[0,1,1] op_sel_hi:[1,1,1]
v_pk_fma_f32 v[38:39], v[38:39], v[14:15], v[30:31] op_sel:[0,1,1] op_sel_hi:[1,1,1]
v_pk_fma_f32 v[40:41], v[40:41], v[14:15], v[30:31] op_sel:[0,1,1] op_sel_hi:[1,1,1]
v_pk_fma_f32 v[42:43], v[42:43], v[14:15], v[30:31] op_sel:[0,1,1] op_sel_hi:[1,1,1]
v_pk_fma_f32 v[44:45], v[44:45], v[14:15], v[30:31] op_sel:[0,1,1] op_sel_hi:[1,1,1]
v_pk_fma_f32 v[46:47], v[46:47], v[14:15], v[30:31] op_sel:[0,1,1] op_sel_hi:[1,1,1]
v_pk_mul_f32 v[80:81], v[80:81], v[32:33] op_sel:[0,0] op_sel_hi:[1,1]
v_pk_mul_f32 v[82:83], v[82:83], v[34:35] op_sel:[0,0] op_sel_hi:[1,1]
v_pk_mul_f32 v[84:85], v[84:85], v[36:37] op_sel:[0,0] op_sel_hi:[1,1]
v_pk_mul_f32 v[86:87], v[86:87], v[38:39] op_sel:[0,0] op_sel_hi:[1,1]
v_pk_mul_f32 v[88:89], v[88:89], v[40:41] op_sel:[0,0] op_sel_hi:[1,1]
v_pk_mul_f32 v[90:91], v[90:91], v[42:43] op_sel:[0,0] op_sel_hi:[1,1]
v_pk_mul_f32 v[92:93], v[92:93], v[44:45] op_sel:[0,0] op_sel_hi:[1,1]
v_pk_mul_f32 v[94:95], v[94:95], v[46:47] op_sel:[0,0] op_sel_hi:[1,1]
s_waitcnt vmcnt(18)
s_barrier
v_mfma_f32_32x32x16_bf16 v[208:223], a[144:147], v[168:171], v[208:223]
buffer_load_dwordx4 v23, s[16:19], s41 offen offset:0 lds
ds_read_b64_tr_b16 a[168:169], v243 offset:6144
ds_read_b64_tr_b16 a[170:171], v243 offset:7168
v_mfma_f32_32x32x16_bf16 v[224:239], a[148:151], v[168:171], v[224:239]
s_waitcnt lgkmcnt(6)
ds_read_b64_tr_b16 a[172:173], v243 offset:6400
ds_read_b64_tr_b16 a[174:175], v243 offset:7424
v_cvt_pk_bf16_f32 v184, v80, v81
v_cvt_pk_bf16_f32 v185, v82, v83
v_cvt_pk_bf16_f32 v186, v84, v85
v_cvt_pk_bf16_f32 v187, v86, v87
v_cvt_pk_bf16_f32 v188, v88, v89
v_cvt_pk_bf16_f32 v189, v90, v91
v_cvt_pk_bf16_f32 v190, v92, v93
v_cvt_pk_bf16_f32 v191, v94, v95
v_mfma_f32_32x32x16_bf16 v[208:223], a[152:155], v[172:175], v[208:223]
ds_read_b64_tr_b16 a[176:177], v243 offset:8192
ds_read_b64_tr_b16 a[178:179], v243 offset:9216
v_mfma_f32_32x32x16_bf16 v[224:239], a[156:159], v[172:175], v[224:239]
s_waitcnt lgkmcnt(6)
buffer_load_dwordx4 v24, s[16:19], s41 offen offset:1024 lds
ds_read_b64_tr_b16 a[180:181], v243 offset:8448
ds_read_b64_tr_b16 a[182:183], v243 offset:9472
v_mfma_f32_32x32x16_bf16 v[208:223], a[160:163], v[176:179], v[208:223]
ds_read_b64_tr_b16 a[184:185], v243 offset:10240
ds_read_b64_tr_b16 a[186:187], v243 offset:11264
v_mfma_f32_32x32x16_bf16 v[224:239], a[164:167], v[176:179], v[224:239]
s_waitcnt lgkmcnt(6)
ds_read_b64_tr_b16 a[188:189], v243 offset:10496
ds_read_b64_tr_b16 a[190:191], v243 offset:11520
v_mfma_f32_32x32x16_bf16 v[208:223], a[168:171], v[180:183], v[208:223]
buffer_load_dwordx4 v25, s[16:19], s41 offen offset:2048 lds
ds_read_b64_tr_b16 a[144:145], v240 offset:12288
ds_read_b64_tr_b16 a[146:147], v240 offset:13312
v_mfma_f32_32x32x16_bf16 v[224:239], a[172:175], v[180:183], v[224:239]
s_waitcnt lgkmcnt(6)
s_add_u32 m0, s35, 3072
ds_read_b64_tr_b16 a[148:149], v240 offset:12544
ds_read_b64_tr_b16 a[150:151], v240 offset:13568
v_mfma_f32_32x32x16_bf16 v[208:223], a[176:179], v[184:187], v[208:223]
s_add_u32 s41, s39, 28032
ds_read_b64_tr_b16 a[152:153], v240 offset:14336
ds_read_b64_tr_b16 a[154:155], v240 offset:15360
v_mfma_f32_32x32x16_bf16 v[224:239], a[180:183], v[184:187], v[224:239]
s_waitcnt lgkmcnt(6)
buffer_load_dwordx4 v23, s[16:19], s41 offen offset:0 lds
ds_read_b64_tr_b16 a[156:157], v240 offset:14592
ds_read_b64_tr_b16 a[158:159], v240 offset:15616
v_mfma_f32_32x32x16_bf16 v[208:223], a[184:187], v[188:191], v[208:223]
ds_read_b64_tr_b16 a[160:161], v240 offset:16384
ds_read_b64_tr_b16 a[162:163], v240 offset:17408
v_mfma_f32_32x32x16_bf16 v[224:239], a[188:191], v[188:191], v[224:239]
s_waitcnt lgkmcnt(6)
ds_read_b64_tr_b16 a[164:165], v240 offset:16640
ds_read_b64_tr_b16 a[166:167], v240 offset:17664
v_mfma_f32_32x32x16_bf16 v[64:79], a[144:147], v[96:99], 0
buffer_load_dwordx4 v24, s[16:19], s41 offen offset:1024 lds
ds_read_b64_tr_b16 a[168:169], v241 offset:12288
ds_read_b64_tr_b16 a[170:171], v241 offset:13312
v_mfma_f32_32x32x16_bf16 v[80:95], a[148:151], v[96:99], 0
s_waitcnt lgkmcnt(6)
ds_read_b64_tr_b16 a[172:173], v241 offset:12544
ds_read_b64_tr_b16 a[174:175], v241 offset:13568
v_mfma_f32_32x32x16_bf16 v[64:79], a[152:155], v[100:103], v[64:79]
ds_read_b64_tr_b16 a[176:177], v241 offset:14336
ds_read_b64_tr_b16 a[178:179], v241 offset:15360
v_mfma_f32_32x32x16_bf16 v[80:95], a[156:159], v[100:103], v[80:95]
s_waitcnt lgkmcnt(6)
buffer_load_dwordx4 v25, s[16:19], s41 offen offset:2048 lds
ds_read_b64_tr_b16 a[180:181], v241 offset:14592
ds_read_b64_tr_b16 a[182:183], v241 offset:15616
v_mfma_f32_32x32x16_bf16 v[64:79], a[160:163], v[104:107], v[64:79]
s_add_u32 m0, s35, 6144
ds_read_b64_tr_b16 a[184:185], v241 offset:16384
ds_read_b64_tr_b16 a[186:187], v241 offset:17408
v_cvt_pk_bf16_f32 v192, v208, v209
v_cvt_pk_bf16_f32 v193, v210, v211
v_cvt_pk_bf16_f32 v194, v212, v213
v_mfma_f32_32x32x16_bf16 v[80:95], a[164:167], v[104:107], v[80:95]
s_waitcnt lgkmcnt(6)
s_add_u32 s41, s39, 221568
ds_read_b64_tr_b16 a[188:189], v241 offset:16640
ds_read_b64_tr_b16 a[190:191], v241 offset:17664
v_cvt_pk_bf16_f32 v195, v214, v215
v_mfma_f32_32x32x16_bf16 v[64:79], a[168:171], v[108:111], v[64:79]
s_add_u32 s42, s40, 0
buffer_store_dwordx4 v[192:195], v19, s[20:23], s42 offen offset:0 sc1
ds_read_b64_tr_b16 a[144:145], v242 offset:12288
ds_read_b64_tr_b16 a[146:147], v242 offset:13312
v_mfma_f32_32x32x16_bf16 v[80:95], a[172:175], v[108:111], v[80:95]
s_waitcnt lgkmcnt(6)
ds_read_b64_tr_b16 a[148:149], v242 offset:12544
ds_read_b64_tr_b16 a[150:151], v242 offset:13568
v_mfma_f32_32x32x16_bf16 v[64:79], a[176:179], v[112:115], v[64:79]
ds_read_b64_tr_b16 a[152:153], v242 offset:14336
ds_read_b64_tr_b16 a[154:155], v242 offset:15360
v_mfma_f32_32x32x16_bf16 v[80:95], a[180:183], v[112:115], v[80:95]
s_waitcnt lgkmcnt(6)
ds_read_b64_tr_b16 a[156:157], v242 offset:14592
ds_read_b64_tr_b16 a[158:159], v242 offset:15616
v_mfma_f32_32x32x16_bf16 v[64:79], a[184:187], v[116:119], v[64:79]
ds_read_b64_tr_b16 a[160:161], v242 offset:16384
ds_read_b64_tr_b16 a[162:163], v242 offset:17408
v_mfma_f32_32x32x16_bf16 v[80:95], a[188:191], v[116:119], v[80:95]
s_waitcnt lgkmcnt(6)
ds_read_b64_tr_b16 a[164:165], v242 offset:16640
ds_read_b64_tr_b16 a[166:167], v242 offset:17664
s_waitcnt vmcnt(19)
s_barrier
v_mfma_f32_32x32x16_bf16 v[64:79], a[144:147], v[120:123], v[64:79]
buffer_load_dwordx4 v23, s[16:19], s41 offen offset:0 lds
ds_read_b64_tr_b16 a[168:169], v243 offset:12288
ds_read_b64_tr_b16 a[170:171], v243 offset:13312
v_mfma_f32_32x32x16_bf16 v[80:95], a[148:151], v[120:123], v[80:95]
s_waitcnt lgkmcnt(6)
ds_read_b64_tr_b16 a[172:173], v243 offset:12544
ds_read_b64_tr_b16 a[174:175], v243 offset:13568
v_cvt_pk_bf16_f32 v196, v216, v217
v_cvt_pk_bf16_f32 v197, v218, v219
v_cvt_pk_bf16_f32 v198, v220, v221
v_mfma_f32_32x32x16_bf16 v[64:79], a[152:155], v[124:127], v[64:79]
ds_read_b64_tr_b16 a[176:177], v243 offset:14336
ds_read_b64_tr_b16 a[178:179], v243 offset:15360
v_cvt_pk_bf16_f32 v199, v222, v223
v_mfma_f32_32x32x16_bf16 v[80:95], a[156:159], v[124:127], v[80:95]
s_waitcnt lgkmcnt(6)
buffer_store_dwordx4 v[196:199], v19, s[20:23], s42 offen offset:1024 sc1
ds_read_b64_tr_b16 a[180:181], v243 offset:14592
ds_read_b64_tr_b16 a[182:183], v243 offset:15616
v_mfma_f32_32x32x16_bf16 v[64:79], a[160:163], v[128:131], v[64:79]
ds_read_b64_tr_b16 a[184:185], v243 offset:16384
ds_read_b64_tr_b16 a[186:187], v243 offset:17408
v_mfma_f32_32x32x16_bf16 v[80:95], a[164:167], v[128:131], v[80:95]
s_waitcnt lgkmcnt(6)
ds_read_b64_tr_b16 a[188:189], v243 offset:16640
ds_read_b64_tr_b16 a[190:191], v243 offset:17664
v_mfma_f32_32x32x16_bf16 v[64:79], a[168:171], v[132:135], v[64:79]
buffer_load_dwordx4 v24, s[16:19], s41 offen offset:1024 lds
ds_read_b64_tr_b16 a[144:145], v240 offset:18432
ds_read_b64_tr_b16 a[146:147], v240 offset:19456
v_mfma_f32_32x32x16_bf16 v[80:95], a[172:175], v[132:135], v[80:95]
s_waitcnt lgkmcnt(6)
ds_read_b64_tr_b16 a[148:149], v240 offset:18688
ds_read_b64_tr_b16 a[150:151], v240 offset:19712
v_mfma_f32_32x32x16_bf16 v[64:79], a[176:179], v[136:139], v[64:79]
ds_read_b64_tr_b16 a[152:153], v240 offset:20480
ds_read_b64_tr_b16 a[154:155], v240 offset:21504
v_mfma_f32_32x32x16_bf16 v[80:95], a[180:183], v[136:139], v[80:95]
s_waitcnt lgkmcnt(6)
buffer_load_dwordx4 v25, s[16:19], s41 offen offset:2048 lds
ds_read_b64_tr_b16 a[156:157], v240 offset:20736
ds_read_b64_tr_b16 a[158:159], v240 offset:21760
v_mfma_f32_32x32x16_bf16 v[64:79], a[184:187], v[140:143], v[64:79]
s_add_u32 m0, s35, 9216
ds_read_b64_tr_b16 a[160:161], v240 offset:22528
ds_read_b64_tr_b16 a[162:163], v240 offset:23552
v_mfma_f32_32x32x16_bf16 v[80:95], a[188:191], v[140:143], v[80:95]
s_waitcnt lgkmcnt(6)
s_add_u32 s41, s39, 249216
ds_read_b64_tr_b16 a[164:165], v240 offset:22784
ds_read_b64_tr_b16 a[166:167], v240 offset:23808
v_cvt_pk_bf16_f32 v200, v224, v225
v_cvt_pk_bf16_f32 v201, v226, v227
v_cvt_pk_bf16_f32 v202, v228, v229
v_mfma_f32_32x32x16_bf16 v[64:79], a[144:147], v[144:147], v[64:79]
buffer_load_dwordx4 v23, s[16:19], s41 offen offset:0 lds
ds_read_b64_tr_b16 a[168:169], v241 offset:18432
ds_read_b64_tr_b16 a[170:171], v241 offset:19456
v_mfma_f32_32x32x16_bf16 v[80:95], a[148:151], v[144:147], v[80:95]
s_waitcnt lgkmcnt(6)
ds_read_b64_tr_b16 a[172:173], v241 offset:18688
ds_read_b64_tr_b16 a[174:175], v241 offset:19712
v_cvt_pk_bf16_f32 v203, v230, v231
v_mfma_f32_32x32x16_bf16 v[64:79], a[152:155], v[148:151], v[64:79]
ds_read_b64_tr_b16 a[176:177], v241 offset:20480
ds_read_b64_tr_b16 a[178:179], v241 offset:21504
v_mfma_f32_32x32x16_bf16 v[80:95], a[156:159], v[148:151], v[80:95]
s_waitcnt lgkmcnt(6)
buffer_store_dwordx4 v[200:203], v19, s[20:23], s42 offen offset:2048 sc1
ds_read_b64_tr_b16 a[180:181], v241 offset:20736
ds_read_b64_tr_b16 a[182:183], v241 offset:21760
v_mfma_f32_32x32x16_bf16 v[64:79], a[160:163], v[152:155], v[64:79]
ds_read_b64_tr_b16 a[184:185], v241 offset:22528
ds_read_b64_tr_b16 a[186:187], v241 offset:23552
v_mfma_f32_32x32x16_bf16 v[80:95], a[164:167], v[152:155], v[80:95]
s_waitcnt lgkmcnt(6)
ds_read_b64_tr_b16 a[188:189], v241 offset:22784
ds_read_b64_tr_b16 a[190:191], v241 offset:23808
v_mfma_f32_32x32x16_bf16 v[64:79], a[168:171], v[156:159], v[64:79]
buffer_load_dwordx4 v24, s[16:19], s41 offen offset:1024 lds
ds_read_b64_tr_b16 a[144:145], v242 offset:18432
ds_read_b64_tr_b16 a[146:147], v242 offset:19456
v_mfma_f32_32x32x16_bf16 v[80:95], a[172:175], v[156:159], v[80:95]
s_waitcnt lgkmcnt(6)
ds_read_b64_tr_b16 a[148:149], v242 offset:18688
ds_read_b64_tr_b16 a[150:151], v242 offset:19712
v_mfma_f32_32x32x16_bf16 v[64:79], a[176:179], v[160:163], v[64:79]
ds_read_b64_tr_b16 a[152:153], v242 offset:20480
ds_read_b64_tr_b16 a[154:155], v242 offset:21504
v_mfma_f32_32x32x16_bf16 v[80:95], a[180:183], v[160:163], v[80:95]
s_waitcnt lgkmcnt(6)
buffer_load_dwordx4 v25, s[16:19], s41 offen offset:2048 lds
ds_read_b64_tr_b16 a[156:157], v242 offset:20736
ds_read_b64_tr_b16 a[158:159], v242 offset:21760
v_mfma_f32_32x32x16_bf16 v[64:79], a[184:187], v[164:167], v[64:79]
s_add_u32 m0, s35, 12288
ds_read_b64_tr_b16 a[160:161], v242 offset:22528
ds_read_b64_tr_b16 a[162:163], v242 offset:23552
v_cvt_pk_bf16_f32 v204, v232, v233
v_cvt_pk_bf16_f32 v205, v234, v235
v_cvt_pk_bf16_f32 v206, v236, v237
v_mfma_f32_32x32x16_bf16 v[80:95], a[188:191], v[164:167], v[80:95]
s_waitcnt lgkmcnt(6)
s_add_u32 s41, s39, 512
ds_read_b64_tr_b16 a[164:165], v242 offset:22784
ds_read_b64_tr_b16 a[166:167], v242 offset:23808
v_cvt_pk_bf16_f32 v207, v238, v239
s_waitcnt vmcnt(21)
s_barrier
v_mfma_f32_32x32x16_bf16 v[64:79], a[144:147], v[168:171], v[64:79]
buffer_store_dwordx4 v[204:207], v19, s[20:23], s42 offen offset:3072 sc1
ds_read_b64_tr_b16 a[168:169], v243 offset:18432
ds_read_b64_tr_b16 a[170:171], v243 offset:19456
v_mfma_f32_32x32x16_bf16 v[80:95], a[148:151], v[168:171], v[80:95]
s_waitcnt lgkmcnt(6)
ds_read_b64_tr_b16 a[172:173], v243 offset:18688
ds_read_b64_tr_b16 a[174:175], v243 offset:19712
v_mfma_f32_32x32x16_bf16 v[64:79], a[152:155], v[172:175], v[64:79]
ds_read_b64_tr_b16 a[176:177], v243 offset:20480
ds_read_b64_tr_b16 a[178:179], v243 offset:21504
v_mfma_f32_32x32x16_bf16 v[80:95], a[156:159], v[172:175], v[80:95]
s_waitcnt lgkmcnt(6)
buffer_load_dwordx4 v23, s[16:19], s41 offen offset:0 lds
ds_read_b64_tr_b16 a[180:181], v243 offset:20736
ds_read_b64_tr_b16 a[182:183], v243 offset:21760
v_mfma_f32_32x32x16_bf16 v[64:79], a[160:163], v[176:179], v[64:79]
ds_read_b64_tr_b16 a[184:185], v243 offset:22528
ds_read_b64_tr_b16 a[186:187], v243 offset:23552
v_mfma_f32_32x32x16_bf16 v[80:95], a[164:167], v[176:179], v[80:95]
s_waitcnt lgkmcnt(6)
ds_read_b64_tr_b16 a[188:189], v243 offset:22784
ds_read_b64_tr_b16 a[190:191], v243 offset:23808
v_mfma_f32_32x32x16_bf16 v[64:79], a[168:171], v[180:183], v[64:79]
buffer_load_dwordx4 v24, s[16:19], s41 offen offset:1024 lds
ds_read_b64_tr_b16 a[144:145], v240 offset:24576
ds_read_b64_tr_b16 a[146:147], v240 offset:25600
v_mfma_f32_32x32x16_bf16 v[80:95], a[172:175], v[180:183], v[80:95]
s_waitcnt lgkmcnt(6)
ds_read_b64_tr_b16 a[148:149], v240 offset:24832
ds_read_b64_tr_b16 a[150:151], v240 offset:25856
v_mfma_f32_32x32x16_bf16 v[64:79], a[176:179], v[184:187], v[64:79]
ds_read_b64_tr_b16 a[152:153], v240 offset:26624
ds_read_b64_tr_b16 a[154:155], v240 offset:27648
v_mfma_f32_32x32x16_bf16 v[80:95], a[180:183], v[184:187], v[80:95]
s_waitcnt lgkmcnt(6)
buffer_load_dwordx4 v25, s[16:19], s41 offen offset:2048 lds
ds_read_b64_tr_b16 a[156:157], v240 offset:26880
ds_read_b64_tr_b16 a[158:159], v240 offset:27904
v_mfma_f32_32x32x16_bf16 v[64:79], a[184:187], v[188:191], v[64:79]
s_add_u32 m0, s35, 15360
ds_read_b64_tr_b16 a[160:161], v240 offset:28672
ds_read_b64_tr_b16 a[162:163], v240 offset:29696
v_mfma_f32_32x32x16_bf16 v[80:95], a[188:191], v[188:191], v[80:95]
s_waitcnt lgkmcnt(6)
s_add_u32 s41, s39, 28160
ds_read_b64_tr_b16 a[164:165], v240 offset:28928
ds_read_b64_tr_b16 a[166:167], v240 offset:29952
v_mfma_f32_32x32x16_bf16 v[208:223], a[144:147], v[96:99], 0
buffer_load_dwordx4 v23, s[16:19], s41 offen offset:0 lds
ds_read_b64_tr_b16 a[168:169], v241 offset:24576
ds_read_b64_tr_b16 a[170:171], v241 offset:25600
v_mfma_f32_32x32x16_bf16 v[224:239], a[148:151], v[96:99], 0
s_waitcnt lgkmcnt(6)
ds_read_b64_tr_b16 a[172:173], v241 offset:24832
ds_read_b64_tr_b16 a[174:175], v241 offset:25856
v_mfma_f32_32x32x16_bf16 v[208:223], a[152:155], v[100:103], v[208:223]
ds_read_b64_tr_b16 a[176:177], v241 offset:26624
ds_read_b64_tr_b16 a[178:179], v241 offset:27648
v_mfma_f32_32x32x16_bf16 v[224:239], a[156:159], v[100:103], v[224:239]
s_waitcnt lgkmcnt(6)
buffer_load_dwordx4 v24, s[16:19], s41 offen offset:1024 lds
ds_read_b64_tr_b16 a[180:181], v241 offset:26880
ds_read_b64_tr_b16 a[182:183], v241 offset:27904
v_mfma_f32_32x32x16_bf16 v[208:223], a[160:163], v[104:107], v[208:223]
ds_read_b64_tr_b16 a[184:185], v241 offset:28672
ds_read_b64_tr_b16 a[186:187], v241 offset:29696
v_cvt_pk_bf16_f32 v192, v64, v65
v_cvt_pk_bf16_f32 v193, v66, v67
v_cvt_pk_bf16_f32 v194, v68, v69
v_mfma_f32_32x32x16_bf16 v[224:239], a[164:167], v[104:107], v[224:239]
s_waitcnt lgkmcnt(6)
ds_read_b64_tr_b16 a[188:189], v241 offset:28928
ds_read_b64_tr_b16 a[190:191], v241 offset:29952
v_cvt_pk_bf16_f32 v195, v70, v71
v_mfma_f32_32x32x16_bf16 v[208:223], a[168:171], v[108:111], v[208:223]
s_add_u32 s42, s40, 4096
buffer_store_dwordx4 v[192:195], v19, s[20:23], s42 offen offset:0 sc1
ds_read_b64_tr_b16 a[144:145], v242 offset:24576
ds_read_b64_tr_b16 a[146:147], v242 offset:25600
v_mfma_f32_32x32x16_bf16 v[224:239], a[172:175], v[108:111], v[224:239]
s_waitcnt lgkmcnt(6)
L_pad_f3_1:
s_cbranch_execz L_warm_f
ds_read_b64_tr_b16 a[148:149], v242 offset:24832
ds_read_b64_tr_b16 a[150:151], v242 offset:25856
v_mfma_f32_32x32x16_bf16 v[208:223], a[176:179], v[112:115], v[208:223]
ds_read_b64_tr_b16 a[152:153], v242 offset:26624
ds_read_b64_tr_b16 a[154:155], v242 offset:27648
v_mfma_f32_32x32x16_bf16 v[224:239], a[180:183], v[112:115], v[224:239]
s_waitcnt lgkmcnt(6)
buffer_load_dwordx4 v25, s[16:19], s41 offen offset:2048 lds
ds_read_b64_tr_b16 a[156:157], v242 offset:26880
ds_read_b64_tr_b16 a[158:159], v242 offset:27904
v_mfma_f32_32x32x16_bf16 v[208:223], a[184:187], v[116:119], v[208:223]
s_add_u32 m0, s35, 18432
ds_read_b64_tr_b16 a[160:161], v242 offset:28672
ds_read_b64_tr_b16 a[162:163], v242 offset:29696
v_mfma_f32_32x32x16_bf16 v[224:239], a[188:191], v[116:119], v[224:239]
s_waitcnt lgkmcnt(6)
s_add_u32 s41, s39, 221696
ds_read_b64_tr_b16 a[164:165], v242 offset:28928
ds_read_b64_tr_b16 a[166:167], v242 offset:29952
s_waitcnt vmcnt(23)
s_barrier
v_mfma_f32_32x32x16_bf16 v[208:223], a[144:147], v[120:123], v[208:223]
buffer_load_dwordx4 v23, s[16:19], s41 offen offset:0 lds
ds_read_b64_tr_b16 a[168:169], v243 offset:24576
ds_read_b64_tr_b16 a[170:171], v243 offset:25600
v_mfma_f32_32x32x16_bf16 v[224:239], a[148:151], v[120:123], v[224:239]
s_waitcnt lgkmcnt(6)
ds_read_b64_tr_b16 a[172:173], v243 offset:24832
ds_read_b64_tr_b16 a[174:175], v243 offset:25856
v_cvt_pk_bf16_f32 v196, v72, v73
v_cvt_pk_bf16_f32 v197, v74, v75
v_cvt_pk_bf16_f32 v198, v76, v77
v_mfma_f32_32x32x16_bf16 v[208:223], a[152:155], v[124:127], v[208:223]
ds_read_b64_tr_b16 a[176:177], v243 offset:26624
ds_read_b64_tr_b16 a[178:179], v243 offset:27648
v_cvt_pk_bf16_f32 v199, v78, v79
v_mfma_f32_32x32x16_bf16 v[224:239], a[156:159], v[124:127], v[224:239]
s_waitcnt lgkmcnt(6)
buffer_store_dwordx4 v[196:199], v19, s[20:23], s42 offen offset:1024 sc1
ds_read_b64_tr_b16 a[180:181], v243 offset:26880
ds_read_b64_tr_b16 a[182:183], v243 offset:27904
v_mfma_f32_32x32x16_bf16 v[208:223], a[160:163], v[128:131], v[208:223]
ds_read_b64_tr_b16 a[184:185], v243 offset:28672
ds_read_b64_tr_b16 a[186:187], v243 offset:29696
v_mfma_f32_32x32x16_bf16 v[224:239], a[164:167], v[128:131], v[224:239]
s_waitcnt lgkmcnt(6)
ds_read_b64_tr_b16 a[188:189], v243 offset:28928
ds_read_b64_tr_b16 a[190:191], v243 offset:29952
v_mfma_f32_32x32x16_bf16 v[208:223], a[168:171], v[132:135], v[208:223]
buffer_load_dwordx4 v24, s[16:19], s41 offen offset:1024 lds
ds_read_b64_tr_b16 a[144:145], v240 offset:30720
ds_read_b64_tr_b16 a[146:147], v240 offset:31744
v_mfma_f32_32x32x16_bf16 v[224:239], a[172:175], v[132:135], v[224:239]
s_waitcnt lgkmcnt(6)
ds_read_b64_tr_b16 a[148:149], v240 offset:30976
ds_read_b64_tr_b16 a[150:151], v240 offset:32000
v_mfma_f32_32x32x16_bf16 v[208:223], a[176:179], v[136:139], v[208:223]
ds_read_b64_tr_b16 a[152:153], v240 offset:32768
ds_read_b64_tr_b16 a[154:155], v240 offset:33792
v_mfma_f32_32x32x16_bf16 v[224:239], a[180:183], v[136:139], v[224:239]
s_waitcnt lgkmcnt(6)
buffer_load_dwordx4 v25, s[16:19], s41 offen offset:2048 lds
ds_read_b64_tr_b16 a[156:157], v240 offset:33024
ds_read_b64_tr_b16 a[158:159], v240 offset:34048
v_mfma_f32_32x32x16_bf16 v[208:223], a[184:187], v[140:143], v[208:223]
s_add_u32 m0, s35, 21504
ds_read_b64_tr_b16 a[160:161], v240 offset:34816
ds_read_b64_tr_b16 a[162:163], v240 offset:35840
v_mfma_f32_32x32x16_bf16 v[224:239], a[188:191], v[140:143], v[224:239]
s_waitcnt lgkmcnt(6)
s_add_u32 s41, s39, 249344
ds_read_b64_tr_b16 a[164:165], v240 offset:35072
ds_read_b64_tr_b16 a[166:167], v240 offset:36096
v_cvt_pk_bf16_f32 v200, v80, v81
v_cvt_pk_bf16_f32 v201, v82, v83
v_cvt_pk_bf16_f32 v202, v84, v85
v_mfma_f32_32x32x16_bf16 v[208:223], a[144:147], v[144:147], v[208:223]
buffer_load_dwordx4 v23, s[16:19], s41 offen offset:0 lds
ds_read_b64_tr_b16 a[168:169], v241 offset:30720
ds_read_b64_tr_b16 a[170:171], v241 offset:31744
v_mfma_f32_32x32x16_bf16 v[224:239], a[148:151], v[144:147], v[224:239]
s_waitcnt lgkmcnt(6)
ds_read_b64_tr_b16 a[172:173], v241 offset:30976
ds_read_b64_tr_b16 a[174:175], v241 offset:32000
v_cvt_pk_bf16_f32 v203, v86, v87
v_mfma_f32_32x32x16_bf16 v[208:223], a[152:155], v[148:151], v[208:223]
ds_read_b64_tr_b16 a[176:177], v241 offset:32768
ds_read_b64_tr_b16 a[178:179], v241 offset:33792
v_mfma_f32_32x32x16_bf16 v[224:239], a[156:159], v[148:151], v[224:239]
s_waitcnt lgkmcnt(6)
buffer_store_dwordx4 v[200:203], v19, s[20:23], s42 offen offset:2048 sc1
ds_read_b64_tr_b16 a[180:181], v241 offset:33024
ds_read_b64_tr_b16 a[182:183], v241 offset:34048
v_mfma_f32_32x32x16_bf16 v[208:223], a[160:163], v[152:155], v[208:223]
ds_read_b64_tr_b16 a[184:185], v241 offset:34816
ds_read_b64_tr_b16 a[186:187], v241 offset:35840
v_mfma_f32_32x32x16_bf16 v[224:239], a[164:167], v[152:155], v[224:239]
s_waitcnt lgkmcnt(6)
ds_read_b64_tr_b16 a[188:189], v241 offset:35072
ds_read_b64_tr_b16 a[190:191], v241 offset:36096
v_mfma_f32_32x32x16_bf16 v[208:223], a[168:171], v[156:159], v[208:223]
buffer_load_dwordx4 v24, s[16:19], s41 offen offset:1024 lds
ds_read_b64_tr_b16 a[144:145], v242 offset:30720
ds_read_b64_tr_b16 a[146:147], v242 offset:31744
v_mfma_f32_32x32x16_bf16 v[224:239], a[172:175], v[156:159], v[224:239]
s_waitcnt lgkmcnt(6)
ds_read_b64_tr_b16 a[148:149], v242 offset:30976
ds_read_b64_tr_b16 a[150:151], v242 offset:32000
v_mfma_f32_32x32x16_bf16 v[208:223], a[176:179], v[160:163], v[208:223]
ds_read_b64_tr_b16 a[152:153], v242 offset:32768
ds_read_b64_tr_b16 a[154:155], v242 offset:33792
v_mfma_f32_32x32x16_bf16 v[224:239], a[180:183], v[160:163], v[224:239]
s_waitcnt lgkmcnt(6)
buffer_load_dwordx4 v25, s[16:19], s41 offen offset:2048 lds
ds_read_b64_tr_b16 a[156:157], v242 offset:33024
ds_read_b64_tr_b16 a[158:159], v242 offset:34048
v_mfma_f32_32x32x16_bf16 v[208:223], a[184:187], v[164:167], v[208:223]
s_add_u32 m0, s35, 24576
ds_read_b64_tr_b16 a[160:161], v242 offset:34816
ds_read_b64_tr_b16 a[162:163], v242 offset:35840
v_cvt_pk_bf16_f32 v204, v88, v89
v_cvt_pk_bf16_f32 v205, v90, v91
v_cvt_pk_bf16_f32 v206, v92, v93
v_mfma_f32_32x32x16_bf16 v[224:239], a[188:191], v[164:167], v[224:239]
s_waitcnt lgkmcnt(6)
s_add_u32 s41, s39, 640
ds_read_b64_tr_b16 a[164:165], v242 offset:35072
ds_read_b64_tr_b16 a[166:167], v242 offset:36096
v_cvt_pk_bf16_f32 v207, v94, v95
s_waitcnt vmcnt(25)
s_barrier
v_mfma_f32_32x32x16_bf16 v[208:223], a[144:147], v[168:171], v[208:223]
buffer_store_dwordx4 v[204:207], v19, s[20:23], s42 offen offset:3072 sc1
ds_read_b64_tr_b16 a[168:169], v243 offset:30720
ds_read_b64_tr_b16 a[170:171], v243 offset:31744
v_mfma_f32_32x32x16_bf16 v[224:239], a[148:151], v[168:171], v[224:239]
s_waitcnt lgkmcnt(6)
ds_read_b64_tr_b16 a[172:173], v243 offset:30976
ds_read_b64_tr_b16 a[174:175], v243 offset:32000
v_mfma_f32_32x32x16_bf16 v[208:223], a[152:155], v[172:175], v[208:223]
ds_read_b64_tr_b16 a[176:177], v243 offset:32768
ds_read_b64_tr_b16 a[178:179], v243 offset:33792
v_mfma_f32_32x32x16_bf16 v[224:239], a[156:159], v[172:175], v[224:239]
s_waitcnt lgkmcnt(6)
buffer_load_dwordx4 v23, s[16:19], s41 offen offset:0 lds
ds_read_b64_tr_b16 a[180:181], v243 offset:33024
ds_read_b64_tr_b16 a[182:183], v243 offset:34048
v_mfma_f32_32x32x16_bf16 v[208:223], a[160:163], v[176:179], v[208:223]
ds_read_b64_tr_b16 a[184:185], v243 offset:34816
ds_read_b64_tr_b16 a[186:187], v243 offset:35840
v_mfma_f32_32x32x16_bf16 v[224:239], a[164:167], v[176:179], v[224:239]
s_waitcnt lgkmcnt(6)
ds_read_b64_tr_b16 a[188:189], v243 offset:35072
ds_read_b64_tr_b16 a[190:191], v243 offset:36096
v_mfma_f32_32x32x16_bf16 v[208:223], a[168:171], v[180:183], v[208:223]
buffer_load_dwordx4 v24, s[16:19], s41 offen offset:1024 lds
ds_read_b64_tr_b16 a[144:145], v240 offset:0
ds_read_b64_tr_b16 a[146:147], v240 offset:1024
v_mfma_f32_32x32x16_bf16 v[224:239], a[172:175], v[180:183], v[224:239]
s_waitcnt lgkmcnt(6)
ds_read_b64_tr_b16 a[148:149], v240 offset:256
ds_read_b64_tr_b16 a[150:151], v240 offset:1280
v_mfma_f32_32x32x16_bf16 v[208:223], a[176:179], v[184:187], v[208:223]
ds_read_b64_tr_b16 a[152:153], v240 offset:2048
ds_read_b64_tr_b16 a[154:155], v240 offset:3072
v_mfma_f32_32x32x16_bf16 v[224:239], a[180:183], v[184:187], v[224:239]
s_waitcnt lgkmcnt(6)
buffer_load_dwordx4 v25, s[16:19], s41 offen offset:2048 lds
ds_read_b64_tr_b16 a[156:157], v240 offset:2304
ds_read_b64_tr_b16 a[158:159], v240 offset:3328
v_mfma_f32_32x32x16_bf16 v[208:223], a[184:187], v[188:191], v[208:223]
s_add_u32 m0, s35, 27648
ds_read_b64_tr_b16 a[160:161], v240 offset:4096
ds_read_b64_tr_b16 a[162:163], v240 offset:5120
v_mfma_f32_32x32x16_bf16 v[224:239], a[188:191], v[188:191], v[224:239]
s_waitcnt lgkmcnt(6)
s_add_u32 s41, s39, 28288
ds_read_b64_tr_b16 a[164:165], v240 offset:4352
ds_read_b64_tr_b16 a[166:167], v240 offset:5376
v_mfma_f32_32x32x16_bf16 v[64:79], a[144:147], v[96:99], 0
buffer_load_dwordx4 v23, s[16:19], s41 offen offset:0 lds
ds_read_b64_tr_b16 a[168:169], v241 offset:0
ds_read_b64_tr_b16 a[170:171], v241 offset:1024
v_mfma_f32_32x32x16_bf16 v[80:95], a[148:151], v[96:99], 0
s_waitcnt lgkmcnt(6)
ds_read_b64_tr_b16 a[172:173], v241 offset:256
ds_read_b64_tr_b16 a[174:175], v241 offset:1280
v_mfma_f32_32x32x16_bf16 v[64:79], a[152:155], v[100:103], v[64:79]
ds_read_b64_tr_b16 a[176:177], v241 offset:2048
ds_read_b64_tr_b16 a[178:179], v241 offset:3072
v_mfma_f32_32x32x16_bf16 v[80:95], a[156:159], v[100:103], v[80:95]
s_waitcnt lgkmcnt(6)
buffer_load_dwordx4 v24, s[16:19], s41 offen offset:1024 lds
ds_read_b64_tr_b16 a[180:181], v241 offset:2304
ds_read_b64_tr_b16 a[182:183], v241 offset:3328
v_mfma_f32_32x32x16_bf16 v[64:79], a[160:163], v[104:107], v[64:79]
ds_read_b64_tr_b16 a[184:185], v241 offset:4096
ds_read_b64_tr_b16 a[186:187], v241 offset:5120
v_cvt_pk_bf16_f32 v192, v208, v209
v_cvt_pk_bf16_f32 v193, v210, v211
v_cvt_pk_bf16_f32 v194, v212, v213
v_mfma_f32_32x32x16_bf16 v[80:95], a[164:167], v[104:107], v[80:95]
s_waitcnt lgkmcnt(6)
ds_read_b64_tr_b16 a[188:189], v241 offset:4352
ds_read_b64_tr_b16 a[190:191], v241 offset:5376
v_cvt_pk_bf16_f32 v195, v214, v215
v_mfma_f32_32x32x16_bf16 v[64:79], a[168:171], v[108:111], v[64:79]
s_add_u32 s42, s40, 8192
buffer_store_dwordx4 v[192:195], v19, s[20:23], s42 offen offset:0 sc1
ds_read_b64_tr_b16 a[144:145], v242 offset:0
ds_read_b64_tr_b16 a[146:147], v242 offset:1024
v_mfma_f32_32x32x16_bf16 v[80:95], a[172:175], v[108:111], v[80:95]
s_waitcnt lgkmcnt(6)
ds_read_b64_tr_b16 a[148:149], v242 offset:256
ds_read_b64_tr_b16 a[150:151], v242 offset:1280
v_mfma_f32_32x32x16_bf16 v[64:79], a[176:179], v[112:115], v[64:79]
ds_read_b64_tr_b16 a[152:153], v242 offset:2048
ds_read_b64_tr_b16 a[154:155], v242 offset:3072
v_mfma_f32_32x32x16_bf16 v[80:95], a[180:183], v[112:115], v[80:95]
s_waitcnt lgkmcnt(6)
buffer_load_dwordx4 v25, s[16:19], s41 offen offset:2048 lds
ds_read_b64_tr_b16 a[156:157], v242 offset:2304
ds_read_b64_tr_b16 a[158:159], v242 offset:3328
v_mfma_f32_32x32x16_bf16 v[64:79], a[184:187], v[116:119], v[64:79]
s_add_u32 m0, s35, 30720
ds_read_b64_tr_b16 a[160:161], v242 offset:4096
ds_read_b64_tr_b16 a[162:163], v242 offset:5120
v_mfma_f32_32x32x16_bf16 v[80:95], a[188:191], v[116:119], v[80:95]
s_waitcnt lgkmcnt(6)
s_add_u32 s41, s39, 221824
ds_read_b64_tr_b16 a[164:165], v242 offset:4352
ds_read_b64_tr_b16 a[166:167], v242 offset:5376
s_waitcnt vmcnt(24)
s_barrier
v_mfma_f32_32x32x16_bf16 v[64:79], a[144:147], v[120:123], v[64:79]
buffer_load_dwordx4 v23, s[16:19], s41 offen offset:0 lds
ds_read_b64_tr_b16 a[168:169], v243 offset:0
ds_read_b64_tr_b16 a[170:171], v243 offset:1024
v_mfma_f32_32x32x16_bf16 v[80:95], a[148:151], v[120:123], v[80:95]
s_waitcnt lgkmcnt(6)
ds_read_b64_tr_b16 a[172:173], v243 offset:256
ds_read_b64_tr_b16 a[174:175], v243 offset:1280
v_cvt_pk_bf16_f32 v196, v216, v217
v_cvt_pk_bf16_f32 v197, v218, v219
v_cvt_pk_bf16_f32 v198, v220, v221
v_mfma_f32_32x32x16_bf16 v[64:79], a[152:155], v[124:127], v[64:79]
ds_read_b64_tr_b16 a[176:177], v243 offset:2048
ds_read_b64_tr_b16 a[178:179], v243 offset:3072
v_cvt_pk_bf16_f32 v199, v222, v223
v_mfma_f32_32x32x16_bf16 v[80:95], a[156:159], v[124:127], v[80:95]
s_waitcnt lgkmcnt(6)
buffer_store_dwordx4 v[196:199], v19, s[20:23], s42 offen offset:1024 sc1
ds_read_b64_tr_b16 a[180:181], v243 offset:2304
ds_read_b64_tr_b16 a[182:183], v243 offset:3328
v_mfma_f32_32x32x16_bf16 v[64:79], a[160:163], v[128:131], v[64:79]
ds_read_b64_tr_b16 a[184:185], v243 offset:4096
ds_read_b64_tr_b16 a[186:187], v243 offset:5120
v_mfma_f32_32x32x16_bf16 v[80:95], a[164:167], v[128:131], v[80:95]
s_waitcnt lgkmcnt(6)
ds_read_b64_tr_b16 a[188:189], v243 offset:4352
ds_read_b64_tr_b16 a[190:191], v243 offset:5376
v_mfma_f32_32x32x16_bf16 v[64:79], a[168:171], v[132:135], v[64:79]
buffer_load_dwordx4 v24, s[16:19], s41 offen offset:1024 lds
ds_read_b64_tr_b16 a[144:145], v240 offset:6144
ds_read_b64_tr_b16 a[146:147], v240 offset:7168
v_mfma_f32_32x32x16_bf16 v[80:95], a[172:175], v[132:135], v[80:95]
s_waitcnt lgkmcnt(6)
ds_read_b64_tr_b16 a[148:149], v240 offset:6400
ds_read_b64_tr_b16 a[150:151], v240 offset:7424
v_mfma_f32_32x32x16_bf16 v[64:79], a[176:179], v[136:139], v[64:79]
ds_read_b64_tr_b16 a[152:153], v240 offset:8192
ds_read_b64_tr_b16 a[154:155], v240 offset:9216
v_mfma_f32_32x32x16_bf16 v[80:95], a[180:183], v[136:139], v[80:95]
s_waitcnt lgkmcnt(6)
buffer_load_dwordx4 v25, s[16:19], s41 offen offset:2048 lds
ds_read_b64_tr_b16 a[156:157], v240 offset:8448
ds_read_b64_tr_b16 a[158:159], v240 offset:9472
v_mfma_f32_32x32x16_bf16 v[64:79], a[184:187], v[140:143], v[64:79]
s_add_u32 m0, s35, 33792
ds_read_b64_tr_b16 a[160:161], v240 offset:10240
ds_read_b64_tr_b16 a[162:163], v240 offset:11264
v_mfma_f32_32x32x16_bf16 v[80:95], a[188:191], v[140:143], v[80:95]
s_waitcnt lgkmcnt(6)
s_add_u32 s41, s39, 249472
ds_read_b64_tr_b16 a[164:165], v240 offset:10496
ds_read_b64_tr_b16 a[166:167], v240 offset:11520
v_cvt_pk_bf16_f32 v200, v224, v225
v_cvt_pk_bf16_f32 v201, v226, v227
v_cvt_pk_bf16_f32 v202, v228, v229
v_mfma_f32_32x32x16_bf16 v[64:79], a[144:147], v[144:147], v[64:79]
buffer_load_dwordx4 v23, s[16:19], s41 offen offset:0 lds
ds_read_b64_tr_b16 a[168:169], v241 offset:6144
ds_read_b64_tr_b16 a[170:171], v241 offset:7168
v_mfma_f32_32x32x16_bf16 v[80:95], a[148:151], v[144:147], v[80:95]
s_waitcnt lgkmcnt(6)
ds_read_b64_tr_b16 a[172:173], v241 offset:6400
ds_read_b64_tr_b16 a[174:175], v241 offset:7424
v_cvt_pk_bf16_f32 v203, v230, v231
v_mfma_f32_32x32x16_bf16 v[64:79], a[152:155], v[148:151], v[64:79]
ds_read_b64_tr_b16 a[176:177], v241 offset:8192
ds_read_b64_tr_b16 a[178:179], v241 offset:9216
v_mfma_f32_32x32x16_bf16 v[80:95], a[156:159], v[148:151], v[80:95]
s_waitcnt lgkmcnt(6)
buffer_store_dwordx4 v[200:203], v19, s[20:23], s42 offen offset:2048 sc1
ds_read_b64_tr_b16 a[180:181], v241 offset:8448
ds_read_b64_tr_b16 a[182:183], v241 offset:9472
v_mfma_f32_32x32x16_bf16 v[64:79], a[160:163], v[152:155], v[64:79]
ds_read_b64_tr_b16 a[184:185], v241 offset:10240
ds_read_b64_tr_b16 a[186:187], v241 offset:11264
v_mfma_f32_32x32x16_bf16 v[80:95], a[164:167], v[152:155], v[80:95]
s_waitcnt lgkmcnt(6)
ds_read_b64_tr_b16 a[188:189], v241 offset:10496
ds_read_b64_tr_b16 a[190:191], v241 offset:11520
v_mfma_f32_32x32x16_bf16 v[64:79], a[168:171], v[156:159], v[64:79]
buffer_load_dwordx4 v24, s[16:19], s41 offen offset:1024 lds
ds_read_b64_tr_b16 a[144:145], v242 offset:6144
ds_read_b64_tr_b16 a[146:147], v242 offset:7168
v_mfma_f32_32x32x16_bf16 v[80:95], a[172:175], v[156:159], v[80:95]
s_waitcnt lgkmcnt(6)
ds_read_b64_tr_b16 a[148:149], v242 offset:6400
ds_read_b64_tr_b16 a[150:151], v242 offset:7424
v_mfma_f32_32x32x16_bf16 v[64:79], a[176:179], v[160:163], v[64:79]
ds_read_b64_tr_b16 a[152:153], v242 offset:8192
ds_read_b64_tr_b16 a[154:155], v242 offset:9216
v_mfma_f32_32x32x16_bf16 v[80:95], a[180:183], v[160:163], v[80:95]
s_waitcnt lgkmcnt(6)
buffer_load_dwordx4 v25, s[16:19], s41 offen offset:2048 lds
ds_read_b64_tr_b16 a[156:157], v242 offset:8448
ds_read_b64_tr_b16 a[158:159], v242 offset:9472
v_mfma_f32_32x32x16_bf16 v[64:79], a[184:187], v[164:167], v[64:79]
s_add_u32 m0, s35, 0
ds_read_b64_tr_b16 a[160:161], v242 offset:10240
ds_read_b64_tr_b16 a[162:163], v242 offset:11264
v_cvt_pk_bf16_f32 v204, v232, v233
v_cvt_pk_bf16_f32 v205, v234, v235
v_cvt_pk_bf16_f32 v206, v236, v237
v_mfma_f32_32x32x16_bf16 v[80:95], a[188:191], v[164:167], v[80:95]
s_waitcnt lgkmcnt(6)
s_add_u32 s41, s39, 768
ds_read_b64_tr_b16 a[164:165], v242 offset:10496
ds_read_b64_tr_b16 a[166:167], v242 offset:11520
v_cvt_pk_bf16_f32 v207, v238, v239
s_waitcnt vmcnt(24)
s_barrier
v_mfma_f32_32x32x16_bf16 v[64:79], a[144:147], v[168:171], v[64:79]
buffer_store_dwordx4 v[204:207], v19, s[20:23], s42 offen offset:3072 sc1
ds_read_b64_tr_b16 a[168:169], v243 offset:6144
ds_read_b64_tr_b16 a[170:171], v243 offset:7168
v_mfma_f32_32x32x16_bf16 v[80:95], a[148:151], v[168:171], v[80:95]
s_waitcnt lgkmcnt(6)
ds_read_b64_tr_b16 a[172:173], v243 offset:6400
ds_read_b64_tr_b16 a[174:175], v243 offset:7424
v_mfma_f32_32x32x16_bf16 v[64:79], a[152:155], v[172:175], v[64:79]
ds_read_b64_tr_b16 a[176:177], v243 offset:8192
ds_read_b64_tr_b16 a[178:179], v243 offset:9216
v_mfma_f32_32x32x16_bf16 v[80:95], a[156:159], v[172:175], v[80:95]
s_waitcnt lgkmcnt(6)
buffer_load_dwordx4 v23, s[16:19], s41 offen offset:0 lds
ds_read_b64_tr_b16 a[180:181], v243 offset:8448
ds_read_b64_tr_b16 a[182:183], v243 offset:9472
v_mfma_f32_32x32x16_bf16 v[64:79], a[160:163], v[176:179], v[64:79]
ds_read_b64_tr_b16 a[184:185], v243 offset:10240
ds_read_b64_tr_b16 a[186:187], v243 offset:11264
v_mfma_f32_32x32x16_bf16 v[80:95], a[164:167], v[176:179], v[80:95]
s_waitcnt lgkmcnt(6)
ds_read_b64_tr_b16 a[188:189], v243 offset:10496
ds_read_b64_tr_b16 a[190:191], v243 offset:11520
v_mfma_f32_32x32x16_bf16 v[64:79], a[168:171], v[180:183], v[64:79]
buffer_load_dwordx4 v24, s[16:19], s41 offen offset:1024 lds
ds_read_b64_tr_b16 a[144:145], v240 offset:12288
ds_read_b64_tr_b16 a[146:147], v240 offset:13312
v_mfma_f32_32x32x16_bf16 v[80:95], a[172:175], v[180:183], v[80:95]
s_waitcnt lgkmcnt(6)
ds_read_b64_tr_b16 a[148:149], v240 offset:12544
ds_read_b64_tr_b16 a[150:151], v240 offset:13568
v_mfma_f32_32x32x16_bf16 v[64:79], a[176:179], v[184:187], v[64:79]
ds_read_b64_tr_b16 a[152:153], v240 offset:14336
ds_read_b64_tr_b16 a[154:155], v240 offset:15360
v_mfma_f32_32x32x16_bf16 v[80:95], a[180:183], v[184:187], v[80:95]
s_waitcnt lgkmcnt(6)
buffer_load_dwordx4 v25, s[16:19], s41 offen offset:2048 lds
ds_read_b64_tr_b16 a[156:157], v240 offset:14592
ds_read_b64_tr_b16 a[158:159], v240 offset:15616
v_mfma_f32_32x32x16_bf16 v[64:79], a[184:187], v[188:191], v[64:79]
s_add_u32 m0, s35, 3072
ds_read_b64_tr_b16 a[160:161], v240 offset:16384
ds_read_b64_tr_b16 a[162:163], v240 offset:17408
v_mfma_f32_32x32x16_bf16 v[80:95], a[188:191], v[188:191], v[80:95]
s_waitcnt lgkmcnt(6)
s_add_u32 s41, s39, 28416
ds_read_b64_tr_b16 a[164:165], v240 offset:16640
ds_read_b64_tr_b16 a[166:167], v240 offset:17664
v_mfma_f32_32x32x16_bf16 v[208:223], a[144:147], v[96:99], 0
buffer_load_dwordx4 v23, s[16:19], s41 offen offset:0 lds
ds_read_b64_tr_b16 a[168:169], v241 offset:12288
ds_read_b64_tr_b16 a[170:171], v241 offset:13312
v_mfma_f32_32x32x16_bf16 v[224:239], a[148:151], v[96:99], 0
s_waitcnt lgkmcnt(6)
ds_read_b64_tr_b16 a[172:173], v241 offset:12544
ds_read_b64_tr_b16 a[174:175], v241 offset:13568
v_mfma_f32_32x32x16_bf16 v[208:223], a[152:155], v[100:103], v[208:223]
ds_read_b64_tr_b16 a[176:177], v241 offset:14336
ds_read_b64_tr_b16 a[178:179], v241 offset:15360
v_mfma_f32_32x32x16_bf16 v[224:239], a[156:159], v[100:103], v[224:239]
s_waitcnt lgkmcnt(6)
buffer_load_dwordx4 v24, s[16:19], s41 offen offset:1024 lds
ds_read_b64_tr_b16 a[180:181], v241 offset:14592
ds_read_b64_tr_b16 a[182:183], v241 offset:15616
v_mfma_f32_32x32x16_bf16 v[208:223], a[160:163], v[104:107], v[208:223]
ds_read_b64_tr_b16 a[184:185], v241 offset:16384
ds_read_b64_tr_b16 a[186:187], v241 offset:17408
v_cvt_pk_bf16_f32 v192, v64, v65
v_cvt_pk_bf16_f32 v193, v66, v67
v_cvt_pk_bf16_f32 v194, v68, v69
v_mfma_f32_32x32x16_bf16 v[224:239], a[164:167], v[104:107], v[224:239]
s_waitcnt lgkmcnt(6)
ds_read_b64_tr_b16 a[188:189], v241 offset:16640
ds_read_b64_tr_b16 a[190:191], v241 offset:17664
v_cvt_pk_bf16_f32 v195, v70, v71
v_mfma_f32_32x32x16_bf16 v[208:223], a[168:171], v[108:111], v[208:223]
s_add_u32 s42, s40, 12288
buffer_store_dwordx4 v[192:195], v19, s[20:23], s42 offen offset:0 sc1
ds_read_b64_tr_b16 a[144:145], v242 offset:12288
ds_read_b64_tr_b16 a[146:147], v242 offset:13312
v_mfma_f32_32x32x16_bf16 v[224:239], a[172:175], v[108:111], v[224:239]
s_waitcnt lgkmcnt(6)
ds_read_b64_tr_b16 a[148:149], v242 offset:12544
ds_read_b64_tr_b16 a[150:151], v242 offset:13568
v_mfma_f32_32x32x16_bf16 v[208:223], a[176:179], v[112:115], v[208:223]
ds_read_b64_tr_b16 a[152:153], v242 offset:14336
ds_read_b64_tr_b16 a[154:155], v242 offset:15360
v_mfma_f32_32x32x16_bf16 v[224:239], a[180:183], v[112:115], v[224:239]
s_waitcnt lgkmcnt(6)
buffer_load_dwordx4 v25, s[16:19], s41 offen offset:2048 lds
ds_read_b64_tr_b16 a[156:157], v242 offset:14592
ds_read_b64_tr_b16 a[158:159], v242 offset:15616
v_mfma_f32_32x32x16_bf16 v[208:223], a[184:187], v[116:119], v[208:223]
s_add_u32 m0, s35, 6144
ds_read_b64_tr_b16 a[160:161], v242 offset:16384
ds_read_b64_tr_b16 a[162:163], v242 offset:17408
v_mfma_f32_32x32x16_bf16 v[224:239], a[188:191], v[116:119], v[224:239]
s_waitcnt lgkmcnt(6)
s_add_u32 s41, s39, 221952
ds_read_b64_tr_b16 a[164:165], v242 offset:16640
ds_read_b64_tr_b16 a[166:167], v242 offset:17664
s_waitcnt vmcnt(24)
s_barrier
v_mfma_f32_32x32x16_bf16 v[208:223], a[144:147], v[120:123], v[208:223]
buffer_load_dwordx4 v23, s[16:19], s41 offen offset:0 lds
ds_read_b64_tr_b16 a[168:169], v243 offset:12288
ds_read_b64_tr_b16 a[170:171], v243 offset:13312
v_mfma_f32_32x32x16_bf16 v[224:239], a[148:151], v[120:123], v[224:239]
s_waitcnt lgkmcnt(6)
ds_read_b64_tr_b16 a[172:173], v243 offset:12544
ds_read_b64_tr_b16 a[174:175], v243 offset:13568
v_cvt_pk_bf16_f32 v196, v72, v73
v_cvt_pk_bf16_f32 v197, v74, v75
v_cvt_pk_bf16_f32 v198, v76, v77
v_mfma_f32_32x32x16_bf16 v[208:223], a[152:155], v[124:127], v[208:223]
ds_read_b64_tr_b16 a[176:177], v243 offset:14336
ds_read_b64_tr_b16 a[178:179], v243 offset:15360
v_cvt_pk_bf16_f32 v199, v78, v79
v_mfma_f32_32x32x16_bf16 v[224:239], a[156:159], v[124:127], v[224:239]
s_waitcnt lgkmcnt(6)
buffer_store_dwordx4 v[196:199], v19, s[20:23], s42 offen offset:1024 sc1
ds_read_b64_tr_b16 a[180:181], v243 offset:14592
ds_read_b64_tr_b16 a[182:183], v243 offset:15616
v_mfma_f32_32x32x16_bf16 v[208:223], a[160:163], v[128:131], v[208:223]
ds_read_b64_tr_b16 a[184:185], v243 offset:16384
ds_read_b64_tr_b16 a[186:187], v243 offset:17408
v_mfma_f32_32x32x16_bf16 v[224:239], a[164:167], v[128:131], v[224:239]
s_waitcnt lgkmcnt(6)
ds_read_b64_tr_b16 a[188:189], v243 offset:16640
ds_read_b64_tr_b16 a[190:191], v243 offset:17664
v_mfma_f32_32x32x16_bf16 v[208:223], a[168:171], v[132:135], v[208:223]
buffer_load_dwordx4 v24, s[16:19], s41 offen offset:1024 lds
ds_read_b64_tr_b16 a[144:145], v240 offset:18432
ds_read_b64_tr_b16 a[146:147], v240 offset:19456
v_mfma_f32_32x32x16_bf16 v[224:239], a[172:175], v[132:135], v[224:239]
s_waitcnt lgkmcnt(6)
ds_read_b64_tr_b16 a[148:149], v240 offset:18688
ds_read_b64_tr_b16 a[150:151], v240 offset:19712
v_mfma_f32_32x32x16_bf16 v[208:223], a[176:179], v[136:139], v[208:223]
ds_read_b64_tr_b16 a[152:153], v240 offset:20480
ds_read_b64_tr_b16 a[154:155], v240 offset:21504
v_mfma_f32_32x32x16_bf16 v[224:239], a[180:183], v[136:139], v[224:239]
s_waitcnt lgkmcnt(6)
buffer_load_dwordx4 v25, s[16:19], s41 offen offset:2048 lds
ds_read_b64_tr_b16 a[156:157], v240 offset:20736
ds_read_b64_tr_b16 a[158:159], v240 offset:21760
v_mfma_f32_32x32x16_bf16 v[208:223], a[184:187], v[140:143], v[208:223]
s_add_u32 m0, s35, 9216
ds_read_b64_tr_b16 a[160:161], v240 offset:22528
ds_read_b64_tr_b16 a[162:163], v240 offset:23552
v_mfma_f32_32x32x16_bf16 v[224:239], a[188:191], v[140:143], v[224:239]
s_waitcnt lgkmcnt(6)
s_add_u32 s41, s39, 249600
ds_read_b64_tr_b16 a[164:165], v240 offset:22784
ds_read_b64_tr_b16 a[166:167], v240 offset:23808
v_cvt_pk_bf16_f32 v200, v80, v81
v_cvt_pk_bf16_f32 v201, v82, v83
v_cvt_pk_bf16_f32 v202, v84, v85
v_mfma_f32_32x32x16_bf16 v[208:223], a[144:147], v[144:147], v[208:223]
buffer_load_dwordx4 v23, s[16:19], s41 offen offset:0 lds
ds_read_b64_tr_b16 a[168:169], v241 offset:18432
ds_read_b64_tr_b16 a[170:171], v241 offset:19456
v_mfma_f32_32x32x16_bf16 v[224:239], a[148:151], v[144:147], v[224:239]
s_waitcnt lgkmcnt(6)
ds_read_b64_tr_b16 a[172:173], v241 offset:18688
ds_read_b64_tr_b16 a[174:175], v241 offset:19712
v_cvt_pk_bf16_f32 v203, v86, v87
v_mfma_f32_32x32x16_bf16 v[208:223], a[152:155], v[148:151], v[208:223]
ds_read_b64_tr_b16 a[176:177], v241 offset:20480
ds_read_b64_tr_b16 a[178:179], v241 offset:21504
v_mfma_f32_32x32x16_bf16 v[224:239], a[156:159], v[148:151], v[224:239]
s_waitcnt lgkmcnt(6)
buffer_store_dwordx4 v[200:203], v19, s[20:23], s42 offen offset:2048 sc1
ds_read_b64_tr_b16 a[180:181], v241 offset:20736
ds_read_b64_tr_b16 a[182:183], v241 offset:21760
v_mfma_f32_32x32x16_bf16 v[208:223], a[160:163], v[152:155], v[208:223]
ds_read_b64_tr_b16 a[184:185], v241 offset:22528
ds_read_b64_tr_b16 a[186:187], v241 offset:23552
v_mfma_f32_32x32x16_bf16 v[224:239], a[164:167], v[152:155], v[224:239]
s_waitcnt lgkmcnt(6)
ds_read_b64_tr_b16 a[188:189], v241 offset:22784
ds_read_b64_tr_b16 a[190:191], v241 offset:23808
v_mfma_f32_32x32x16_bf16 v[208:223], a[168:171], v[156:159], v[208:223]
buffer_load_dwordx4 v24, s[16:19], s41 offen offset:1024 lds
ds_read_b64_tr_b16 a[144:145], v242 offset:18432
ds_read_b64_tr_b16 a[146:147], v242 offset:19456
v_mfma_f32_32x32x16_bf16 v[224:239], a[172:175], v[156:159], v[224:239]
s_waitcnt lgkmcnt(6)
ds_read_b64_tr_b16 a[148:149], v242 offset:18688
ds_read_b64_tr_b16 a[150:151], v242 offset:19712
v_mfma_f32_32x32x16_bf16 v[208:223], a[176:179], v[160:163], v[208:223]
ds_read_b64_tr_b16 a[152:153], v242 offset:20480
ds_read_b64_tr_b16 a[154:155], v242 offset:21504
v_mfma_f32_32x32x16_bf16 v[224:239], a[180:183], v[160:163], v[224:239]
s_waitcnt lgkmcnt(6)
buffer_load_dwordx4 v25, s[16:19], s41 offen offset:2048 lds
ds_read_b64_tr_b16 a[156:157], v242 offset:20736
ds_read_b64_tr_b16 a[158:159], v242 offset:21760
v_mfma_f32_32x32x16_bf16 v[208:223], a[184:187], v[164:167], v[208:223]
s_add_u32 m0, s35, 12288
ds_read_b64_tr_b16 a[160:161], v242 offset:22528
ds_read_b64_tr_b16 a[162:163], v242 offset:23552
v_cvt_pk_bf16_f32 v204, v88, v89
v_cvt_pk_bf16_f32 v205, v90, v91
L_pad_f0_2:
s_cbranch_execz L_warm_f
v_cvt_pk_bf16_f32 v206, v92, v93
v_mfma_f32_32x32x16_bf16 v[224:239], a[188:191], v[164:167], v[224:239]
s_waitcnt lgkmcnt(6)
s_add_u32 s41, s39, 896
ds_read_b64_tr_b16 a[164:165], v242 offset:22784
ds_read_b64_tr_b16 a[166:167], v242 offset:23808
v_cvt_pk_bf16_f32 v207, v94, v95
s_waitcnt vmcnt(15)
s_barrier
v_mov_b32 v9, 1
buffer_store_dword v9, v7, s[20:23], s5 offen sc1
v_mfma_f32_32x32x16_bf16 v[208:223], a[144:147], v[168:171], v[208:223]
buffer_store_dwordx4 v[204:207], v19, s[20:23], s42 offen offset:3072 sc1
ds_read_b64_tr_b16 a[168:169], v243 offset:18432
ds_read_b64_tr_b16 a[170:171], v243 offset:19456
v_mfma_f32_32x32x16_bf16 v[224:239], a[148:151], v[168:171], v[224:239]
s_waitcnt lgkmcnt(6)
ds_read_b64_tr_b16 a[172:173], v243 offset:18688
ds_read_b64_tr_b16 a[174:175], v243 offset:19712
v_mfma_f32_32x32x16_bf16 v[208:223], a[152:155], v[172:175], v[208:223]
ds_read_b64_tr_b16 a[176:177], v243 offset:20480
ds_read_b64_tr_b16 a[178:179], v243 offset:21504
v_mfma_f32_32x32x16_bf16 v[224:239], a[156:159], v[172:175], v[224:239]
s_waitcnt lgkmcnt(6)
buffer_load_dwordx4 v23, s[16:19], s41 offen offset:0 lds
ds_read_b64_tr_b16 a[180:181], v243 offset:20736
ds_read_b64_tr_b16 a[182:183], v243 offset:21760
v_mfma_f32_32x32x16_bf16 v[208:223], a[160:163], v[176:179], v[208:223]
ds_read_b64_tr_b16 a[184:185], v243 offset:22528
ds_read_b64_tr_b16 a[186:187], v243 offset:23552
v_mfma_f32_32x32x16_bf16 v[224:239], a[164:167], v[176:179], v[224:239]
s_waitcnt lgkmcnt(6)
ds_read_b64_tr_b16 a[188:189], v243 offset:22784
ds_read_b64_tr_b16 a[190:191], v243 offset:23808
v_mfma_f32_32x32x16_bf16 v[208:223], a[168:171], v[180:183], v[208:223]
buffer_load_dwordx4 v24, s[16:19], s41 offen offset:1024 lds
ds_read_b64_tr_b16 a[144:145], v240 offset:24576
ds_read_b64_tr_b16 a[146:147], v240 offset:25600
v_mfma_f32_32x32x16_bf16 v[224:239], a[172:175], v[180:183], v[224:239]
s_waitcnt lgkmcnt(6)
ds_read_b64_tr_b16 a[148:149], v240 offset:24832
ds_read_b64_tr_b16 a[150:151], v240 offset:25856
v_mfma_f32_32x32x16_bf16 v[208:223], a[176:179], v[184:187], v[208:223]
ds_read_b64_tr_b16 a[152:153], v240 offset:26624
ds_read_b64_tr_b16 a[154:155], v240 offset:27648
v_mfma_f32_32x32x16_bf16 v[224:239], a[180:183], v[184:187], v[224:239]
s_waitcnt lgkmcnt(6)
buffer_load_dwordx4 v25, s[16:19], s41 offen offset:2048 lds
ds_read_b64_tr_b16 a[156:157], v240 offset:26880
ds_read_b64_tr_b16 a[158:159], v240 offset:27904
v_mfma_f32_32x32x16_bf16 v[208:223], a[184:187], v[188:191], v[208:223]
s_add_u32 m0, s35, 15360
ds_read_b64_tr_b16 a[160:161], v240 offset:28672
ds_read_b64_tr_b16 a[162:163], v240 offset:29696
v_mfma_f32_32x32x16_bf16 v[224:239], a[188:191], v[188:191], v[224:239]
s_waitcnt lgkmcnt(6)
s_add_u32 s41, s39, 28544
ds_read_b64_tr_b16 a[164:165], v240 offset:28928
ds_read_b64_tr_b16 a[166:167], v240 offset:29952
v_mfma_f32_32x32x16_bf16 v[64:79], a[144:147], v[96:99], 0
buffer_load_dwordx4 v23, s[16:19], s41 offen offset:0 lds
ds_read_b64_tr_b16 a[168:169], v241 offset:24576
ds_read_b64_tr_b16 a[170:171], v241 offset:25600
v_mfma_f32_32x32x16_bf16 v[80:95], a[148:151], v[96:99], 0
s_waitcnt lgkmcnt(6)
ds_read_b64_tr_b16 a[172:173], v241 offset:24832
ds_read_b64_tr_b16 a[174:175], v241 offset:25856
v_mfma_f32_32x32x16_bf16 v[64:79], a[152:155], v[100:103], v[64:79]
ds_read_b64_tr_b16 a[176:177], v241 offset:26624
ds_read_b64_tr_b16 a[178:179], v241 offset:27648
v_mfma_f32_32x32x16_bf16 v[80:95], a[156:159], v[100:103], v[80:95]
s_waitcnt lgkmcnt(6)
buffer_load_dwordx4 v24, s[16:19], s41 offen offset:1024 lds
ds_read_b64_tr_b16 a[180:181], v241 offset:26880
ds_read_b64_tr_b16 a[182:183], v241 offset:27904
v_mfma_f32_32x32x16_bf16 v[64:79], a[160:163], v[104:107], v[64:79]
ds_read_b64_tr_b16 a[184:185], v241 offset:28672
ds_read_b64_tr_b16 a[186:187], v241 offset:29696
v_cvt_pk_bf16_f32 v192, v208, v209
v_cvt_pk_bf16_f32 v193, v210, v211
v_cvt_pk_bf16_f32 v194, v212, v213
v_mfma_f32_32x32x16_bf16 v[80:95], a[164:167], v[104:107], v[80:95]
s_waitcnt lgkmcnt(6)
ds_read_b64_tr_b16 a[188:189], v241 offset:28928
ds_read_b64_tr_b16 a[190:191], v241 offset:29952
v_cvt_pk_bf16_f32 v195, v214, v215
v_mfma_f32_32x32x16_bf16 v[64:79], a[168:171], v[108:111], v[64:79]
s_add_u32 s42, s40, 16384
buffer_store_dwordx4 v[192:195], v19, s[20:23], s42 offen offset:0 sc1
ds_read_b64_tr_b16 a[144:145], v242 offset:24576
ds_read_b64_tr_b16 a[146:147], v242 offset:25600
v_mfma_f32_32x32x16_bf16 v[80:95], a[172:175], v[108:111], v[80:95]
s_waitcnt lgkmcnt(6)
ds_read_b64_tr_b16 a[148:149], v242 offset:24832
ds_read_b64_tr_b16 a[150:151], v242 offset:25856
v_mfma_f32_32x32x16_bf16 v[64:79], a[176:179], v[112:115], v[64:79]
ds_read_b64_tr_b16 a[152:153], v242 offset:26624
ds_read_b64_tr_b16 a[154:155], v242 offset:27648
v_mfma_f32_32x32x16_bf16 v[80:95], a[180:183], v[112:115], v[80:95]
s_waitcnt lgkmcnt(6)
buffer_load_dwordx4 v25, s[16:19], s41 offen offset:2048 lds
ds_read_b64_tr_b16 a[156:157], v242 offset:26880
ds_read_b64_tr_b16 a[158:159], v242 offset:27904
v_mfma_f32_32x32x16_bf16 v[64:79], a[184:187], v[116:119], v[64:79]
s_add_u32 m0, s35, 18432
ds_read_b64_tr_b16 a[160:161], v242 offset:28672
ds_read_b64_tr_b16 a[162:163], v242 offset:29696
v_mfma_f32_32x32x16_bf16 v[80:95], a[188:191], v[116:119], v[80:95]
s_waitcnt lgkmcnt(6)
s_add_u32 s41, s39, 222080
ds_read_b64_tr_b16 a[164:165], v242 offset:28928
ds_read_b64_tr_b16 a[166:167], v242 offset:29952
s_barrier
v_mfma_f32_32x32x16_bf16 v[64:79], a[144:147], v[120:123], v[64:79]
buffer_load_dwordx4 v23, s[16:19], s41 offen offset:0 lds
ds_read_b64_tr_b16 a[168:169], v243 offset:24576
ds_read_b64_tr_b16 a[170:171], v243 offset:25600
v_mfma_f32_32x32x16_bf16 v[80:95], a[148:151], v[120:123], v[80:95]
s_waitcnt lgkmcnt(6)
ds_read_b64_tr_b16 a[172:173], v243 offset:24832
ds_read_b64_tr_b16 a[174:175], v243 offset:25856
v_cvt_pk_bf16_f32 v196, v216, v217
v_cvt_pk_bf16_f32 v197, v218, v219
v_cvt_pk_bf16_f32 v198, v220, v221
v_mfma_f32_32x32x16_bf16 v[64:79], a[152:155], v[124:127], v[64:79]
ds_read_b64_tr_b16 a[176:177], v243 offset:26624
ds_read_b64_tr_b16 a[178:179], v243 offset:27648
v_cvt_pk_bf16_f32 v199, v222, v223
v_mfma_f32_32x32x16_bf16 v[80:95], a[156:159], v[124:127], v[80:95]
s_waitcnt lgkmcnt(6)
buffer_store_dwordx4 v[196:199], v19, s[20:23], s42 offen offset:1024 sc1
ds_read_b64_tr_b16 a[180:181], v243 offset:26880
ds_read_b64_tr_b16 a[182:183], v243 offset:27904
v_mfma_f32_32x32x16_bf16 v[64:79], a[160:163], v[128:131], v[64:79]
ds_read_b64_tr_b16 a[184:185], v243 offset:28672
ds_read_b64_tr_b16 a[186:187], v243 offset:29696
v_mfma_f32_32x32x16_bf16 v[80:95], a[164:167], v[128:131], v[80:95]
s_waitcnt lgkmcnt(6)
ds_read_b64_tr_b16 a[188:189], v243 offset:28928
ds_read_b64_tr_b16 a[190:191], v243 offset:29952
v_mfma_f32_32x32x16_bf16 v[64:79], a[168:171], v[132:135], v[64:79]
buffer_load_dwordx4 v24, s[16:19], s41 offen offset:1024 lds
ds_read_b64_tr_b16 a[144:145], v240 offset:30720
ds_read_b64_tr_b16 a[146:147], v240 offset:31744
v_mfma_f32_32x32x16_bf16 v[80:95], a[172:175], v[132:135], v[80:95]
s_waitcnt lgkmcnt(6)
ds_read_b64_tr_b16 a[148:149], v240 offset:30976
ds_read_b64_tr_b16 a[150:151], v240 offset:32000
v_mfma_f32_32x32x16_bf16 v[64:79], a[176:179], v[136:139], v[64:79]
ds_read_b64_tr_b16 a[152:153], v240 offset:32768
ds_read_b64_tr_b16 a[154:155], v240 offset:33792
v_mfma_f32_32x32x16_bf16 v[80:95], a[180:183], v[136:139], v[80:95]
s_waitcnt lgkmcnt(6)
buffer_load_dwordx4 v25, s[16:19], s41 offen offset:2048 lds
ds_read_b64_tr_b16 a[156:157], v240 offset:33024
ds_read_b64_tr_b16 a[158:159], v240 offset:34048
v_mfma_f32_32x32x16_bf16 v[64:79], a[184:187], v[140:143], v[64:79]
s_add_u32 m0, s35, 21504
ds_read_b64_tr_b16 a[160:161], v240 offset:34816
ds_read_b64_tr_b16 a[162:163], v240 offset:35840
v_mfma_f32_32x32x16_bf16 v[80:95], a[188:191], v[140:143], v[80:95]
s_waitcnt lgkmcnt(6)
s_add_u32 s41, s39, 249728
ds_read_b64_tr_b16 a[164:165], v240 offset:35072
ds_read_b64_tr_b16 a[166:167], v240 offset:36096
v_cvt_pk_bf16_f32 v200, v224, v225
v_cvt_pk_bf16_f32 v201, v226, v227
v_cvt_pk_bf16_f32 v202, v228, v229
v_mfma_f32_32x32x16_bf16 v[64:79], a[144:147], v[144:147], v[64:79]
buffer_load_dwordx4 v23, s[16:19], s41 offen offset:0 lds
ds_read_b64_tr_b16 a[168:169], v241 offset:30720
ds_read_b64_tr_b16 a[170:171], v241 offset:31744
v_mfma_f32_32x32x16_bf16 v[80:95], a[148:151], v[144:147], v[80:95]
s_waitcnt lgkmcnt(6)
ds_read_b64_tr_b16 a[172:173], v241 offset:30976
ds_read_b64_tr_b16 a[174:175], v241 offset:32000
v_cvt_pk_bf16_f32 v203, v230, v231
v_mfma_f32_32x32x16_bf16 v[64:79], a[152:155], v[148:151], v[64:79]
ds_read_b64_tr_b16 a[176:177], v241 offset:32768
ds_read_b64_tr_b16 a[178:179], v241 offset:33792
v_mfma_f32_32x32x16_bf16 v[80:95], a[156:159], v[148:151], v[80:95]
s_waitcnt lgkmcnt(6)
buffer_store_dwordx4 v[200:203], v19, s[20:23], s42 offen offset:2048 sc1
ds_read_b64_tr_b16 a[180:181], v241 offset:33024
ds_read_b64_tr_b16 a[182:183], v241 offset:34048
v_mfma_f32_32x32x16_bf16 v[64:79], a[160:163], v[152:155], v[64:79]
ds_read_b64_tr_b16 a[184:185], v241 offset:34816
ds_read_b64_tr_b16 a[186:187], v241 offset:35840
v_mfma_f32_32x32x16_bf16 v[80:95], a[164:167], v[152:155], v[80:95]
s_waitcnt lgkmcnt(6)
ds_read_b64_tr_b16 a[188:189], v241 offset:35072
ds_read_b64_tr_b16 a[190:191], v241 offset:36096
v_mfma_f32_32x32x16_bf16 v[64:79], a[168:171], v[156:159], v[64:79]
buffer_load_dwordx4 v24, s[16:19], s41 offen offset:1024 lds
ds_read_b64_tr_b16 a[144:145], v242 offset:30720
ds_read_b64_tr_b16 a[146:147], v242 offset:31744
v_mfma_f32_32x32x16_bf16 v[80:95], a[172:175], v[156:159], v[80:95]
s_waitcnt lgkmcnt(6)
ds_read_b64_tr_b16 a[148:149], v242 offset:30976
ds_read_b64_tr_b16 a[150:151], v242 offset:32000
v_mfma_f32_32x32x16_bf16 v[64:79], a[176:179], v[160:163], v[64:79]
ds_read_b64_tr_b16 a[152:153], v242 offset:32768
ds_read_b64_tr_b16 a[154:155], v242 offset:33792
v_mfma_f32_32x32x16_bf16 v[80:95], a[180:183], v[160:163], v[80:95]
s_waitcnt lgkmcnt(6)
buffer_load_dwordx4 v25, s[16:19], s41 offen offset:2048 lds
ds_read_b64_tr_b16 a[156:157], v242 offset:33024
ds_read_b64_tr_b16 a[158:159], v242 offset:34048
v_mfma_f32_32x32x16_bf16 v[64:79], a[184:187], v[164:167], v[64:79]
s_add_u32 m0, s35, 24576
ds_read_b64_tr_b16 a[160:161], v242 offset:34816
ds_read_b64_tr_b16 a[162:163], v242 offset:35840
v_cvt_pk_bf16_f32 v204, v232, v233
v_cvt_pk_bf16_f32 v205, v234, v235
v_cvt_pk_bf16_f32 v206, v236, v237
v_mfma_f32_32x32x16_bf16 v[80:95], a[188:191], v[164:167], v[80:95]
s_waitcnt lgkmcnt(6)
s_add_u32 s41, s39, 1024
ds_read_b64_tr_b16 a[164:165], v242 offset:35072
ds_read_b64_tr_b16 a[166:167], v242 offset:36096
v_cvt_pk_bf16_f32 v207, v238, v239
s_waitcnt vmcnt(25)
s_barrier
v_mfma_f32_32x32x16_bf16 v[64:79], a[144:147], v[168:171], v[64:79]
buffer_store_dwordx4 v[204:207], v19, s[20:23], s42 offen offset:3072 sc1
ds_read_b64_tr_b16 a[168:169], v243 offset:30720
ds_read_b64_tr_b16 a[170:171], v243 offset:31744
v_mfma_f32_32x32x16_bf16 v[80:95], a[148:151], v[168:171], v[80:95]
s_waitcnt lgkmcnt(6)
ds_read_b64_tr_b16 a[172:173], v243 offset:30976
ds_read_b64_tr_b16 a[174:175], v243 offset:32000
v_mfma_f32_32x32x16_bf16 v[64:79], a[152:155], v[172:175], v[64:79]
ds_read_b64_tr_b16 a[176:177], v243 offset:32768
ds_read_b64_tr_b16 a[178:179], v243 offset:33792
v_mfma_f32_32x32x16_bf16 v[80:95], a[156:159], v[172:175], v[80:95]
s_waitcnt lgkmcnt(6)
buffer_load_dwordx4 v23, s[16:19], s41 offen offset:0 lds
ds_read_b64_tr_b16 a[180:181], v243 offset:33024
ds_read_b64_tr_b16 a[182:183], v243 offset:34048
v_mfma_f32_32x32x16_bf16 v[64:79], a[160:163], v[176:179], v[64:79]
ds_read_b64_tr_b16 a[184:185], v243 offset:34816
ds_read_b64_tr_b16 a[186:187], v243 offset:35840
v_mfma_f32_32x32x16_bf16 v[80:95], a[164:167], v[176:179], v[80:95]
s_waitcnt lgkmcnt(6)
ds_read_b64_tr_b16 a[188:189], v243 offset:35072
ds_read_b64_tr_b16 a[190:191], v243 offset:36096
v_mfma_f32_32x32x16_bf16 v[64:79], a[168:171], v[180:183], v[64:79]
buffer_load_dwordx4 v24, s[16:19], s41 offen offset:1024 lds
ds_read_b64_tr_b16 a[144:145], v240 offset:0
ds_read_b64_tr_b16 a[146:147], v240 offset:1024
v_mfma_f32_32x32x16_bf16 v[80:95], a[172:175], v[180:183], v[80:95]
s_waitcnt lgkmcnt(6)
ds_read_b64_tr_b16 a[148:149], v240 offset:256
ds_read_b64_tr_b16 a[150:151], v240 offset:1280
v_mfma_f32_32x32x16_bf16 v[64:79], a[176:179], v[184:187], v[64:79]
ds_read_b64_tr_b16 a[152:153], v240 offset:2048
ds_read_b64_tr_b16 a[154:155], v240 offset:3072
v_mfma_f32_32x32x16_bf16 v[80:95], a[180:183], v[184:187], v[80:95]
s_waitcnt lgkmcnt(6)
buffer_load_dwordx4 v25, s[16:19], s41 offen offset:2048 lds
ds_read_b64_tr_b16 a[156:157], v240 offset:2304
ds_read_b64_tr_b16 a[158:159], v240 offset:3328
v_mfma_f32_32x32x16_bf16 v[64:79], a[184:187], v[188:191], v[64:79]
s_add_u32 m0, s35, 27648
ds_read_b64_tr_b16 a[160:161], v240 offset:4096
ds_read_b64_tr_b16 a[162:163], v240 offset:5120
v_mfma_f32_32x32x16_bf16 v[80:95], a[188:191], v[188:191], v[80:95]
s_waitcnt lgkmcnt(6)
s_add_u32 s41, s39, 28672
ds_read_b64_tr_b16 a[164:165], v240 offset:4352
ds_read_b64_tr_b16 a[166:167], v240 offset:5376
v_mfma_f32_32x32x16_bf16 v[208:223], a[144:147], v[96:99], 0
buffer_load_dwordx4 v23, s[16:19], s41 offen offset:0 lds
ds_read_b64_tr_b16 a[168:169], v241 offset:0
ds_read_b64_tr_b16 a[170:171], v241 offset:1024
v_mfma_f32_32x32x16_bf16 v[224:239], a[148:151], v[96:99], 0
s_waitcnt lgkmcnt(6)
ds_read_b64_tr_b16 a[172:173], v241 offset:256
ds_read_b64_tr_b16 a[174:175], v241 offset:1280
v_mfma_f32_32x32x16_bf16 v[208:223], a[152:155], v[100:103], v[208:223]
ds_read_b64_tr_b16 a[176:177], v241 offset:2048
ds_read_b64_tr_b16 a[178:179], v241 offset:3072
v_mfma_f32_32x32x16_bf16 v[224:239], a[156:159], v[100:103], v[224:239]
s_waitcnt lgkmcnt(6)
buffer_load_dwordx4 v24, s[16:19], s41 offen offset:1024 lds
ds_read_b64_tr_b16 a[180:181], v241 offset:2304
ds_read_b64_tr_b16 a[182:183], v241 offset:3328
v_mfma_f32_32x32x16_bf16 v[208:223], a[160:163], v[104:107], v[208:223]
ds_read_b64_tr_b16 a[184:185], v241 offset:4096
ds_read_b64_tr_b16 a[186:187], v241 offset:5120
v_cvt_pk_bf16_f32 v192, v64, v65
v_cvt_pk_bf16_f32 v193, v66, v67
v_cvt_pk_bf16_f32 v194, v68, v69
v_mfma_f32_32x32x16_bf16 v[224:239], a[164:167], v[104:107], v[224:239]
s_waitcnt lgkmcnt(6)
ds_read_b64_tr_b16 a[188:189], v241 offset:4352
ds_read_b64_tr_b16 a[190:191], v241 offset:5376
v_cvt_pk_bf16_f32 v195, v70, v71
v_mfma_f32_32x32x16_bf16 v[208:223], a[168:171], v[108:111], v[208:223]
s_add_u32 s42, s40, 20480
buffer_store_dwordx4 v[192:195], v19, s[20:23], s42 offen offset:0 sc1
ds_read_b64_tr_b16 a[144:145], v242 offset:0
ds_read_b64_tr_b16 a[146:147], v242 offset:1024
v_mfma_f32_32x32x16_bf16 v[224:239], a[172:175], v[108:111], v[224:239]
s_waitcnt lgkmcnt(6)
ds_read_b64_tr_b16 a[148:149], v242 offset:256
ds_read_b64_tr_b16 a[150:151], v242 offset:1280
v_mfma_f32_32x32x16_bf16 v[208:223], a[176:179], v[112:115], v[208:223]
ds_read_b64_tr_b16 a[152:153], v242 offset:2048
ds_read_b64_tr_b16 a[154:155], v242 offset:3072
v_mfma_f32_32x32x16_bf16 v[224:239], a[180:183], v[112:115], v[224:239]
s_waitcnt lgkmcnt(6)
buffer_load_dwordx4 v25, s[16:19], s41 offen offset:2048 lds
ds_read_b64_tr_b16 a[156:157], v242 offset:2304
ds_read_b64_tr_b16 a[158:159], v242 offset:3328
v_mfma_f32_32x32x16_bf16 v[208:223], a[184:187], v[116:119], v[208:223]
s_add_u32 m0, s35, 30720
ds_read_b64_tr_b16 a[160:161], v242 offset:4096
ds_read_b64_tr_b16 a[162:163], v242 offset:5120
v_mfma_f32_32x32x16_bf16 v[224:239], a[188:191], v[116:119], v[224:239]
s_waitcnt lgkmcnt(6)
s_add_u32 s41, s39, 222208
ds_read_b64_tr_b16 a[164:165], v242 offset:4352
ds_read_b64_tr_b16 a[166:167], v242 offset:5376
s_waitcnt vmcnt(25)
s_barrier
v_mfma_f32_32x32x16_bf16 v[208:223], a[144:147], v[120:123], v[208:223]
buffer_load_dwordx4 v23, s[16:19], s41 offen offset:0 lds
ds_read_b64_tr_b16 a[168:169], v243 offset:0
ds_read_b64_tr_b16 a[170:171], v243 offset:1024
v_mfma_f32_32x32x16_bf16 v[224:239], a[148:151], v[120:123], v[224:239]
s_waitcnt lgkmcnt(6)
ds_read_b64_tr_b16 a[172:173], v243 offset:256
ds_read_b64_tr_b16 a[174:175], v243 offset:1280
v_cvt_pk_bf16_f32 v196, v72, v73
v_cvt_pk_bf16_f32 v197, v74, v75
v_cvt_pk_bf16_f32 v198, v76, v77
v_mfma_f32_32x32x16_bf16 v[208:223], a[152:155], v[124:127], v[208:223]
ds_read_b64_tr_b16 a[176:177], v243 offset:2048
ds_read_b64_tr_b16 a[178:179], v243 offset:3072
v_cvt_pk_bf16_f32 v199, v78, v79
v_mfma_f32_32x32x16_bf16 v[224:239], a[156:159], v[124:127], v[224:239]
s_waitcnt lgkmcnt(6)
buffer_store_dwordx4 v[196:199], v19, s[20:23], s42 offen offset:1024 sc1
ds_read_b64_tr_b16 a[180:181], v243 offset:2304
ds_read_b64_tr_b16 a[182:183], v243 offset:3328
v_mfma_f32_32x32x16_bf16 v[208:223], a[160:163], v[128:131], v[208:223]
ds_read_b64_tr_b16 a[184:185], v243 offset:4096
ds_read_b64_tr_b16 a[186:187], v243 offset:5120
v_mfma_f32_32x32x16_bf16 v[224:239], a[164:167], v[128:131], v[224:239]
s_waitcnt lgkmcnt(6)
ds_read_b64_tr_b16 a[188:189], v243 offset:4352
ds_read_b64_tr_b16 a[190:191], v243 offset:5376
v_mfma_f32_32x32x16_bf16 v[208:223], a[168:171], v[132:135], v[208:223]
buffer_load_dwordx4 v24, s[16:19], s41 offen offset:1024 lds
ds_read_b64_tr_b16 a[144:145], v240 offset:6144
ds_read_b64_tr_b16 a[146:147], v240 offset:7168
v_mfma_f32_32x32x16_bf16 v[224:239], a[172:175], v[132:135], v[224:239]
s_waitcnt lgkmcnt(6)
ds_read_b64_tr_b16 a[148:149], v240 offset:6400
ds_read_b64_tr_b16 a[150:151], v240 offset:7424
v_mfma_f32_32x32x16_bf16 v[208:223], a[176:179], v[136:139], v[208:223]
ds_read_b64_tr_b16 a[152:153], v240 offset:8192
ds_read_b64_tr_b16 a[154:155], v240 offset:9216
v_mfma_f32_32x32x16_bf16 v[224:239], a[180:183], v[136:139], v[224:239]
s_waitcnt lgkmcnt(6)
buffer_load_dword v8, v10, s[20:23], s4 offen sc1
ds_read_b64_tr_b16 a[156:157], v240 offset:8448
ds_read_b64_tr_b16 a[158:159], v240 offset:9472
v_mfma_f32_32x32x16_bf16 v[208:223], a[184:187], v[140:143], v[208:223]
ds_read_b64_tr_b16 a[160:161], v240 offset:10240
ds_read_b64_tr_b16 a[162:163], v240 offset:11264
v_mfma_f32_32x32x16_bf16 v[224:239], a[188:191], v[140:143], v[224:239]
s_waitcnt lgkmcnt(6)
ds_read_b64_tr_b16 a[164:165], v240 offset:10496
ds_read_b64_tr_b16 a[166:167], v240 offset:11520
v_cvt_pk_bf16_f32 v200, v80, v81
v_cvt_pk_bf16_f32 v201, v82, v83
v_cvt_pk_bf16_f32 v202, v84, v85
v_mfma_f32_32x32x16_bf16 v[208:223], a[144:147], v[144:147], v[208:223]
buffer_load_dwordx4 v25, s[16:19], s41 offen offset:2048 lds
ds_read_b64_tr_b16 a[168:169], v241 offset:6144
ds_read_b64_tr_b16 a[170:171], v241 offset:7168
v_mfma_f32_32x32x16_bf16 v[224:239], a[148:151], v[144:147], v[224:239]
s_waitcnt lgkmcnt(6)
s_add_u32 m0, s35, 33792
ds_read_b64_tr_b16 a[172:173], v241 offset:6400
ds_read_b64_tr_b16 a[174:175], v241 offset:7424
v_cvt_pk_bf16_f32 v203, v86, v87
v_mfma_f32_32x32x16_bf16 v[208:223], a[152:155], v[148:151], v[208:223]
ds_read_b64_tr_b16 a[176:177], v241 offset:8192
ds_read_b64_tr_b16 a[178:179], v241 offset:9216
v_mfma_f32_32x32x16_bf16 v[224:239], a[156:159], v[148:151], v[224:239]
s_waitcnt lgkmcnt(6)
buffer_store_dwordx4 v[200:203], v19, s[20:23], s42 offen offset:2048 sc1
ds_read_b64_tr_b16 a[180:181], v241 offset:8448
ds_read_b64_tr_b16 a[182:183], v241 offset:9472
v_mfma_f32_32x32x16_bf16 v[208:223], a[160:163], v[152:155], v[208:223]
s_add_u32 s41, s39, 249856
ds_read_b64_tr_b16 a[184:185], v241 offset:10240
ds_read_b64_tr_b16 a[186:187], v241 offset:11264
v_mfma_f32_32x32x16_bf16 v[224:239], a[164:167], v[152:155], v[224:239]
s_waitcnt lgkmcnt(6)
ds_read_b64_tr_b16 a[188:189], v241 offset:10496
ds_read_b64_tr_b16 a[190:191], v241 offset:11520
v_mfma_f32_32x32x16_bf16 v[208:223], a[168:171], v[156:159], v[208:223]
buffer_load_dwordx4 v23, s[16:19], s41 offen offset:0 lds
ds_read_b64_tr_b16 a[144:145], v242 offset:6144
ds_read_b64_tr_b16 a[146:147], v242 offset:7168
v_mfma_f32_32x32x16_bf16 v[224:239], a[172:175], v[156:159], v[224:239]
s_waitcnt lgkmcnt(6)
ds_read_b64_tr_b16 a[148:149], v242 offset:6400
ds_read_b64_tr_b16 a[150:151], v242 offset:7424
v_mfma_f32_32x32x16_bf16 v[208:223], a[176:179], v[160:163], v[208:223]
ds_read_b64_tr_b16 a[152:153], v242 offset:8192
ds_read_b64_tr_b16 a[154:155], v242 offset:9216
v_mfma_f32_32x32x16_bf16 v[224:239], a[180:183], v[160:163], v[224:239]
s_waitcnt lgkmcnt(6)
buffer_load_dwordx4 v24, s[16:19], s41 offen offset:1024 lds
ds_read_b64_tr_b16 a[156:157], v242 offset:8448
ds_read_b64_tr_b16 a[158:159], v242 offset:9472
v_mfma_f32_32x32x16_bf16 v[208:223], a[184:187], v[164:167], v[208:223]
ds_read_b64_tr_b16 a[160:161], v242 offset:10240
ds_read_b64_tr_b16 a[162:163], v242 offset:11264
v_cvt_pk_bf16_f32 v204, v88, v89
v_cvt_pk_bf16_f32 v205, v90, v91
v_cvt_pk_bf16_f32 v206, v92, v93
v_mfma_f32_32x32x16_bf16 v[224:239], a[188:191], v[164:167], v[224:239]
s_waitcnt lgkmcnt(6)
ds_read_b64_tr_b16 a[164:165], v242 offset:10496
ds_read_b64_tr_b16 a[166:167], v242 offset:11520
v_cvt_pk_bf16_f32 v207, v94, v95
s_waitcnt vmcnt(24)
s_barrier
v_mfma_f32_32x32x16_bf16 v[208:223], a[144:147], v[168:171], v[208:223]
buffer_store_dwordx4 v[204:207], v19, s[20:23], s42 offen offset:3072 sc1
ds_read_b64_tr_b16 a[168:169], v243 offset:6144
ds_read_b64_tr_b16 a[170:171], v243 offset:7168
v_mfma_f32_32x32x16_bf16 v[224:239], a[148:151], v[168:171], v[224:239]
s_waitcnt lgkmcnt(6)
ds_read_b64_tr_b16 a[172:173], v243 offset:6400
ds_read_b64_tr_b16 a[174:175], v243 offset:7424
v_mfma_f32_32x32x16_bf16 v[208:223], a[152:155], v[172:175], v[208:223]
ds_read_b64_tr_b16 a[176:177], v243 offset:8192
ds_read_b64_tr_b16 a[178:179], v243 offset:9216
v_mfma_f32_32x32x16_bf16 v[224:239], a[156:159], v[172:175], v[224:239]
s_waitcnt lgkmcnt(6)
buffer_load_dwordx4 v25, s[16:19], s41 offen offset:2048 lds
ds_read_b64_tr_b16 a[180:181], v243 offset:8448
ds_read_b64_tr_b16 a[182:183], v243 offset:9472
v_mfma_f32_32x32x16_bf16 v[208:223], a[160:163], v[176:179], v[208:223]
ds_read_b64_tr_b16 a[184:185], v243 offset:10240
ds_read_b64_tr_b16 a[186:187], v243 offset:11264
v_mfma_f32_32x32x16_bf16 v[224:239], a[164:167], v[176:179], v[224:239]
s_waitcnt lgkmcnt(6)
ds_read_b64_tr_b16 a[188:189], v243 offset:10496
ds_read_b64_tr_b16 a[190:191], v243 offset:11520
v_mfma_f32_32x32x16_bf16 v[208:223], a[168:171], v[180:183], v[208:223]
ds_read_b64_tr_b16 a[144:145], v240 offset:12288
ds_read_b64_tr_b16 a[146:147], v240 offset:13312
v_mfma_f32_32x32x16_bf16 v[224:239], a[172:175], v[180:183], v[224:239]
s_waitcnt lgkmcnt(6)
ds_read_b64_tr_b16 a[148:149], v240 offset:12544
ds_read_b64_tr_b16 a[150:151], v240 offset:13568
s_waitcnt vmcnt(6)
v_cmp_le_u32 vcc, 1, v8
s_nop 1
s_andn2_b32 s7, 0xfff, vcc_lo
s_cbranch_scc1 L_spin_f0
L_back_f0:
v_mfma_f32_32x32x16_bf16 v[208:223], a[176:179], v[184:187], v[208:223]
s_add_u32 s63, s52, 0
buffer_load_dwordx4 a[0:3], v12, s[20:23], s63 offen sc1
ds_read_b64_tr_b16 a[152:153], v240 offset:14336
ds_read_b64_tr_b16 a[154:155], v240 offset:15360
v_mfma_f32_32x32x16_bf16 v[224:239], a[180:183], v[184:187], v[224:239]
s_waitcnt lgkmcnt(6)
s_add_u32 s63, s52, 2359296
ds_read_b64_tr_b16 a[156:157], v240 offset:14592
ds_read_b64_tr_b16 a[158:159], v240 offset:15616
v_mfma_f32_32x32x16_bf16 v[208:223], a[184:187], v[188:191], v[208:223]
ds_read_b64_tr_b16 a[160:161], v240 offset:16384
ds_read_b64_tr_b16 a[162:163], v240 offset:17408
v_mfma_f32_32x32x16_bf16 v[224:239], a[188:191], v[188:191], v[224:239]
s_waitcnt lgkmcnt(6)
buffer_load_dwordx4 a[4:7], v12, s[20:23], s63 offen sc1
ds_read_b64_tr_b16 a[164:165], v240 offset:16640
ds_read_b64_tr_b16 a[166:167], v240 offset:17664
v_mfma_f32_32x32x16_bf16 v[64:79], a[144:147], v[96:99], 0
s_add_u32 s63, s52, 4718592
ds_read_b64_tr_b16 a[168:169], v241 offset:12288
ds_read_b64_tr_b16 a[170:171], v241 offset:13312
v_mfma_f32_32x32x16_bf16 v[80:95], a[148:151], v[96:99], 0
s_waitcnt lgkmcnt(6)
ds_read_b64_tr_b16 a[172:173], v241 offset:12544
ds_read_b64_tr_b16 a[174:175], v241 offset:13568
v_mfma_f32_32x32x16_bf16 v[64:79], a[152:155], v[100:103], v[64:79]
buffer_load_dwordx4 a[8:11], v12, s[20:23], s63 offen sc1
ds_read_b64_tr_b16 a[176:177], v241 offset:14336
ds_read_b64_tr_b16 a[178:179], v241 offset:15360
v_mfma_f32_32x32x16_bf16 v[80:95], a[156:159], v[100:103], v[80:95]
s_waitcnt lgkmcnt(6)
s_add_u32 s63, s52, 7077888
ds_read_b64_tr_b16 a[180:181], v241 offset:14592
ds_read_b64_tr_b16 a[182:183], v241 offset:15616
v_cvt_pk_bf16_f32 v192, v208, v209
v_cvt_pk_bf16_f32 v193, v210, v211
v_cvt_pk_bf16_f32 v194, v212, v213
v_mfma_f32_32x32x16_bf16 v[64:79], a[160:163], v[104:107], v[64:79]
ds_read_b64_tr_b16 a[184:185], v241 offset:16384
ds_read_b64_tr_b16 a[186:187], v241 offset:17408
v_cvt_pk_bf16_f32 v195, v214, v215
v_mfma_f32_32x32x16_bf16 v[80:95], a[164:167], v[104:107], v[80:95]
s_waitcnt lgkmcnt(6)
buffer_load_dwordx4 a[12:15], v12, s[20:23], s63 offen sc1
ds_read_b64_tr_b16 a[188:189], v241 offset:16640
ds_read_b64_tr_b16 a[190:191], v241 offset:17664
v_mfma_f32_32x32x16_bf16 v[64:79], a[168:171], v[108:111], v[64:79]
s_add_u32 s63, s52, 9437184
ds_read_b64_tr_b16 a[144:145], v242 offset:12288
ds_read_b64_tr_b16 a[146:147], v242 offset:13312
v_mfma_f32_32x32x16_bf16 v[80:95], a[172:175], v[108:111], v[80:95]
s_waitcnt lgkmcnt(6)
ds_read_b64_tr_b16 a[148:149], v242 offset:12544
ds_read_b64_tr_b16 a[150:151], v242 offset:13568
v_mfma_f32_32x32x16_bf16 v[64:79], a[176:179], v[112:115], v[64:79]
buffer_load_dwordx4 a[16:19], v12, s[20:23], s63 offen sc1
ds_read_b64_tr_b16 a[152:153], v242 offset:14336
ds_read_b64_tr_b16 a[154:155], v242 offset:15360
v_mfma_f32_32x32x16_bf16 v[80:95], a[180:183], v[112:115], v[80:95]
s_waitcnt lgkmcnt(6)
s_add_u32 s63, s52, 11796480
ds_read_b64_tr_b16 a[156:157], v242 offset:14592
ds_read_b64_tr_b16 a[158:159], v242 offset:15616
v_mfma_f32_32x32x16_bf16 v[64:79], a[184:187], v[116:119], v[64:79]
ds_read_b64_tr_b16 a[160:161], v242 offset:16384
ds_read_b64_tr_b16 a[162:163], v242 offset:17408
v_mfma_f32_32x32x16_bf16 v[80:95], a[188:191], v[116:119], v[80:95]
s_waitcnt lgkmcnt(6)
buffer_load_dwordx4 a[20:23], v12, s[20:23], s63 offen sc1
ds_read_b64_tr_b16 a[164:165], v242 offset:16640
ds_read_b64_tr_b16 a[166:167], v242 offset:17664
s_waitcnt vmcnt(7)
s_barrier
v_mov_b32 v9, 2
buffer_store_dword v9, v7, s[20:23], s5 offen sc1
v_mfma_f32_32x32x16_bf16 v[64:79], a[144:147], v[120:123], v[64:79]
s_add_u32 s63, s52, 14155776
ds_read_b64_tr_b16 a[168:169], v243 offset:12288
ds_read_b64_tr_b16 a[170:171], v243 offset:13312
v_mfma_f32_32x32x16_bf16 v[80:95], a[148:151], v[120:123], v[80:95]
s_waitcnt lgkmcnt(6)
L_pad_f1_2:
s_cbranch_execz L_warm_f
ds_read_b64_tr_b16 a[172:173], v243 offset:12544
ds_read_b64_tr_b16 a[174:175], v243 offset:13568
v_cvt_pk_bf16_f32 v196, v216, v217
v_cvt_pk_bf16_f32 v197, v218, v219
v_cvt_pk_bf16_f32 v198, v220, v221
v_mfma_f32_32x32x16_bf16 v[64:79], a[152:155], v[124:127], v[64:79]
buffer_load_dwordx4 a[24:27], v12, s[20:23], s63 offen sc1
ds_read_b64_tr_b16 a[176:177], v243 offset:14336
ds_read_b64_tr_b16 a[178:179], v243 offset:15360
v_mfma_f32_32x32x16_bf16 v[80:95], a[156:159], v[124:127], v[80:95]
s_waitcnt lgkmcnt(6)
s_add_u32 s63, s52, 16515072
ds_read_b64_tr_b16 a[180:181], v243 offset:14592
ds_read_b64_tr_b16 a[182:183], v243 offset:15616
v_cvt_pk_bf16_f32 v199, v222, v223
v_mfma_f32_32x32x16_bf16 v[64:79], a[160:163], v[128:131], v[64:79]
ds_read_b64_tr_b16 a[184:185], v243 offset:16384
ds_read_b64_tr_b16 a[186:187], v243 offset:17408
v_mfma_f32_32x32x16_bf16 v[80:95], a[164:167], v[128:131], v[80:95]
s_waitcnt lgkmcnt(6)
buffer_load_dwordx4 a[28:31], v12, s[20:23], s63 offen sc1
ds_read_b64_tr_b16 a[188:189], v243 offset:16640
ds_read_b64_tr_b16 a[190:191], v243 offset:17664
v_mfma_f32_32x32x16_bf16 v[64:79], a[168:171], v[132:135], v[64:79]
s_add_u32 s63, s52, 18874368
ds_read_b64_tr_b16 a[144:145], v240 offset:18432
ds_read_b64_tr_b16 a[146:147], v240 offset:19456
v_mfma_f32_32x32x16_bf16 v[80:95], a[172:175], v[132:135], v[80:95]
s_waitcnt lgkmcnt(6)
ds_read_b64_tr_b16 a[148:149], v240 offset:18688
ds_read_b64_tr_b16 a[150:151], v240 offset:19712
v_mfma_f32_32x32x16_bf16 v[64:79], a[176:179], v[136:139], v[64:79]
buffer_load_dwordx4 a[32:35], v12, s[20:23], s63 offen sc1
ds_read_b64_tr_b16 a[152:153], v240 offset:20480
ds_read_b64_tr_b16 a[154:155], v240 offset:21504
v_mfma_f32_32x32x16_bf16 v[80:95], a[180:183], v[136:139], v[80:95]
s_waitcnt lgkmcnt(6)
s_add_u32 s63, s52, 21233664
ds_read_b64_tr_b16 a[156:157], v240 offset:20736
ds_read_b64_tr_b16 a[158:159], v240 offset:21760
v_mfma_f32_32x32x16_bf16 v[64:79], a[184:187], v[140:143], v[64:79]
ds_read_b64_tr_b16 a[160:161], v240 offset:22528
ds_read_b64_tr_b16 a[162:163], v240 offset:23552
v_mfma_f32_32x32x16_bf16 v[80:95], a[188:191], v[140:143], v[80:95]
s_waitcnt lgkmcnt(6)
buffer_load_dwordx4 a[36:39], v12, s[20:23], s63 offen sc1
ds_read_b64_tr_b16 a[164:165], v240 offset:22784
ds_read_b64_tr_b16 a[166:167], v240 offset:23808
v_mfma_f32_32x32x16_bf16 v[64:79], a[144:147], v[144:147], v[64:79]
s_add_u32 s63, s52, 23592960
ds_read_b64_tr_b16 a[168:169], v241 offset:18432
ds_read_b64_tr_b16 a[170:171], v241 offset:19456
v_cvt_pk_bf16_f32 v200, v224, v225
v_cvt_pk_bf16_f32 v201, v226, v227
v_cvt_pk_bf16_f32 v202, v228, v229
v_mfma_f32_32x32x16_bf16 v[80:95], a[148:151], v[144:147], v[80:95]
s_waitcnt lgkmcnt(6)
ds_read_b64_tr_b16 a[172:173], v241 offset:18688
ds_read_b64_tr_b16 a[174:175], v241 offset:19712
v_cvt_pk_bf16_f32 v203, v230, v231
v_mfma_f32_32x32x16_bf16 v[64:79], a[152:155], v[148:151], v[64:79]
buffer_load_dwordx4 a[40:43], v12, s[20:23], s63 offen sc1
ds_read_b64_tr_b16 a[176:177], v241 offset:20480
ds_read_b64_tr_b16 a[178:179], v241 offset:21504
v_mfma_f32_32x32x16_bf16 v[80:95], a[156:159], v[148:151], v[80:95]
s_waitcnt lgkmcnt(6)
s_add_u32 s63, s52, 25952256
ds_read_b64_tr_b16 a[180:181], v241 offset:20736
ds_read_b64_tr_b16 a[182:183], v241 offset:21760
v_mfma_f32_32x32x16_bf16 v[64:79], a[160:163], v[152:155], v[64:79]
ds_read_b64_tr_b16 a[184:185], v241 offset:22528
ds_read_b64_tr_b16 a[186:187], v241 offset:23552
v_mfma_f32_32x32x16_bf16 v[80:95], a[164:167], v[152:155], v[80:95]
s_waitcnt lgkmcnt(6)
buffer_load_dwordx4 a[44:47], v12, s[20:23], s63 offen sc1
ds_read_b64_tr_b16 a[188:189], v241 offset:22784
ds_read_b64_tr_b16 a[190:191], v241 offset:23808
v_mfma_f32_32x32x16_bf16 v[64:79], a[168:171], v[156:159], v[64:79]
s_add_u32 s42, s40, 24576
ds_read_b64_tr_b16 a[144:145], v242 offset:18432
ds_read_b64_tr_b16 a[146:147], v242 offset:19456
v_mfma_f32_32x32x16_bf16 v[80:95], a[172:175], v[156:159], v[80:95]
s_waitcnt lgkmcnt(6)
ds_read_b64_tr_b16 a[148:149], v242 offset:18688
ds_read_b64_tr_b16 a[150:151], v242 offset:19712
v_mfma_f32_32x32x16_bf16 v[64:79], a[176:179], v[160:163], v[64:79]
buffer_store_dwordx4 v[192:195], v19, s[20:23], s42 offen offset:0 sc1
ds_read_b64_tr_b16 a[152:153], v242 offset:20480
ds_read_b64_tr_b16 a[154:155], v242 offset:21504
v_mfma_f32_32x32x16_bf16 v[80:95], a[180:183], v[160:163], v[80:95]
s_waitcnt lgkmcnt(6)
ds_read_b64_tr_b16 a[156:157], v242 offset:20736
ds_read_b64_tr_b16 a[158:159], v242 offset:21760
v_cvt_pk_bf16_f32 v204, v232, v233
v_cvt_pk_bf16_f32 v205, v234, v235
v_cvt_pk_bf16_f32 v206, v236, v237
v_mfma_f32_32x32x16_bf16 v[64:79], a[184:187], v[164:167], v[64:79]
ds_read_b64_tr_b16 a[160:161], v242 offset:22528
ds_read_b64_tr_b16 a[162:163], v242 offset:23552
v_cvt_pk_bf16_f32 v207, v238, v239
v_mfma_f32_32x32x16_bf16 v[80:95], a[188:191], v[164:167], v[80:95]
s_waitcnt lgkmcnt(6)
buffer_store_dwordx4 v[196:199], v19, s[20:23], s42 offen offset:1024 sc1
ds_read_b64_tr_b16 a[164:165], v242 offset:22784
ds_read_b64_tr_b16 a[166:167], v242 offset:23808
s_barrier
v_mfma_f32_32x32x16_bf16 v[64:79], a[144:147], v[168:171], v[64:79]
ds_read_b64_tr_b16 a[168:169], v243 offset:18432
ds_read_b64_tr_b16 a[170:171], v243 offset:19456
v_mfma_f32_32x32x16_bf16 v[80:95], a[148:151], v[168:171], v[80:95]
s_waitcnt lgkmcnt(6)
ds_read_b64_tr_b16 a[172:173], v243 offset:18688
ds_read_b64_tr_b16 a[174:175], v243 offset:19712
v_mfma_f32_32x32x16_bf16 v[64:79], a[152:155], v[172:175], v[64:79]
buffer_store_dwordx4 v[200:203], v19, s[20:23], s42 offen offset:2048 sc1
ds_read_b64_tr_b16 a[176:177], v243 offset:20480
ds_read_b64_tr_b16 a[178:179], v243 offset:21504
v_mfma_f32_32x32x16_bf16 v[80:95], a[156:159], v[172:175], v[80:95]
s_waitcnt lgkmcnt(6)
ds_read_b64_tr_b16 a[180:181], v243 offset:20736
ds_read_b64_tr_b16 a[182:183], v243 offset:21760
v_mfma_f32_32x32x16_bf16 v[64:79], a[160:163], v[176:179], v[64:79]
ds_read_b64_tr_b16 a[184:185], v243 offset:22528
ds_read_b64_tr_b16 a[186:187], v243 offset:23552
v_mfma_f32_32x32x16_bf16 v[80:95], a[164:167], v[176:179], v[80:95]
s_waitcnt lgkmcnt(6)
buffer_store_dwordx4 v[204:207], v19, s[20:23], s42 offen offset:3072 sc1
ds_read_b64_tr_b16 a[188:189], v243 offset:22784
ds_read_b64_tr_b16 a[190:191], v243 offset:23808
v_mfma_f32_32x32x16_bf16 v[64:79], a[168:171], v[180:183], v[64:79]
ds_read_b64_tr_b16 a[144:145], v240 offset:24576
ds_read_b64_tr_b16 a[146:147], v240 offset:25600
v_mfma_f32_32x32x16_bf16 v[80:95], a[172:175], v[180:183], v[80:95]
s_waitcnt lgkmcnt(6)
ds_read_b64_tr_b16 a[148:149], v240 offset:24832
ds_read_b64_tr_b16 a[150:151], v240 offset:25856
v_mfma_f32_32x32x16_bf16 v[64:79], a[176:179], v[184:187], v[64:79]
buffer_load_dword v8, v10, s[20:23], s4 offen sc1
ds_read_b64_tr_b16 a[152:153], v240 offset:26624
ds_read_b64_tr_b16 a[154:155], v240 offset:27648
v_mfma_f32_32x32x16_bf16 v[80:95], a[180:183], v[184:187], v[80:95]
s_waitcnt lgkmcnt(6)
ds_read_b64_tr_b16 a[156:157], v240 offset:26880
ds_read_b64_tr_b16 a[158:159], v240 offset:27904
v_mfma_f32_32x32x16_bf16 v[64:79], a[184:187], v[188:191], v[64:79]
ds_read_b64_tr_b16 a[160:161], v240 offset:28672
ds_read_b64_tr_b16 a[162:163], v240 offset:29696
v_mfma_f32_32x32x16_bf16 v[80:95], a[188:191], v[188:191], v[80:95]
s_waitcnt lgkmcnt(6)
ds_read_b64_tr_b16 a[164:165], v240 offset:28928
ds_read_b64_tr_b16 a[166:167], v240 offset:29952
v_mfma_f32_32x32x16_bf16 v[208:223], a[144:147], v[96:99], 0
ds_read_b64_tr_b16 a[168:169], v241 offset:24576
ds_read_b64_tr_b16 a[170:171], v241 offset:25600
v_mfma_f32_32x32x16_bf16 v[224:239], a[148:151], v[96:99], 0
s_waitcnt lgkmcnt(6)
ds_read_b64_tr_b16 a[172:173], v241 offset:24832
ds_read_b64_tr_b16 a[174:175], v241 offset:25856
v_mfma_f32_32x32x16_bf16 v[208:223], a[152:155], v[100:103], v[208:223]
ds_read_b64_tr_b16 a[176:177], v241 offset:26624
ds_read_b64_tr_b16 a[178:179], v241 offset:27648
v_mfma_f32_32x32x16_bf16 v[224:239], a[156:159], v[100:103], v[224:239]
s_waitcnt lgkmcnt(6)
ds_read_b64_tr_b16 a[180:181], v241 offset:26880
ds_read_b64_tr_b16 a[182:183], v241 offset:27904
v_cvt_pk_bf16_f32 v192, v64, v65
v_cvt_pk_bf16_f32 v193, v66, v67
v_cvt_pk_bf16_f32 v194, v68, v69
v_mfma_f32_32x32x16_bf16 v[208:223], a[160:163], v[104:107], v[208:223]
ds_read_b64_tr_b16 a[184:185], v241 offset:28672
ds_read_b64_tr_b16 a[186:187], v241 offset:29696
v_cvt_pk_bf16_f32 v195, v70, v71
v_mfma_f32_32x32x16_bf16 v[224:239], a[164:167], v[104:107], v[224:239]
s_waitcnt lgkmcnt(6)
s_add_u32 s42, s40, 28672
buffer_store_dwordx4 v[192:195], v19, s[20:23], s42 offen offset:0 sc1
ds_read_b64_tr_b16 a[188:189], v241 offset:28928
ds_read_b64_tr_b16 a[190:191], v241 offset:29952
v_mfma_f32_32x32x16_bf16 v[208:223], a[168:171], v[108:111], v[208:223]
ds_read_b64_tr_b16 a[144:145], v242 offset:24576
ds_read_b64_tr_b16 a[146:147], v242 offset:25600
v_mfma_f32_32x32x16_bf16 v[224:239], a[172:175], v[108:111], v[224:239]
s_waitcnt lgkmcnt(6)
ds_read_b64_tr_b16 a[148:149], v242 offset:24832
ds_read_b64_tr_b16 a[150:151], v242 offset:25856
v_mfma_f32_32x32x16_bf16 v[208:223], a[176:179], v[112:115], v[208:223]
ds_read_b64_tr_b16 a[152:153], v242 offset:26624
ds_read_b64_tr_b16 a[154:155], v242 offset:27648
v_mfma_f32_32x32x16_bf16 v[224:239], a[180:183], v[112:115], v[224:239]
s_waitcnt lgkmcnt(6)
ds_read_b64_tr_b16 a[156:157], v242 offset:26880
ds_read_b64_tr_b16 a[158:159], v242 offset:27904
v_mfma_f32_32x32x16_bf16 v[208:223], a[184:187], v[116:119], v[208:223]
ds_read_b64_tr_b16 a[160:161], v242 offset:28672
ds_read_b64_tr_b16 a[162:163], v242 offset:29696
v_mfma_f32_32x32x16_bf16 v[224:239], a[188:191], v[116:119], v[224:239]
s_waitcnt lgkmcnt(6)
ds_read_b64_tr_b16 a[164:165], v242 offset:28928
ds_read_b64_tr_b16 a[166:167], v242 offset:29952
s_waitcnt vmcnt(19)
s_barrier
v_mfma_f32_32x32x16_bf16 v[208:223], a[144:147], v[120:123], v[208:223]
ds_read_b64_tr_b16 a[168:169], v243 offset:24576
ds_read_b64_tr_b16 a[170:171], v243 offset:25600
v_mfma_f32_32x32x16_bf16 v[224:239], a[148:151], v[120:123], v[224:239]
s_waitcnt lgkmcnt(6)
ds_read_b64_tr_b16 a[172:173], v243 offset:24832
ds_read_b64_tr_b16 a[174:175], v243 offset:25856
v_cvt_pk_bf16_f32 v196, v72, v73
v_cvt_pk_bf16_f32 v197, v74, v75
v_cvt_pk_bf16_f32 v198, v76, v77
s_waitcnt vmcnt(1)
v_cmp_le_u32 vcc, 2, v8
s_nop 1
s_andn2_b32 s7, 0xfff, vcc_lo
s_cbranch_scc1 L_spin_f1
L_back_f1:
v_mfma_f32_32x32x16_bf16 v[208:223], a[152:155], v[124:127], v[208:223]
s_add_u32 s63, s52, 12288
buffer_load_dwordx4 a[48:51], v12, s[20:23], s63 offen sc1
ds_read_b64_tr_b16 a[176:177], v243 offset:26624
ds_read_b64_tr_b16 a[178:179], v243 offset:27648
v_mfma_f32_32x32x16_bf16 v[224:239], a[156:159], v[124:127], v[224:239]
s_waitcnt lgkmcnt(6)
s_add_u32 s63, s52, 2371584
ds_read_b64_tr_b16 a[180:181], v243 offset:26880
ds_read_b64_tr_b16 a[182:183], v243 offset:27904
v_cvt_pk_bf16_f32 v199, v78, v79
v_mfma_f32_32x32x16_bf16 v[208:223], a[160:163], v[128:131], v[208:223]
ds_read_b64_tr_b16 a[184:185], v243 offset:28672
ds_read_b64_tr_b16 a[186:187], v243 offset:29696
v_mfma_f32_32x32x16_bf16 v[224:239], a[164:167], v[128:131], v[224:239]
s_waitcnt lgkmcnt(6)
buffer_load_dwordx4 a[52:55], v12, s[20:23], s63 offen sc1
ds_read_b64_tr_b16 a[188:189], v243 offset:28928
ds_read_b64_tr_b16 a[190:191], v243 offset:29952
v_mfma_f32_32x32x16_bf16 v[208:223], a[168:171], v[132:135], v[208:223]
s_add_u32 s63, s52, 4730880
ds_read_b64_tr_b16 a[144:145], v240 offset:30720
ds_read_b64_tr_b16 a[146:147], v240 offset:31744
v_mfma_f32_32x32x16_bf16 v[224:239], a[172:175], v[132:135], v[224:239]
s_waitcnt lgkmcnt(6)
ds_read_b64_tr_b16 a[148:149], v240 offset:30976
ds_read_b64_tr_b16 a[150:151], v240 offset:32000
v_mfma_f32_32x32x16_bf16 v[208:223], a[176:179], v[136:139], v[208:223]
buffer_load_dwordx4 a[56:59], v12, s[20:23], s63 offen sc1
ds_read_b64_tr_b16 a[152:153], v240 offset:32768
ds_read_b64_tr_b16 a[154:155], v240 offset:33792
v_mfma_f32_32x32x16_bf16 v[224:239], a[180:183], v[136:139], v[224:239]
s_waitcnt lgkmcnt(6)
s_add_u32 s63, s52, 7090176
ds_read_b64_tr_b16 a[156:157], v240 offset:33024
ds_read_b64_tr_b16 a[158:159], v240 offset:34048
v_mfma_f32_32x32x16_bf16 v[208:223], a[184:187], v[140:143], v[208:223]
ds_read_b64_tr_b16 a[160:161], v240 offset:34816
ds_read_b64_tr_b16 a[162:163], v240 offset:35840
v_mfma_f32_32x32x16_bf16 v[224:239], a[188:191], v[140:143], v[224:239]
s_waitcnt lgkmcnt(6)
buffer_load_dwordx4 a[60:63], v12, s[20:23], s63 offen sc1
ds_read_b64_tr_b16 a[164:165], v240 offset:35072
ds_read_b64_tr_b16 a[166:167], v240 offset:36096
v_mfma_f32_32x32x16_bf16 v[208:223], a[144:147], v[144:147], v[208:223]
s_add_u32 s63, s52, 9449472
ds_read_b64_tr_b16 a[168:169], v241 offset:30720
ds_read_b64_tr_b16 a[170:171], v241 offset:31744
v_cvt_pk_bf16_f32 v200, v80, v81
v_cvt_pk_bf16_f32 v201, v82, v83
v_cvt_pk_bf16_f32 v202, v84, v85
v_mfma_f32_32x32x16_bf16 v[224:239], a[148:151], v[144:147], v[224:239]
s_waitcnt lgkmcnt(6)
ds_read_b64_tr_b16 a[172:173], v241 offset:30976
ds_read_b64_tr_b16 a[174:175], v241 offset:32000
v_cvt_pk_bf16_f32 v203, v86, v87
v_mfma_f32_32x32x16_bf16 v[208:223], a[152:155], v[148:151], v[208:223]
buffer_load_dwordx4 a[64:67], v12, s[20:23], s63 offen sc1
ds_read_b64_tr_b16 a[176:177], v241 offset:32768
ds_read_b64_tr_b16 a[178:179], v241 offset:33792
v_mfma_f32_32x32x16_bf16 v[224:239], a[156:159], v[148:151], v[224:239]
s_waitcnt lgkmcnt(6)
s_add_u32 s63, s52, 11808768
ds_read_b64_tr_b16 a[180:181], v241 offset:33024
ds_read_b64_tr_b16 a[182:183], v241 offset:34048
v_mfma_f32_32x32x16_bf16 v[208:223], a[160:163], v[152:155], v[208:223]
ds_read_b64_tr_b16 a[184:185], v241 offset:34816
ds_read_b64_tr_b16 a[186:187], v241 offset:35840
v_mfma_f32_32x32x16_bf16 v[224:239], a[164:167], v[152:155], v[224:239]
s_waitcnt lgkmcnt(6)
buffer_load_dwordx4 a[68:71], v12, s[20:23], s63 offen sc1
ds_read_b64_tr_b16 a[188:189], v241 offset:35072
ds_read_b64_tr_b16 a[190:191], v241 offset:36096
v_mfma_f32_32x32x16_bf16 v[208:223], a[168:171], v[156:159], v[208:223]
s_add_u32 s63, s52, 14168064
ds_read_b64_tr_b16 a[144:145], v242 offset:30720
ds_read_b64_tr_b16 a[146:147], v242 offset:31744
v_mfma_f32_32x32x16_bf16 v[224:239], a[172:175], v[156:159], v[224:239]
s_waitcnt lgkmcnt(6)
ds_read_b64_tr_b16 a[148:149], v242 offset:30976
ds_read_b64_tr_b16 a[150:151], v242 offset:32000
v_mfma_f32_32x32x16_bf16 v[208:223], a[176:179], v[160:163], v[208:223]
buffer_load_dwordx4 a[72:75], v12, s[20:23], s63 offen sc1
ds_read_b64_tr_b16 a[152:153], v242 offset:32768
ds_read_b64_tr_b16 a[154:155], v242 offset:33792
v_mfma_f32_32x32x16_bf16 v[224:239], a[180:183], v[160:163], v[224:239]
s_waitcnt lgkmcnt(6)
s_add_u32 s63, s52, 16527360
ds_read_b64_tr_b16 a[156:157], v242 offset:33024
ds_read_b64_tr_b16 a[158:159], v242 offset:34048
v_cvt_pk_bf16_f32 v204, v88, v89
v_cvt_pk_bf16_f32 v205, v90, v91
v_cvt_pk_bf16_f32 v206, v92, v93
v_mfma_f32_32x32x16_bf16 v[208:223], a[184:187], v[164:167], v[208:223]
ds_read_b64_tr_b16 a[160:161], v242 offset:34816
ds_read_b64_tr_b16 a[162:163], v242 offset:35840
v_cvt_pk_bf16_f32 v207, v94, v95
v_mfma_f32_32x32x16_bf16 v[224:239], a[188:191], v[164:167], v[224:239]
s_waitcnt lgkmcnt(6)
buffer_load_dwordx4 a[76:79], v12, s[20:23], s63 offen sc1
ds_read_b64_tr_b16 a[164:165], v242 offset:35072
ds_read_b64_tr_b16 a[166:167], v242 offset:36096
s_barrier
v_mfma_f32_32x32x16_bf16 v[208:223], a[144:147], v[168:171], v[208:223]
s_add_u32 s63, s52, 18886656
ds_read_b64_tr_b16 a[168:169], v243 offset:30720
ds_read_b64_tr_b16 a[170:171], v243 offset:31744
v_mfma_f32_32x32x16_bf16 v[224:239], a[148:151], v[168:171], v[224:239]
s_waitcnt lgkmcnt(6)
ds_read_b64_tr_b16 a[172:173], v243 offset:30976
ds_read_b64_tr_b16 a[174:175], v243 offset:32000
v_mfma_f32_32x32x16_bf16 v[208:223], a[152:155], v[172:175], v[208:223]
buffer_load_dwordx4 a[80:83], v12, s[20:23], s63 offen sc1
ds_read_b64_tr_b16 a[176:177], v243 offset:32768
ds_read_b64_tr_b16 a[178:179], v243 offset:33792
v_mfma_f32_32x32x16_bf16 v[224:239], a[156:159], v[172:175], v[224:239]
s_waitcnt lgkmcnt(6)
s_add_u32 s63, s52, 21245952
ds_read_b64_tr_b16 a[180:181], v243 offset:33024
ds_read_b64_tr_b16 a[182:183], v243 offset:34048
v_mfma_f32_32x32x16_bf16 v[208:223], a[160:163], v[176:179], v[208:223]
ds_read_b64_tr_b16 a[184:185], v243 offset:34816
ds_read_b64_tr_b16 a[186:187], v243 offset:35840
v_mfma_f32_32x32x16_bf16 v[224:239], a[164:167], v[176:179], v[224:239]
s_waitcnt lgkmcnt(6)
buffer_load_dwordx4 a[84:87], v12, s[20:23], s63 offen sc1
ds_read_b64_tr_b16 a[188:189], v243 offset:35072
ds_read_b64_tr_b16 a[190:191], v243 offset:36096
v_mfma_f32_32x32x16_bf16 v[208:223], a[168:171], v[180:183], v[208:223]
s_add_u32 s63, s52, 23605248
v_mfma_f32_32x32x16_bf16 v[224:239], a[172:175], v[180:183], v[224:239]
s_waitcnt lgkmcnt(4)
v_mfma_f32_32x32x16_bf16 v[208:223], a[176:179], v[184:187], v[208:223]
buffer_load_dwordx4 a[88:91], v12, s[20:23], s63 offen sc1
v_mfma_f32_32x32x16_bf16 v[224:239], a[180:183], v[184:187], v[224:239]
s_waitcnt lgkmcnt(0)
s_add_u32 s63, s52, 25964544
v_mfma_f32_32x32x16_bf16 v[208:223], a[184:187], v[188:191], v[208:223]
v_mfma_f32_32x32x16_bf16 v[224:239], a[188:191], v[188:191], v[224:239]
buffer_load_dwordx4 a[92:95], v12, s[20:23], s63 offen sc1
buffer_store_dwordx4 v[196:199], v19, s[20:23], s42 offen offset:1024 sc1
buffer_store_dwordx4 v[200:203], v19, s[20:23], s42 offen offset:2048 sc1
buffer_store_dwordx4 v[204:207], v19, s[20:23], s42 offen offset:3072 sc1
s_nop 6
v_cvt_pk_bf16_f32 v192, v208, v209
v_cvt_pk_bf16_f32 v193, v210, v211
v_cvt_pk_bf16_f32 v194, v212, v213
v_cvt_pk_bf16_f32 v195, v214, v215
s_add_u32 s42, s40, 32768
buffer_store_dwordx4 v[192:195], v19, s[20:23], s42 offen offset:0 sc1
v_cvt_pk_bf16_f32 v196, v216, v217
v_cvt_pk_bf16_f32 v197, v218, v219
v_cvt_pk_bf16_f32 v198, v220, v221
v_cvt_pk_bf16_f32 v199, v222, v223
buffer_store_dwordx4 v[196:199], v19, s[20:23], s42 offen offset:1024 sc1
v_cvt_pk_bf16_f32 v200, v224, v225
v_cvt_pk_bf16_f32 v201, v226, v227
v_cvt_pk_bf16_f32 v202, v228, v229
v_cvt_pk_bf16_f32 v203, v230, v231
buffer_store_dwordx4 v[200:203], v19, s[20:23], s42 offen offset:2048 sc1
v_cvt_pk_bf16_f32 v204, v232, v233
v_cvt_pk_bf16_f32 v205, v234, v235
v_cvt_pk_bf16_f32 v206, v236, v237
v_cvt_pk_bf16_f32 v207, v238, v239
buffer_store_dwordx4 v[204:207], v19, s[20:23], s42 offen offset:3072 sc1
v_accvgpr_read_b32 v96, a0
v_accvgpr_read_b32 v97, a1
v_accvgpr_read_b32 v98, a2
v_accvgpr_read_b32 v99, a3
v_accvgpr_read_b32 v100, a4
v_accvgpr_read_b32 v101, a5
v_accvgpr_read_b32 v102, a6
v_accvgpr_read_b32 v103, a7
v_accvgpr_read_b32 v104, a8
v_accvgpr_read_b32 v105, a9
v_accvgpr_read_b32 v106, a10
v_accvgpr_read_b32 v107, a11
v_accvgpr_read_b32 v108, a12
v_accvgpr_read_b32 v109, a13
v_accvgpr_read_b32 v110, a14
v_accvgpr_read_b32 v111, a15
v_accvgpr_read_b32 v112, a16
v_accvgpr_read_b32 v113, a17
v_accvgpr_read_b32 v114, a18
v_accvgpr_read_b32 v115, a19
v_accvgpr_read_b32 v116, a20
v_accvgpr_read_b32 v117, a21
v_accvgpr_read_b32 v118, a22
v_accvgpr_read_b32 v119, a23
v_accvgpr_read_b32 v120, a24
v_accvgpr_read_b32 v121, a25
v_accvgpr_read_b32 v122, a26
v_accvgpr_read_b32 v123, a27
v_accvgpr_read_b32 v124, a28
v_accvgpr_read_b32 v125, a29
v_accvgpr_read_b32 v126, a30
v_accvgpr_read_b32 v127, a31
v_accvgpr_read_b32 v128, a32
v_accvgpr_read_b32 v129, a33
v_accvgpr_read_b32 v130, a34
v_accvgpr_read_b32 v131, a35
v_accvgpr_read_b32 v132, a36
v_accvgpr_read_b32 v133, a37
v_accvgpr_read_b32 v134, a38
v_accvgpr_read_b32 v135, a39
v_accvgpr_read_b32 v136, a40
v_accvgpr_read_b32 v137, a41
v_accvgpr_read_b32 v138, a42
v_accvgpr_read_b32 v139, a43
v_accvgpr_read_b32 v140, a44
v_accvgpr_read_b32 v141, a45
v_accvgpr_read_b32 v142, a46
v_accvgpr_read_b32 v143, a47
v_lshlrev_b32 v244, 16, v96
v_and_b32 v245, s47, v96
v_lshlrev_b32 v246, 16, v97
v_and_b32 v247, s47, v97
v_lshlrev_b32 v248, 16, v98
v_and_b32 v249, s47, v98
v_lshlrev_b32 v250, 16, v99
v_and_b32 v251, s47, v99
v_dot2c_f32_bf16 v244, s44, v100
v_dot2c_f32_bf16 v245, s45, v100
v_dot2c_f32_bf16 v246, s44, v101
v_dot2c_f32_bf16 v247, s45, v101
v_dot2c_f32_bf16 v248, s44, v102
v_dot2c_f32_bf16 v249, s45, v102
v_dot2c_f32_bf16 v250, s44, v103
v_dot2c_f32_bf16 v251, s45, v103
v_dot2c_f32_bf16 v244, s44, v104
v_dot2c_f32_bf16 v245, s45, v104
v_dot2c_f32_bf16 v246, s44, v105
v_dot2c_f32_bf16 v247, s45, v105
v_dot2c_f32_bf16 v248, s44, v106
v_dot2c_f32_bf16 v249, s45, v106
v_dot2c_f32_bf16 v250, s44, v107
v_dot2c_f32_bf16 v251, s45, v107
v_dot2c_f32_bf16 v244, s44, v108
v_dot2c_f32_bf16 v245, s45, v108
v_dot2c_f32_bf16 v246, s44, v109
v_dot2c_f32_bf16 v247, s45, v109
v_dot2c_f32_bf16 v248, s44, v110
v_dot2c_f32_bf16 v249, s45, v110
v_dot2c_f32_bf16 v250, s44, v111
v_dot2c_f32_bf16 v251, s45, v111
v_dot2c_f32_bf16 v244, s44, v112
v_dot2c_f32_bf16 v245, s45, v112
v_dot2c_f32_bf16 v246, s44, v113
v_dot2c_f32_bf16 v247, s45, v113
v_dot2c_f32_bf16 v248, s44, v114
v_dot2c_f32_bf16 v249, s45, v114
v_dot2c_f32_bf16 v250, s44, v115
v_dot2c_f32_bf16 v251, s45, v115
v_dot2c_f32_bf16 v244, s44, v116
v_dot2c_f32_bf16 v245, s45, v116
v_dot2c_f32_bf16 v246, s44, v117
v_dot2c_f32_bf16 v247, s45, v117
v_dot2c_f32_bf16 v248, s44, v118
v_dot2c_f32_bf16 v249, s45, v118
v_dot2c_f32_bf16 v250, s44, v119
v_dot2c_f32_bf16 v251, s45, v119
v_dot2c_f32_bf16 v244, s44, v120
v_dot2c_f32_bf16 v245, s45, v120
v_dot2c_f32_bf16 v246, s44, v121
v_dot2c_f32_bf16 v247, s45, v121
v_dot2c_f32_bf16 v248, s44, v122
v_dot2c_f32_bf16 v249, s45, v122
v_dot2c_f32_bf16 v250, s44, v123
v_dot2c_f32_bf16 v251, s45, v123
v_dot2c_f32_bf16 v244, s44, v124
v_dot2c_f32_bf16 v245, s45, v124
v_dot2c_f32_bf16 v246, s44, v125
v_dot2c_f32_bf16 v247, s45, v125
v_dot2c_f32_bf16 v248, s44, v126
v_dot2c_f32_bf16 v249, s45, v126
v_dot2c_f32_bf16 v250, s44, v127
v_dot2c_f32_bf16 v251, s45, v127
v_dot2c_f32_bf16 v244, s44, v128
v_dot2c_f32_bf16 v245, s45, v128
v_dot2c_f32_bf16 v246, s44, v129
v_dot2c_f32_bf16 v247, s45, v129
v_dot2c_f32_bf16 v248, s44, v130
v_dot2c_f32_bf16 v249, s45, v130
v_dot2c_f32_bf16 v250, s44, v131
v_dot2c_f32_bf16 v251, s45, v131
v_dot2c_f32_bf16 v244, s44, v132
v_dot2c_f32_bf16 v245, s45, v132
v_dot2c_f32_bf16 v246, s44, v133
v_dot2c_f32_bf16 v247, s45, v133
v_dot2c_f32_bf16 v248, s44, v134
v_dot2c_f32_bf16 v249, s45, v134
v_dot2c_f32_bf16 v250, s44, v135
v_dot2c_f32_bf16 v251, s45, v135
v_dot2c_f32_bf16 v244, s44, v136
v_dot2c_f32_bf16 v245, s45, v136
v_dot2c_f32_bf16 v246, s44, v137
v_dot2c_f32_bf16 v247, s45, v137
v_dot2c_f32_bf16 v248, s44, v138
v_dot2c_f32_bf16 v249, s45, v138
v_dot2c_f32_bf16 v250, s44, v139
v_dot2c_f32_bf16 v251, s45, v139
v_dot2c_f32_bf16 v244, s44, v140
v_dot2c_f32_bf16 v245, s45, v140
v_dot2c_f32_bf16 v246, s44, v141
v_dot2c_f32_bf16 v247, s45, v141
v_dot2c_f32_bf16 v248, s44, v142
v_dot2c_f32_bf16 v249, s45, v142
v_dot2c_f32_bf16 v250, s44, v143
v_dot2c_f32_bf16 v251, s45, v143
s_waitcnt vmcnt(0)
s_barrier
v_mov_b32 v9, 3
buffer_store_dword v9, v7, s[20:23], s5 offen sc1
v_accvgpr_read_b32 v96, a48
v_accvgpr_read_b32 v97, a49
v_accvgpr_read_b32 v98, a50
v_accvgpr_read_b32 v99, a51
v_accvgpr_read_b32 v100, a52
v_accvgpr_read_b32 v101, a53
v_accvgpr_read_b32 v102, a54
v_accvgpr_read_b32 v103, a55
v_accvgpr_read_b32 v104, a56
v_accvgpr_read_b32 v105, a57
v_accvgpr_read_b32 v106, a58
v_accvgpr_read_b32 v107, a59
v_accvgpr_read_b32 v108, a60
v_accvgpr_read_b32 v109, a61
v_accvgpr_read_b32 v110, a62
v_accvgpr_read_b32 v111, a63
v_accvgpr_read_b32 v112, a64
v_accvgpr_read_b32 v113, a65
v_accvgpr_read_b32 v114, a66
v_accvgpr_read_b32 v115, a67
v_accvgpr_read_b32 v116, a68
v_accvgpr_read_b32 v117, a69
v_accvgpr_read_b32 v118, a70
v_accvgpr_read_b32 v119, a71
v_accvgpr_read_b32 v120, a72
v_accvgpr_read_b32 v121, a73
v_accvgpr_read_b32 v122, a74
v_accvgpr_read_b32 v123, a75
v_accvgpr_read_b32 v124, a76
v_accvgpr_read_b32 v125, a77
v_accvgpr_read_b32 v126, a78
v_accvgpr_read_b32 v127, a79
v_accvgpr_read_b32 v128, a80
v_accvgpr_read_b32 v129, a81
v_accvgpr_read_b32 v130, a82
v_accvgpr_read_b32 v131, a83
v_accvgpr_read_b32 v132, a84
v_accvgpr_read_b32 v133, a85
v_accvgpr_read_b32 v134, a86
v_accvgpr_read_b32 v135, a87
v_accvgpr_read_b32 v136, a88
v_accvgpr_read_b32 v137, a89
v_accvgpr_read_b32 v138, a90
v_accvgpr_read_b32 v139, a91
v_accvgpr_read_b32 v140, a92
v_accvgpr_read_b32 v141, a93
v_accvgpr_read_b32 v142, a94
v_accvgpr_read_b32 v143, a95
v_lshlrev_b32 v56, 16, v96
v_and_b32 v57, s47, v96
v_lshlrev_b32 v58, 16, v97
v_and_b32 v59, s47, v97
v_lshlrev_b32 v60, 16, v98
v_and_b32 v61, s47, v98
v_lshlrev_b32 v62, 16, v99
v_and_b32 v63, s47, v99
v_dot2c_f32_bf16 v56, s44, v100
v_dot2c_f32_bf16 v57, s45, v100
v_dot2c_f32_bf16 v58, s44, v101
v_dot2c_f32_bf16 v59, s45, v101
v_dot2c_f32_bf16 v60, s44, v102
v_dot2c_f32_bf16 v61, s45, v102
v_dot2c_f32_bf16 v62, s44, v103
v_dot2c_f32_bf16 v63, s45, v103
v_dot2c_f32_bf16 v56, s44, v104
L_pad_f2_2:
s_cbranch_execz L_warm_f
v_dot2c_f32_bf16 v57, s45, v104
v_dot2c_f32_bf16 v58, s44, v105
v_dot2c_f32_bf16 v59, s45, v105
v_dot2c_f32_bf16 v60, s44, v106
v_dot2c_f32_bf16 v61, s45, v106
v_dot2c_f32_bf16 v62, s44, v107
v_dot2c_f32_bf16 v63, s45, v107
v_dot2c_f32_bf16 v56, s44, v108
v_dot2c_f32_bf16 v57, s45, v108
v_dot2c_f32_bf16 v58, s44, v109
v_dot2c_f32_bf16 v59, s45, v109
v_dot2c_f32_bf16 v60, s44, v110
v_dot2c_f32_bf16 v61, s45, v110
v_dot2c_f32_bf16 v62, s44, v111
v_dot2c_f32_bf16 v63, s45, v111
v_dot2c_f32_bf16 v56, s44, v112
v_dot2c_f32_bf16 v57, s45, v112
v_dot2c_f32_bf16 v58, s44, v113
v_dot2c_f32_bf16 v59, s45, v113
v_dot2c_f32_bf16 v60, s44, v114
v_dot2c_f32_bf16 v61, s45, v114
v_dot2c_f32_bf16 v62, s44, v115
v_dot2c_f32_bf16 v63, s45, v115
v_dot2c_f32_bf16 v56, s44, v116
v_dot2c_f32_bf16 v57, s45, v116
v_dot2c_f32_bf16 v58, s44, v117
v_dot2c_f32_bf16 v59, s45, v117
v_dot2c_f32_bf16 v60, s44, v118
v_dot2c_f32_bf16 v61, s45, v118
v_dot2c_f32_bf16 v62, s44, v119
v_dot2c_f32_bf16 v63, s45, v119
v_dot2c_f32_bf16 v56, s44, v120
v_dot2c_f32_bf16 v57, s45, v120
v_dot2c_f32_bf16 v58, s44, v121
v_dot2c_f32_bf16 v59, s45, v121
v_dot2c_f32_bf16 v60, s44, v122
v_dot2c_f32_bf16 v61, s45, v122
v_dot2c_f32_bf16 v62, s44, v123
v_dot2c_f32_bf16 v63, s45, v123
v_dot2c_f32_bf16 v56, s44, v124
v_dot2c_f32_bf16 v57, s45, v124
v_dot2c_f32_bf16 v58, s44, v125
v_dot2c_f32_bf16 v59, s45, v125
v_dot2c_f32_bf16 v60, s44, v126
v_dot2c_f32_bf16 v61, s45, v126
v_dot2c_f32_bf16 v62, s44, v127
v_dot2c_f32_bf16 v63, s45, v127
v_dot2c_f32_bf16 v56, s44, v128
v_dot2c_f32_bf16 v57, s45, v128
v_dot2c_f32_bf16 v58, s44, v129
v_dot2c_f32_bf16 v59, s45, v129
v_dot2c_f32_bf16 v60, s44, v130
v_dot2c_f32_bf16 v61, s45, v130
v_dot2c_f32_bf16 v62, s44, v131
v_dot2c_f32_bf16 v63, s45, v131
v_dot2c_f32_bf16 v56, s44, v132
v_dot2c_f32_bf16 v57, s45, v132
v_dot2c_f32_bf16 v58, s44, v133
v_dot2c_f32_bf16 v59, s45, v133
v_dot2c_f32_bf16 v60, s44, v134
v_dot2c_f32_bf16 v61, s45, v134
v_dot2c_f32_bf16 v62, s44, v135
v_dot2c_f32_bf16 v63, s45, v135
v_dot2c_f32_bf16 v56, s44, v136
v_dot2c_f32_bf16 v57, s45, v136
v_dot2c_f32_bf16 v58, s44, v137
v_dot2c_f32_bf16 v59, s45, v137
v_dot2c_f32_bf16 v60, s44, v138
v_dot2c_f32_bf16 v61, s45, v138
v_dot2c_f32_bf16 v62, s44, v139
v_dot2c_f32_bf16 v63, s45, v139
v_dot2c_f32_bf16 v56, s44, v140
v_dot2c_f32_bf16 v57, s45, v140
v_dot2c_f32_bf16 v58, s44, v141
v_dot2c_f32_bf16 v59, s45, v141
v_dot2c_f32_bf16 v60, s44, v142
v_dot2c_f32_bf16 v61, s45, v142
v_dot2c_f32_bf16 v62, s44, v143
v_dot2c_f32_bf16 v63, s45, v143
buffer_load_dword v8, v10, s[20:23], s4 offen sc1
v_mul_f32 v32, 0xbfb8aa3b, v244
v_mul_f32 v33, 0xbfb8aa3b, v245
v_mul_f32 v34, 0xbfb8aa3b, v246
v_mul_f32 v35, 0xbfb8aa3b, v247
v_mul_f32 v36, 0xbfb8aa3b, v248
v_mul_f32 v37, 0xbfb8aa3b, v249
v_mul_f32 v38, 0xbfb8aa3b, v250
v_mul_f32 v39, 0xbfb8aa3b, v251
v_exp_f32 v32, v32
v_exp_f32 v33, v33
v_exp_f32 v34, v34
v_exp_f32 v35, v35
v_exp_f32 v36, v36
v_exp_f32 v37, v37
v_exp_f32 v38, v38
v_exp_f32 v39, v39
v_add_f32 v32, 1.0, v32
v_add_f32 v33, 1.0, v33
v_add_f32 v34, 1.0, v34
v_add_f32 v35, 1.0, v35
v_add_f32 v36, 1.0, v36
v_add_f32 v37, 1.0, v37
v_add_f32 v38, 1.0, v38
v_add_f32 v39, 1.0, v39
v_rcp_f32 v32, v32
v_rcp_f32 v33, v33
v_rcp_f32 v34, v34
v_rcp_f32 v35, v35
v_rcp_f32 v36, v36
v_rcp_f32 v37, v37
v_rcp_f32 v38, v38
v_rcp_f32 v39, v39
v_mul_f32 v244, v244, v32
v_mul_f32 v245, v245, v33
v_mul_f32 v246, v246, v34
v_mul_f32 v247, v247, v35
v_mul_f32 v248, v248, v36
v_mul_f32 v249, v249, v37
v_mul_f32 v250, v250, v38
v_mul_f32 v251, v251, v39
v_mul_f32 v32, 0xbfb8aa3b, v56
v_mul_f32 v33, 0xbfb8aa3b, v57
v_mul_f32 v34, 0xbfb8aa3b, v58
v_mul_f32 v35, 0xbfb8aa3b, v59
v_mul_f32 v36, 0xbfb8aa3b, v60
v_mul_f32 v37, 0xbfb8aa3b, v61
v_mul_f32 v38, 0xbfb8aa3b, v62
v_mul_f32 v39, 0xbfb8aa3b, v63
v_exp_f32 v32, v32
v_exp_f32 v33, v33
v_exp_f32 v34, v34
v_exp_f32 v35, v35
v_exp_f32 v36, v36
v_exp_f32 v37, v37
v_exp_f32 v38, v38
v_exp_f32 v39, v39
v_add_f32 v32, 1.0, v32
v_add_f32 v33, 1.0, v33
v_add_f32 v34, 1.0, v34
v_add_f32 v35, 1.0, v35
v_add_f32 v36, 1.0, v36
v_add_f32 v37, 1.0, v37
v_add_f32 v38, 1.0, v38
v_add_f32 v39, 1.0, v39
v_rcp_f32 v32, v32
v_rcp_f32 v33, v33
v_rcp_f32 v34, v34
v_rcp_f32 v35, v35
v_rcp_f32 v36, v36
v_rcp_f32 v37, v37
v_rcp_f32 v38, v38
v_rcp_f32 v39, v39
v_mul_f32 v56, v56, v32
v_mul_f32 v57, v57, v33
v_mul_f32 v58, v58, v34
v_mul_f32 v59, v59, v35
v_mul_f32 v60, v60, v36
v_mul_f32 v61, v61, v37
v_mul_f32 v62, v62, v38
v_mul_f32 v63, v63, v39
v_accvgpr_read_b32 v32, a192
v_lshlrev_b32 v64, 16, v32
v_and_b32 v65, s47, v32
v_accvgpr_read_b32 v32, a193
v_lshlrev_b32 v66, 16, v32
v_and_b32 v67, s47, v32
v_accvgpr_read_b32 v32, a194
v_lshlrev_b32 v68, 16, v32
v_and_b32 v69, s47, v32
v_accvgpr_read_b32 v32, a195
v_lshlrev_b32 v70, 16, v32
v_and_b32 v71, s47, v32
v_accvgpr_read_b32 v32, a196
v_lshlrev_b32 v72, 16, v32
v_and_b32 v73, s47, v32
v_accvgpr_read_b32 v32, a197
v_lshlrev_b32 v74, 16, v32
v_and_b32 v75, s47, v32
v_accvgpr_read_b32 v32, a198
v_lshlrev_b32 v76, 16, v32
v_and_b32 v77, s47, v32
v_accvgpr_read_b32 v32, a199
v_lshlrev_b32 v78, 16, v32
v_and_b32 v79, s47, v32
v_accvgpr_read_b32 v32, a200
v_lshlrev_b32 v80, 16, v32
v_and_b32 v81, s47, v32
v_accvgpr_read_b32 v32, a201
v_lshlrev_b32 v82, 16, v32
v_and_b32 v83, s47, v32
v_accvgpr_read_b32 v32, a202
v_lshlrev_b32 v84, 16, v32
v_and_b32 v85, s47, v32
v_accvgpr_read_b32 v32, a203
v_lshlrev_b32 v86, 16, v32
v_and_b32 v87, s47, v32
s_waitcnt vmcnt(0)
v_cmp_le_u32 vcc, 3, v8
s_nop 1
s_andn2_b32 s7, 0xfff, vcc_lo
s_cbranch_scc1 L_spin_f2
L_back_f2:
s_add_u32 s63, s52, 24576
buffer_load_dwordx4 v[96:99], v12, s[20:23], s63 offen sc1
s_add_u32 s63, s52, 2383872
buffer_load_dwordx4 v[100:103], v12, s[20:23], s63 offen sc1
s_add_u32 s63, s52, 4743168
buffer_load_dwordx4 v[104:107], v12, s[20:23], s63 offen sc1
s_add_u32 s63, s52, 7102464
buffer_load_dwordx4 v[108:111], v12, s[20:23], s63 offen sc1
s_add_u32 s63, s52, 9461760
buffer_load_dwordx4 v[112:115], v12, s[20:23], s63 offen sc1
s_add_u32 s63, s52, 11821056
buffer_load_dwordx4 v[116:119], v12, s[20:23], s63 offen sc1
s_add_u32 s63, s52, 14180352
buffer_load_dwordx4 v[120:123], v12, s[20:23], s63 offen sc1
s_add_u32 s63, s52, 16539648
buffer_load_dwordx4 v[124:127], v12, s[20:23], s63 offen sc1
s_add_u32 s63, s52, 18898944
buffer_load_dwordx4 v[128:131], v12, s[20:23], s63 offen sc1
s_add_u32 s63, s52, 21258240
buffer_load_dwordx4 v[132:135], v12, s[20:23], s63 offen sc1
s_add_u32 s63, s52, 23617536
buffer_load_dwordx4 v[136:139], v12, s[20:23], s63 offen sc1
s_add_u32 s63, s52, 25976832
buffer_load_dwordx4 v[140:143], v12, s[20:23], s63 offen sc1
buffer_load_dword v8, v10, s[20:23], s4 offen sc1
s_waitcnt vmcnt(12)
v_lshlrev_b32 v48, 16, v96
v_and_b32 v49, s47, v96
v_lshlrev_b32 v50, 16, v97
v_and_b32 v51, s47, v97
v_lshlrev_b32 v52, 16, v98
v_and_b32 v53, s47, v98
v_lshlrev_b32 v54, 16, v99
v_and_b32 v55, s47, v99
s_waitcnt vmcnt(11)
v_dot2c_f32_bf16 v48, s44, v100
v_dot2c_f32_bf16 v49, s45, v100
v_dot2c_f32_bf16 v50, s44, v101
v_dot2c_f32_bf16 v51, s45, v101
v_dot2c_f32_bf16 v52, s44, v102
v_dot2c_f32_bf16 v53, s45, v102
v_dot2c_f32_bf16 v54, s44, v103
v_dot2c_f32_bf16 v55, s45, v103
s_waitcnt vmcnt(10)
v_dot2c_f32_bf16 v48, s44, v104
v_dot2c_f32_bf16 v49, s45, v104
v_dot2c_f32_bf16 v50, s44, v105
v_dot2c_f32_bf16 v51, s45, v105
v_dot2c_f32_bf16 v52, s44, v106
v_dot2c_f32_bf16 v53, s45, v106
v_dot2c_f32_bf16 v54, s44, v107
v_dot2c_f32_bf16 v55, s45, v107
s_waitcnt vmcnt(9)
v_dot2c_f32_bf16 v48, s44, v108
v_dot2c_f32_bf16 v49, s45, v108
v_dot2c_f32_bf16 v50, s44, v109
v_dot2c_f32_bf16 v51, s45, v109
v_dot2c_f32_bf16 v52, s44, v110
v_dot2c_f32_bf16 v53, s45, v110
v_dot2c_f32_bf16 v54, s44, v111
v_dot2c_f32_bf16 v55, s45, v111
s_waitcnt vmcnt(8)
v_dot2c_f32_bf16 v48, s44, v112
v_dot2c_f32_bf16 v49, s45, v112
v_dot2c_f32_bf16 v50, s44, v113
v_dot2c_f32_bf16 v51, s45, v113
v_dot2c_f32_bf16 v52, s44, v114
v_dot2c_f32_bf16 v53, s45, v114
v_dot2c_f32_bf16 v54, s44, v115
v_dot2c_f32_bf16 v55, s45, v115
s_waitcnt vmcnt(7)
v_dot2c_f32_bf16 v48, s44, v116
v_dot2c_f32_bf16 v49, s45, v116
v_dot2c_f32_bf16 v50, s44, v117
v_dot2c_f32_bf16 v51, s45, v117
v_dot2c_f32_bf16 v52, s44, v118
v_dot2c_f32_bf16 v53, s45, v118
v_dot2c_f32_bf16 v54, s44, v119
v_dot2c_f32_bf16 v55, s45, v119
s_waitcnt vmcnt(6)
v_dot2c_f32_bf16 v48, s44, v120
v_dot2c_f32_bf16 v49, s45, v120
v_dot2c_f32_bf16 v50, s44, v121
v_dot2c_f32_bf16 v51, s45, v121
v_dot2c_f32_bf16 v52, s44, v122
v_dot2c_f32_bf16 v53, s45, v122
v_dot2c_f32_bf16 v54, s44, v123
v_dot2c_f32_bf16 v55, s45, v123
s_waitcnt vmcnt(5)
v_dot2c_f32_bf16 v48, s44, v124
v_dot2c_f32_bf16 v49, s45, v124
v_dot2c_f32_bf16 v50, s44, v125
v_dot2c_f32_bf16 v51, s45, v125
v_dot2c_f32_bf16 v52, s44, v126
v_dot2c_f32_bf16 v53, s45, v126
v_dot2c_f32_bf16 v54, s44, v127
v_dot2c_f32_bf16 v55, s45, v127
s_waitcnt vmcnt(4)
v_dot2c_f32_bf16 v48, s44, v128
v_dot2c_f32_bf16 v49, s45, v128
v_dot2c_f32_bf16 v50, s44, v129
v_dot2c_f32_bf16 v51, s45, v129
v_dot2c_f32_bf16 v52, s44, v130
v_dot2c_f32_bf16 v53, s45, v130
v_dot2c_f32_bf16 v54, s44, v131
v_dot2c_f32_bf16 v55, s45, v131
s_waitcnt vmcnt(3)
v_dot2c_f32_bf16 v48, s44, v132
v_dot2c_f32_bf16 v49, s45, v132
v_dot2c_f32_bf16 v50, s44, v133
v_dot2c_f32_bf16 v51, s45, v133
v_dot2c_f32_bf16 v52, s44, v134
v_dot2c_f32_bf16 v53, s45, v134
v_dot2c_f32_bf16 v54, s44, v135
v_dot2c_f32_bf16 v55, s45, v135
s_waitcnt vmcnt(2)
v_dot2c_f32_bf16 v48, s44, v136
v_dot2c_f32_bf16 v49, s45, v136
v_dot2c_f32_bf16 v50, s44, v137
v_dot2c_f32_bf16 v51, s45, v137
v_dot2c_f32_bf16 v52, s44, v138
v_dot2c_f32_bf16 v53, s45, v138
v_dot2c_f32_bf16 v54, s44, v139
v_dot2c_f32_bf16 v55, s45, v139
s_waitcnt vmcnt(1)
v_dot2c_f32_bf16 v48, s44, v140
v_dot2c_f32_bf16 v49, s45, v140
v_dot2c_f32_bf16 v50, s44, v141
v_dot2c_f32_bf16 v51, s45, v141
v_dot2c_f32_bf16 v52, s44, v142
v_dot2c_f32_bf16 v53, s45, v142
v_dot2c_f32_bf16 v54, s44, v143
v_dot2c_f32_bf16 v55, s45, v143
v_mul_f32 v32, 0xbfb8aa3b, v48
v_mul_f32 v33, 0xbfb8aa3b, v49
v_mul_f32 v34, 0xbfb8aa3b, v50
v_mul_f32 v35, 0xbfb8aa3b, v51
v_mul_f32 v36, 0xbfb8aa3b, v52
v_mul_f32 v37, 0xbfb8aa3b, v53
v_mul_f32 v38, 0xbfb8aa3b, v54
v_mul_f32 v39, 0xbfb8aa3b, v55
v_exp_f32 v32, v32
v_exp_f32 v33, v33
v_exp_f32 v34, v34
v_exp_f32 v35, v35
v_exp_f32 v36, v36
v_exp_f32 v37, v37
v_exp_f32 v38, v38
v_exp_f32 v39, v39
v_add_f32 v32, 1.0, v32
v_add_f32 v33, 1.0, v33
v_add_f32 v34, 1.0, v34
v_add_f32 v35, 1.0, v35
v_add_f32 v36, 1.0, v36
v_add_f32 v37, 1.0, v37
v_add_f32 v38, 1.0, v38
v_add_f32 v39, 1.0, v39
v_rcp_f32 v32, v32
v_rcp_f32 v33, v33
v_rcp_f32 v34, v34
v_rcp_f32 v35, v35
v_rcp_f32 v36, v36
v_rcp_f32 v37, v37
v_rcp_f32 v38, v38
v_rcp_f32 v39, v39
v_mul_f32 v48, v48, v32
v_mul_f32 v49, v49, v33
v_mul_f32 v50, v50, v34
v_mul_f32 v51, v51, v35
v_mul_f32 v52, v52, v36
v_mul_f32 v53, v53, v37
v_mul_f32 v54, v54, v38
v_mul_f32 v55, v55, v39
s_waitcnt vmcnt(0)
v_cmp_le_u32 vcc, 3, v8
s_nop 1
s_andn2_b32 s7, 0xf000, vcc_lo
s_cbranch_scc1 L_spin_f3
L_back_f3:
s_add_u32 s63, s52, 28311552
buffer_load_dwordx4 v[144:147], v12, s[20:23], s63 offen sc1
s_add_u32 s63, s52, 30670848
buffer_load_dwordx4 v[148:151], v12, s[20:23], s63 offen sc1
s_add_u32 s63, s52, 33030144
buffer_load_dwordx4 v[152:155], v12, s[20:23], s63 offen sc1
s_add_u32 s63, s52, 35389440
buffer_load_dwordx4 v[156:159], v12, s[20:23], s63 offen sc1
s_add_u32 s63, s52, 28323840
buffer_load_dwordx4 v[160:163], v12, s[20:23], s63 offen sc1
s_add_u32 s63, s52, 30683136
buffer_load_dwordx4 v[164:167], v12, s[20:23], s63 offen sc1
s_add_u32 s63, s52, 33042432
buffer_load_dwordx4 v[168:171], v12, s[20:23], s63 offen sc1
s_add_u32 s63, s52, 35401728
buffer_load_dwordx4 v[172:175], v12, s[20:23], s63 offen sc1
s_add_u32 s63, s52, 28336128
buffer_load_dwordx4 v[176:179], v12, s[20:23], s63 offen sc1
s_add_u32 s63, s52, 30695424
buffer_load_dwordx4 v[180:183], v12, s[20:23], s63 offen sc1
s_add_u32 s63, s52, 33054720
buffer_load_dwordx4 v[184:187], v12, s[20:23], s63 offen sc1
s_add_u32 s63, s52, 35414016
buffer_load_dwordx4 v[188:191], v12, s[20:23], s63 offen sc1
s_waitcnt vmcnt(11)
v_lshlrev_b32 v208, 16, v144
v_and_b32 v209, s47, v144
v_lshlrev_b32 v210, 16, v145
v_and_b32 v211, s47, v145
v_lshlrev_b32 v212, 16, v146
v_and_b32 v213, s47, v146
v_lshlrev_b32 v214, 16, v147
v_and_b32 v215, s47, v147
s_waitcnt vmcnt(10)
v_dot2c_f32_bf16 v208, s44, v148
v_dot2c_f32_bf16 v209, s45, v148
v_dot2c_f32_bf16 v210, s44, v149
v_dot2c_f32_bf16 v211, s45, v149
v_dot2c_f32_bf16 v212, s44, v150
v_dot2c_f32_bf16 v213, s45, v150
v_dot2c_f32_bf16 v214, s44, v151
v_dot2c_f32_bf16 v215, s45, v151
s_waitcnt vmcnt(9)
v_dot2c_f32_bf16 v208, s44, v152
v_dot2c_f32_bf16 v209, s45, v152
v_dot2c_f32_bf16 v210, s44, v153
v_dot2c_f32_bf16 v211, s45, v153
v_dot2c_f32_bf16 v212, s44, v154
v_dot2c_f32_bf16 v213, s45, v154
v_dot2c_f32_bf16 v214, s44, v155
v_dot2c_f32_bf16 v215, s45, v155
s_waitcnt vmcnt(8)
v_dot2c_f32_bf16 v208, s44, v156
v_dot2c_f32_bf16 v209, s45, v156
v_dot2c_f32_bf16 v210, s44, v157
v_dot2c_f32_bf16 v211, s45, v157
v_dot2c_f32_bf16 v212, s44, v158
v_dot2c_f32_bf16 v213, s45, v158
v_dot2c_f32_bf16 v214, s44, v159
v_dot2c_f32_bf16 v215, s45, v159
v_fmac_f32 v64, v208, v244
v_fmac_f32 v65, v209, v245
v_fmac_f32 v66, v210, v246
v_fmac_f32 v67, v211, v247
v_fmac_f32 v68, v212, v248
v_fmac_f32 v69, v213, v249
v_fmac_f32 v70, v214, v250
v_fmac_f32 v71, v215, v251
v_cvt_pk_bf16_f32 v192, v64, v65
v_cvt_pk_bf16_f32 v193, v66, v67
v_cvt_pk_bf16_f32 v194, v68, v69
v_cvt_pk_bf16_f32 v195, v70, v71
buffer_store_dwordx4 v[192:195], v11, s[24:27], s53 offen offset:0 sc1
s_waitcnt vmcnt(8)
v_lshlrev_b32 v216, 16, v160
v_and_b32 v217, s47, v160
v_lshlrev_b32 v218, 16, v161
v_and_b32 v219, s47, v161
v_lshlrev_b32 v220, 16, v162
v_and_b32 v221, s47, v162
v_lshlrev_b32 v222, 16, v163
v_and_b32 v223, s47, v163
s_waitcnt vmcnt(7)
v_dot2c_f32_bf16 v216, s44, v164
v_dot2c_f32_bf16 v217, s45, v164
v_dot2c_f32_bf16 v218, s44, v165
v_dot2c_f32_bf16 v219, s45, v165
v_dot2c_f32_bf16 v220, s44, v166
v_dot2c_f32_bf16 v221, s45, v166
v_dot2c_f32_bf16 v222, s44, v167
v_dot2c_f32_bf16 v223, s45, v167
s_waitcnt vmcnt(6)
v_dot2c_f32_bf16 v216, s44, v168
v_dot2c_f32_bf16 v217, s45, v168
v_dot2c_f32_bf16 v218, s44, v169
v_dot2c_f32_bf16 v219, s45, v169
v_dot2c_f32_bf16 v220, s44, v170
v_dot2c_f32_bf16 v221, s45, v170
v_dot2c_f32_bf16 v222, s44, v171
v_dot2c_f32_bf16 v223, s45, v171
s_waitcnt vmcnt(5)
v_dot2c_f32_bf16 v216, s44, v172
v_dot2c_f32_bf16 v217, s45, v172
v_dot2c_f32_bf16 v218, s44, v173
v_dot2c_f32_bf16 v219, s45, v173
v_dot2c_f32_bf16 v220, s44, v174
v_dot2c_f32_bf16 v221, s45, v174
v_dot2c_f32_bf16 v222, s44, v175
v_dot2c_f32_bf16 v223, s45, v175
v_fmac_f32 v72, v216, v56
v_fmac_f32 v73, v217, v57
v_fmac_f32 v74, v218, v58
v_fmac_f32 v75, v219, v59
v_fmac_f32 v76, v220, v60
v_fmac_f32 v77, v221, v61
v_fmac_f32 v78, v222, v62
v_fmac_f32 v79, v223, v63
v_cvt_pk_bf16_f32 v196, v72, v73
v_cvt_pk_bf16_f32 v197, v74, v75
v_cvt_pk_bf16_f32 v198, v76, v77
v_cvt_pk_bf16_f32 v199, v78, v79
buffer_store_dwordx4 v[196:199], v11, s[24:27], s53 offen offset:384 sc1
s_waitcnt vmcnt(5)
v_lshlrev_b32 v224, 16, v176
v_and_b32 v225, s47, v176
v_lshlrev_b32 v226, 16, v177
v_and_b32 v227, s47, v177
v_lshlrev_b32 v228, 16, v178
v_and_b32 v229, s47, v178
v_lshlrev_b32 v230, 16, v179
v_and_b32 v231, s47, v179
s_waitcnt vmcnt(4)
v_dot2c_f32_bf16 v224, s44, v180
v_dot2c_f32_bf16 v225, s45, v180
v_dot2c_f32_bf16 v226, s44, v181
v_dot2c_f32_bf16 v227, s45, v181
v_dot2c_f32_bf16 v228, s44, v182
v_dot2c_f32_bf16 v229, s45, v182
v_dot2c_f32_bf16 v230, s44, v183
v_dot2c_f32_bf16 v231, s45, v183
s_waitcnt vmcnt(3)
v_dot2c_f32_bf16 v224, s44, v184
v_dot2c_f32_bf16 v225, s45, v184
v_dot2c_f32_bf16 v226, s44, v185
v_dot2c_f32_bf16 v227, s45, v185
v_dot2c_f32_bf16 v228, s44, v186
v_dot2c_f32_bf16 v229, s45, v186
v_dot2c_f32_bf16 v230, s44, v187
v_dot2c_f32_bf16 v231, s45, v187
s_waitcnt vmcnt(2)
v_dot2c_f32_bf16 v224, s44, v188
v_dot2c_f32_bf16 v225, s45, v188
v_dot2c_f32_bf16 v226, s44, v189
v_dot2c_f32_bf16 v227, s45, v189
v_dot2c_f32_bf16 v228, s44, v190
v_dot2c_f32_bf16 v229, s45, v190
v_dot2c_f32_bf16 v230, s44, v191
v_dot2c_f32_bf16 v231, s45, v191
v_fmac_f32 v80, v224, v48
v_fmac_f32 v81, v225, v49
v_fmac_f32 v82, v226, v50
v_fmac_f32 v83, v227, v51
v_fmac_f32 v84, v228, v52
v_fmac_f32 v85, v229, v53
v_fmac_f32 v86, v230, v54
v_fmac_f32 v87, v231, v55
v_cvt_pk_bf16_f32 v200, v80, v81
v_cvt_pk_bf16_f32 v201, v82, v83
v_cvt_pk_bf16_f32 v202, v84, v85
v_cvt_pk_bf16_f32 v203, v86, v87
buffer_store_dwordx4 v[200:203], v11, s[24:27], s53 offen offset:768 sc1
s_branch L_end
L_attn:
s_mov_b32 s34, s3
s_lshl_b32 s5, s34, 2
s_add_u32 s59, s5, 64
s_add_u32 s5, s5, s4
s_add_u32 s5, s5, 48
s_lshl_b32 s54, s34, 7
s_add_u32 s54, s54, 47187968
s_lshl_b32 s58, s33, 2
s_add_u32 s55, s58, s54
s_cmp_eq_u32 s33, 0
s_cselect_b32 s100, s54, 0x7f000000
s_cselect_b32 s101, s59, 0x7f000000
s_waitcnt lgkmcnt(0)
s_mov_b32 s8, s64
s_and_b32 s9, s65, 0xffff
s_mov_b32 s10, 2359296
s_mov_b32 s11, 0x20000
s_add_u32 m0, s35, 16128
s_nop 0
buffer_load_dwordx4 v7, s[8:11], s36 offen offset:256 lds
s_add_u32 m0, s35, 17152
s_nop 0
buffer_load_dwordx4 v8, s[8:11], s36 offen offset:256 lds
s_add_u32 m0, s35, 18176
s_nop 0
buffer_load_dwordx4 v7, s[8:11], s37 offen offset:256 lds
s_add_u32 m0, s35, 19200
s_nop 0
buffer_load_dwordx4 v8, s[8:11], s37 offen offset:256 lds
s_add_u32 m0, s35, 19840
s_nop 0
buffer_load_dwordx4 v7, s[8:11], s36 offen offset:640 lds
s_add_u32 m0, s35, 20864
s_nop 0
buffer_load_dwordx4 v8, s[8:11], s36 offen offset:640 lds
s_add_u32 m0, s35, 21888
s_nop 0
buffer_load_dwordx4 v7, s[8:11], s37 offen offset:640 lds
s_add_u32 m0, s35, 22912
s_nop 0
buffer_load_dwordx4 v8, s[8:11], s37 offen offset:640 lds
s_add_u32 m0, s35, 23552
s_nop 0
buffer_load_dwordx4 v7, s[8:11], s36 offen offset:1024 lds
s_add_u32 m0, s35, 24576
s_nop 0
buffer_load_dwordx4 v8, s[8:11], s36 offen offset:1024 lds
s_add_u32 m0, s35, 25600
s_nop 0
buffer_load_dwordx4 v7, s[8:11], s37 offen offset:1024 lds
s_add_u32 m0, s35, 26624
s_nop 0
buffer_load_dwordx4 v8, s[8:11], s37 offen offset:1024 lds
s_mov_b32 s20, s84
s_and_b32 s21, s85, 0xffff
s_mov_b32 s22, 50331648
s_mov_b32 s23, 0x20000
s_mov_b32 s28, s82
s_and_b32 s29, s83, 0xffff
s_mov_b32 s30, 256
s_mov_b32 s31, 0x20000
s_mov_b32 s44, 0x00003f80
s_mov_b32 s45, 0x3f800000
s_mov_b32 s46, 0x3f803f80
s_mov_b32 s47, 0xffff0000
s_mov_b32 s48, 0x3fb8aa3b
s_mov_b32 s49, 0xbfb17218
v_mov_b32 v3, 0x7f000000
v_lshlrev_b32 v13, 2, v0
v_cmp_gt_u32 vcc, 16, v0
v_mov_b32 v14, 0
s_nop 0
v_cndmask_b32 v13, v3, v13, vcc
buffer_store_dword v14, v13, s[20:23], s100 offen sc1
v_mov_b32 v3, 0x7f000000
v_cmp_eq_u32 vcc, 0, v0
s_nop 1
v_cndmask_b32 v13, v3, v0, vcc
v_and_b32 v3, 31, v1
v_lshrrev_b32 v4, 3, v3
v_lshlrev_b32 v4, 10, v4
v_and_b32 v5, 7, v3
v_lshl_add_u32 v4, v5, 7, v4
v_add_u32 v4, s35, v4
v_bfe_u32 v5, v3, 1, 3
v_xor_b32 v5, v5, v2
v_xor_b32 v6, 0, v5
v_lshl_add_u32 v9, v6, 4, v4
v_xor_b32 v6, 2, v5
v_lshl_add_u32 v10, v6, 4, v4
v_xor_b32 v6, 4, v5
v_lshl_add_u32 v11, v6, 4, v4
v_xor_b32 v6, 6, v5
v_lshl_add_u32 v12, v6, 4, v4
v_lshlrev_b32 v19, 4, v1
s_sub_u32 s66, s66, 3072
s_subb_u32 s67, s67, 0
s_mov_b32 s12, s66
s_and_b32 s13, s67, 0xffff
s_mov_b32 s14, 1993728
s_mov_b32 s15, 0x20000
s_mov_b32 s16, s70
s_and_b32 s17, s71, 0xffff
s_mov_b32 s18, 663552
s_mov_b32 s19, 0x20000
s_mov_b32 s24, s68
s_and_b32 s25, s69, 0xffff
s_mov_b32 s26, 20736
s_mov_b32 s27, 0x20000
s_mul_i32 s50, s34, 288
s_mul_i32 s38, s32, 55296
s_add_u32 s38, s38, s50
s_mul_i32 s51, s34, 165888
s_lshl_b32 s39, s32, 6
s_add_u32 s39, s39, s51
s_add_u32 s40, s34, 12
s_mul_i32 s40, s40, 2359296
s_add_u32 s40, s40, s43
s_lshl_b32 s62, s32, 12
s_add_u32 s62, s62, 147456
s_lshl_b32 s72, s34, 4
s_add_u32 s72, s72, s33
s_mul_i32 s72, s72, 23040
s_mul_i32 s73, s32, 5760
s_add_u32 s72, s72, s73
s_add_u32 s72, s72, 41943040
s_add_u32 s73, s72, 2880
s_mul_i32 s52, s34, 368640
s_mul_i32 s53, s33, 1440
s_add_u32 s52, s52, s53
s_add_u32 s52, s52, 41943040
s_mul_i32 s53, s34, 11520
s_add_u32 s53, s53, 46137344
s_mul_i32 s74, s33, 720
s_add_u32 s74, s74, s53
s_mul_i32 s75, s32, 2880
s_add_u32 s75, s75, s53
s_mul_i32 s76, s32, 23
v_lshrrev_b32 v4, 2, v1
v_and_b32 v5, 3, v1
v_lshlrev_b32 v5, 4, v5
v_mul_u32_u24 v20, 3456, v4
v_add_u32 v20, v20, v5
v_add_u32 v20, 3072, v20
v_subrev_u32 v21, 960, v20
v_subrev_u32 v22, 1920, v20
v_subrev_u32 v23, 2880, v20
v_bfe_u32 v6, v1, 1, 1
v_mul_u32_u24 v6, 864, v6
v_add_u32 v24, v20, v6
v_bfe_u32 v26, v1, 2, 2
v_lshlrev_b32 v26, 6, v26
v_bfe_u32 v6, v1, 4, 1
v_lshl_add_u32 v26, v6, 5, v26
v_and_b32 v6, 3, v1
v_lshl_add_u32 v26, v6, 3, v26
v_mul_u32_u24 v6, 512, v2
v_add_u32 v26, v26, v6
v_add_u32 v27, 36864, v26
v_add_u32 v28, 73728, v26
v_add_u32 v29, 110592, v26
v_mov_b32 v15, 0
v_mov_b32 v16, 0
v_mov_b32 v17, 0
v_mov_b32 v18, 0
s_mul_i32 s6, s32, 3
s_add_u32 s6, s6, 2
s_cmp_eq_u32 s32, 3
s_cselect_b32 s6, 0, s6
s_lshl_b32 s6, s6, 3
s_and_b32 s7, s33, 7
s_add_u32 s6, s6, s7
s_mul_i32 s6, s6, 27648
s_and_b32 s7, s50, 0xffffff80
s_add_u32 s6, s6, s7
s_add_u32 s6, s6, 4224
v_lshrrev_b32 v3, 2, v1
v_mul_u32_u24 v3, 3456, v3
v_and_b32 v4, 3, v1
v_lshl_add_u32 v3, v4, 7, v3
v_mov_b32 v4, 0x7f000000
v_cmp_gt_u32 vcc, 32, v1
s_nop 1
v_cndmask_b32 v3, v4, v3, vcc
buffer_load_dword a254, v3, s[12:15], s6 offen
s_add_u32 m0, s35, 28672
s_nop 0
buffer_load_dwordx4 v7, s[8:11], s36 offen offset:0 lds
s_add_u32 m0, s35, 29696
s_nop 0
buffer_load_dwordx4 v8, s[8:11], s36 offen offset:0 lds
s_add_u32 m0, s35, 30720
s_nop 0
buffer_load_dwordx4 v7, s[8:11], s37 offen offset:0 lds
s_add_u32 m0, s35, 31744
s_nop 0
buffer_load_dwordx4 v8, s[8:11], s37 offen offset:0 lds
s_mov_b64 exec, 0
s_cmp_eq_u32 s32, 0
s_cbranch_scc1 L_pad_a0_0
s_cmp_eq_u32 s32, 1
s_cbranch_scc1 L_pad_a1_0
s_cmp_eq_u32 s32, 2
s_cbranch_scc1 L_pad_a2_0
s_branch L_pad_a3_0
L_warm_a:
s_mov_b64 exec, -1
s_waitcnt vmcnt(14)
s_add_u32 m0, s35, 32384
s_nop 0
buffer_load_dwordx4 v7, s[8:11], s36 offen offset:384 lds
s_add_u32 m0, s35, 33408
s_nop 0
buffer_load_dwordx4 v8, s[8:11], s36 offen offset:384 lds
s_add_u32 m0, s35, 34432
s_nop 0
buffer_load_dwordx4 v7, s[8:11], s37 offen offset:384 lds
s_add_u32 m0, s35, 35456
s_nop 0
buffer_load_dwordx4 v8, s[8:11], s37 offen offset:384 lds
ds_read_b128 v[64:67], v9 offset:16384
ds_read_b128 v[68:71], v10 offset:16384
ds_read_b128 v[72:75], v11 offset:16384
ds_read_b128 v[76:79], v12 offset:16384
s_waitcnt vmcnt(14)
s_waitcnt lgkmcnt(0)
s_add_u32 m0, s35, 15616
s_nop 0
buffer_load_dwordx4 v7, s[8:11], s36 offen offset:768 lds
s_add_u32 m0, s35, 16640
s_nop 0
buffer_load_dwordx4 v8, s[8:11], s36 offen offset:768 lds
s_add_u32 m0, s35, 17664
s_nop 0
buffer_load_dwordx4 v7, s[8:11], s37 offen offset:768 lds
s_add_u32 m0, s35, 18688
s_nop 0
buffer_load_dwordx4 v8, s[8:11], s37 offen offset:768 lds
ds_read_b128 v[80:83], v9 offset:20480
ds_read_b128 v[84:87], v10 offset:20480
ds_read_b128 v[88:91], v11 offset:20480
L_pad_a0_0:
s_cbranch_execz L_pad_a0_1
ds_read_b128 v[92:95], v12 offset:20480
v_dot2c_f32_bf16 v15, s46, v64
v_dot2c_f32_bf16 v17, v64, v64
v_dot2c_f32_bf16 v16, s46, v65
v_dot2c_f32_bf16 v18, v65, v65
v_dot2c_f32_bf16 v15, s46, v66
v_dot2c_f32_bf16 v17, v66, v66
v_dot2c_f32_bf16 v16, s46, v67
v_dot2c_f32_bf16 v18, v67, v67
v_dot2c_f32_bf16 v15, s46, v68
v_dot2c_f32_bf16 v17, v68, v68
v_dot2c_f32_bf16 v16, s46, v69
v_dot2c_f32_bf16 v18, v69, v69
v_dot2c_f32_bf16 v15, s46, v70
v_dot2c_f32_bf16 v17, v70, v70
v_dot2c_f32_bf16 v16, s46, v71
v_dot2c_f32_bf16 v18, v71, v71
v_dot2c_f32_bf16 v15, s46, v72
v_dot2c_f32_bf16 v17, v72, v72
v_dot2c_f32_bf16 v16, s46, v73
v_dot2c_f32_bf16 v18, v73, v73
v_dot2c_f32_bf16 v15, s46, v74
v_dot2c_f32_bf16 v17, v74, v74
v_dot2c_f32_bf16 v16, s46, v75
v_dot2c_f32_bf16 v18, v75, v75
v_dot2c_f32_bf16 v15, s46, v76
v_dot2c_f32_bf16 v17, v76, v76
v_dot2c_f32_bf16 v16, s46, v77
v_dot2c_f32_bf16 v18, v77, v77
v_dot2c_f32_bf16 v15, s46, v78
v_dot2c_f32_bf16 v17, v78, v78
v_dot2c_f32_bf16 v16, s46, v79
v_dot2c_f32_bf16 v18, v79, v79
s_waitcnt vmcnt(14)
s_waitcnt lgkmcnt(0)
s_add_u32 m0, s35, 20352
s_nop 0
buffer_load_dwordx4 v7, s[8:11], s36 offen offset:128 lds
s_add_u32 m0, s35, 21376
s_nop 0
buffer_load_dwordx4 v8, s[8:11], s36 offen offset:128 lds
s_add_u32 m0, s35, 22400
s_nop 0
buffer_load_dwordx4 v7, s[8:11], s37 offen offset:128 lds
s_add_u32 m0, s35, 23424
s_nop 0
buffer_load_dwordx4 v8, s[8:11], s37 offen offset:128 lds
ds_read_b128 v[96:99], v9 offset:24576
ds_read_b128 v[100:103], v10 offset:24576
ds_read_b128 v[104:107], v11 offset:24576
ds_read_b128 v[108:111], v12 offset:24576
v_dot2c_f32_bf16 v15, s46, v80
v_dot2c_f32_bf16 v17, v80, v80
v_dot2c_f32_bf16 v16, s46, v81
v_dot2c_f32_bf16 v18, v81, v81
v_dot2c_f32_bf16 v15, s46, v82
v_dot2c_f32_bf16 v17, v82, v82
v_dot2c_f32_bf16 v16, s46, v83
v_dot2c_f32_bf16 v18, v83, v83
v_dot2c_f32_bf16 v15, s46, v84
v_dot2c_f32_bf16 v17, v84, v84
v_dot2c_f32_bf16 v16, s46, v85
v_dot2c_f32_bf16 v18, v85, v85
v_dot2c_f32_bf16 v15, s46, v86
v_dot2c_f32_bf16 v17, v86, v86
v_dot2c_f32_bf16 v16, s46, v87
v_dot2c_f32_bf16 v18, v87, v87
v_dot2c_f32_bf16 v15, s46, v88
v_dot2c_f32_bf16 v17, v88, v88
v_dot2c_f32_bf16 v16, s46, v89
v_dot2c_f32_bf16 v18, v89, v89
v_dot2c_f32_bf16 v15, s46, v90
v_dot2c_f32_bf16 v17, v90, v90
v_dot2c_f32_bf16 v16, s46, v91
v_dot2c_f32_bf16 v18, v91, v91
v_dot2c_f32_bf16 v15, s46, v92
v_dot2c_f32_bf16 v17, v92, v92
v_dot2c_f32_bf16 v16, s46, v93
v_dot2c_f32_bf16 v18, v93, v93
v_dot2c_f32_bf16 v15, s46, v94
v_dot2c_f32_bf16 v17, v94, v94
v_dot2c_f32_bf16 v16, s46, v95
v_dot2c_f32_bf16 v18, v95, v95
s_waitcnt vmcnt(12)
s_waitcnt lgkmcnt(0)
s_add_u32 m0, s35, 24064
s_nop 0
buffer_load_dwordx4 v7, s[8:11], s36 offen offset:512 lds
s_add_u32 m0, s35, 25088
s_nop 0
buffer_load_dwordx4 v8, s[8:11], s36 offen offset:512 lds
s_add_u32 m0, s35, 26112
s_nop 0
buffer_load_dwordx4 v7, s[8:11], s37 offen offset:512 lds
s_add_u32 m0, s35, 27136
s_nop 0
buffer_load_dwordx4 v8, s[8:11], s37 offen offset:512 lds
ds_read_b128 v[112:115], v9 offset:28672
ds_read_b128 v[116:119], v10 offset:28672
ds_read_b128 v[120:123], v11 offset:28672
ds_read_b128 v[124:127], v12 offset:28672
v_dot2c_f32_bf16 v15, s46, v96
v_dot2c_f32_bf16 v17, v96, v96
v_dot2c_f32_bf16 v16, s46, v97
v_dot2c_f32_bf16 v18, v97, v97
v_dot2c_f32_bf16 v15, s46, v98
v_dot2c_f32_bf16 v17, v98, v98
v_dot2c_f32_bf16 v16, s46, v99
v_dot2c_f32_bf16 v18, v99, v99
v_dot2c_f32_bf16 v15, s46, v100
v_dot2c_f32_bf16 v17, v100, v100
v_dot2c_f32_bf16 v16, s46, v101
v_dot2c_f32_bf16 v18, v101, v101
v_dot2c_f32_bf16 v15, s46, v102
v_dot2c_f32_bf16 v17, v102, v102
v_dot2c_f32_bf16 v16, s46, v103
v_dot2c_f32_bf16 v18, v103, v103
v_dot2c_f32_bf16 v15, s46, v104
v_dot2c_f32_bf16 v17, v104, v104
v_dot2c_f32_bf16 v16, s46, v105
v_dot2c_f32_bf16 v18, v105, v105
v_dot2c_f32_bf16 v15, s46, v106
v_dot2c_f32_bf16 v17, v106, v106
v_dot2c_f32_bf16 v16, s46, v107
v_dot2c_f32_bf16 v18, v107, v107
v_dot2c_f32_bf16 v15, s46, v108
v_dot2c_f32_bf16 v17, v108, v108
v_dot2c_f32_bf16 v16, s46, v109
v_dot2c_f32_bf16 v18, v109, v109
v_dot2c_f32_bf16 v15, s46, v110
v_dot2c_f32_bf16 v17, v110, v110
v_dot2c_f32_bf16 v16, s46, v111
v_dot2c_f32_bf16 v18, v111, v111
s_waitcnt vmcnt(12)
s_waitcnt lgkmcnt(0)
s_add_u32 m0, s35, 27776
s_nop 0
buffer_load_dwordx4 v7, s[8:11], s36 offen offset:896 lds
s_add_u32 m0, s35, 28800
s_nop 0
buffer_load_dwordx4 v8, s[8:11], s36 offen offset:896 lds
s_add_u32 m0, s35, 29824
s_nop 0
buffer_load_dwordx4 v7, s[8:11], s37 offen offset:896 lds
s_add_u32 m0, s35, 30848
s_nop 0
buffer_load_dwordx4 v8, s[8:11], s37 offen offset:896 lds
ds_read_b128 v[128:131], v9 offset:32768
ds_read_b128 v[132:135], v10 offset:32768
ds_read_b128 v[136:139], v11 offset:32768
ds_read_b128 v[140:143], v12 offset:32768
s_add_u32 m0, s35, 0
s_add_u32 s41, s38, 443520
buffer_load_dwordx4 v20, s[12:15], s41 offen offset:0 lds
buffer_load_dwordx4 v21, s[12:15], s41 offen offset:1024 lds
buffer_load_dwordx4 v22, s[12:15], s41 offen offset:2048 lds
buffer_load_dwordx4 v23, s[12:15], s41 offen offset:3072 lds
s_add_u32 m0, s35, 3840
s_nop 0
buffer_load_dwordx4 v24, s[12:15], s41 offen offset:256 lds
v_dot2c_f32_bf16 v15, s46, v112
v_dot2c_f32_bf16 v17, v112, v112
v_dot2c_f32_bf16 v16, s46, v113
v_dot2c_f32_bf16 v18, v113, v113
v_dot2c_f32_bf16 v15, s46, v114
v_dot2c_f32_bf16 v17, v114, v114
v_dot2c_f32_bf16 v16, s46, v115
v_dot2c_f32_bf16 v18, v115, v115
v_dot2c_f32_bf16 v15, s46, v116
v_dot2c_f32_bf16 v17, v116, v116
v_dot2c_f32_bf16 v16, s46, v117
v_dot2c_f32_bf16 v18, v117, v117
v_dot2c_f32_bf16 v15, s46, v118
v_dot2c_f32_bf16 v17, v118, v118
v_dot2c_f32_bf16 v16, s46, v119
v_dot2c_f32_bf16 v18, v119, v119
v_dot2c_f32_bf16 v15, s46, v120
v_dot2c_f32_bf16 v17, v120, v120
v_dot2c_f32_bf16 v16, s46, v121
v_dot2c_f32_bf16 v18, v121, v121
v_dot2c_f32_bf16 v15, s46, v122
v_dot2c_f32_bf16 v17, v122, v122
v_dot2c_f32_bf16 v16, s46, v123
v_dot2c_f32_bf16 v18, v123, v123
v_dot2c_f32_bf16 v15, s46, v124
v_dot2c_f32_bf16 v17, v124, v124
v_dot2c_f32_bf16 v16, s46, v125
v_dot2c_f32_bf16 v18, v125, v125
v_dot2c_f32_bf16 v15, s46, v126
v_dot2c_f32_bf16 v17, v126, v126
v_dot2c_f32_bf16 v16, s46, v127
v_dot2c_f32_bf16 v18, v127, v127
s_waitcnt vmcnt(17)
ds_read_b128 v[144:147], v9 offset:16384
ds_read_b128 v[148:151], v10 offset:16384
ds_read_b128 v[152:155], v11 offset:16384
ds_read_b128 v[156:159], v12 offset:16384
s_add_u32 m0, s35, 5120
s_add_u32 s41, s38, 1107072
buffer_load_dwordx4 v20, s[12:15], s41 offen offset:0 lds
buffer_load_dwordx4 v21, s[12:15], s41 offen offset:1024 lds
buffer_load_dwordx4 v22, s[12:15], s41 offen offset:2048 lds
buffer_load_dwordx4 v23, s[12:15], s41 offen offset:3072 lds
s_add_u32 m0, s35, 8960
s_nop 0
buffer_load_dwordx4 v24, s[12:15], s41 offen offset:256 lds
s_waitcnt lgkmcnt(7)
v_dot2c_f32_bf16 v15, s46, v128
v_dot2c_f32_bf16 v17, v128, v128
v_dot2c_f32_bf16 v16, s46, v129
v_dot2c_f32_bf16 v18, v129, v129
v_dot2c_f32_bf16 v15, s46, v130
v_dot2c_f32_bf16 v17, v130, v130
v_dot2c_f32_bf16 v16, s46, v131
v_dot2c_f32_bf16 v18, v131, v131
s_waitcnt lgkmcnt(6)
v_dot2c_f32_bf16 v15, s46, v132
v_dot2c_f32_bf16 v17, v132, v132
v_dot2c_f32_bf16 v16, s46, v133
v_dot2c_f32_bf16 v18, v133, v133
v_dot2c_f32_bf16 v15, s46, v134
v_dot2c_f32_bf16 v17, v134, v134
v_dot2c_f32_bf16 v16, s46, v135
v_dot2c_f32_bf16 v18, v135, v135
s_waitcnt lgkmcnt(5)
v_dot2c_f32_bf16 v15, s46, v136
v_dot2c_f32_bf16 v17, v136, v136
v_dot2c_f32_bf16 v16, s46, v137
v_dot2c_f32_bf16 v18, v137, v137
v_dot2c_f32_bf16 v15, s46, v138
v_dot2c_f32_bf16 v17, v138, v138
v_dot2c_f32_bf16 v16, s46, v139
v_dot2c_f32_bf16 v18, v139, v139
s_waitcnt lgkmcnt(4)
v_dot2c_f32_bf16 v15, s46, v140
v_dot2c_f32_bf16 v17, v140, v140
v_dot2c_f32_bf16 v16, s46, v141
v_dot2c_f32_bf16 v18, v141, v141
v_dot2c_f32_bf16 v15, s46, v142
v_dot2c_f32_bf16 v17, v142, v142
v_dot2c_f32_bf16 v16, s46, v143
v_dot2c_f32_bf16 v18, v143, v143
s_waitcnt vmcnt(18)
ds_read_b128 v[160:163], v9 offset:20480
ds_read_b128 v[164:167], v10 offset:20480
ds_read_b128 v[168:171], v11 offset:20480
ds_read_b128 v[172:175], v12 offset:20480
s_waitcnt lgkmcnt(7)
v_dot2c_f32_bf16 v15, s46, v144
v_dot2c_f32_bf16 v17, v144, v144
v_dot2c_f32_bf16 v16, s46, v145
v_dot2c_f32_bf16 v18, v145, v145
v_dot2c_f32_bf16 v15, s46, v146
v_dot2c_f32_bf16 v17, v146, v146
v_dot2c_f32_bf16 v16, s46, v147
v_dot2c_f32_bf16 v18, v147, v147
s_waitcnt lgkmcnt(6)
v_dot2c_f32_bf16 v15, s46, v148
v_dot2c_f32_bf16 v17, v148, v148
v_dot2c_f32_bf16 v16, s46, v149
v_dot2c_f32_bf16 v18, v149, v149
v_dot2c_f32_bf16 v15, s46, v150
v_dot2c_f32_bf16 v17, v150, v150
v_dot2c_f32_bf16 v16, s46, v151
v_dot2c_f32_bf16 v18, v151, v151
s_waitcnt lgkmcnt(5)
v_dot2c_f32_bf16 v15, s46, v152
v_dot2c_f32_bf16 v17, v152, v152
v_dot2c_f32_bf16 v16, s46, v153
v_dot2c_f32_bf16 v18, v153, v153
v_dot2c_f32_bf16 v15, s46, v154
v_dot2c_f32_bf16 v17, v154, v154
v_dot2c_f32_bf16 v16, s46, v155
v_dot2c_f32_bf16 v18, v155, v155
s_waitcnt lgkmcnt(4)
v_dot2c_f32_bf16 v15, s46, v156
v_dot2c_f32_bf16 v17, v156, v156
v_dot2c_f32_bf16 v16, s46, v157
v_dot2c_f32_bf16 v18, v157, v157
v_dot2c_f32_bf16 v15, s46, v158
v_dot2c_f32_bf16 v17, v158, v158
v_dot2c_f32_bf16 v16, s46, v159
v_dot2c_f32_bf16 v18, v159, v159
s_waitcnt vmcnt(14)
ds_read_b128 v[176:179], v9 offset:24576
ds_read_b128 v[180:183], v10 offset:24576
ds_read_b128 v[184:187], v11 offset:24576
ds_read_b128 v[188:191], v12 offset:24576
s_waitcnt lgkmcnt(7)
v_dot2c_f32_bf16 v15, s46, v160
v_dot2c_f32_bf16 v17, v160, v160
v_dot2c_f32_bf16 v16, s46, v161
v_dot2c_f32_bf16 v18, v161, v161
v_dot2c_f32_bf16 v15, s46, v162
v_dot2c_f32_bf16 v17, v162, v162
v_dot2c_f32_bf16 v16, s46, v163
v_dot2c_f32_bf16 v18, v163, v163
s_waitcnt lgkmcnt(6)
v_dot2c_f32_bf16 v15, s46, v164
v_dot2c_f32_bf16 v17, v164, v164
v_dot2c_f32_bf16 v16, s46, v165
v_dot2c_f32_bf16 v18, v165, v165
v_dot2c_f32_bf16 v15, s46, v166
v_dot2c_f32_bf16 v17, v166, v166
v_dot2c_f32_bf16 v16, s46, v167
v_dot2c_f32_bf16 v18, v167, v167
s_waitcnt lgkmcnt(5)
v_dot2c_f32_bf16 v15, s46, v168
v_dot2c_f32_bf16 v17, v168, v168
v_dot2c_f32_bf16 v16, s46, v169
v_dot2c_f32_bf16 v18, v169, v169
v_dot2c_f32_bf16 v15, s46, v170
v_dot2c_f32_bf16 v17, v170, v170
v_dot2c_f32_bf16 v16, s46, v171
v_dot2c_f32_bf16 v18, v171, v171
s_waitcnt lgkmcnt(4)
v_dot2c_f32_bf16 v15, s46, v172
v_dot2c_f32_bf16 v17, v172, v172
v_dot2c_f32_bf16 v16, s46, v173
v_dot2c_f32_bf16 v18, v173, v173
v_dot2c_f32_bf16 v15, s46, v174
v_dot2c_f32_bf16 v17, v174, v174
v_dot2c_f32_bf16 v16, s46, v175
v_dot2c_f32_bf16 v18, v175, v175
s_waitcnt vmcnt(10)
ds_read_b128 v[192:195], v9 offset:28672
ds_read_b128 v[196:199], v10 offset:28672
ds_read_b128 v[200:203], v11 offset:28672
ds_read_b128 v[204:207], v12 offset:28672
v_mov_b32 v14, 1
buffer_store_dword v14, v13, s[28:31], s101 offen sc1
s_waitcnt lgkmcnt(7)
v_dot2c_f32_bf16 v15, s46, v176
v_dot2c_f32_bf16 v17, v176, v176
v_dot2c_f32_bf16 v16, s46, v177
v_dot2c_f32_bf16 v18, v177, v177
v_dot2c_f32_bf16 v15, s46, v178
v_dot2c_f32_bf16 v17, v178, v178
v_dot2c_f32_bf16 v16, s46, v179
v_dot2c_f32_bf16 v18, v179, v179
s_waitcnt lgkmcnt(6)
v_dot2c_f32_bf16 v15, s46, v180
v_dot2c_f32_bf16 v17, v180, v180
v_dot2c_f32_bf16 v16, s46, v181
v_dot2c_f32_bf16 v18, v181, v181
v_dot2c_f32_bf16 v15, s46, v182
v_dot2c_f32_bf16 v17, v182, v182
v_dot2c_f32_bf16 v16, s46, v183
v_dot2c_f32_bf16 v18, v183, v183
s_waitcnt lgkmcnt(5)
v_dot2c_f32_bf16 v15, s46, v184
v_dot2c_f32_bf16 v17, v184, v184
v_dot2c_f32_bf16 v16, s46, v185
v_dot2c_f32_bf16 v18, v185, v185
v_dot2c_f32_bf16 v15, s46, v186
v_dot2c_f32_bf16 v17, v186, v186
v_dot2c_f32_bf16 v16, s46, v187
v_dot2c_f32_bf16 v18, v187, v187
s_waitcnt lgkmcnt(4)
v_dot2c_f32_bf16 v15, s46, v188
v_dot2c_f32_bf16 v17, v188, v188
v_dot2c_f32_bf16 v16, s46, v189
v_dot2c_f32_bf16 v18, v189, v189
v_dot2c_f32_bf16 v15, s46, v190
v_dot2c_f32_bf16 v17, v190, v190
v_dot2c_f32_bf16 v16, s46, v191
v_dot2c_f32_bf16 v18, v191, v191
s_waitcnt lgkmcnt(3)
v_dot2c_f32_bf16 v15, s46, v192
v_dot2c_f32_bf16 v17, v192, v192
v_dot2c_f32_bf16 v16, s46, v193
v_dot2c_f32_bf16 v18, v193, v193
v_dot2c_f32_bf16 v15, s46, v194
v_dot2c_f32_bf16 v17, v194, v194
v_dot2c_f32_bf16 v16, s46, v195
v_dot2c_f32_bf16 v18, v195, v195
s_waitcnt lgkmcnt(2)
v_dot2c_f32_bf16 v15, s46, v196
v_dot2c_f32_bf16 v17, v196, v196
v_dot2c_f32_bf16 v16, s46, v197
v_dot2c_f32_bf16 v18, v197, v197
v_dot2c_f32_bf16 v15, s46, v198
v_dot2c_f32_bf16 v17, v198, v198
v_dot2c_f32_bf16 v16, s46, v199
v_dot2c_f32_bf16 v18, v199, v199
s_waitcnt lgkmcnt(1)
v_dot2c_f32_bf16 v15, s46, v200
v_dot2c_f32_bf16 v17, v200, v200
v_dot2c_f32_bf16 v16, s46, v201
v_dot2c_f32_bf16 v18, v201, v201
v_dot2c_f32_bf16 v15, s46, v202
v_dot2c_f32_bf16 v17, v202, v202
v_dot2c_f32_bf16 v16, s46, v203
v_dot2c_f32_bf16 v18, v203, v203
s_waitcnt lgkmcnt(0)
v_dot2c_f32_bf16 v15, s46, v204
v_dot2c_f32_bf16 v17, v204, v204
v_dot2c_f32_bf16 v16, s46, v205
v_dot2c_f32_bf16 v18, v205, v205
v_dot2c_f32_bf16 v15, s46, v206
v_dot2c_f32_bf16 v17, v206, v206
v_dot2c_f32_bf16 v16, s46, v207
v_dot2c_f32_bf16 v18, v207, v207
s_nop 1
v_add_f32 v15, v15, v16
v_add_f32 v17, v17, v18
v_mov_b32 v16, v15
s_nop 1
v_permlane32_swap_b32 v15, v16
v_add_f32 v15, v15, v16
v_mov_b32 v18, v17
s_nop 1
v_permlane32_swap_b32 v17, v18
v_add_f32 v17, v17, v18
v_mul_f32 v15, 0x3ae38e39, v15
v_mul_f32 v17, 0x3ae38e39, v17
v_mov_b32 v13, v15
v_cvt_pk_bf16_f32 v13, v13, v13
v_and_b32 v13, s47, v13
v_sub_f32 v16, v15, v13
v_sub_f32 v13, 0, v13
v_mul_f32 v18, v15, v15
v_sub_f32 v14, v17, v18
v_dot2_f32_bf16 v32, v64, s44, v13
v_dot2_f32_bf16 v33, v64, s45, v13
v_dot2_f32_bf16 v34, v65, s44, v13
v_dot2_f32_bf16 v35, v65, s45, v13
v_dot2_f32_bf16 v36, v66, s44, v13
v_dot2_f32_bf16 v37, v66, s45, v13
v_dot2_f32_bf16 v38, v67, s44, v13
v_dot2_f32_bf16 v39, v67, s45, v13
v_dot2_f32_bf16 v40, v68, s44, v13
v_dot2_f32_bf16 v41, v68, s45, v13
v_dot2_f32_bf16 v42, v69, s44, v13
v_dot2_f32_bf16 v43, v69, s45, v13
v_dot2_f32_bf16 v44, v70, s44, v13
v_dot2_f32_bf16 v45, v70, s45, v13
v_dot2_f32_bf16 v46, v71, s44, v13
v_dot2_f32_bf16 v47, v71, s45, v13
s_add_u32 m0, s35, 10240
s_add_u32 s41, s38, 1770624
buffer_load_dwordx4 v20, s[12:15], s41 offen offset:0 lds
v_cvt_pk_bf16_f32 v64, v32, v33
v_cvt_pk_bf16_f32 v65, v34, v35
v_cvt_pk_bf16_f32 v66, v36, v37
v_cvt_pk_bf16_f32 v67, v38, v39
v_cvt_pk_bf16_f32 v68, v40, v41
v_cvt_pk_bf16_f32 v69, v42, v43
v_cvt_pk_bf16_f32 v70, v44, v45
v_cvt_pk_bf16_f32 v71, v46, v47
v_dot2_f32_bf16 v32, v72, s44, v13
v_dot2_f32_bf16 v33, v72, s45, v13
v_dot2_f32_bf16 v34, v73, s44, v13
v_dot2_f32_bf16 v35, v73, s45, v13
v_dot2_f32_bf16 v36, v74, s44, v13
v_dot2_f32_bf16 v37, v74, s45, v13
v_dot2_f32_bf16 v38, v75, s44, v13
v_dot2_f32_bf16 v39, v75, s45, v13
v_dot2_f32_bf16 v40, v76, s44, v13
v_dot2_f32_bf16 v41, v76, s45, v13
v_dot2_f32_bf16 v42, v77, s44, v13
v_dot2_f32_bf16 v43, v77, s45, v13
v_dot2_f32_bf16 v44, v78, s44, v13
v_dot2_f32_bf16 v45, v78, s45, v13
v_dot2_f32_bf16 v46, v79, s44, v13
v_dot2_f32_bf16 v47, v79, s45, v13
buffer_load_dwordx4 v21, s[12:15], s41 offen offset:1024 lds
v_cvt_pk_bf16_f32 v72, v32, v33
v_cvt_pk_bf16_f32 v73, v34, v35
v_cvt_pk_bf16_f32 v74, v36, v37
v_cvt_pk_bf16_f32 v75, v38, v39
v_cvt_pk_bf16_f32 v76, v40, v41
v_cvt_pk_bf16_f32 v77, v42, v43
v_cvt_pk_bf16_f32 v78, v44, v45
v_cvt_pk_bf16_f32 v79, v46, v47
v_dot2_f32_bf16 v32, v80, s44, v13
v_dot2_f32_bf16 v33, v80, s45, v13
v_dot2_f32_bf16 v34, v81, s44, v13
v_dot2_f32_bf16 v35, v81, s45, v13
v_dot2_f32_bf16 v36, v82, s44, v13
v_dot2_f32_bf16 v37, v82, s45, v13
v_dot2_f32_bf16 v38, v83, s44, v13
v_dot2_f32_bf16 v39, v83, s45, v13
v_dot2_f32_bf16 v40, v84, s44, v13
v_dot2_f32_bf16 v41, v84, s45, v13
v_dot2_f32_bf16 v42, v85, s44, v13
v_dot2_f32_bf16 v43, v85, s45, v13
v_dot2_f32_bf16 v44, v86, s44, v13
v_dot2_f32_bf16 v45, v86, s45, v13
v_dot2_f32_bf16 v46, v87, s44, v13
v_dot2_f32_bf16 v47, v87, s45, v13
buffer_load_dwordx4 v22, s[12:15], s41 offen offset:2048 lds
v_cvt_pk_bf16_f32 v80, v32, v33
v_cvt_pk_bf16_f32 v81, v34, v35
v_cvt_pk_bf16_f32 v82, v36, v37
v_cvt_pk_bf16_f32 v83, v38, v39
v_cvt_pk_bf16_f32 v84, v40, v41
v_cvt_pk_bf16_f32 v85, v42, v43
v_cvt_pk_bf16_f32 v86, v44, v45
v_cvt_pk_bf16_f32 v87, v46, v47
v_dot2_f32_bf16 v32, v88, s44, v13
v_dot2_f32_bf16 v33, v88, s45, v13
v_dot2_f32_bf16 v34, v89, s44, v13
v_dot2_f32_bf16 v35, v89, s45, v13
v_dot2_f32_bf16 v36, v90, s44, v13
v_dot2_f32_bf16 v37, v90, s45, v13
v_dot2_f32_bf16 v38, v91, s44, v13
v_dot2_f32_bf16 v39, v91, s45, v13
v_dot2_f32_bf16 v40, v92, s44, v13
v_dot2_f32_bf16 v41, v92, s45, v13
v_dot2_f32_bf16 v42, v93, s44, v13
v_dot2_f32_bf16 v43, v93, s45, v13
v_dot2_f32_bf16 v44, v94, s44, v13
v_dot2_f32_bf16 v45, v94, s45, v13
v_dot2_f32_bf16 v46, v95, s44, v13
v_dot2_f32_bf16 v47, v95, s45, v13
buffer_load_dwordx4 v23, s[12:15], s41 offen offset:3072 lds
v_cvt_pk_bf16_f32 v88, v32, v33
v_cvt_pk_bf16_f32 v89, v34, v35
v_cvt_pk_bf16_f32 v90, v36, v37
v_cvt_pk_bf16_f32 v91, v38, v39
v_cvt_pk_bf16_f32 v92, v40, v41
v_cvt_pk_bf16_f32 v93, v42, v43
v_cvt_pk_bf16_f32 v94, v44, v45
v_cvt_pk_bf16_f32 v95, v46, v47
v_dot2_f32_bf16 v32, v96, s44, v13
v_dot2_f32_bf16 v33, v96, s45, v13
v_dot2_f32_bf16 v34, v97, s44, v13
v_dot2_f32_bf16 v35, v97, s45, v13
v_dot2_f32_bf16 v36, v98, s44, v13
v_dot2_f32_bf16 v37, v98, s45, v13
v_dot2_f32_bf16 v38, v99, s44, v13
v_dot2_f32_bf16 v39, v99, s45, v13
v_dot2_f32_bf16 v40, v100, s44, v13
v_dot2_f32_bf16 v41, v100, s45, v13
v_dot2_f32_bf16 v42, v101, s44, v13
v_dot2_f32_bf16 v43, v101, s45, v13
v_dot2_f32_bf16 v44, v102, s44, v13
v_dot2_f32_bf16 v45, v102, s45, v13
v_dot2_f32_bf16 v46, v103, s44, v13
v_dot2_f32_bf16 v47, v103, s45, v13
s_add_u32 m0, s35, 14080
s_nop 0
buffer_load_dwordx4 v24, s[12:15], s41 offen offset:256 lds
v_cvt_pk_bf16_f32 v96, v32, v33
v_cvt_pk_bf16_f32 v97, v34, v35
v_cvt_pk_bf16_f32 v98, v36, v37
v_cvt_pk_bf16_f32 v99, v38, v39
v_cvt_pk_bf16_f32 v100, v40, v41
v_cvt_pk_bf16_f32 v101, v42, v43
v_cvt_pk_bf16_f32 v102, v44, v45
v_cvt_pk_bf16_f32 v103, v46, v47
v_dot2_f32_bf16 v32, v104, s44, v13
v_dot2_f32_bf16 v33, v104, s45, v13
v_dot2_f32_bf16 v34, v105, s44, v13
v_dot2_f32_bf16 v35, v105, s45, v13
v_dot2_f32_bf16 v36, v106, s44, v13
v_dot2_f32_bf16 v37, v106, s45, v13
v_dot2_f32_bf16 v38, v107, s44, v13
v_dot2_f32_bf16 v39, v107, s45, v13
v_dot2_f32_bf16 v40, v108, s44, v13
v_dot2_f32_bf16 v41, v108, s45, v13
v_dot2_f32_bf16 v42, v109, s44, v13
v_dot2_f32_bf16 v43, v109, s45, v13
v_dot2_f32_bf16 v44, v110, s44, v13
v_dot2_f32_bf16 v45, v110, s45, v13
v_dot2_f32_bf16 v46, v111, s44, v13
v_dot2_f32_bf16 v47, v111, s45, v13
s_add_u32 m0, s35, 15360
s_add_u32 s41, s38, 1152
buffer_load_dwordx4 v20, s[12:15], s41 offen offset:0 lds
v_cvt_pk_bf16_f32 v104, v32, v33
v_cvt_pk_bf16_f32 v105, v34, v35
v_cvt_pk_bf16_f32 v106, v36, v37
v_cvt_pk_bf16_f32 v107, v38, v39
v_cvt_pk_bf16_f32 v108, v40, v41
v_cvt_pk_bf16_f32 v109, v42, v43
v_cvt_pk_bf16_f32 v110, v44, v45
v_cvt_pk_bf16_f32 v111, v46, v47
v_dot2_f32_bf16 v32, v112, s44, v13
v_dot2_f32_bf16 v33, v112, s45, v13
v_dot2_f32_bf16 v34, v113, s44, v13
v_dot2_f32_bf16 v35, v113, s45, v13
v_dot2_f32_bf16 v36, v114, s44, v13
v_dot2_f32_bf16 v37, v114, s45, v13
v_dot2_f32_bf16 v38, v115, s44, v13
v_dot2_f32_bf16 v39, v115, s45, v13
v_dot2_f32_bf16 v40, v116, s44, v13
v_dot2_f32_bf16 v41, v116, s45, v13
v_dot2_f32_bf16 v42, v117, s44, v13
v_dot2_f32_bf16 v43, v117, s45, v13
v_dot2_f32_bf16 v44, v118, s44, v13
v_dot2_f32_bf16 v45, v118, s45, v13
v_dot2_f32_bf16 v46, v119, s44, v13
v_dot2_f32_bf16 v47, v119, s45, v13
buffer_load_dwordx4 v21, s[12:15], s41 offen offset:1024 lds
v_cvt_pk_bf16_f32 v112, v32, v33
v_cvt_pk_bf16_f32 v113, v34, v35
v_cvt_pk_bf16_f32 v114, v36, v37
v_cvt_pk_bf16_f32 v115, v38, v39
v_cvt_pk_bf16_f32 v116, v40, v41
v_cvt_pk_bf16_f32 v117, v42, v43
v_cvt_pk_bf16_f32 v118, v44, v45
v_cvt_pk_bf16_f32 v119, v46, v47
v_dot2_f32_bf16 v32, v120, s44, v13
v_dot2_f32_bf16 v33, v120, s45, v13
v_dot2_f32_bf16 v34, v121, s44, v13
v_dot2_f32_bf16 v35, v121, s45, v13
v_dot2_f32_bf16 v36, v122, s44, v13
v_dot2_f32_bf16 v37, v122, s45, v13
v_dot2_f32_bf16 v38, v123, s44, v13
v_dot2_f32_bf16 v39, v123, s45, v13
v_dot2_f32_bf16 v40, v124, s44, v13
v_dot2_f32_bf16 v41, v124, s45, v13
v_dot2_f32_bf16 v42, v125, s44, v13
v_dot2_f32_bf16 v43, v125, s45, v13
v_dot2_f32_bf16 v44, v126, s44, v13
v_dot2_f32_bf16 v45, v126, s45, v13
v_dot2_f32_bf16 v46, v127, s44, v13
v_dot2_f32_bf16 v47, v127, s45, v13
buffer_load_dwordx4 v22, s[12:15], s41 offen offset:2048 lds
v_cvt_pk_bf16_f32 v120, v32, v33
v_cvt_pk_bf16_f32 v121, v34, v35
v_cvt_pk_bf16_f32 v122, v36, v37
v_cvt_pk_bf16_f32 v123, v38, v39
v_cvt_pk_bf16_f32 v124, v40, v41
v_cvt_pk_bf16_f32 v125, v42, v43
v_cvt_pk_bf16_f32 v126, v44, v45
v_cvt_pk_bf16_f32 v127, v46, v47
v_dot2_f32_bf16 v32, v128, s44, v13
v_dot2_f32_bf16 v33, v128, s45, v13
v_dot2_f32_bf16 v34, v129, s44, v13
v_dot2_f32_bf16 v35, v129, s45, v13
v_dot2_f32_bf16 v36, v130, s44, v13
v_dot2_f32_bf16 v37, v130, s45, v13
v_dot2_f32_bf16 v38, v131, s44, v13
v_dot2_f32_bf16 v39, v131, s45, v13
v_dot2_f32_bf16 v40, v132, s44, v13
v_dot2_f32_bf16 v41, v132, s45, v13
v_dot2_f32_bf16 v42, v133, s44, v13
v_dot2_f32_bf16 v43, v133, s45, v13
v_dot2_f32_bf16 v44, v134, s44, v13
v_dot2_f32_bf16 v45, v134, s45, v13
v_dot2_f32_bf16 v46, v135, s44, v13
v_dot2_f32_bf16 v47, v135, s45, v13
buffer_load_dwordx4 v23, s[12:15], s41 offen offset:3072 lds
v_cvt_pk_bf16_f32 v128, v32, v33
v_cvt_pk_bf16_f32 v129, v34, v35
v_cvt_pk_bf16_f32 v130, v36, v37
v_cvt_pk_bf16_f32 v131, v38, v39
v_cvt_pk_bf16_f32 v132, v40, v41
v_cvt_pk_bf16_f32 v133, v42, v43
v_cvt_pk_bf16_f32 v134, v44, v45
v_cvt_pk_bf16_f32 v135, v46, v47
v_dot2_f32_bf16 v32, v136, s44, v13
v_dot2_f32_bf16 v33, v136, s45, v13
v_dot2_f32_bf16 v34, v137, s44, v13
v_dot2_f32_bf16 v35, v137, s45, v13
v_dot2_f32_bf16 v36, v138, s44, v13
v_dot2_f32_bf16 v37, v138, s45, v13
v_dot2_f32_bf16 v38, v139, s44, v13
v_dot2_f32_bf16 v39, v139, s45, v13
v_dot2_f32_bf16 v40, v140, s44, v13
v_dot2_f32_bf16 v41, v140, s45, v13
v_dot2_f32_bf16 v42, v141, s44, v13
v_dot2_f32_bf16 v43, v141, s45, v13
v_dot2_f32_bf16 v44, v142, s44, v13
v_dot2_f32_bf16 v45, v142, s45, v13
v_dot2_f32_bf16 v46, v143, s44, v13
v_dot2_f32_bf16 v47, v143, s45, v13
s_add_u32 m0, s35, 19200
s_nop 0
buffer_load_dwordx4 v24, s[12:15], s41 offen offset:256 lds
v_cvt_pk_bf16_f32 v136, v32, v33
v_cvt_pk_bf16_f32 v137, v34, v35
v_cvt_pk_bf16_f32 v138, v36, v37
v_cvt_pk_bf16_f32 v139, v38, v39
v_cvt_pk_bf16_f32 v140, v40, v41
v_cvt_pk_bf16_f32 v141, v42, v43
v_cvt_pk_bf16_f32 v142, v44, v45
v_cvt_pk_bf16_f32 v143, v46, v47
v_dot2_f32_bf16 v32, v144, s44, v13
v_dot2_f32_bf16 v33, v144, s45, v13
v_dot2_f32_bf16 v34, v145, s44, v13
v_dot2_f32_bf16 v35, v145, s45, v13
v_dot2_f32_bf16 v36, v146, s44, v13
v_dot2_f32_bf16 v37, v146, s45, v13
v_dot2_f32_bf16 v38, v147, s44, v13
L_pad_a1_0:
s_cbranch_execz L_pad_a1_1
v_dot2_f32_bf16 v39, v147, s45, v13
v_dot2_f32_bf16 v40, v148, s44, v13
v_dot2_f32_bf16 v41, v148, s45, v13
v_dot2_f32_bf16 v42, v149, s44, v13
v_dot2_f32_bf16 v43, v149, s45, v13
v_dot2_f32_bf16 v44, v150, s44, v13
v_dot2_f32_bf16 v45, v150, s45, v13
v_dot2_f32_bf16 v46, v151, s44, v13
v_dot2_f32_bf16 v47, v151, s45, v13
s_add_u32 m0, s35, 20480
s_add_u32 s41, s38, 664704
buffer_load_dwordx4 v20, s[12:15], s41 offen offset:0 lds
v_cvt_pk_bf16_f32 v144, v32, v33
v_cvt_pk_bf16_f32 v145, v34, v35
v_cvt_pk_bf16_f32 v146, v36, v37
v_cvt_pk_bf16_f32 v147, v38, v39
v_cvt_pk_bf16_f32 v148, v40, v41
v_cvt_pk_bf16_f32 v149, v42, v43
v_cvt_pk_bf16_f32 v150, v44, v45
v_cvt_pk_bf16_f32 v151, v46, v47
v_dot2_f32_bf16 v32, v152, s44, v13
v_dot2_f32_bf16 v33, v152, s45, v13
v_dot2_f32_bf16 v34, v153, s44, v13
v_dot2_f32_bf16 v35, v153, s45, v13
v_dot2_f32_bf16 v36, v154, s44, v13
v_dot2_f32_bf16 v37, v154, s45, v13
v_dot2_f32_bf16 v38, v155, s44, v13
v_dot2_f32_bf16 v39, v155, s45, v13
v_dot2_f32_bf16 v40, v156, s44, v13
v_dot2_f32_bf16 v41, v156, s45, v13
v_dot2_f32_bf16 v42, v157, s44, v13
v_dot2_f32_bf16 v43, v157, s45, v13
v_dot2_f32_bf16 v44, v158, s44, v13
v_dot2_f32_bf16 v45, v158, s45, v13
v_dot2_f32_bf16 v46, v159, s44, v13
v_dot2_f32_bf16 v47, v159, s45, v13
buffer_load_dwordx4 v21, s[12:15], s41 offen offset:1024 lds
v_cvt_pk_bf16_f32 v152, v32, v33
v_cvt_pk_bf16_f32 v153, v34, v35
v_cvt_pk_bf16_f32 v154, v36, v37
v_cvt_pk_bf16_f32 v155, v38, v39
v_cvt_pk_bf16_f32 v156, v40, v41
v_cvt_pk_bf16_f32 v157, v42, v43
v_cvt_pk_bf16_f32 v158, v44, v45
v_cvt_pk_bf16_f32 v159, v46, v47
v_dot2_f32_bf16 v32, v160, s44, v13
v_dot2_f32_bf16 v33, v160, s45, v13
v_dot2_f32_bf16 v34, v161, s44, v13
v_dot2_f32_bf16 v35, v161, s45, v13
v_dot2_f32_bf16 v36, v162, s44, v13
v_dot2_f32_bf16 v37, v162, s45, v13
v_dot2_f32_bf16 v38, v163, s44, v13
v_dot2_f32_bf16 v39, v163, s45, v13
v_dot2_f32_bf16 v40, v164, s44, v13
v_dot2_f32_bf16 v41, v164, s45, v13
v_dot2_f32_bf16 v42, v165, s44, v13
v_dot2_f32_bf16 v43, v165, s45, v13
v_dot2_f32_bf16 v44, v166, s44, v13
v_dot2_f32_bf16 v45, v166, s45, v13
v_dot2_f32_bf16 v46, v167, s44, v13
v_dot2_f32_bf16 v47, v167, s45, v13
buffer_load_dwordx4 v22, s[12:15], s41 offen offset:2048 lds
v_cvt_pk_bf16_f32 v160, v32, v33
v_cvt_pk_bf16_f32 v161, v34, v35
v_cvt_pk_bf16_f32 v162, v36, v37
v_cvt_pk_bf16_f32 v163, v38, v39
v_cvt_pk_bf16_f32 v164, v40, v41
v_cvt_pk_bf16_f32 v165, v42, v43
v_cvt_pk_bf16_f32 v166, v44, v45
v_cvt_pk_bf16_f32 v167, v46, v47
v_dot2_f32_bf16 v32, v168, s44, v13
v_dot2_f32_bf16 v33, v168, s45, v13
v_dot2_f32_bf16 v34, v169, s44, v13
v_dot2_f32_bf16 v35, v169, s45, v13
v_dot2_f32_bf16 v36, v170, s44, v13
v_dot2_f32_bf16 v37, v170, s45, v13
v_dot2_f32_bf16 v38, v171, s44, v13
v_dot2_f32_bf16 v39, v171, s45, v13
v_dot2_f32_bf16 v40, v172, s44, v13
v_dot2_f32_bf16 v41, v172, s45, v13
v_dot2_f32_bf16 v42, v173, s44, v13
v_dot2_f32_bf16 v43, v173, s45, v13
v_dot2_f32_bf16 v44, v174, s44, v13
v_dot2_f32_bf16 v45, v174, s45, v13
v_dot2_f32_bf16 v46, v175, s44, v13
v_dot2_f32_bf16 v47, v175, s45, v13
buffer_load_dwordx4 v23, s[12:15], s41 offen offset:3072 lds
v_cvt_pk_bf16_f32 v168, v32, v33
v_cvt_pk_bf16_f32 v169, v34, v35
v_cvt_pk_bf16_f32 v170, v36, v37
v_cvt_pk_bf16_f32 v171, v38, v39
v_cvt_pk_bf16_f32 v172, v40, v41
v_cvt_pk_bf16_f32 v173, v42, v43
v_cvt_pk_bf16_f32 v174, v44, v45
v_cvt_pk_bf16_f32 v175, v46, v47
v_dot2_f32_bf16 v32, v176, s44, v13
v_dot2_f32_bf16 v33, v176, s45, v13
v_dot2_f32_bf16 v34, v177, s44, v13
v_dot2_f32_bf16 v35, v177, s45, v13
v_dot2_f32_bf16 v36, v178, s44, v13
v_dot2_f32_bf16 v37, v178, s45, v13
v_dot2_f32_bf16 v38, v179, s44, v13
v_dot2_f32_bf16 v39, v179, s45, v13
v_dot2_f32_bf16 v40, v180, s44, v13
v_dot2_f32_bf16 v41, v180, s45, v13
v_dot2_f32_bf16 v42, v181, s44, v13
v_dot2_f32_bf16 v43, v181, s45, v13
v_dot2_f32_bf16 v44, v182, s44, v13
v_dot2_f32_bf16 v45, v182, s45, v13
v_dot2_f32_bf16 v46, v183, s44, v13
v_dot2_f32_bf16 v47, v183, s45, v13
s_add_u32 m0, s35, 24320
s_nop 0
buffer_load_dwordx4 v24, s[12:15], s41 offen offset:256 lds
v_cvt_pk_bf16_f32 v176, v32, v33
v_cvt_pk_bf16_f32 v177, v34, v35
v_cvt_pk_bf16_f32 v178, v36, v37
v_cvt_pk_bf16_f32 v179, v38, v39
v_cvt_pk_bf16_f32 v180, v40, v41
v_cvt_pk_bf16_f32 v181, v42, v43
v_cvt_pk_bf16_f32 v182, v44, v45
v_cvt_pk_bf16_f32 v183, v46, v47
v_dot2_f32_bf16 v32, v184, s44, v13
v_dot2_f32_bf16 v33, v184, s45, v13
v_dot2_f32_bf16 v34, v185, s44, v13
v_dot2_f32_bf16 v35, v185, s45, v13
v_dot2_f32_bf16 v36, v186, s44, v13
v_dot2_f32_bf16 v37, v186, s45, v13
v_dot2_f32_bf16 v38, v187, s44, v13
v_dot2_f32_bf16 v39, v187, s45, v13
v_dot2_f32_bf16 v40, v188, s44, v13
v_dot2_f32_bf16 v41, v188, s45, v13
v_dot2_f32_bf16 v42, v189, s44, v13
v_dot2_f32_bf16 v43, v189, s45, v13
v_dot2_f32_bf16 v44, v190, s44, v13
v_dot2_f32_bf16 v45, v190, s45, v13
v_dot2_f32_bf16 v46, v191, s44, v13
v_dot2_f32_bf16 v47, v191, s45, v13
s_add_u32 m0, s35, 25600
s_add_u32 s41, s38, 1328256
buffer_load_dwordx4 v20, s[12:15], s41 offen offset:0 lds
v_cvt_pk_bf16_f32 v184, v32, v33
v_cvt_pk_bf16_f32 v185, v34, v35
v_cvt_pk_bf16_f32 v186, v36, v37
v_cvt_pk_bf16_f32 v187, v38, v39
v_cvt_pk_bf16_f32 v188, v40, v41
v_cvt_pk_bf16_f32 v189, v42, v43
v_cvt_pk_bf16_f32 v190, v44, v45
v_cvt_pk_bf16_f32 v191, v46, v47
v_dot2_f32_bf16 v32, v192, s44, v13
v_dot2_f32_bf16 v33, v192, s45, v13
v_dot2_f32_bf16 v34, v193, s44, v13
v_dot2_f32_bf16 v35, v193, s45, v13
v_dot2_f32_bf16 v36, v194, s44, v13
v_dot2_f32_bf16 v37, v194, s45, v13
v_dot2_f32_bf16 v38, v195, s44, v13
v_dot2_f32_bf16 v39, v195, s45, v13
v_dot2_f32_bf16 v40, v196, s44, v13
v_dot2_f32_bf16 v41, v196, s45, v13
v_dot2_f32_bf16 v42, v197, s44, v13
v_dot2_f32_bf16 v43, v197, s45, v13
v_dot2_f32_bf16 v44, v198, s44, v13
v_dot2_f32_bf16 v45, v198, s45, v13
v_dot2_f32_bf16 v46, v199, s44, v13
v_dot2_f32_bf16 v47, v199, s45, v13
buffer_load_dwordx4 v21, s[12:15], s41 offen offset:1024 lds
v_cvt_pk_bf16_f32 v192, v32, v33
v_cvt_pk_bf16_f32 v193, v34, v35
v_cvt_pk_bf16_f32 v194, v36, v37
v_cvt_pk_bf16_f32 v195, v38, v39
v_cvt_pk_bf16_f32 v196, v40, v41
v_cvt_pk_bf16_f32 v197, v42, v43
v_cvt_pk_bf16_f32 v198, v44, v45
v_cvt_pk_bf16_f32 v199, v46, v47
v_dot2_f32_bf16 v32, v200, s44, v13
v_dot2_f32_bf16 v33, v200, s45, v13
v_dot2_f32_bf16 v34, v201, s44, v13
v_dot2_f32_bf16 v35, v201, s45, v13
v_dot2_f32_bf16 v36, v202, s44, v13
v_dot2_f32_bf16 v37, v202, s45, v13
v_dot2_f32_bf16 v38, v203, s44, v13
v_dot2_f32_bf16 v39, v203, s45, v13
v_dot2_f32_bf16 v40, v204, s44, v13
v_dot2_f32_bf16 v41, v204, s45, v13
v_dot2_f32_bf16 v42, v205, s44, v13
v_dot2_f32_bf16 v43, v205, s45, v13
v_dot2_f32_bf16 v44, v206, s44, v13
v_dot2_f32_bf16 v45, v206, s45, v13
v_dot2_f32_bf16 v46, v207, s44, v13
v_dot2_f32_bf16 v47, v207, s45, v13
buffer_load_dwordx4 v22, s[12:15], s41 offen offset:2048 lds
v_cvt_pk_bf16_f32 v200, v32, v33
v_cvt_pk_bf16_f32 v201, v34, v35
v_cvt_pk_bf16_f32 v202, v36, v37
v_cvt_pk_bf16_f32 v203, v38, v39
v_cvt_pk_bf16_f32 v204, v40, v41
v_cvt_pk_bf16_f32 v205, v42, v43
v_cvt_pk_bf16_f32 v206, v44, v45
v_cvt_pk_bf16_f32 v207, v46, v47
v_mul_f32 v17, 0x41800000, v14
v_cmp_nge_f32 vcc, v17, v18
s_nop 4
s_cbranch_vccz L_att_var
v_mov_b32 v17, 0
v_mov_b32 v18, 0
v_dot2c_f32_bf16 v17, v64, v64
v_dot2c_f32_bf16 v18, v65, v65
v_dot2c_f32_bf16 v17, v66, v66
v_dot2c_f32_bf16 v18, v67, v67
v_dot2c_f32_bf16 v17, v68, v68
v_dot2c_f32_bf16 v18, v69, v69
v_dot2c_f32_bf16 v17, v70, v70
v_dot2c_f32_bf16 v18, v71, v71
v_dot2c_f32_bf16 v17, v72, v72
v_dot2c_f32_bf16 v18, v73, v73
v_dot2c_f32_bf16 v17, v74, v74
v_dot2c_f32_bf16 v18, v75, v75
v_dot2c_f32_bf16 v17, v76, v76
v_dot2c_f32_bf16 v18, v77, v77
v_dot2c_f32_bf16 v17, v78, v78
v_dot2c_f32_bf16 v18, v79, v79
v_dot2c_f32_bf16 v17, v80, v80
v_dot2c_f32_bf16 v18, v81, v81
v_dot2c_f32_bf16 v17, v82, v82
v_dot2c_f32_bf16 v18, v83, v83
v_dot2c_f32_bf16 v17, v84, v84
v_dot2c_f32_bf16 v18, v85, v85
v_dot2c_f32_bf16 v17, v86, v86
v_dot2c_f32_bf16 v18, v87, v87
v_dot2c_f32_bf16 v17, v88, v88
v_dot2c_f32_bf16 v18, v89, v89
v_dot2c_f32_bf16 v17, v90, v90
v_dot2c_f32_bf16 v18, v91, v91
v_dot2c_f32_bf16 v17, v92, v92
v_dot2c_f32_bf16 v18, v93, v93
v_dot2c_f32_bf16 v17, v94, v94
v_dot2c_f32_bf16 v18, v95, v95
v_dot2c_f32_bf16 v17, v96, v96
v_dot2c_f32_bf16 v18, v97, v97
v_dot2c_f32_bf16 v17, v98, v98
v_dot2c_f32_bf16 v18, v99, v99
v_dot2c_f32_bf16 v17, v100, v100
v_dot2c_f32_bf16 v18, v101, v101
v_dot2c_f32_bf16 v17, v102, v102
v_dot2c_f32_bf16 v18, v103, v103
v_dot2c_f32_bf16 v17, v104, v104
v_dot2c_f32_bf16 v18, v105, v105
v_dot2c_f32_bf16 v17, v106, v106
v_dot2c_f32_bf16 v18, v107, v107
v_dot2c_f32_bf16 v17, v108, v108
v_dot2c_f32_bf16 v18, v109, v109
v_dot2c_f32_bf16 v17, v110, v110
v_dot2c_f32_bf16 v18, v111, v111
v_dot2c_f32_bf16 v17, v112, v112
v_dot2c_f32_bf16 v18, v113, v113
v_dot2c_f32_bf16 v17, v114, v114
v_dot2c_f32_bf16 v18, v115, v115
v_dot2c_f32_bf16 v17, v116, v116
v_dot2c_f32_bf16 v18, v117, v117
v_dot2c_f32_bf16 v17, v118, v118
v_dot2c_f32_bf16 v18, v119, v119
v_dot2c_f32_bf16 v17, v120, v120
v_dot2c_f32_bf16 v18, v121, v121
v_dot2c_f32_bf16 v17, v122, v122
v_dot2c_f32_bf16 v18, v123, v123
v_dot2c_f32_bf16 v17, v124, v124
v_dot2c_f32_bf16 v18, v125, v125
v_dot2c_f32_bf16 v17, v126, v126
v_dot2c_f32_bf16 v18, v127, v127
v_dot2c_f32_bf16 v17, v128, v128
v_dot2c_f32_bf16 v18, v129, v129
v_dot2c_f32_bf16 v17, v130, v130
v_dot2c_f32_bf16 v18, v131, v131
v_dot2c_f32_bf16 v17, v132, v132
v_dot2c_f32_bf16 v18, v133, v133
v_dot2c_f32_bf16 v17, v134, v134
v_dot2c_f32_bf16 v18, v135, v135
v_dot2c_f32_bf16 v17, v136, v136
v_dot2c_f32_bf16 v18, v137, v137
v_dot2c_f32_bf16 v17, v138, v138
v_dot2c_f32_bf16 v18, v139, v139
v_dot2c_f32_bf16 v17, v140, v140
v_dot2c_f32_bf16 v18, v141, v141
v_dot2c_f32_bf16 v17, v142, v142
v_dot2c_f32_bf16 v18, v143, v143
v_dot2c_f32_bf16 v17, v144, v144
v_dot2c_f32_bf16 v18, v145, v145
v_dot2c_f32_bf16 v17, v146, v146
v_dot2c_f32_bf16 v18, v147, v147
v_dot2c_f32_bf16 v17, v148, v148
v_dot2c_f32_bf16 v18, v149, v149
v_dot2c_f32_bf16 v17, v150, v150
v_dot2c_f32_bf16 v18, v151, v151
v_dot2c_f32_bf16 v17, v152, v152
v_dot2c_f32_bf16 v18, v153, v153
v_dot2c_f32_bf16 v17, v154, v154
v_dot2c_f32_bf16 v18, v155, v155
v_dot2c_f32_bf16 v17, v156, v156
v_dot2c_f32_bf16 v18, v157, v157
v_dot2c_f32_bf16 v17, v158, v158
v_dot2c_f32_bf16 v18, v159, v159
v_dot2c_f32_bf16 v17, v160, v160
v_dot2c_f32_bf16 v18, v161, v161
v_dot2c_f32_bf16 v17, v162, v162
v_dot2c_f32_bf16 v18, v163, v163
v_dot2c_f32_bf16 v17, v164, v164
v_dot2c_f32_bf16 v18, v165, v165
v_dot2c_f32_bf16 v17, v166, v166
v_dot2c_f32_bf16 v18, v167, v167
v_dot2c_f32_bf16 v17, v168, v168
v_dot2c_f32_bf16 v18, v169, v169
v_dot2c_f32_bf16 v17, v170, v170
v_dot2c_f32_bf16 v18, v171, v171
v_dot2c_f32_bf16 v17, v172, v172
v_dot2c_f32_bf16 v18, v173, v173
v_dot2c_f32_bf16 v17, v174, v174
v_dot2c_f32_bf16 v18, v175, v175
v_dot2c_f32_bf16 v17, v176, v176
v_dot2c_f32_bf16 v18, v177, v177
v_dot2c_f32_bf16 v17, v178, v178
v_dot2c_f32_bf16 v18, v179, v179
v_dot2c_f32_bf16 v17, v180, v180
v_dot2c_f32_bf16 v18, v181, v181
v_dot2c_f32_bf16 v17, v182, v182
v_dot2c_f32_bf16 v18, v183, v183
v_dot2c_f32_bf16 v17, v184, v184
v_dot2c_f32_bf16 v18, v185, v185
v_dot2c_f32_bf16 v17, v186, v186
v_dot2c_f32_bf16 v18, v187, v187
v_dot2c_f32_bf16 v17, v188, v188
v_dot2c_f32_bf16 v18, v189, v189
v_dot2c_f32_bf16 v17, v190, v190
v_dot2c_f32_bf16 v18, v191, v191
v_dot2c_f32_bf16 v17, v192, v192
v_dot2c_f32_bf16 v18, v193, v193
v_dot2c_f32_bf16 v17, v194, v194
v_dot2c_f32_bf16 v18, v195, v195
v_dot2c_f32_bf16 v17, v196, v196
v_dot2c_f32_bf16 v18, v197, v197
v_dot2c_f32_bf16 v17, v198, v198
v_dot2c_f32_bf16 v18, v199, v199
v_dot2c_f32_bf16 v17, v200, v200
v_dot2c_f32_bf16 v18, v201, v201
v_dot2c_f32_bf16 v17, v202, v202
v_dot2c_f32_bf16 v18, v203, v203
v_dot2c_f32_bf16 v17, v204, v204
v_dot2c_f32_bf16 v18, v205, v205
v_dot2c_f32_bf16 v17, v206, v206
v_dot2c_f32_bf16 v18, v207, v207
s_nop 2
v_add_f32 v17, v17, v18
v_mov_b32 v18, v17
s_nop 1
v_permlane32_swap_b32 v17, v18
v_add_f32 v17, v17, v18
v_mul_f32 v17, 0x3ae38e39, v17
v_mul_f32 v16, v16, v16
v_sub_f32 v14, v17, v16
s_nop 3
L_att_var:
v_max_f32 v14, 0, v14
v_cvt_pk_bf16_f32 v14, v14, v14
v_and_b32 v14, s47, v14
v_add_f32 v14, 0x3727c5ac, v14
v_cvt_pk_bf16_f32 v14, v14, v14
v_and_b32 v14, s47, v14
v_sqrt_f32 v14, v14
s_nop 0
v_cvt_pk_bf16_f32 v14, v14, v14
v_and_b32 v14, s47, v14
v_lshrrev_b32 v13, 16, v14
v_rcp_f32 v14, v14
v_mov_b32 v3, 0x7f000000
v_cmp_eq_u32 vcc, 0, v0
s_nop 1
v_cndmask_b32 v7, v3, v0, vcc
v_min_u32 v10, 15, v1
v_lshlrev_b32 v10, 2, v10
v_mul_f32 v30, s48, v14
s_waitcnt vmcnt(24)
s_barrier
ds_read_b64_tr_b16 a[144:145], v26 offset:0
ds_read_b64_tr_b16 a[146:147], v26 offset:256
ds_read_b64_tr_b16 a[148:149], v26 offset:1024
ds_read_b64_tr_b16 a[150:151], v26 offset:1280
ds_read_b64_tr_b16 a[152:153], v26 offset:2048
ds_read_b64_tr_b16 a[154:155], v26 offset:2304
ds_read_b64_tr_b16 a[156:157], v26 offset:3072
ds_read_b64_tr_b16 a[158:159], v26 offset:3328
ds_read_b64_tr_b16 a[160:161], v26 offset:4096
ds_read_b64_tr_b16 a[162:163], v26 offset:4352
ds_read_b64_tr_b16 a[164:165], v27 offset:0
ds_read_b64_tr_b16 a[166:167], v27 offset:256
s_waitcnt lgkmcnt(10)
v_mfma_f32_32x32x16_bf16 v[32:47], a[144:147], v[64:67], 0
ds_read_b64_tr_b16 a[168:169], v27 offset:1024
ds_read_b64_tr_b16 a[170:171], v27 offset:1280
v_accvgpr_write_b32 a0, v64
v_accvgpr_write_b32 a1, v65
v_accvgpr_write_b32 a2, v66
s_waitcnt lgkmcnt(10)
v_mfma_f32_32x32x16_bf16 v[48:63], a[148:151], v[64:67], 0
s_waitcnt lgkmcnt(6)
ds_read_b64_tr_b16 a[144:145], v27 offset:2048
ds_read_b64_tr_b16 a[146:147], v27 offset:2304
v_accvgpr_write_b32 a3, v67
v_accvgpr_write_b32 a4, v68
v_accvgpr_write_b32 a5, v69
v_mfma_f32_32x32x16_bf16 v[208:223], a[152:155], v[64:67], 0
buffer_load_dwordx4 v23, s[12:15], s41 offen offset:3072 lds
ds_read_b64_tr_b16 a[148:149], v27 offset:3072
ds_read_b64_tr_b16 a[150:151], v27 offset:3328
v_mfma_f32_32x32x16_bf16 v[224:239], a[156:159], v[64:67], 0
s_waitcnt lgkmcnt(6)
s_add_u32 m0, s35, 29440
ds_read_b64_tr_b16 a[152:153], v27 offset:4096
ds_read_b64_tr_b16 a[154:155], v27 offset:4352
v_accvgpr_write_b32 a6, v70
v_accvgpr_write_b32 a7, v71
v_accvgpr_write_b32 a8, v72
v_mfma_f32_32x32x16_bf16 v[240:255], a[160:163], v[64:67], 0
ds_read_b64_tr_b16 a[156:157], v28 offset:0
ds_read_b64_tr_b16 a[158:159], v28 offset:256
v_accvgpr_write_b32 a9, v73
v_accvgpr_write_b32 a10, v74
v_accvgpr_write_b32 a11, v75
v_mfma_f32_32x32x16_bf16 v[32:47], a[164:167], v[68:71], v[32:47]
s_waitcnt lgkmcnt(6)
buffer_load_dwordx4 v24, s[12:15], s41 offen offset:256 lds
ds_read_b64_tr_b16 a[160:161], v28 offset:1024
ds_read_b64_tr_b16 a[162:163], v28 offset:1280
v_mfma_f32_32x32x16_bf16 v[48:63], a[168:171], v[68:71], v[48:63]
s_add_u32 m0, s35, 30720
ds_read_b64_tr_b16 a[164:165], v28 offset:2048
ds_read_b64_tr_b16 a[166:167], v28 offset:2304
v_accvgpr_write_b32 a12, v76
v_accvgpr_write_b32 a13, v77
v_accvgpr_write_b32 a14, v78
v_mfma_f32_32x32x16_bf16 v[208:223], a[144:147], v[68:71], v[208:223]
s_waitcnt lgkmcnt(6)
s_add_u32 s41, s38, 222336
ds_read_b64_tr_b16 a[168:169], v28 offset:3072
ds_read_b64_tr_b16 a[170:171], v28 offset:3328
v_accvgpr_write_b32 a15, v79
v_accvgpr_write_b32 a16, v80
v_accvgpr_write_b32 a17, v81
v_mfma_f32_32x32x16_bf16 v[224:239], a[148:151], v[68:71], v[224:239]
buffer_load_dwordx4 v20, s[12:15], s41 offen offset:0 lds
ds_read_b64_tr_b16 a[144:145], v28 offset:4096
ds_read_b64_tr_b16 a[146:147], v28 offset:4352
v_mfma_f32_32x32x16_bf16 v[240:255], a[152:155], v[68:71], v[240:255]
s_waitcnt lgkmcnt(6)
ds_read_b64_tr_b16 a[148:149], v29 offset:0
ds_read_b64_tr_b16 a[150:151], v29 offset:256
v_accvgpr_write_b32 a18, v82
v_accvgpr_write_b32 a19, v83
v_accvgpr_write_b32 a20, v84
s_waitcnt vmcnt(22)
s_barrier
v_mfma_f32_32x32x16_bf16 v[32:47], a[156:159], v[72:75], v[32:47]
ds_read_b64_tr_b16 a[152:153], v29 offset:1024
ds_read_b64_tr_b16 a[154:155], v29 offset:1280
v_accvgpr_write_b32 a21, v85
v_accvgpr_write_b32 a22, v86
v_accvgpr_write_b32 a23, v87
v_mfma_f32_32x32x16_bf16 v[48:63], a[160:163], v[72:75], v[48:63]
s_waitcnt lgkmcnt(6)
buffer_load_dwordx4 v21, s[12:15], s41 offen offset:1024 lds
ds_read_b64_tr_b16 a[156:157], v29 offset:2048
ds_read_b64_tr_b16 a[158:159], v29 offset:2304
v_mfma_f32_32x32x16_bf16 v[208:223], a[164:167], v[72:75], v[208:223]
ds_read_b64_tr_b16 a[160:161], v29 offset:3072
ds_read_b64_tr_b16 a[162:163], v29 offset:3328
v_lshlrev_b32 v70, 2, v0
v_accvgpr_write_b32 a24, v88
v_accvgpr_write_b32 a25, v89
v_mfma_f32_32x32x16_bf16 v[224:239], a[168:171], v[72:75], v[224:239]
s_waitcnt lgkmcnt(6)
s_mul_i32 s63, s34, 5184
ds_read_b64_tr_b16 a[164:165], v29 offset:4096
ds_read_b64_tr_b16 a[166:167], v29 offset:4352
v_accvgpr_write_b32 a26, v90
v_accvgpr_write_b32 a27, v91
v_accvgpr_write_b32 a28, v92
v_mfma_f32_32x32x16_bf16 v[240:255], a[144:147], v[72:75], v[240:255]
buffer_load_dword v64, v70, s[24:27], s63 offen offset:0
ds_read_b64_tr_b16 a[168:169], v26 offset:5120
ds_read_b64_tr_b16 a[170:171], v26 offset:5376
v_mfma_f32_32x32x16_bf16 v[32:47], a[148:151], v[76:79], v[32:47]
s_waitcnt lgkmcnt(6)
ds_read_b64_tr_b16 a[144:145], v26 offset:6144
ds_read_b64_tr_b16 a[146:147], v26 offset:6400
v_accvgpr_write_b32 a29, v93
v_accvgpr_write_b32 a30, v94
v_accvgpr_write_b32 a31, v95
v_mfma_f32_32x32x16_bf16 v[48:63], a[152:155], v[76:79], v[48:63]
ds_read_b64_tr_b16 a[148:149], v26 offset:7168
ds_read_b64_tr_b16 a[150:151], v26 offset:7424
v_accvgpr_write_b32 a32, v96
v_accvgpr_write_b32 a33, v97
v_accvgpr_write_b32 a34, v98
v_mfma_f32_32x32x16_bf16 v[208:223], a[156:159], v[76:79], v[208:223]
s_waitcnt lgkmcnt(6)
buffer_load_dword v65, v70, s[24:27], s63 offen offset:1024
ds_read_b64_tr_b16 a[152:153], v26 offset:8192
ds_read_b64_tr_b16 a[154:155], v26 offset:8448
v_mfma_f32_32x32x16_bf16 v[224:239], a[160:163], v[76:79], v[224:239]
ds_read_b64_tr_b16 a[156:157], v26 offset:9216
ds_read_b64_tr_b16 a[158:159], v26 offset:9472
v_accvgpr_write_b32 a35, v99
v_accvgpr_write_b32 a36, v100
v_accvgpr_write_b32 a37, v101
v_mfma_f32_32x32x16_bf16 v[240:255], a[164:167], v[76:79], v[240:255]
s_waitcnt lgkmcnt(6)
ds_read_b64_tr_b16 a[160:161], v27 offset:5120
ds_read_b64_tr_b16 a[162:163], v27 offset:5376
v_accvgpr_write_b32 a38, v102
v_accvgpr_write_b32 a39, v103
v_accvgpr_write_b32 a40, v104
v_mfma_f32_32x32x16_bf16 v[32:47], a[168:171], v[80:83], v[32:47]
buffer_load_dword v66, v70, s[24:27], s63 offen offset:2048
ds_read_b64_tr_b16 a[164:165], v27 offset:6144
ds_read_b64_tr_b16 a[166:167], v27 offset:6400
v_mfma_f32_32x32x16_bf16 v[48:63], a[144:147], v[80:83], v[48:63]
s_waitcnt lgkmcnt(6)
ds_read_b64_tr_b16 a[168:169], v27 offset:7168
ds_read_b64_tr_b16 a[170:171], v27 offset:7424
v_accvgpr_write_b32 a41, v105
v_accvgpr_write_b32 a42, v106
v_accvgpr_write_b32 a43, v107
v_mfma_f32_32x32x16_bf16 v[208:223], a[148:151], v[80:83], v[208:223]
ds_read_b64_tr_b16 a[144:145], v27 offset:8192
ds_read_b64_tr_b16 a[146:147], v27 offset:8448
v_accvgpr_write_b32 a44, v108
v_accvgpr_write_b32 a45, v109
v_accvgpr_write_b32 a46, v110
v_mfma_f32_32x32x16_bf16 v[224:239], a[152:155], v[80:83], v[224:239]
s_waitcnt lgkmcnt(6)
buffer_load_dword v67, v70, s[24:27], s63 offen offset:3072
ds_read_b64_tr_b16 a[148:149], v27 offset:9216
ds_read_b64_tr_b16 a[150:151], v27 offset:9472
v_mfma_f32_32x32x16_bf16 v[240:255], a[156:159], v[80:83], v[240:255]
s_add_u32 s63, s63, 4096
ds_read_b64_tr_b16 a[152:153], v28 offset:5120
ds_read_b64_tr_b16 a[154:155], v28 offset:5376
v_accvgpr_write_b32 a47, v111
v_accvgpr_write_b32 a48, v112
v_accvgpr_write_b32 a49, v113
v_mfma_f32_32x32x16_bf16 v[32:47], a[160:163], v[84:87], v[32:47]
s_waitcnt lgkmcnt(6)
ds_read_b64_tr_b16 a[156:157], v28 offset:6144
ds_read_b64_tr_b16 a[158:159], v28 offset:6400
v_accvgpr_write_b32 a50, v114
v_accvgpr_write_b32 a51, v115
v_accvgpr_write_b32 a52, v116
v_mfma_f32_32x32x16_bf16 v[48:63], a[164:167], v[84:87], v[48:63]
buffer_load_dword v68, v70, s[24:27], s63 offen offset:0
ds_read_b64_tr_b16 a[160:161], v28 offset:7168
ds_read_b64_tr_b16 a[162:163], v28 offset:7424
v_mfma_f32_32x32x16_bf16 v[208:223], a[168:171], v[84:87], v[208:223]
s_waitcnt lgkmcnt(6)
ds_read_b64_tr_b16 a[164:165], v28 offset:8192
ds_read_b64_tr_b16 a[166:167], v28 offset:8448
v_mov_b32 v72, 0
v_mov_b32 v73, 0
v_min_u32 v74, 44, v1
v_mfma_f32_32x32x16_bf16 v[224:239], a[144:147], v[84:87], v[224:239]
ds_read_b64_tr_b16 a[168:169], v28 offset:9216
ds_read_b64_tr_b16 a[170:171], v28 offset:9472
v_mul_u32_u24 v75, 52, v74
v_lshrrev_b32 v75, 8, v75
v_mul_u32_u24 v75, 720, v75
v_mfma_f32_32x32x16_bf16 v[240:255], a[148:151], v[84:87], v[240:255]
s_waitcnt lgkmcnt(6)
buffer_load_dword v69, v70, s[24:27], s63 offen offset:1024
ds_read_b64_tr_b16 a[144:145], v29 offset:5120
ds_read_b64_tr_b16 a[146:147], v29 offset:5376
s_waitcnt vmcnt(23)
s_barrier
v_mfma_f32_32x32x16_bf16 v[32:47], a[152:155], v[88:91], v[32:47]
ds_read_b64_tr_b16 a[148:149], v29 offset:6144
ds_read_b64_tr_b16 a[150:151], v29 offset:6400
v_lshl_add_u32 v75, v74, 3, v75
v_add_u32 v75, 147456, v75
ds_write_b64 v75, v[72:73]
v_mfma_f32_32x32x16_bf16 v[48:63], a[156:159], v[88:91], v[48:63]
s_waitcnt lgkmcnt(7)
ds_read_b64_tr_b16 a[152:153], v29 offset:7168
ds_read_b64_tr_b16 a[154:155], v29 offset:7424
v_add_u32 v74, 0, v0
v_mul_u32_u24 v75, 7282, v74
v_lshrrev_b32 v75, 16, v75
v_mfma_f32_32x32x16_bf16 v[208:223], a[160:163], v[88:91], v[208:223]
buffer_load_dwordx4 v22, s[12:15], s41 offen offset:2048 lds
ds_read_b64_tr_b16 a[156:157], v29 offset:8192
ds_read_b64_tr_b16 a[158:159], v29 offset:8448
v_mfma_f32_32x32x16_bf16 v[224:239], a[164:167], v[88:91], v[224:239]
s_waitcnt lgkmcnt(7)
ds_read_b64_tr_b16 a[160:161], v29 offset:9216
ds_read_b64_tr_b16 a[162:163], v29 offset:9472
v_mul_u32_u24 v76, 3641, v75
v_lshrrev_b32 v76, 16, v76
v_mul_u32_u24 v76, 40, v76
v_mfma_f32_32x32x16_bf16 v[240:255], a[168:171], v[88:91], v[240:255]
ds_read_b64_tr_b16 a[164:165], v26 offset:10240
ds_read_b64_tr_b16 a[166:167], v26 offset:10496
v_lshl_add_u32 v76, v75, 2, v76
v_lshl_add_u32 v76, v74, 2, v76
v_add_u32 v76, 147496, v76
v_mfma_f32_32x32x16_bf16 v[32:47], a[144:147], v[92:95], v[32:47]
s_waitcnt lgkmcnt(6)
buffer_load_dwordx4 v23, s[12:15], s41 offen offset:3072 lds
ds_read_b64_tr_b16 a[168:169], v26 offset:11264
ds_read_b64_tr_b16 a[170:171], v26 offset:11520
v_mfma_f32_32x32x16_bf16 v[48:63], a[148:151], v[92:95], v[48:63]
s_add_u32 m0, s35, 34560
ds_read_b64_tr_b16 a[144:145], v26 offset:12288
L_pad_a2_0:
s_cbranch_execz L_pad_a2_1
ds_read_b64_tr_b16 a[146:147], v26 offset:12544
v_add_u32 v74, 256, v0
v_mul_u32_u24 v75, 7282, v74
v_lshrrev_b32 v75, 16, v75
v_mfma_f32_32x32x16_bf16 v[208:223], a[152:155], v[92:95], v[208:223]
s_waitcnt lgkmcnt(6)
ds_read_b64_tr_b16 a[148:149], v26 offset:13312
ds_read_b64_tr_b16 a[150:151], v26 offset:13568
v_mul_u32_u24 v77, 3641, v75
v_lshrrev_b32 v77, 16, v77
v_mul_u32_u24 v77, 40, v77
v_mfma_f32_32x32x16_bf16 v[224:239], a[156:159], v[92:95], v[224:239]
buffer_load_dwordx4 v24, s[12:15], s41 offen offset:256 lds
ds_read_b64_tr_b16 a[152:153], v26 offset:14336
ds_read_b64_tr_b16 a[154:155], v26 offset:14592
v_mfma_f32_32x32x16_bf16 v[240:255], a[160:163], v[92:95], v[240:255]
s_waitcnt lgkmcnt(6)
s_add_u32 m0, s35, 0
ds_read_b64_tr_b16 a[156:157], v27 offset:10240
ds_read_b64_tr_b16 a[158:159], v27 offset:10496
v_lshl_add_u32 v77, v75, 2, v77
v_lshl_add_u32 v77, v74, 2, v77
v_add_u32 v77, 147496, v77
v_mfma_f32_32x32x16_bf16 v[32:47], a[164:167], v[96:99], v[32:47]
s_add_u32 s41, s38, 885888
ds_read_b64_tr_b16 a[160:161], v27 offset:11264
ds_read_b64_tr_b16 a[162:163], v27 offset:11520
v_add_u32 v74, 512, v0
v_mul_u32_u24 v75, 7282, v74
v_lshrrev_b32 v75, 16, v75
v_mfma_f32_32x32x16_bf16 v[48:63], a[168:171], v[96:99], v[48:63]
s_waitcnt lgkmcnt(6)
buffer_load_dwordx4 v20, s[12:15], s41 offen offset:0 lds
ds_read_b64_tr_b16 a[164:165], v27 offset:12288
ds_read_b64_tr_b16 a[166:167], v27 offset:12544
v_mfma_f32_32x32x16_bf16 v[208:223], a[144:147], v[96:99], v[208:223]
ds_read_b64_tr_b16 a[168:169], v27 offset:13312
ds_read_b64_tr_b16 a[170:171], v27 offset:13568
v_mul_u32_u24 v78, 3641, v75
v_lshrrev_b32 v78, 16, v78
v_mul_u32_u24 v78, 40, v78
v_mfma_f32_32x32x16_bf16 v[224:239], a[148:151], v[96:99], v[224:239]
s_waitcnt lgkmcnt(6)
ds_read_b64_tr_b16 a[144:145], v27 offset:14336
ds_read_b64_tr_b16 a[146:147], v27 offset:14592
v_lshl_add_u32 v78, v75, 2, v78
v_lshl_add_u32 v78, v74, 2, v78
v_add_u32 v78, 147496, v78
v_mfma_f32_32x32x16_bf16 v[240:255], a[152:155], v[96:99], v[240:255]
buffer_load_dwordx4 v21, s[12:15], s41 offen offset:1024 lds
ds_read_b64_tr_b16 a[148:149], v28 offset:10240
ds_read_b64_tr_b16 a[150:151], v28 offset:10496
v_mfma_f32_32x32x16_bf16 v[32:47], a[156:159], v[100:103], v[32:47]
s_waitcnt lgkmcnt(6)
ds_read_b64_tr_b16 a[152:153], v28 offset:11264
ds_read_b64_tr_b16 a[154:155], v28 offset:11520
v_add_u32 v74, 768, v0
v_mul_u32_u24 v75, 7282, v74
v_lshrrev_b32 v75, 16, v75
v_mfma_f32_32x32x16_bf16 v[48:63], a[160:163], v[100:103], v[48:63]
ds_read_b64_tr_b16 a[156:157], v28 offset:12288
ds_read_b64_tr_b16 a[158:159], v28 offset:12544
v_mul_u32_u24 v79, 3641, v75
v_lshrrev_b32 v79, 16, v79
v_mul_u32_u24 v79, 40, v79
v_mfma_f32_32x32x16_bf16 v[208:223], a[164:167], v[100:103], v[208:223]
s_waitcnt lgkmcnt(6)
buffer_load_dwordx4 v22, s[12:15], s41 offen offset:2048 lds
ds_read_b64_tr_b16 a[160:161], v28 offset:13312
ds_read_b64_tr_b16 a[162:163], v28 offset:13568
v_mfma_f32_32x32x16_bf16 v[224:239], a[168:171], v[100:103], v[224:239]
ds_read_b64_tr_b16 a[164:165], v28 offset:14336
ds_read_b64_tr_b16 a[166:167], v28 offset:14592
v_lshl_add_u32 v79, v75, 2, v79
v_lshl_add_u32 v79, v74, 2, v79
v_add_u32 v79, 147496, v79
v_mfma_f32_32x32x16_bf16 v[240:255], a[144:147], v[100:103], v[240:255]
s_waitcnt lgkmcnt(6)
ds_read_b64_tr_b16 a[168:169], v29 offset:10240
ds_read_b64_tr_b16 a[170:171], v29 offset:10496
v_add_u32 v74, 1024, v0
v_mul_u32_u24 v75, 7282, v74
v_lshrrev_b32 v75, 16, v75
s_waitcnt vmcnt(24)
s_barrier
v_mfma_f32_32x32x16_bf16 v[32:47], a[148:151], v[104:107], v[32:47]
buffer_load_dwordx4 v23, s[12:15], s41 offen offset:3072 lds
ds_read_b64_tr_b16 a[144:145], v29 offset:11264
ds_read_b64_tr_b16 a[146:147], v29 offset:11520
v_mfma_f32_32x32x16_bf16 v[48:63], a[152:155], v[104:107], v[48:63]
s_waitcnt lgkmcnt(6)
s_add_u32 m0, s35, 3840
ds_read_b64_tr_b16 a[148:149], v29 offset:12288
ds_read_b64_tr_b16 a[150:151], v29 offset:12544
v_mul_u32_u24 v80, 3641, v75
v_lshrrev_b32 v80, 16, v80
v_mul_u32_u24 v80, 40, v80
v_mfma_f32_32x32x16_bf16 v[208:223], a[156:159], v[104:107], v[208:223]
ds_read_b64_tr_b16 a[152:153], v29 offset:13312
ds_read_b64_tr_b16 a[154:155], v29 offset:13568
v_mov_b32 v96, -1
v_mov_b32 v97, -1
v_mov_b32 v98, -1
v_mfma_f32_32x32x16_bf16 v[224:239], a[160:163], v[104:107], v[224:239]
s_waitcnt lgkmcnt(6)
buffer_load_dwordx4 v24, s[12:15], s41 offen offset:256 lds
ds_read_b64_tr_b16 a[156:157], v29 offset:14336
ds_read_b64_tr_b16 a[158:159], v29 offset:14592
v_mfma_f32_32x32x16_bf16 v[240:255], a[164:167], v[104:107], v[240:255]
s_add_u32 m0, s35, 5120
ds_read_b64_tr_b16 a[160:161], v26 offset:15360
ds_read_b64_tr_b16 a[162:163], v26 offset:15616
v_mov_b32 v99, -1
v_and_b32 v101, 31, v1
v_min_u32 v101, 22, v101
v_mfma_f32_32x32x16_bf16 v[32:47], a[168:171], v[108:111], v[32:47]
s_waitcnt lgkmcnt(6)
s_add_u32 s41, s38, 1549440
ds_read_b64_tr_b16 a[164:165], v26 offset:16384
ds_read_b64_tr_b16 a[166:167], v26 offset:16640
v_add_u32 v101, s76, v101
v_min_u32 v101, 89, v101
v_lshlrev_b32 v100, 3, v101
v_mfma_f32_32x32x16_bf16 v[48:63], a[144:147], v[108:111], v[48:63]
buffer_store_dwordx4 v[96:99], v19, s[20:23], s72 offen offset:0 sc1
ds_read_b64_tr_b16 a[168:169], v26 offset:17408
ds_read_b64_tr_b16 a[170:171], v26 offset:17664
v_mfma_f32_32x32x16_bf16 v[208:223], a[148:151], v[108:111], v[208:223]
s_waitcnt lgkmcnt(6)
ds_read_b64_tr_b16 a[144:145], v26 offset:18432
ds_read_b64_tr_b16 a[146:147], v26 offset:18688
v_lshl_add_u32 v80, v75, 2, v80
v_lshl_add_u32 v80, v74, 2, v80
v_add_u32 v80, 147496, v80
v_mfma_f32_32x32x16_bf16 v[224:239], a[152:155], v[108:111], v[224:239]
ds_read_b64_tr_b16 a[148:149], v26 offset:19456
ds_read_b64_tr_b16 a[150:151], v26 offset:19712
v_add_u32 v74, 1280, v0
v_mul_u32_u24 v75, 7282, v74
v_lshrrev_b32 v75, 16, v75
v_mfma_f32_32x32x16_bf16 v[240:255], a[156:159], v[108:111], v[240:255]
s_waitcnt lgkmcnt(6)
buffer_store_dwordx4 v[96:99], v19, s[20:23], s73 offen offset:0 sc1
ds_read_b64_tr_b16 a[152:153], v27 offset:15360
ds_read_b64_tr_b16 a[154:155], v27 offset:15616
v_mfma_f32_32x32x16_bf16 v[32:47], a[160:163], v[112:115], v[32:47]
ds_read_b64_tr_b16 a[156:157], v27 offset:16384
ds_read_b64_tr_b16 a[158:159], v27 offset:16640
v_mul_u32_u24 v81, 3641, v75
v_lshrrev_b32 v81, 16, v81
v_mul_u32_u24 v81, 40, v81
v_lshl_add_u32 v81, v75, 2, v81
v_mfma_f32_32x32x16_bf16 v[48:63], a[164:167], v[112:115], v[48:63]
s_waitcnt lgkmcnt(6)
ds_read_b64_tr_b16 a[160:161], v27 offset:17408
ds_read_b64_tr_b16 a[162:163], v27 offset:17664
v_lshl_add_u32 v81, v74, 2, v81
v_add_u32 v81, 147496, v81
v_bfe_u32 v84, v1, 2, 2
v_lshl_add_u32 v84, v2, 2, v84
v_mfma_f32_32x32x16_bf16 v[208:223], a[168:171], v[112:115], v[208:223]
buffer_store_dwordx4 v[96:99], v19, s[20:23], s72 offen offset:1024 sc1
ds_read_b64_tr_b16 a[164:165], v27 offset:18432
ds_read_b64_tr_b16 a[166:167], v27 offset:18688
v_mfma_f32_32x32x16_bf16 v[224:239], a[144:147], v[112:115], v[224:239]
s_waitcnt lgkmcnt(6)
ds_read_b64_tr_b16 a[168:169], v27 offset:19456
ds_read_b64_tr_b16 a[170:171], v27 offset:19712
v_bfe_u32 v85, v1, 4, 1
v_bfe_u32 v87, v1, 1, 1
v_lshl_add_u32 v85, v85, 1, v87
v_and_b32 v86, 1, v1
v_mfma_f32_32x32x16_bf16 v[240:255], a[148:151], v[112:115], v[240:255]
ds_read_b64_tr_b16 a[144:145], v28 offset:15360
ds_read_b64_tr_b16 a[146:147], v28 offset:15616
v_mul_u32_u24 v87, 18, v86
v_sub_u32 v88, v84, v87
v_mul_u32_u24 v89, 760, v86
v_mfma_f32_32x32x16_bf16 v[32:47], a[152:155], v[116:119], v[32:47]
s_waitcnt lgkmcnt(6)
buffer_store_dwordx4 v[96:99], v19, s[20:23], s73 offen offset:1024 sc1
ds_read_b64_tr_b16 a[148:149], v28 offset:16384
ds_read_b64_tr_b16 a[150:151], v28 offset:16640
v_mfma_f32_32x32x16_bf16 v[48:63], a[156:159], v[116:119], v[48:63]
ds_read_b64_tr_b16 a[152:153], v28 offset:17408
ds_read_b64_tr_b16 a[154:155], v28 offset:17664
v_lshl_add_u32 v89, v85, 3, v89
v_add_u32 v89, 147496, v89
v_lshl_add_u32 v87, v85, 1, v86
v_mul_u32_u24 v90, 18, v87
v_mfma_f32_32x32x16_bf16 v[208:223], a[160:163], v[116:119], v[208:223]
s_waitcnt lgkmcnt(6)
ds_read_b64_tr_b16 a[156:157], v28 offset:18432
ds_read_b64_tr_b16 a[158:159], v28 offset:18688
v_sub_u32 v90, v84, v90
v_mul_u32_u24 v91, 760, v87
v_add_u32 v91, 147528, v91
v_accvgpr_write_b32 a53, v117
v_mfma_f32_32x32x16_bf16 v[224:239], a[164:167], v[116:119], v[224:239]
buffer_store_dwordx4 v[96:99], v19, s[20:23], s72 offen offset:1856 sc1
ds_read_b64_tr_b16 a[160:161], v28 offset:19456
ds_read_b64_tr_b16 a[162:163], v28 offset:19712
v_mfma_f32_32x32x16_bf16 v[240:255], a[168:171], v[116:119], v[240:255]
s_waitcnt lgkmcnt(6)
ds_read_b64_tr_b16 a[164:165], v29 offset:15360
ds_read_b64_tr_b16 a[166:167], v29 offset:15616
v_accvgpr_write_b32 a54, v118
v_accvgpr_write_b32 a55, v119
v_accvgpr_write_b32 a56, v120
v_accvgpr_write_b32 a57, v121
s_waitcnt vmcnt(26)
s_barrier
v_mfma_f32_32x32x16_bf16 v[32:47], a[144:147], v[120:123], v[32:47]
ds_read_b64_tr_b16 a[168:169], v29 offset:16384
ds_read_b64_tr_b16 a[170:171], v29 offset:16640
v_accvgpr_write_b32 a58, v122
v_accvgpr_write_b32 a59, v123
v_accvgpr_write_b32 a60, v124
v_accvgpr_write_b32 a61, v125
v_mfma_f32_32x32x16_bf16 v[48:63], a[148:151], v[120:123], v[48:63]
s_waitcnt lgkmcnt(6)
buffer_store_dwordx4 v[96:99], v19, s[20:23], s73 offen offset:1856 sc1
ds_read_b64_tr_b16 a[144:145], v29 offset:17408
ds_read_b64_tr_b16 a[146:147], v29 offset:17664
v_mfma_f32_32x32x16_bf16 v[208:223], a[152:155], v[120:123], v[208:223]
ds_read_b64_tr_b16 a[148:149], v29 offset:18432
ds_read_b64_tr_b16 a[150:151], v29 offset:18688
v_accvgpr_write_b32 a62, v126
v_accvgpr_write_b32 a63, v127
v_accvgpr_write_b32 a64, v128
v_accvgpr_write_b32 a65, v129
v_mfma_f32_32x32x16_bf16 v[224:239], a[156:159], v[120:123], v[224:239]
s_waitcnt lgkmcnt(6)
ds_read_b64_tr_b16 a[152:153], v29 offset:19456
ds_read_b64_tr_b16 a[154:155], v29 offset:19712
s_waitcnt vmcnt(19)
ds_write_b32 v76, v64
s_waitcnt vmcnt(18)
ds_write_b32 v77, v65
s_waitcnt vmcnt(17)
ds_write_b32 v78, v66
s_waitcnt vmcnt(16)
ds_write_b32 v79, v67
v_mfma_f32_32x32x16_bf16 v[240:255], a[160:163], v[120:123], v[240:255]
buffer_store_dwordx2 v[96:97], v100, s[20:23], s74 offen sc1
ds_read_b64_tr_b16 a[156:157], v26 offset:20480
ds_read_b64_tr_b16 a[158:159], v26 offset:20736
v_mfma_f32_32x32x16_bf16 v[32:47], a[164:167], v[124:127], v[32:47]
s_waitcnt lgkmcnt(10)
ds_read_b64_tr_b16 a[160:161], v26 offset:21504
ds_read_b64_tr_b16 a[162:163], v26 offset:21760
s_waitcnt vmcnt(16)
ds_write_b32 v80, v68
s_waitcnt vmcnt(15)
ds_write_b32 v81, v69
v_accvgpr_write_b32 a66, v130
v_accvgpr_write_b32 a67, v131
v_mfma_f32_32x32x16_bf16 v[48:63], a[168:171], v[124:127], v[48:63]
ds_read_b64_tr_b16 a[164:165], v26 offset:22528
ds_read_b64_tr_b16 a[166:167], v26 offset:22784
v_accvgpr_write_b32 a68, v132
v_accvgpr_write_b32 a69, v133
v_accvgpr_write_b32 a70, v134
v_accvgpr_write_b32 a71, v135
v_mfma_f32_32x32x16_bf16 v[208:223], a[144:147], v[124:127], v[208:223]
s_waitcnt lgkmcnt(12)
buffer_load_dwordx4 v20, s[12:15], s41 offen offset:0 lds
ds_read_b64_tr_b16 a[168:169], v26 offset:23552
ds_read_b64_tr_b16 a[170:171], v26 offset:23808
v_mfma_f32_32x32x16_bf16 v[224:239], a[148:151], v[124:127], v[224:239]
ds_read_b64_tr_b16 a[144:145], v26 offset:24576
ds_read_b64_tr_b16 a[146:147], v26 offset:24832
v_accvgpr_write_b32 a72, v136
v_accvgpr_write_b32 a73, v137
v_accvgpr_write_b32 a74, v138
v_accvgpr_write_b32 a75, v139
v_mfma_f32_32x32x16_bf16 v[240:255], a[152:155], v[124:127], v[240:255]
s_waitcnt lgkmcnt(8)
ds_read_b64_tr_b16 a[148:149], v27 offset:20480
ds_read_b64_tr_b16 a[150:151], v27 offset:20736
v_accvgpr_write_b32 a76, v140
v_accvgpr_write_b32 a77, v141
v_accvgpr_write_b32 a78, v142
v_accvgpr_write_b32 a79, v143
v_mfma_f32_32x32x16_bf16 v[32:47], a[156:159], v[128:131], v[32:47]
buffer_load_dwordx4 v21, s[12:15], s41 offen offset:1024 lds
ds_read_b64_tr_b16 a[152:153], v27 offset:21504
ds_read_b64_tr_b16 a[154:155], v27 offset:21760
v_mfma_f32_32x32x16_bf16 v[48:63], a[160:163], v[128:131], v[48:63]
s_waitcnt lgkmcnt(6)
ds_read_b64_tr_b16 a[156:157], v27 offset:22528
ds_read_b64_tr_b16 a[158:159], v27 offset:22784
v_accvgpr_write_b32 a80, v144
v_accvgpr_write_b32 a81, v145
v_accvgpr_write_b32 a82, v146
v_accvgpr_write_b32 a83, v147
v_mfma_f32_32x32x16_bf16 v[208:223], a[164:167], v[128:131], v[208:223]
ds_read_b64_tr_b16 a[160:161], v27 offset:23552
ds_read_b64_tr_b16 a[162:163], v27 offset:23808
v_accvgpr_write_b32 a84, v148
v_accvgpr_write_b32 a85, v149
v_accvgpr_write_b32 a86, v150
v_accvgpr_write_b32 a87, v151
v_mfma_f32_32x32x16_bf16 v[224:239], a[168:171], v[128:131], v[224:239]
s_waitcnt lgkmcnt(6)
buffer_load_dwordx4 v22, s[12:15], s41 offen offset:2048 lds
ds_read_b64_tr_b16 a[164:165], v27 offset:24576
ds_read_b64_tr_b16 a[166:167], v27 offset:24832
v_mfma_f32_32x32x16_bf16 v[240:255], a[144:147], v[128:131], v[240:255]
ds_read_b64_tr_b16 a[168:169], v28 offset:20480
ds_read_b64_tr_b16 a[170:171], v28 offset:20736
v_accvgpr_write_b32 a88, v152
v_accvgpr_write_b32 a89, v153
v_accvgpr_write_b32 a90, v154
v_accvgpr_write_b32 a91, v155
v_mfma_f32_32x32x16_bf16 v[32:47], a[148:151], v[132:135], v[32:47]
s_waitcnt lgkmcnt(6)
ds_read_b64_tr_b16 a[144:145], v28 offset:21504
ds_read_b64_tr_b16 a[146:147], v28 offset:21760
v_accvgpr_write_b32 a92, v156
v_accvgpr_write_b32 a93, v157
v_accvgpr_write_b32 a94, v158
v_accvgpr_write_b32 a95, v159
v_mfma_f32_32x32x16_bf16 v[48:63], a[152:155], v[132:135], v[48:63]
buffer_load_dwordx4 v23, s[12:15], s41 offen offset:3072 lds
ds_read_b64_tr_b16 a[148:149], v28 offset:22528
ds_read_b64_tr_b16 a[150:151], v28 offset:22784
v_mfma_f32_32x32x16_bf16 v[208:223], a[156:159], v[132:135], v[208:223]
s_waitcnt lgkmcnt(6)
s_add_u32 m0, s35, 8960
ds_read_b64_tr_b16 a[152:153], v28 offset:23552
ds_read_b64_tr_b16 a[154:155], v28 offset:23808
v_accvgpr_write_b32 a96, v160
v_accvgpr_write_b32 a97, v161
v_accvgpr_write_b32 a98, v162
v_accvgpr_write_b32 a99, v163
v_accvgpr_write_b32 a100, v164
v_mfma_f32_32x32x16_bf16 v[224:239], a[160:163], v[132:135], v[224:239]
ds_read_b64_tr_b16 a[156:157], v28 offset:24576
ds_read_b64_tr_b16 a[158:159], v28 offset:24832
v_accvgpr_write_b32 a101, v165
v_accvgpr_write_b32 a102, v166
v_accvgpr_write_b32 a103, v167
v_accvgpr_write_b32 a104, v168
v_accvgpr_write_b32 a105, v169
v_mfma_f32_32x32x16_bf16 v[240:255], a[164:167], v[132:135], v[240:255]
s_waitcnt lgkmcnt(6)
buffer_load_dwordx4 v24, s[12:15], s41 offen offset:256 lds
ds_read_b64_tr_b16 a[160:161], v29 offset:20480
ds_read_b64_tr_b16 a[162:163], v29 offset:20736
s_barrier
v_mfma_f32_32x32x16_bf16 v[32:47], a[168:171], v[136:139], v[32:47]
s_add_u32 m0, s35, 20480
ds_read_b64_tr_b16 a[164:165], v29 offset:21504
ds_read_b64_tr_b16 a[166:167], v29 offset:21760
v_accvgpr_write_b32 a106, v170
v_accvgpr_write_b32 a107, v171
v_accvgpr_write_b32 a108, v172
v_accvgpr_write_b32 a109, v173
v_accvgpr_write_b32 a110, v174
v_mfma_f32_32x32x16_bf16 v[48:63], a[144:147], v[136:139], v[48:63]
s_waitcnt lgkmcnt(6)
s_add_u32 s41, s38, 444704
ds_read_b64_tr_b16 a[168:169], v29 offset:22528
ds_read_b64_tr_b16 a[170:171], v29 offset:22784
v_accvgpr_write_b32 a111, v175
v_accvgpr_write_b32 a112, v176
v_accvgpr_write_b32 a113, v177
v_accvgpr_write_b32 a114, v178
v_accvgpr_write_b32 a115, v179
v_mfma_f32_32x32x16_bf16 v[208:223], a[148:151], v[136:139], v[208:223]
ds_read_b64_tr_b16 a[144:145], v29 offset:23552
ds_read_b64_tr_b16 a[146:147], v29 offset:23808
v_accvgpr_write_b32 a116, v180
v_accvgpr_write_b32 a117, v181
v_accvgpr_write_b32 a118, v182
v_accvgpr_write_b32 a119, v183
v_mfma_f32_32x32x16_bf16 v[224:239], a[152:155], v[136:139], v[224:239]
s_waitcnt lgkmcnt(6)
ds_read_b64_tr_b16 a[148:149], v29 offset:24576
ds_read_b64_tr_b16 a[150:151], v29 offset:24832
v_accvgpr_write_b32 a120, v184
v_accvgpr_write_b32 a121, v185
v_accvgpr_write_b32 a122, v186
v_accvgpr_write_b32 a123, v187
v_accvgpr_write_b32 a124, v188
v_mfma_f32_32x32x16_bf16 v[240:255], a[156:159], v[136:139], v[240:255]
ds_read_b64_tr_b16 a[152:153], v26 offset:25600
ds_read_b64_tr_b16 a[154:155], v26 offset:25856
v_accvgpr_write_b32 a125, v189
v_accvgpr_write_b32 a126, v190
v_accvgpr_write_b32 a127, v191
v_accvgpr_write_b32 a128, v192
v_mfma_f32_32x32x16_bf16 v[32:47], a[160:163], v[140:143], v[32:47]
s_waitcnt lgkmcnt(6)
ds_read_b64_tr_b16 a[156:157], v26 offset:26624
ds_read_b64_tr_b16 a[158:159], v26 offset:26880
v_accvgpr_write_b32 a129, v193
v_accvgpr_write_b32 a130, v194
v_accvgpr_write_b32 a131, v195
v_accvgpr_write_b32 a132, v196
v_accvgpr_write_b32 a133, v197
v_mfma_f32_32x32x16_bf16 v[48:63], a[164:167], v[140:143], v[48:63]
ds_read_b64_tr_b16 a[160:161], v26 offset:27648
ds_read_b64_tr_b16 a[162:163], v26 offset:27904
v_accvgpr_write_b32 a134, v198
v_accvgpr_write_b32 a135, v199
v_accvgpr_write_b32 a136, v200
v_mfma_f32_32x32x16_bf16 v[208:223], a[168:171], v[140:143], v[208:223]
s_waitcnt lgkmcnt(6)
ds_read_b64_tr_b16 a[164:165], v26 offset:28672
ds_read_b64_tr_b16 a[166:167], v26 offset:28928
v_accvgpr_write_b32 a137, v201
v_accvgpr_write_b32 a138, v202
v_accvgpr_write_b32 a139, v203
v_mfma_f32_32x32x16_bf16 v[224:239], a[144:147], v[140:143], v[224:239]
ds_read_b64_tr_b16 a[168:169], v26 offset:29696
ds_read_b64_tr_b16 a[170:171], v26 offset:29952
v_accvgpr_write_b32 a140, v204
v_accvgpr_write_b32 a141, v205
v_accvgpr_write_b32 a142, v206
v_accvgpr_write_b32 a143, v207
v_mfma_f32_32x32x16_bf16 v[240:255], a[148:151], v[140:143], v[240:255]
s_waitcnt lgkmcnt(6)
ds_read_b64_tr_b16 a[144:145], v27 offset:25600
ds_read_b64_tr_b16 a[146:147], v27 offset:25856
v_add_u32 v92, 0, v88
v_med3_i32 v92, v92, -1, 18
v_mad_i32_i24 v92, v92, 40, v89
v_mfma_f32_32x32x16_bf16 v[32:47], a[152:155], v[144:147], v[32:47]
buffer_load_dword v8, off, s[28:31], s59 sc1
ds_read_b64_tr_b16 a[148:149], v27 offset:26624
ds_read_b64_tr_b16 a[150:151], v27 offset:26880
v_mfma_f32_32x32x16_bf16 v[48:63], a[156:159], v[144:147], v[48:63]
s_waitcnt lgkmcnt(6)
ds_read_b64_tr_b16 a[152:153], v27 offset:27648
ds_read_b64_tr_b16 a[154:155], v27 offset:27904
ds_read_b64_tr_b16 a[172:173], v92 offset:0
v_add_u32 v93, 8, v88
v_med3_i32 v93, v93, -1, 18
v_mfma_f32_32x32x16_bf16 v[208:223], a[160:163], v[144:147], v[208:223]
ds_read_b64_tr_b16 a[156:157], v27 offset:28672
ds_read_b64_tr_b16 a[158:159], v27 offset:28928
v_mad_i32_i24 v93, v93, 40, v89
ds_read_b64_tr_b16 a[174:175], v93 offset:0
v_add_u32 v94, 16, v88
v_mfma_f32_32x32x16_bf16 v[224:239], a[164:167], v[144:147], v[224:239]
s_waitcnt lgkmcnt(8)
ds_read_b64_tr_b16 a[160:161], v27 offset:29696
ds_read_b64_tr_b16 a[162:163], v27 offset:29952
v_med3_i32 v94, v94, -1, 18
v_mad_i32_i24 v94, v94, 40, v89
ds_read_b64_tr_b16 a[176:177], v94 offset:0
v_mfma_f32_32x32x16_bf16 v[240:255], a[168:171], v[144:147], v[240:255]
ds_read_b64_tr_b16 a[164:165], v28 offset:25600
ds_read_b64_tr_b16 a[166:167], v28 offset:25856
v_add_u32 v95, 24, v88
v_med3_i32 v95, v95, -1, 18
v_mad_i32_i24 v95, v95, 40, v89
v_mfma_f32_32x32x16_bf16 v[32:47], a[144:147], v[148:151], v[32:47]
s_waitcnt lgkmcnt(9)
ds_read_b64_tr_b16 a[168:169], v28 offset:26624
ds_read_b64_tr_b16 a[170:171], v28 offset:26880
ds_read_b64_tr_b16 a[178:179], v95 offset:0
v_add_u32 v92, 32, v88
v_med3_i32 v92, v92, -1, 18
v_mfma_f32_32x32x16_bf16 v[48:63], a[148:151], v[148:151], v[48:63]
ds_read_b64_tr_b16 a[144:145], v28 offset:27648
ds_read_b64_tr_b16 a[146:147], v28 offset:27904
v_mad_i32_i24 v92, v92, 40, v89
ds_read_b64_tr_b16 a[180:181], v92 offset:0
v_add_u32 v93, 40, v88
v_mfma_f32_32x32x16_bf16 v[208:223], a[152:155], v[148:151], v[208:223]
s_waitcnt lgkmcnt(9)
ds_read_b64_tr_b16 a[148:149], v28 offset:28672
ds_read_b64_tr_b16 a[150:151], v28 offset:28928
v_med3_i32 v93, v93, -1, 18
v_mad_i32_i24 v93, v93, 40, v89
ds_read_b64_tr_b16 a[182:183], v93 offset:0
v_mfma_f32_32x32x16_bf16 v[224:239], a[156:159], v[148:151], v[224:239]
ds_read_b64_tr_b16 a[152:153], v28 offset:29696
ds_read_b64_tr_b16 a[154:155], v28 offset:29952
v_subrev_u32 v94, 4, v88
v_med3_i32 v94, v94, -1, 18
v_mad_i32_i24 v94, v94, 40, v89
v_mfma_f32_32x32x16_bf16 v[240:255], a[160:163], v[148:151], v[240:255]
s_waitcnt lgkmcnt(9)
ds_read_b64_tr_b16 a[156:157], v29 offset:25600
ds_read_b64_tr_b16 a[158:159], v29 offset:25856
ds_read_b64_tr_b16 a[184:185], v94 offset:1520
v_add_u32 v95, 4, v88
v_med3_i32 v95, v95, -1, 18
s_waitcnt vmcnt(18)
s_barrier
v_mfma_f32_32x32x16_bf16 v[32:47], a[164:167], v[152:155], v[32:47]
buffer_load_dwordx4 v20, s[12:15], s41 offen offset:0 lds
ds_read_b64_tr_b16 a[160:161], v29 offset:26624
ds_read_b64_tr_b16 a[162:163], v29 offset:26880
v_mfma_f32_32x32x16_bf16 v[48:63], a[168:171], v[152:155], v[48:63]
s_waitcnt lgkmcnt(8)
ds_read_b64_tr_b16 a[164:165], v29 offset:27648
ds_read_b64_tr_b16 a[166:167], v29 offset:27904
v_mad_i32_i24 v95, v95, 40, v89
ds_read_b64_tr_b16 a[186:187], v95 offset:1520
v_add_u32 v92, 12, v88
v_mfma_f32_32x32x16_bf16 v[208:223], a[144:147], v[152:155], v[208:223]
ds_read_b64_tr_b16 a[168:169], v29 offset:28672
ds_read_b64_tr_b16 a[170:171], v29 offset:28928
v_med3_i32 v92, v92, -1, 18
v_mad_i32_i24 v92, v92, 40, v89
ds_read_b64_tr_b16 a[188:189], v92 offset:1520
v_mfma_f32_32x32x16_bf16 v[224:239], a[148:151], v[152:155], v[224:239]
s_waitcnt lgkmcnt(9)
buffer_load_dwordx4 v21, s[12:15], s41 offen offset:1024 lds
ds_read_b64_tr_b16 a[144:145], v29 offset:29696
ds_read_b64_tr_b16 a[146:147], v29 offset:29952
v_mfma_f32_32x32x16_bf16 v[240:255], a[152:155], v[152:155], v[240:255]
ds_read_b64_tr_b16 a[148:149], v26 offset:30720
ds_read_b64_tr_b16 a[150:151], v26 offset:30976
v_add_u32 v93, 20, v88
v_med3_i32 v93, v93, -1, 18
v_mad_i32_i24 v93, v93, 40, v89
v_mfma_f32_32x32x16_bf16 v[32:47], a[156:159], v[156:159], v[32:47]
s_waitcnt lgkmcnt(8)
ds_read_b64_tr_b16 a[152:153], v26 offset:31744
ds_read_b64_tr_b16 a[154:155], v26 offset:32000
ds_read_b64_tr_b16 a[190:191], v93 offset:1520
v_add_u32 v94, 28, v88
v_med3_i32 v94, v94, -1, 18
v_mfma_f32_32x32x16_bf16 v[48:63], a[160:163], v[156:159], v[48:63]
buffer_load_dwordx4 v22, s[12:15], s41 offen offset:2048 lds
ds_read_b64_tr_b16 a[156:157], v26 offset:32768
ds_read_b64_tr_b16 a[158:159], v26 offset:33024
v_mfma_f32_32x32x16_bf16 v[208:223], a[164:167], v[156:159], v[208:223]
s_waitcnt lgkmcnt(7)
ds_read_b64_tr_b16 a[160:161], v26 offset:33792
ds_read_b64_tr_b16 a[162:163], v26 offset:34048
v_mad_i32_i24 v94, v94, 40, v89
ds_read_b64_tr_b16 a[192:193], v94 offset:1520
v_add_u32 v95, 36, v88
v_mfma_f32_32x32x16_bf16 v[224:239], a[168:171], v[156:159], v[224:239]
ds_read_b64_tr_b16 a[164:165], v26 offset:34816
ds_read_b64_tr_b16 a[166:167], v26 offset:35072
v_med3_i32 v95, v95, -1, 18
v_mad_i32_i24 v95, v95, 40, v89
ds_read_b64_tr_b16 a[194:195], v95 offset:1520
v_mfma_f32_32x32x16_bf16 v[240:255], a[144:147], v[156:159], v[240:255]
s_waitcnt lgkmcnt(9)
buffer_load_dwordx4 v23, s[12:15], s41 offen offset:3072 lds
ds_read_b64_tr_b16 a[168:169], v27 offset:30720
ds_read_b64_tr_b16 a[170:171], v27 offset:30976
v_mfma_f32_32x32x16_bf16 v[32:47], a[148:151], v[160:163], v[32:47]
s_add_u32 m0, s35, 24576
ds_read_b64_tr_b16 a[144:145], v27 offset:31744
ds_read_b64_tr_b16 a[146:147], v27 offset:32000
v_subrev_u32 v92, 8, v88
v_med3_i32 v92, v92, -1, 18
v_mad_i32_i24 v92, v92, 40, v89
v_mfma_f32_32x32x16_bf16 v[48:63], a[152:155], v[160:163], v[48:63]
s_waitcnt lgkmcnt(8)
s_add_u32 s41, s38, 1108256
L_pad_a3_0:
s_cbranch_execz L_pad_a3_1
ds_read_b64_tr_b16 a[148:149], v27 offset:32768
ds_read_b64_tr_b16 a[150:151], v27 offset:33024
ds_read_b64_tr_b16 a[196:197], v92 offset:3040
v_add_u32 v93, 0, v88
v_med3_i32 v93, v93, -1, 18
v_mfma_f32_32x32x16_bf16 v[208:223], a[156:159], v[160:163], v[208:223]
ds_read_b64_tr_b16 a[152:153], v27 offset:33792
ds_read_b64_tr_b16 a[154:155], v27 offset:34048
v_mad_i32_i24 v93, v93, 40, v89
ds_read_b64_tr_b16 a[198:199], v93 offset:3040
v_add_u32 v94, 8, v88
v_mfma_f32_32x32x16_bf16 v[224:239], a[160:163], v[160:163], v[224:239]
s_waitcnt lgkmcnt(8)
ds_read_b64_tr_b16 a[156:157], v27 offset:34816
ds_read_b64_tr_b16 a[158:159], v27 offset:35072
v_med3_i32 v94, v94, -1, 18
v_mad_i32_i24 v94, v94, 40, v89
ds_read_b64_tr_b16 a[200:201], v94 offset:3040
v_mfma_f32_32x32x16_bf16 v[240:255], a[164:167], v[160:163], v[240:255]
ds_read_b64_tr_b16 a[160:161], v28 offset:30720
ds_read_b64_tr_b16 a[162:163], v28 offset:30976
v_add_u32 v95, 16, v88
v_med3_i32 v95, v95, -1, 18
v_mad_i32_i24 v95, v95, 40, v89
v_mfma_f32_32x32x16_bf16 v[32:47], a[168:171], v[164:167], v[32:47]
s_waitcnt lgkmcnt(9)
ds_read_b64_tr_b16 a[164:165], v28 offset:31744
ds_read_b64_tr_b16 a[166:167], v28 offset:32000
ds_read_b64_tr_b16 a[202:203], v95 offset:3040
v_add_u32 v92, 24, v88
v_med3_i32 v92, v92, -1, 18
v_mfma_f32_32x32x16_bf16 v[48:63], a[144:147], v[164:167], v[48:63]
ds_read_b64_tr_b16 a[168:169], v28 offset:32768
ds_read_b64_tr_b16 a[170:171], v28 offset:33024
v_mad_i32_i24 v92, v92, 40, v89
ds_read_b64_tr_b16 a[204:205], v92 offset:3040
v_add_u32 v93, 32, v88
v_mfma_f32_32x32x16_bf16 v[208:223], a[148:151], v[164:167], v[208:223]
s_waitcnt lgkmcnt(9)
ds_read_b64_tr_b16 a[144:145], v28 offset:33792
ds_read_b64_tr_b16 a[146:147], v28 offset:34048
v_med3_i32 v93, v93, -1, 18
v_mad_i32_i24 v93, v93, 40, v89
ds_read_b64_tr_b16 a[206:207], v93 offset:3040
v_mfma_f32_32x32x16_bf16 v[224:239], a[152:155], v[164:167], v[224:239]
ds_read_b64_tr_b16 a[148:149], v28 offset:34816
ds_read_b64_tr_b16 a[150:151], v28 offset:35072
v_subrev_u32 v94, 12, v88
v_med3_i32 v94, v94, -1, 18
v_mad_i32_i24 v94, v94, 40, v89
v_mfma_f32_32x32x16_bf16 v[240:255], a[156:159], v[164:167], v[240:255]
s_waitcnt lgkmcnt(9)
ds_read_b64_tr_b16 a[152:153], v29 offset:30720
ds_read_b64_tr_b16 a[154:155], v29 offset:30976
ds_read_b64_tr_b16 a[208:209], v94 offset:4560
v_subrev_u32 v95, 4, v88
v_med3_i32 v95, v95, -1, 18
s_waitcnt vmcnt(17)
s_barrier
v_mfma_f32_32x32x16_bf16 v[32:47], a[160:163], v[168:171], v[32:47]
buffer_load_dwordx4 v20, s[12:15], s41 offen offset:0 lds
ds_read_b64_tr_b16 a[156:157], v29 offset:31744
ds_read_b64_tr_b16 a[158:159], v29 offset:32000
v_mfma_f32_32x32x16_bf16 v[48:63], a[164:167], v[168:171], v[48:63]
s_waitcnt lgkmcnt(8)
ds_read_b64_tr_b16 a[160:161], v29 offset:32768
ds_read_b64_tr_b16 a[162:163], v29 offset:33024
v_mad_i32_i24 v95, v95, 40, v89
ds_read_b64_tr_b16 a[210:211], v95 offset:4560
v_add_u32 v92, 4, v88
v_mfma_f32_32x32x16_bf16 v[208:223], a[168:171], v[168:171], v[208:223]
ds_read_b64_tr_b16 a[164:165], v29 offset:33792
ds_read_b64_tr_b16 a[166:167], v29 offset:34048
v_med3_i32 v92, v92, -1, 18
v_mad_i32_i24 v92, v92, 40, v89
ds_read_b64_tr_b16 a[212:213], v92 offset:4560
v_mfma_f32_32x32x16_bf16 v[224:239], a[144:147], v[168:171], v[224:239]
s_waitcnt lgkmcnt(9)
buffer_load_dwordx4 v21, s[12:15], s41 offen offset:1024 lds
ds_read_b64_tr_b16 a[168:169], v29 offset:34816
ds_read_b64_tr_b16 a[170:171], v29 offset:35072
v_mfma_f32_32x32x16_bf16 v[240:255], a[148:151], v[168:171], v[240:255]
ds_read_b64_tr_b16 a[144:145], v26 offset:0
ds_read_b64_tr_b16 a[146:147], v26 offset:256
v_add_u32 v93, 12, v88
v_med3_i32 v93, v93, -1, 18
v_mad_i32_i24 v93, v93, 40, v89
s_waitcnt vmcnt(6)
v_cmp_le_u32 vcc, 1, v8
s_nop 1
s_andn2_b32 s7, 0x1, vcc_lo
s_cbranch_scc1 L_spin_ai
L_back_ai:
v_mfma_f32_32x32x16_bf16 v[32:47], a[152:155], v[172:175], v[32:47]
s_waitcnt lgkmcnt(8)
ds_read_b64_tr_b16 a[148:149], v26 offset:1024
ds_read_b64_tr_b16 a[150:151], v26 offset:1280
ds_read_b64_tr_b16 a[214:215], v93 offset:4560
v_add_u32 v94, 20, v88
v_med3_i32 v94, v94, -1, 18
v_mfma_f32_32x32x16_bf16 v[48:63], a[156:159], v[172:175], v[48:63]
buffer_load_dwordx4 v22, s[12:15], s41 offen offset:2048 lds
ds_read_b64_tr_b16 a[152:153], v26 offset:2048
ds_read_b64_tr_b16 a[154:155], v26 offset:2304
v_mfma_f32_32x32x16_bf16 v[208:223], a[160:163], v[172:175], v[208:223]
s_waitcnt lgkmcnt(7)
ds_read_b64_tr_b16 a[156:157], v26 offset:3072
ds_read_b64_tr_b16 a[158:159], v26 offset:3328
v_mad_i32_i24 v94, v94, 40, v89
ds_read_b64_tr_b16 a[216:217], v94 offset:4560
v_add_u32 v95, 28, v88
v_mfma_f32_32x32x16_bf16 v[224:239], a[164:167], v[172:175], v[224:239]
ds_read_b64_tr_b16 a[160:161], v26 offset:4096
ds_read_b64_tr_b16 a[162:163], v26 offset:4352
v_med3_i32 v95, v95, -1, 18
v_mad_i32_i24 v95, v95, 40, v89
ds_read_b64_tr_b16 a[218:219], v95 offset:4560
v_mfma_f32_32x32x16_bf16 v[240:255], a[168:171], v[172:175], v[240:255]
s_waitcnt lgkmcnt(9)
buffer_load_dwordx4 v23, s[12:15], s41 offen offset:3072 lds
ds_read_b64_tr_b16 a[164:165], v27 offset:0
ds_read_b64_tr_b16 a[166:167], v27 offset:256
v_mfma_f32_32x32x16_bf16 v[32:47], a[144:147], v[176:179], v[32:47]
ds_read_b64_tr_b16 a[168:169], v27 offset:1024
ds_read_b64_tr_b16 a[170:171], v27 offset:1280
v_add_u32 v92, 0, v90
v_med3_i32 v92, v92, -1, 18
v_mad_i32_i24 v92, v92, 40, v91
v_mfma_f32_32x32x16_bf16 v[48:63], a[148:151], v[176:179], v[48:63]
s_waitcnt lgkmcnt(8)
ds_read_b64_tr_b16 a[144:145], v27 offset:2048
ds_read_b64_tr_b16 a[146:147], v27 offset:2304
ds_read_b64_tr_b16 a[220:221], v92 offset:0
v_add_u32 v93, 8, v90
v_med3_i32 v93, v93, -1, 18
v_mfma_f32_32x32x16_bf16 v[208:223], a[152:155], v[176:179], v[208:223]
buffer_load_dword v8, off, s[28:31], s58 sc1
ds_read_b64_tr_b16 a[148:149], v27 offset:3072
ds_read_b64_tr_b16 a[150:151], v27 offset:3328
v_mfma_f32_32x32x16_bf16 v[224:239], a[156:159], v[176:179], v[224:239]
s_waitcnt lgkmcnt(7)
s_add_u32 m0, s35, 28672
ds_read_b64_tr_b16 a[152:153], v27 offset:4096
ds_read_b64_tr_b16 a[154:155], v27 offset:4352
v_mad_i32_i24 v93, v93, 40, v91
ds_read_b64_tr_b16 a[222:223], v93 offset:0
v_add_u32 v94, 16, v90
v_mfma_f32_32x32x16_bf16 v[240:255], a[160:163], v[176:179], v[240:255]
s_add_u32 s41, s38, 1771808
ds_read_b64_tr_b16 a[156:157], v28 offset:0
ds_read_b64_tr_b16 a[158:159], v28 offset:256
v_med3_i32 v94, v94, -1, 18
v_mad_i32_i24 v94, v94, 40, v91
ds_read_b64_tr_b16 a[224:225], v94 offset:0
v_mfma_f32_32x32x16_bf16 v[32:47], a[164:167], v[180:183], v[32:47]
s_waitcnt lgkmcnt(9)
ds_read_b64_tr_b16 a[160:161], v28 offset:1024
ds_read_b64_tr_b16 a[162:163], v28 offset:1280
v_add_u32 v95, 24, v90
v_med3_i32 v95, v95, -1, 18
v_mad_i32_i24 v95, v95, 40, v91
v_mfma_f32_32x32x16_bf16 v[48:63], a[168:171], v[180:183], v[48:63]
ds_read_b64_tr_b16 a[164:165], v28 offset:2048
ds_read_b64_tr_b16 a[166:167], v28 offset:2304
ds_read_b64_tr_b16 a[226:227], v95 offset:0
v_add_u32 v92, 32, v90
v_med3_i32 v92, v92, -1, 18
v_mfma_f32_32x32x16_bf16 v[208:223], a[144:147], v[180:183], v[208:223]
s_waitcnt lgkmcnt(9)
ds_read_b64_tr_b16 a[168:169], v28 offset:3072
ds_read_b64_tr_b16 a[170:171], v28 offset:3328
v_mad_i32_i24 v92, v92, 40, v91
ds_read_b64_tr_b16 a[228:229], v92 offset:0
v_add_u32 v93, 40, v90
v_mfma_f32_32x32x16_bf16 v[224:239], a[148:151], v[180:183], v[224:239]
ds_read_b64_tr_b16 a[144:145], v28 offset:4096
ds_read_b64_tr_b16 a[146:147], v28 offset:4352
v_med3_i32 v93, v93, -1, 18
v_mad_i32_i24 v93, v93, 40, v91
ds_read_b64_tr_b16 a[230:231], v93 offset:0
v_mfma_f32_32x32x16_bf16 v[240:255], a[152:155], v[180:183], v[240:255]
s_waitcnt lgkmcnt(9)
ds_read_b64_tr_b16 a[148:149], v29 offset:0
ds_read_b64_tr_b16 a[150:151], v29 offset:256
v_add_u32 v94, 48, v90
v_med3_i32 v94, v94, -1, 18
v_mad_i32_i24 v94, v94, 40, v91
s_barrier
v_mov_b32 v9, 1
buffer_store_dword v9, v7, s[20:23], s55 offen sc1
v_mfma_f32_32x32x16_bf16 v[32:47], a[156:159], v[184:187], v[32:47]
buffer_load_dwordx4 v20, s[12:15], s41 offen offset:0 lds
ds_read_b64_tr_b16 a[152:153], v29 offset:1024
ds_read_b64_tr_b16 a[154:155], v29 offset:1280
v_mfma_f32_32x32x16_bf16 v[48:63], a[160:163], v[184:187], v[48:63]
s_waitcnt lgkmcnt(8)
ds_read_b64_tr_b16 a[156:157], v29 offset:2048
ds_read_b64_tr_b16 a[158:159], v29 offset:2304
ds_read_b64_tr_b16 a[232:233], v94 offset:0
v_add_u32 v95, 56, v90
v_med3_i32 v95, v95, -1, 18
v_mfma_f32_32x32x16_bf16 v[208:223], a[164:167], v[184:187], v[208:223]
ds_read_b64_tr_b16 a[160:161], v29 offset:3072
ds_read_b64_tr_b16 a[162:163], v29 offset:3328
v_mad_i32_i24 v95, v95, 40, v91
ds_read_b64_tr_b16 a[234:235], v95 offset:0
v_add_u32 v92, 64, v90
v_mfma_f32_32x32x16_bf16 v[224:239], a[168:171], v[184:187], v[224:239]
s_waitcnt lgkmcnt(8)
buffer_load_dwordx4 v21, s[12:15], s41 offen offset:1024 lds
ds_read_b64_tr_b16 a[164:165], v29 offset:4096
ds_read_b64_tr_b16 a[166:167], v29 offset:4352
v_mfma_f32_32x32x16_bf16 v[240:255], a[144:147], v[184:187], v[240:255]
ds_read_b64_tr_b16 a[168:169], v26 offset:5120
ds_read_b64_tr_b16 a[170:171], v26 offset:5376
v_med3_i32 v92, v92, -1, 18
v_mad_i32_i24 v92, v92, 40, v91
ds_read_b64_tr_b16 a[236:237], v92 offset:0
v_mfma_f32_32x32x16_bf16 v[32:47], a[148:151], v[188:191], v[32:47]
s_waitcnt lgkmcnt(9)
ds_read_b64_tr_b16 a[144:145], v26 offset:6144
ds_read_b64_tr_b16 a[146:147], v26 offset:6400
v_add_u32 v93, 72, v90
v_med3_i32 v93, v93, -1, 18
v_mad_i32_i24 v93, v93, 40, v91
v_mfma_f32_32x32x16_bf16 v[48:63], a[152:155], v[188:191], v[48:63]
buffer_load_dwordx4 v22, s[12:15], s41 offen offset:2048 lds
ds_read_b64_tr_b16 a[148:149], v26 offset:7168
ds_read_b64_tr_b16 a[150:151], v26 offset:7424
v_mfma_f32_32x32x16_bf16 v[208:223], a[156:159], v[188:191], v[208:223]
s_waitcnt lgkmcnt(7)
ds_read_b64_tr_b16 a[152:153], v26 offset:8192
ds_read_b64_tr_b16 a[154:155], v26 offset:8448
ds_read_b64_tr_b16 a[238:239], v93 offset:0
v_add_u32 v94, 80, v90
v_med3_i32 v94, v94, -1, 18
v_mfma_f32_32x32x16_bf16 v[224:239], a[160:163], v[188:191], v[224:239]
ds_read_b64_tr_b16 a[156:157], v26 offset:9216
ds_read_b64_tr_b16 a[158:159], v26 offset:9472
v_mad_i32_i24 v94, v94, 40, v91
ds_read_b64_tr_b16 a[240:241], v94 offset:0
v_add_u32 v95, 88, v90
v_mfma_f32_32x32x16_bf16 v[240:255], a[164:167], v[188:191], v[240:255]
s_waitcnt lgkmcnt(8)
buffer_load_dwordx4 v23, s[12:15], s41 offen offset:3072 lds
ds_read_b64_tr_b16 a[160:161], v27 offset:5120
ds_read_b64_tr_b16 a[162:163], v27 offset:5376
v_mfma_f32_32x32x16_bf16 v[32:47], a[168:171], v[192:195], v[32:47]
s_add_u32 m0, s35, 32768
ds_read_b64_tr_b16 a[164:165], v27 offset:6144
ds_read_b64_tr_b16 a[166:167], v27 offset:6400
v_med3_i32 v95, v95, -1, 18
v_mad_i32_i24 v95, v95, 40, v91
ds_read_b64_tr_b16 a[242:243], v95 offset:0
v_mfma_f32_32x32x16_bf16 v[48:63], a[144:147], v[192:195], v[48:63]
s_waitcnt lgkmcnt(9)
s_add_u32 s41, s38, 2336
ds_read_b64_tr_b16 a[168:169], v27 offset:7168
ds_read_b64_tr_b16 a[170:171], v27 offset:7424
v_add_u32 v92, 96, v90
v_med3_i32 v92, v92, -1, 18
v_mad_i32_i24 v92, v92, 40, v91
v_mfma_f32_32x32x16_bf16 v[208:223], a[148:151], v[192:195], v[208:223]
buffer_load_dwordx4 v20, s[12:15], s41 offen offset:0 lds
ds_read_b64_tr_b16 a[144:145], v27 offset:8192
ds_read_b64_tr_b16 a[146:147], v27 offset:8448
v_mfma_f32_32x32x16_bf16 v[224:239], a[152:155], v[192:195], v[224:239]
s_waitcnt lgkmcnt(7)
ds_read_b64_tr_b16 a[148:149], v27 offset:9216
ds_read_b64_tr_b16 a[150:151], v27 offset:9472
ds_read_b64_tr_b16 a[244:245], v92 offset:0
v_add_u32 v93, 104, v90
v_med3_i32 v93, v93, -1, 18
v_mfma_f32_32x32x16_bf16 v[240:255], a[156:159], v[192:195], v[240:255]
ds_read_b64_tr_b16 a[152:153], v28 offset:5120
ds_read_b64_tr_b16 a[154:155], v28 offset:5376
v_mad_i32_i24 v93, v93, 40, v91
ds_read_b64_tr_b16 a[246:247], v93 offset:0
v_add_u32 v94, 112, v90
v_mfma_f32_32x32x16_bf16 v[32:47], a[160:163], v[196:199], v[32:47]
s_waitcnt lgkmcnt(8)
buffer_load_dwordx4 v21, s[12:15], s41 offen offset:1024 lds
ds_read_b64_tr_b16 a[156:157], v28 offset:6144
ds_read_b64_tr_b16 a[158:159], v28 offset:6400
v_mfma_f32_32x32x16_bf16 v[48:63], a[164:167], v[196:199], v[48:63]
ds_read_b64_tr_b16 a[160:161], v28 offset:7168
ds_read_b64_tr_b16 a[162:163], v28 offset:7424
v_med3_i32 v94, v94, -1, 18
v_mad_i32_i24 v94, v94, 40, v91
ds_read_b64_tr_b16 a[248:249], v94 offset:0
v_mfma_f32_32x32x16_bf16 v[208:223], a[168:171], v[196:199], v[208:223]
s_waitcnt lgkmcnt(9)
ds_read_b64_tr_b16 a[164:165], v28 offset:8192
ds_read_b64_tr_b16 a[166:167], v28 offset:8448
v_add_u32 v95, 120, v90
v_med3_i32 v95, v95, -1, 18
v_mad_i32_i24 v95, v95, 40, v91
v_mfma_f32_32x32x16_bf16 v[224:239], a[144:147], v[196:199], v[224:239]
buffer_load_dwordx4 v22, s[12:15], s41 offen offset:2048 lds
ds_read_b64_tr_b16 a[168:169], v28 offset:9216
ds_read_b64_tr_b16 a[170:171], v28 offset:9472
v_mfma_f32_32x32x16_bf16 v[240:255], a[148:151], v[196:199], v[240:255]
s_waitcnt lgkmcnt(7)
ds_read_b64_tr_b16 a[144:145], v29 offset:5120
ds_read_b64_tr_b16 a[146:147], v29 offset:5376
ds_read_b64_tr_b16 a[250:251], v95 offset:0
v_add_u32 v92, 128, v90
v_med3_i32 v92, v92, -1, 18
v_mad_i32_i24 v92, v92, 40, v91
s_waitcnt vmcnt(13)
s_barrier
v_mfma_f32_32x32x16_bf16 v[32:47], a[152:155], v[200:203], v[32:47]
ds_read_b64_tr_b16 a[148:149], v29 offset:6144
ds_read_b64_tr_b16 a[150:151], v29 offset:6400
ds_read_b64_tr_b16 a[252:253], v92 offset:0
v_add_u32 v93, 136, v90
v_med3_i32 v93, v93, -1, 18
v_mfma_f32_32x32x16_bf16 v[48:63], a[156:159], v[200:203], v[48:63]
s_waitcnt lgkmcnt(8)
buffer_load_dwordx4 v23, s[12:15], s41 offen offset:3072 lds
ds_read_b64_tr_b16 a[152:153], v29 offset:7168
ds_read_b64_tr_b16 a[154:155], v29 offset:7424
v_mfma_f32_32x32x16_bf16 v[208:223], a[160:163], v[200:203], v[208:223]
s_add_u32 m0, s35, 20480
ds_read_b64_tr_b16 a[156:157], v29 offset:8192
ds_read_b64_tr_b16 a[158:159], v29 offset:8448
v_mad_i32_i24 v93, v93, 40, v91
ds_read_b64_tr_b16 a[254:255], v93 offset:0
v_add_u32 v11, 147456, v26
v_lshrrev_b32 v4, 2, v1
v_mfma_f32_32x32x16_bf16 v[224:239], a[164:167], v[200:203], v[224:239]
s_waitcnt lgkmcnt(9)
s_add_u32 s41, s38, 665888
ds_read_b64_tr_b16 a[160:161], v29 offset:9216
ds_read_b64_tr_b16 a[162:163], v29 offset:9472
v_and_b32 v5, 3, v1
v_lshlrev_b32 v5, 4, v5
v_mul_u32_u24 v15, 1152, v4
v_add_u32 v15, v15, v5
v_add_u32 v16, 17408, v15
v_mfma_f32_32x32x16_bf16 v[240:255], a[168:171], v[200:203], v[240:255]
ds_read_b64_tr_b16 a[164:165], v26 offset:20480
ds_read_b64_tr_b16 a[166:167], v26 offset:20736
v_add_u32 v17, 34816, v15
v_and_b32 v3, 31, v1
v_mul_u32_u24 v12, 584, v3
s_waitcnt vmcnt(9)
v_cmp_le_u32 vcc, 1, v8
s_nop 1
s_andn2_b32 s7, 0x1, vcc_lo
s_cbranch_scc1 L_spin_aj
L_back_aj:
v_mfma_f32_32x32x16_bf16 v[32:47], a[144:147], v[204:207], v[32:47]
s_waitcnt lgkmcnt(7)
ds_read_b64_tr_b16 a[168:169], v26 offset:21504
ds_read_b64_tr_b16 a[170:171], v26 offset:21760
v_mul_u32_u24 v4, 72, v2
v_add3_u32 v12, v12, v4, s35
v_mul_u32_u24 v18, 328, v3
v_mfma_f32_32x32x16_bf16 v[48:63], a[148:151], v[204:207], v[48:63]
ds_read_b64_tr_b16 a[144:145], v26 offset:22528
ds_read_b64_tr_b16 a[146:147], v26 offset:22784
v_add_u32 v18, s35, v18
v_mul_u32_u24 v4, 12, v2
v_add_u32 v25, v18, v4
v_lshl_add_u32 v18, v2, 3, v18
v_mfma_f32_32x32x16_bf16 v[208:223], a[152:155], v[204:207], v[208:223]
s_waitcnt lgkmcnt(6)
ds_read_b64_tr_b16 a[148:149], v26 offset:23552
ds_read_b64_tr_b16 a[150:151], v26 offset:23808
v_mfma_f32_32x32x16_bf16 v[224:239], a[156:159], v[204:207], v[224:239]
ds_read_b64_tr_b16 a[152:153], v27 offset:20480
ds_read_b64_tr_b16 a[154:155], v27 offset:20736
v_mfma_f32_32x32x16_bf16 v[240:255], a[160:163], v[204:207], v[240:255]
ds_read_b64_tr_b16 a[156:157], v27 offset:21504
ds_read_b64_tr_b16 a[158:159], v27 offset:21760
s_waitcnt lgkmcnt(10)
v_mfma_f32_32x32x16_bf16 v[64:79], a[164:167], a[0:3], 0
ds_read_b64_tr_b16 a[160:161], v27 offset:22528
ds_read_b64_tr_b16 a[162:163], v27 offset:22784
s_waitcnt lgkmcnt(10)
v_mfma_f32_32x32x16_bf16 v[80:95], a[168:171], a[0:3], 0
s_waitcnt lgkmcnt(6)
ds_read_b64_tr_b16 a[164:165], v27 offset:23552
ds_read_b64_tr_b16 a[166:167], v27 offset:23808
v_mfma_f32_32x32x16_bf16 v[96:111], a[144:147], a[0:3], 0
ds_read_b64_tr_b16 a[168:169], v28 offset:20480
ds_read_b64_tr_b16 a[170:171], v28 offset:20736
v_cvt_pk_bf16_f32 v128, v32, v33
v_cvt_pk_bf16_f32 v129, v34, v35
v_cvt_pk_bf16_f32 v130, v36, v37
v_cvt_pk_bf16_f32 v131, v38, v39
v_mfma_f32_32x32x16_bf16 v[112:127], a[148:151], a[0:3], 0
s_waitcnt lgkmcnt(6)
ds_read_b64_tr_b16 a[144:145], v28 offset:21504
ds_read_b64_tr_b16 a[146:147], v28 offset:21760
v_cvt_pk_bf16_f32 v132, v40, v41
v_cvt_pk_bf16_f32 v133, v42, v43
v_cvt_pk_bf16_f32 v134, v44, v45
v_cvt_pk_bf16_f32 v135, v46, v47
v_mfma_f32_32x32x16_bf16 v[64:79], a[152:155], a[4:7], v[64:79]
ds_read_b64_tr_b16 a[148:149], v28 offset:22528
ds_read_b64_tr_b16 a[150:151], v28 offset:22784
v_cvt_pk_bf16_f32 v136, v48, v49
v_cvt_pk_bf16_f32 v137, v50, v51
v_cvt_pk_bf16_f32 v138, v52, v53
v_cvt_pk_bf16_f32 v139, v54, v55
v_mfma_f32_32x32x16_bf16 v[80:95], a[156:159], a[4:7], v[80:95]
s_waitcnt lgkmcnt(6)
ds_read_b64_tr_b16 a[152:153], v28 offset:23552
ds_read_b64_tr_b16 a[154:155], v28 offset:23808
v_cvt_pk_bf16_f32 v140, v56, v57
v_cvt_pk_bf16_f32 v141, v58, v59
v_cvt_pk_bf16_f32 v142, v60, v61
v_cvt_pk_bf16_f32 v143, v62, v63
v_mfma_f32_32x32x16_bf16 v[96:111], a[160:163], a[4:7], v[96:111]
ds_read_b64_tr_b16 a[156:157], v29 offset:20480
ds_read_b64_tr_b16 a[158:159], v29 offset:20736
v_cvt_pk_bf16_f32 v144, v208, v209
v_cvt_pk_bf16_f32 v145, v210, v211
v_cvt_pk_bf16_f32 v146, v212, v213
v_cvt_pk_bf16_f32 v147, v214, v215
v_mfma_f32_32x32x16_bf16 v[112:127], a[164:167], a[4:7], v[112:127]
s_waitcnt lgkmcnt(6)
ds_read_b64_tr_b16 a[160:161], v29 offset:21504
ds_read_b64_tr_b16 a[162:163], v29 offset:21760
v_cvt_pk_bf16_f32 v148, v216, v217
v_cvt_pk_bf16_f32 v149, v218, v219
v_cvt_pk_bf16_f32 v150, v220, v221
v_cvt_pk_bf16_f32 v151, v222, v223
s_barrier
v_mfma_f32_32x32x16_bf16 v[64:79], a[168:171], a[8:11], v[64:79]
v_cvt_pk_bf16_f32 v152, v224, v225
v_cvt_pk_bf16_f32 v153, v226, v227
v_cvt_pk_bf16_f32 v154, v228, v229
v_cvt_pk_bf16_f32 v155, v230, v231
v_mfma_f32_32x32x16_bf16 v[80:95], a[144:147], a[8:11], v[80:95]
s_waitcnt lgkmcnt(4)
v_cvt_pk_bf16_f32 v156, v232, v233
v_cvt_pk_bf16_f32 v157, v234, v235
v_cvt_pk_bf16_f32 v158, v236, v237
v_cvt_pk_bf16_f32 v159, v238, v239
v_mfma_f32_32x32x16_bf16 v[96:111], a[148:151], a[8:11], v[96:111]
v_cvt_pk_bf16_f32 v160, v240, v241
v_cvt_pk_bf16_f32 v161, v242, v243
v_cvt_pk_bf16_f32 v162, v244, v245
v_mfma_f32_32x32x16_bf16 v[112:127], a[152:155], a[8:11], v[112:127]
s_waitcnt lgkmcnt(0)
v_cvt_pk_bf16_f32 v163, v246, v247
v_cvt_pk_bf16_f32 v164, v248, v249
v_cvt_pk_bf16_f32 v165, v250, v251
v_mfma_f32_32x32x16_bf16 v[64:79], a[156:159], a[12:15], v[64:79]
v_cvt_pk_bf16_f32 v166, v252, v253
v_cvt_pk_bf16_f32 v167, v254, v255
v_mfma_f32_32x32x16_bf16 v[80:95], a[160:163], a[12:15], v[80:95]
v_mfma_f32_32x32x16_bf16 v[240:255], a[220:223], v[128:131], 0
v_mfma_f32_32x32x16_bf16 v[240:255], a[224:227], v[132:135], v[240:255]
v_mfma_f32_32x32x16_bf16 v[240:255], a[228:231], v[136:139], v[240:255]
v_mfma_f32_32x32x16_bf16 v[240:255], a[232:235], v[140:143], v[240:255]
v_mfma_f32_32x32x16_bf16 v[240:255], a[236:239], v[144:147], v[240:255]
v_mfma_f32_32x32x16_bf16 v[240:255], a[240:243], v[148:151], v[240:255]
v_mfma_f32_32x32x16_bf16 v[240:255], a[244:247], v[152:155], v[240:255]
v_mfma_f32_32x32x16_bf16 v[240:255], a[248:251], v[156:159], v[240:255]
v_mfma_f32_32x32x16_bf16 v[240:255], a[252:255], v[160:163], v[240:255]
v_mfma_f32_32x32x16_bf16 v[32:47], a[172:175], v[128:131], 0
v_mfma_f32_32x32x16_bf16 v[32:47], a[176:179], v[132:135], v[32:47]
v_mfma_f32_32x32x16_bf16 v[32:47], a[180:183], v[136:139], v[32:47]
v_mfma_f32_32x32x16_bf16 v[48:63], a[184:187], v[136:139], 0
v_mfma_f32_32x32x16_bf16 v[48:63], a[188:191], v[140:143], v[48:63]
v_mfma_f32_32x32x16_bf16 v[48:63], a[192:195], v[144:147], v[48:63]
s_nop 8
v_max3_f32 v186, v32, v33, v34
v_min3_f32 v187, v32, v33, v34
v_max3_f32 v186, v186, v35, v36
v_min3_f32 v187, v187, v35, v36
v_mfma_f32_32x32x16_bf16 v[208:223], a[196:199], v[144:147], 0
ds_read_b64_tr_b16 a[164:165], v29 offset:22528
ds_read_b64_tr_b16 a[166:167], v29 offset:22784
v_max3_f32 v186, v186, v37, v38
v_min3_f32 v187, v187, v37, v38
v_max3_f32 v186, v186, v39, v40
v_min3_f32 v187, v187, v39, v40
v_mfma_f32_32x32x16_bf16 v[208:223], a[200:203], v[148:151], v[208:223]
ds_read_b64_tr_b16 a[168:169], v29 offset:23552
ds_read_b64_tr_b16 a[170:171], v29 offset:23808
v_max3_f32 v186, v186, v41, v42
v_min3_f32 v187, v187, v41, v42
v_max3_f32 v186, v186, v43, v44
v_min3_f32 v187, v187, v43, v44
v_mfma_f32_32x32x16_bf16 v[208:223], a[204:207], v[152:155], v[208:223]
ds_read_b64_tr_b16 a[144:145], v26 offset:24576
ds_read_b64_tr_b16 a[146:147], v26 offset:24832
v_max3_f32 v186, v186, v45, v46
v_min3_f32 v187, v187, v45, v46
v_max3_f32 v186, v186, v47, v240
v_min3_f32 v187, v187, v47, v240
v_mfma_f32_32x32x16_bf16 v[224:239], a[208:211], v[152:155], 0
ds_read_b64_tr_b16 a[148:149], v26 offset:25600
ds_read_b64_tr_b16 a[150:151], v26 offset:25856
v_max_f32 v186, v186, v241
v_min_f32 v187, v187, v241
v_mul_f32 v186, v186, v30
v_mul_f32 v187, v187, v30
v_pk_fma_f32 v[168:169], v[32:33], v[30:31], v[186:187] op_sel:[0,0,0] op_sel_hi:[1,0,0] neg_lo:[0,0,1] neg_hi:[0,0,1]
v_pk_fma_f32 v[32:33], v[32:33], v[30:31], v[186:187] op_sel:[0,0,1] op_sel_hi:[1,0,1] neg_lo:[1,0,0] neg_hi:[1,0,0]
v_pk_fma_f32 v[170:171], v[34:35], v[30:31], v[186:187] op_sel:[0,0,0] op_sel_hi:[1,0,0] neg_lo:[0,0,1] neg_hi:[0,0,1]
v_pk_fma_f32 v[34:35], v[34:35], v[30:31], v[186:187] op_sel:[0,0,1] op_sel_hi:[1,0,1] neg_lo:[1,0,0] neg_hi:[1,0,0]
v_pk_fma_f32 v[172:173], v[36:37], v[30:31], v[186:187] op_sel:[0,0,0] op_sel_hi:[1,0,0] neg_lo:[0,0,1] neg_hi:[0,0,1]
v_pk_fma_f32 v[36:37], v[36:37], v[30:31], v[186:187] op_sel:[0,0,1] op_sel_hi:[1,0,1] neg_lo:[1,0,0] neg_hi:[1,0,0]
v_pk_fma_f32 v[174:175], v[38:39], v[30:31], v[186:187] op_sel:[0,0,0] op_sel_hi:[1,0,0] neg_lo:[0,0,1] neg_hi:[0,0,1]
v_pk_fma_f32 v[38:39], v[38:39], v[30:31], v[186:187] op_sel:[0,0,1] op_sel_hi:[1,0,1] neg_lo:[1,0,0] neg_hi:[1,0,0]
v_pk_fma_f32 v[176:177], v[40:41], v[30:31], v[186:187] op_sel:[0,0,0] op_sel_hi:[1,0,0] neg_lo:[0,0,1] neg_hi:[0,0,1]
v_pk_fma_f32 v[40:41], v[40:41], v[30:31], v[186:187] op_sel:[0,0,1] op_sel_hi:[1,0,1] neg_lo:[1,0,0] neg_hi:[1,0,0]
v_pk_fma_f32 v[178:179], v[42:43], v[30:31], v[186:187] op_sel:[0,0,0] op_sel_hi:[1,0,0] neg_lo:[0,0,1] neg_hi:[0,0,1]
v_pk_fma_f32 v[42:43], v[42:43], v[30:31], v[186:187] op_sel:[0,0,1] op_sel_hi:[1,0,1] neg_lo:[1,0,0] neg_hi:[1,0,0]
v_pk_fma_f32 v[180:181], v[44:45], v[30:31], v[186:187] op_sel:[0,0,0] op_sel_hi:[1,0,0] neg_lo:[0,0,1] neg_hi:[0,0,1]
v_pk_fma_f32 v[44:45], v[44:45], v[30:31], v[186:187] op_sel:[0,0,1] op_sel_hi:[1,0,1] neg_lo:[1,0,0] neg_hi:[1,0,0]
v_pk_fma_f32 v[182:183], v[46:47], v[30:31], v[186:187] op_sel:[0,0,0] op_sel_hi:[1,0,0] neg_lo:[0,0,1] neg_hi:[0,0,1]
v_pk_fma_f32 v[46:47], v[46:47], v[30:31], v[186:187] op_sel:[0,0,1] op_sel_hi:[1,0,1] neg_lo:[1,0,0] neg_hi:[1,0,0]
v_pk_fma_f32 v[184:185], v[240:241], v[30:31], v[186:187] op_sel:[0,0,0] op_sel_hi:[1,0,0] neg_lo:[0,0,1] neg_hi:[0,0,1]
v_pk_fma_f32 v[240:241], v[240:241], v[30:31], v[186:187] op_sel:[0,0,1] op_sel_hi:[1,0,1] neg_lo:[1,0,0] neg_hi:[1,0,0]
v_mfma_f32_32x32x16_bf16 v[224:239], a[212:215], v[156:159], v[224:239]
s_waitcnt lgkmcnt(6)
ds_read_b64_tr_b16 a[152:153], v26 offset:26624
ds_read_b64_tr_b16 a[154:155], v26 offset:26880
v_exp_f32 v168, v168
v_exp_f32 v32, v32
v_mfma_f32_32x32x16_bf16 v[224:239], a[216:219], v[160:163], v[224:239]
ds_read_b64_tr_b16 a[156:157], v26 offset:27648
ds_read_b64_tr_b16 a[158:159], v26 offset:27904
v_exp_f32 v169, v169
v_exp_f32 v33, v33
v_mfma_f32_32x32x16_bf16 v[96:111], a[164:167], a[12:15], v[96:111]
s_waitcnt lgkmcnt(6)
ds_read_b64_tr_b16 a[160:161], v27 offset:24576
ds_read_b64_tr_b16 a[162:163], v27 offset:24832
v_exp_f32 v170, v170
v_exp_f32 v34, v34
v_mfma_f32_32x32x16_bf16 v[112:127], a[168:171], a[12:15], v[112:127]
ds_read_b64_tr_b16 a[164:165], v27 offset:25600
ds_read_b64_tr_b16 a[166:167], v27 offset:25856
v_exp_f32 v171, v171
v_exp_f32 v35, v35
v_mfma_f32_32x32x16_bf16 v[64:79], a[144:147], a[16:19], v[64:79]
s_waitcnt lgkmcnt(6)
ds_read_b64_tr_b16 a[168:169], v27 offset:26624
ds_read_b64_tr_b16 a[170:171], v27 offset:26880
v_exp_f32 v172, v172
v_exp_f32 v36, v36
v_mfma_f32_32x32x16_bf16 v[80:95], a[148:151], a[16:19], v[80:95]
ds_read_b64_tr_b16 a[144:145], v27 offset:27648
ds_read_b64_tr_b16 a[146:147], v27 offset:27904
v_exp_f32 v173, v173
v_exp_f32 v37, v37
v_mfma_f32_32x32x16_bf16 v[96:111], a[152:155], a[16:19], v[96:111]
s_waitcnt lgkmcnt(6)
ds_read_b64_tr_b16 a[148:149], v28 offset:24576
ds_read_b64_tr_b16 a[150:151], v28 offset:24832
v_exp_f32 v174, v174
v_exp_f32 v38, v38
v_mfma_f32_32x32x16_bf16 v[112:127], a[156:159], a[16:19], v[112:127]
ds_read_b64_tr_b16 a[152:153], v28 offset:25600
ds_read_b64_tr_b16 a[154:155], v28 offset:25856
v_exp_f32 v175, v175
v_exp_f32 v39, v39
v_mfma_f32_32x32x16_bf16 v[64:79], a[160:163], a[20:23], v[64:79]
L_pad_a0_1:
s_cbranch_execz L_pad_a0_2
s_waitcnt lgkmcnt(6)
ds_read_b64_tr_b16 a[156:157], v28 offset:26624
ds_read_b64_tr_b16 a[158:159], v28 offset:26880
v_exp_f32 v176, v176
v_exp_f32 v40, v40
v_mfma_f32_32x32x16_bf16 v[80:95], a[164:167], a[20:23], v[80:95]
ds_read_b64_tr_b16 a[160:161], v28 offset:27648
ds_read_b64_tr_b16 a[162:163], v28 offset:27904
v_exp_f32 v177, v177
v_exp_f32 v41, v41
v_mfma_f32_32x32x16_bf16 v[96:111], a[168:171], a[20:23], v[96:111]
s_waitcnt lgkmcnt(6)
ds_read_b64_tr_b16 a[164:165], v29 offset:24576
ds_read_b64_tr_b16 a[166:167], v29 offset:24832
v_exp_f32 v178, v178
v_exp_f32 v42, v42
v_mfma_f32_32x32x16_bf16 v[112:127], a[144:147], a[20:23], v[112:127]
ds_read_b64_tr_b16 a[168:169], v29 offset:25600
ds_read_b64_tr_b16 a[170:171], v29 offset:25856
v_exp_f32 v179, v179
v_exp_f32 v43, v43
s_waitcnt vmcnt(4)
s_barrier
v_mfma_f32_32x32x16_bf16 v[64:79], a[148:151], a[24:27], v[64:79]
s_waitcnt lgkmcnt(6)
buffer_load_dwordx4 v20, s[12:15], s41 offen offset:0 lds
ds_read_b64_tr_b16 a[144:145], v29 offset:26624
ds_read_b64_tr_b16 a[146:147], v29 offset:26880
v_mfma_f32_32x32x16_bf16 v[80:95], a[152:155], a[24:27], v[80:95]
ds_read_b64_tr_b16 a[148:149], v29 offset:27648
ds_read_b64_tr_b16 a[150:151], v29 offset:27904
v_exp_f32 v180, v180
v_exp_f32 v44, v44
v_mfma_f32_32x32x16_bf16 v[96:111], a[156:159], a[24:27], v[96:111]
s_waitcnt lgkmcnt(6)
ds_read_b64_tr_b16 a[152:153], v26 offset:28672
ds_read_b64_tr_b16 a[154:155], v26 offset:28928
v_exp_f32 v181, v181
v_exp_f32 v45, v45
v_mfma_f32_32x32x16_bf16 v[112:127], a[160:163], a[24:27], v[112:127]
buffer_load_dwordx4 v21, s[12:15], s41 offen offset:1024 lds
ds_read_b64_tr_b16 a[156:157], v26 offset:29696
ds_read_b64_tr_b16 a[158:159], v26 offset:29952
v_mfma_f32_32x32x16_bf16 v[64:79], a[164:167], a[28:31], v[64:79]
s_waitcnt lgkmcnt(6)
ds_read_b64_tr_b16 a[160:161], v26 offset:30720
ds_read_b64_tr_b16 a[162:163], v26 offset:30976
v_exp_f32 v182, v182
v_exp_f32 v46, v46
v_mfma_f32_32x32x16_bf16 v[80:95], a[168:171], a[28:31], v[80:95]
ds_read_b64_tr_b16 a[164:165], v26 offset:31744
ds_read_b64_tr_b16 a[166:167], v26 offset:32000
v_exp_f32 v183, v183
v_exp_f32 v47, v47
v_mfma_f32_32x32x16_bf16 v[96:111], a[144:147], a[28:31], v[96:111]
s_waitcnt lgkmcnt(6)
buffer_load_dwordx4 v22, s[12:15], s41 offen offset:2048 lds
ds_read_b64_tr_b16 a[168:169], v27 offset:28672
ds_read_b64_tr_b16 a[170:171], v27 offset:28928
v_mfma_f32_32x32x16_bf16 v[112:127], a[148:151], a[28:31], v[112:127]
ds_read_b64_tr_b16 a[144:145], v27 offset:29696
ds_read_b64_tr_b16 a[146:147], v27 offset:29952
v_exp_f32 v184, v184
v_exp_f32 v240, v240
v_mfma_f32_32x32x16_bf16 v[64:79], a[152:155], a[32:35], v[64:79]
s_waitcnt lgkmcnt(6)
ds_read_b64_tr_b16 a[148:149], v27 offset:30720
ds_read_b64_tr_b16 a[150:151], v27 offset:30976
v_exp_f32 v185, v185
v_exp_f32 v241, v241
v_pk_add_f32 v[186:187], v[168:169], v[170:171] op_sel:[0,0] op_sel_hi:[1,1]
v_pk_add_f32 v[188:189], v[32:33], v[34:35] op_sel:[0,0] op_sel_hi:[1,1]
v_pk_add_f32 v[186:187], v[186:187], v[172:173] op_sel:[0,0] op_sel_hi:[1,1]
v_pk_add_f32 v[188:189], v[188:189], v[36:37] op_sel:[0,0] op_sel_hi:[1,1]
v_pk_add_f32 v[186:187], v[186:187], v[174:175] op_sel:[0,0] op_sel_hi:[1,1]
v_pk_add_f32 v[188:189], v[188:189], v[38:39] op_sel:[0,0] op_sel_hi:[1,1]
v_pk_add_f32 v[186:187], v[186:187], v[176:177] op_sel:[0,0] op_sel_hi:[1,1]
v_pk_add_f32 v[188:189], v[188:189], v[40:41] op_sel:[0,0] op_sel_hi:[1,1]
v_pk_add_f32 v[186:187], v[186:187], v[178:179] op_sel:[0,0] op_sel_hi:[1,1]
v_pk_add_f32 v[188:189], v[188:189], v[42:43] op_sel:[0,0] op_sel_hi:[1,1]
v_pk_add_f32 v[186:187], v[186:187], v[180:181] op_sel:[0,0] op_sel_hi:[1,1]
v_pk_add_f32 v[188:189], v[188:189], v[44:45] op_sel:[0,0] op_sel_hi:[1,1]
v_pk_add_f32 v[186:187], v[186:187], v[182:183] op_sel:[0,0] op_sel_hi:[1,1]
v_pk_add_f32 v[188:189], v[188:189], v[46:47] op_sel:[0,0] op_sel_hi:[1,1]
v_pk_add_f32 v[186:187], v[186:187], v[184:185] op_sel:[0,0] op_sel_hi:[1,1]
v_pk_add_f32 v[188:189], v[188:189], v[240:241] op_sel:[0,0] op_sel_hi:[1,1]
v_add_f32 v188, v188, v189
v_add_f32 v186, v186, v187
v_rcp_f32 v188, v188
v_rcp_f32 v186, v186
v_mul_f32 v188, v188, v14
v_mul_f32 v186, v186, v14
v_pk_mul_f32 v[32:33], v[32:33], v[188:189] op_sel:[0,0] op_sel_hi:[1,0]
v_pk_mul_f32 v[34:35], v[34:35], v[188:189] op_sel:[0,0] op_sel_hi:[1,0]
v_pk_mul_f32 v[36:37], v[36:37], v[188:189] op_sel:[0,0] op_sel_hi:[1,0]
v_pk_mul_f32 v[38:39], v[38:39], v[188:189] op_sel:[0,0] op_sel_hi:[1,0]
v_pk_mul_f32 v[40:41], v[40:41], v[188:189] op_sel:[0,0] op_sel_hi:[1,0]
v_pk_mul_f32 v[42:43], v[42:43], v[188:189] op_sel:[0,0] op_sel_hi:[1,0]
v_pk_mul_f32 v[44:45], v[44:45], v[188:189] op_sel:[0,0] op_sel_hi:[1,0]
v_pk_mul_f32 v[46:47], v[46:47], v[188:189] op_sel:[0,0] op_sel_hi:[1,0]
v_pk_mul_f32 v[240:241], v[240:241], v[188:189] op_sel:[0,0] op_sel_hi:[1,0]
v_pk_mul_f32 v[168:169], v[168:169], v[186:187] op_sel:[0,0] op_sel_hi:[1,0]
v_pk_mul_f32 v[170:171], v[170:171], v[186:187] op_sel:[0,0] op_sel_hi:[1,0]
v_pk_mul_f32 v[172:173], v[172:173], v[186:187] op_sel:[0,0] op_sel_hi:[1,0]
v_pk_mul_f32 v[174:175], v[174:175], v[186:187] op_sel:[0,0] op_sel_hi:[1,0]
v_pk_mul_f32 v[176:177], v[176:177], v[186:187] op_sel:[0,0] op_sel_hi:[1,0]
v_pk_mul_f32 v[178:179], v[178:179], v[186:187] op_sel:[0,0] op_sel_hi:[1,0]
v_pk_mul_f32 v[180:181], v[180:181], v[186:187] op_sel:[0,0] op_sel_hi:[1,0]
v_pk_mul_f32 v[182:183], v[182:183], v[186:187] op_sel:[0,0] op_sel_hi:[1,0]
v_pk_mul_f32 v[184:185], v[184:185], v[186:187] op_sel:[0,0] op_sel_hi:[1,0]
v_mfma_f32_32x32x16_bf16 v[80:95], a[156:159], a[32:35], v[80:95]
buffer_load_dwordx4 v23, s[12:15], s41 offen offset:3072 lds
ds_read_b64_tr_b16 a[152:153], v27 offset:31744
ds_read_b64_tr_b16 a[154:155], v27 offset:32000
v_mfma_f32_32x32x16_bf16 v[96:111], a[160:163], a[32:35], v[96:111]
s_waitcnt lgkmcnt(6)
s_add_u32 m0, s35, 24576
ds_read_b64_tr_b16 a[156:157], v28 offset:28672
ds_read_b64_tr_b16 a[158:159], v28 offset:28928
v_cvt_pk_bf16_f32 v190, v168, v169
v_cvt_pk_bf16_f32 v191, v170, v171
v_cvt_pk_bf16_f32 v192, v172, v173
v_cvt_pk_bf16_f32 v193, v174, v175
v_mfma_f32_32x32x16_bf16 v[112:127], a[164:167], a[32:35], v[112:127]
s_add_u32 s41, s38, 1329440
ds_read_b64_tr_b16 a[160:161], v28 offset:29696
ds_read_b64_tr_b16 a[162:163], v28 offset:29952
v_cvt_pk_bf16_f32 v194, v176, v177
v_cvt_pk_bf16_f32 v195, v178, v179
v_cvt_pk_bf16_f32 v196, v180, v181
v_cvt_pk_bf16_f32 v197, v182, v183
v_mfma_f32_32x32x16_bf16 v[64:79], a[168:171], a[36:39], v[64:79]
s_waitcnt lgkmcnt(6)
ds_read_b64_tr_b16 a[164:165], v28 offset:30720
ds_read_b64_tr_b16 a[166:167], v28 offset:30976
v_cvt_pk_bf16_f32 v198, v184, v185
v_cvt_pk_bf16_f32 v199, v32, v33
v_cvt_pk_bf16_f32 v200, v34, v35
v_cvt_pk_bf16_f32 v201, v36, v37
v_mfma_f32_32x32x16_bf16 v[80:95], a[144:147], a[36:39], v[80:95]
ds_read_b64_tr_b16 a[168:169], v28 offset:31744
ds_read_b64_tr_b16 a[170:171], v28 offset:32000
v_cvt_pk_bf16_f32 v202, v38, v39
v_cvt_pk_bf16_f32 v203, v40, v41
v_cvt_pk_bf16_f32 v204, v42, v43
v_cvt_pk_bf16_f32 v205, v44, v45
v_mfma_f32_32x32x16_bf16 v[96:111], a[148:151], a[36:39], v[96:111]
s_waitcnt lgkmcnt(6)
ds_read_b64_tr_b16 a[144:145], v29 offset:28672
ds_read_b64_tr_b16 a[146:147], v29 offset:28928
v_cvt_pk_bf16_f32 v206, v46, v47
v_cvt_pk_bf16_f32 v207, v240, v241
ds_write_b64 v12, v[190:191] offset:0
ds_write_b64 v12, v[192:193] offset:8
v_mfma_f32_32x32x16_bf16 v[112:127], a[152:155], a[36:39], v[112:127]
buffer_load_dword v8, v10, s[20:23], s54 offen sc1
ds_read_b64_tr_b16 a[148:149], v29 offset:29696
ds_read_b64_tr_b16 a[150:151], v29 offset:29952
s_waitcnt vmcnt(5)
s_barrier
v_mfma_f32_32x32x16_bf16 v[64:79], a[156:159], a[40:43], v[64:79]
s_waitcnt lgkmcnt(8)
ds_read_b64_tr_b16 a[152:153], v29 offset:30720
ds_read_b64_tr_b16 a[154:155], v29 offset:30976
ds_write_b64 v12, v[194:195] offset:16
ds_write_b64 v12, v[196:197] offset:24
ds_write_b64 v12, v[198:199] offset:32
ds_write_b64 v12, v[200:201] offset:40
v_mfma_f32_32x32x16_bf16 v[80:95], a[160:163], a[40:43], v[80:95]
ds_read_b64_tr_b16 a[156:157], v29 offset:31744
ds_read_b64_tr_b16 a[158:159], v29 offset:32000
ds_write_b64 v12, v[202:203] offset:48
ds_write_b64 v12, v[204:205] offset:56
ds_write_b64 v12, v[206:207] offset:64
v_max3_f32 v186, v48, v49, v50
v_mfma_f32_32x32x16_bf16 v[96:111], a[164:167], a[40:43], v[96:111]
s_waitcnt lgkmcnt(15)
buffer_load_dwordx4 v20, s[12:15], s41 offen offset:0 lds
ds_read_b64_tr_b16 a[160:161], v26 offset:32768
ds_read_b64_tr_b16 a[162:163], v26 offset:33024
v_mfma_f32_32x32x16_bf16 v[112:127], a[168:171], a[40:43], v[112:127]
ds_read_b64_tr_b16 a[164:165], v26 offset:33792
ds_read_b64_tr_b16 a[166:167], v26 offset:34048
v_min3_f32 v187, v48, v49, v50
v_max3_f32 v186, v186, v51, v52
v_min3_f32 v187, v187, v51, v52
v_max3_f32 v186, v186, v53, v54
v_mfma_f32_32x32x16_bf16 v[64:79], a[144:147], a[44:47], v[64:79]
s_waitcnt lgkmcnt(13)
ds_read_b64_tr_b16 a[168:169], v26 offset:34816
ds_read_b64_tr_b16 a[170:171], v26 offset:35072
v_min3_f32 v187, v187, v53, v54
v_max3_f32 v186, v186, v55, v56
v_min3_f32 v187, v187, v55, v56
v_max3_f32 v186, v186, v57, v58
v_mfma_f32_32x32x16_bf16 v[80:95], a[148:151], a[44:47], v[80:95]
buffer_load_dwordx4 v21, s[12:15], s41 offen offset:1024 lds
ds_read_b64_tr_b16 a[144:145], v26 offset:35840
ds_read_b64_tr_b16 a[146:147], v26 offset:36096
v_mfma_f32_32x32x16_bf16 v[96:111], a[152:155], a[44:47], v[96:111]
s_waitcnt lgkmcnt(6)
ds_read_b64_tr_b16 a[148:149], v27 offset:32768
ds_read_b64_tr_b16 a[150:151], v27 offset:33024
v_min3_f32 v187, v187, v57, v58
v_max3_f32 v186, v186, v59, v60
v_min3_f32 v187, v187, v59, v60
v_max3_f32 v186, v186, v61, v62
v_min3_f32 v187, v187, v61, v62
v_mfma_f32_32x32x16_bf16 v[112:127], a[156:159], a[44:47], v[112:127]
ds_read_b64_tr_b16 a[152:153], v27 offset:33792
ds_read_b64_tr_b16 a[154:155], v27 offset:34048
v_max3_f32 v186, v186, v63, v244
v_min3_f32 v187, v187, v63, v244
v_max_f32 v186, v186, v245
v_min_f32 v187, v187, v245
v_mul_f32 v186, v186, v30
v_mfma_f32_32x32x16_bf16 v[64:79], a[160:163], a[48:51], v[64:79]
s_waitcnt lgkmcnt(6)
buffer_load_dwordx4 v22, s[12:15], s41 offen offset:2048 lds
ds_read_b64_tr_b16 a[156:157], v27 offset:34816
ds_read_b64_tr_b16 a[158:159], v27 offset:35072
v_mfma_f32_32x32x16_bf16 v[80:95], a[164:167], a[48:51], v[80:95]
ds_read_b64_tr_b16 a[160:161], v27 offset:35840
ds_read_b64_tr_b16 a[162:163], v27 offset:36096
v_mul_f32 v187, v187, v30
v_pk_fma_f32 v[168:169], v[48:49], v[30:31], v[186:187] op_sel:[0,0,0] op_sel_hi:[1,0,0] neg_lo:[0,0,1] neg_hi:[0,0,1]
v_pk_fma_f32 v[48:49], v[48:49], v[30:31], v[186:187] op_sel:[0,0,1] op_sel_hi:[1,0,1] neg_lo:[1,0,0] neg_hi:[1,0,0]
v_pk_fma_f32 v[170:171], v[50:51], v[30:31], v[186:187] op_sel:[0,0,0] op_sel_hi:[1,0,0] neg_lo:[0,0,1] neg_hi:[0,0,1]
v_pk_fma_f32 v[50:51], v[50:51], v[30:31], v[186:187] op_sel:[0,0,1] op_sel_hi:[1,0,1] neg_lo:[1,0,0] neg_hi:[1,0,0]
v_pk_fma_f32 v[172:173], v[52:53], v[30:31], v[186:187] op_sel:[0,0,0] op_sel_hi:[1,0,0] neg_lo:[0,0,1] neg_hi:[0,0,1]
v_pk_fma_f32 v[52:53], v[52:53], v[30:31], v[186:187] op_sel:[0,0,1] op_sel_hi:[1,0,1] neg_lo:[1,0,0] neg_hi:[1,0,0]
v_pk_fma_f32 v[174:175], v[54:55], v[30:31], v[186:187] op_sel:[0,0,0] op_sel_hi:[1,0,0] neg_lo:[0,0,1] neg_hi:[0,0,1]
v_pk_fma_f32 v[54:55], v[54:55], v[30:31], v[186:187] op_sel:[0,0,1] op_sel_hi:[1,0,1] neg_lo:[1,0,0] neg_hi:[1,0,0]
v_pk_fma_f32 v[176:177], v[56:57], v[30:31], v[186:187] op_sel:[0,0,0] op_sel_hi:[1,0,0] neg_lo:[0,0,1] neg_hi:[0,0,1]
v_pk_fma_f32 v[56:57], v[56:57], v[30:31], v[186:187] op_sel:[0,0,1] op_sel_hi:[1,0,1] neg_lo:[1,0,0] neg_hi:[1,0,0]
v_pk_fma_f32 v[178:179], v[58:59], v[30:31], v[186:187] op_sel:[0,0,0] op_sel_hi:[1,0,0] neg_lo:[0,0,1] neg_hi:[0,0,1]
v_pk_fma_f32 v[58:59], v[58:59], v[30:31], v[186:187] op_sel:[0,0,1] op_sel_hi:[1,0,1] neg_lo:[1,0,0] neg_hi:[1,0,0]
v_pk_fma_f32 v[180:181], v[60:61], v[30:31], v[186:187] op_sel:[0,0,0] op_sel_hi:[1,0,0] neg_lo:[0,0,1] neg_hi:[0,0,1]
v_pk_fma_f32 v[60:61], v[60:61], v[30:31], v[186:187] op_sel:[0,0,1] op_sel_hi:[1,0,1] neg_lo:[1,0,0] neg_hi:[1,0,0]
v_pk_fma_f32 v[182:183], v[62:63], v[30:31], v[186:187] op_sel:[0,0,0] op_sel_hi:[1,0,0] neg_lo:[0,0,1] neg_hi:[0,0,1]
v_pk_fma_f32 v[62:63], v[62:63], v[30:31], v[186:187] op_sel:[0,0,1] op_sel_hi:[1,0,1] neg_lo:[1,0,0] neg_hi:[1,0,0]
v_pk_fma_f32 v[184:185], v[244:245], v[30:31], v[186:187] op_sel:[0,0,0] op_sel_hi:[1,0,0] neg_lo:[0,0,1] neg_hi:[0,0,1]
v_pk_fma_f32 v[244:245], v[244:245], v[30:31], v[186:187] op_sel:[0,0,1] op_sel_hi:[1,0,1] neg_lo:[1,0,0] neg_hi:[1,0,0]
v_mfma_f32_32x32x16_bf16 v[96:111], a[168:171], a[48:51], v[96:111]
s_waitcnt lgkmcnt(6)
ds_read_b64_tr_b16 a[164:165], v28 offset:32768
ds_read_b64_tr_b16 a[166:167], v28 offset:33024
v_exp_f32 v168, v168
v_exp_f32 v48, v48
v_mfma_f32_32x32x16_bf16 v[112:127], a[144:147], a[48:51], v[112:127]
buffer_load_dwordx4 v23, s[12:15], s41 offen offset:3072 lds
ds_read_b64_tr_b16 a[168:169], v28 offset:33792
ds_read_b64_tr_b16 a[170:171], v28 offset:34048
v_mfma_f32_32x32x16_bf16 v[64:79], a[148:151], a[52:55], v[64:79]
s_waitcnt lgkmcnt(6)
s_add_u32 m0, s35, 28672
ds_read_b64_tr_b16 a[144:145], v28 offset:34816
ds_read_b64_tr_b16 a[146:147], v28 offset:35072
v_exp_f32 v169, v169
v_exp_f32 v49, v49
v_mfma_f32_32x32x16_bf16 v[80:95], a[152:155], a[52:55], v[80:95]
s_add_u32 s41, s38, 223520
ds_read_b64_tr_b16 a[148:149], v28 offset:35840
ds_read_b64_tr_b16 a[150:151], v28 offset:36096
v_exp_f32 v170, v170
v_exp_f32 v50, v50
v_mfma_f32_32x32x16_bf16 v[96:111], a[156:159], a[52:55], v[96:111]
s_waitcnt lgkmcnt(6)
ds_read_b64_tr_b16 a[152:153], v29 offset:32768
ds_read_b64_tr_b16 a[154:155], v29 offset:33024
v_exp_f32 v171, v171
v_exp_f32 v51, v51
v_mfma_f32_32x32x16_bf16 v[112:127], a[160:163], a[52:55], v[112:127]
ds_read_b64_tr_b16 a[156:157], v29 offset:33792
ds_read_b64_tr_b16 a[158:159], v29 offset:34048
v_exp_f32 v172, v172
v_exp_f32 v52, v52
s_waitcnt vmcnt(5)
s_barrier
v_mfma_f32_32x32x16_bf16 v[64:79], a[164:167], a[56:59], v[64:79]
s_waitcnt lgkmcnt(6)
buffer_load_dwordx4 v20, s[12:15], s41 offen offset:0 lds
ds_read_b64_tr_b16 a[160:161], v29 offset:34816
ds_read_b64_tr_b16 a[162:163], v29 offset:35072
v_mfma_f32_32x32x16_bf16 v[80:95], a[168:171], a[56:59], v[80:95]
ds_read_b64_tr_b16 a[164:165], v29 offset:35840
ds_read_b64_tr_b16 a[166:167], v29 offset:36096
v_exp_f32 v173, v173
v_exp_f32 v53, v53
v_mfma_f32_32x32x16_bf16 v[96:111], a[144:147], a[56:59], v[96:111]
s_waitcnt lgkmcnt(6)
ds_read_b64_tr_b16 a[168:169], v26 offset:20480
ds_read_b64_tr_b16 a[170:171], v26 offset:20736
v_exp_f32 v174, v174
v_exp_f32 v54, v54
v_mfma_f32_32x32x16_bf16 v[112:127], a[148:151], a[56:59], v[112:127]
buffer_load_dwordx4 v21, s[12:15], s41 offen offset:1024 lds
ds_read_b64_tr_b16 a[144:145], v26 offset:21504
ds_read_b64_tr_b16 a[146:147], v26 offset:21760
v_mfma_f32_32x32x16_bf16 v[64:79], a[152:155], a[60:63], v[64:79]
s_waitcnt lgkmcnt(6)
ds_read_b64_tr_b16 a[148:149], v26 offset:22528
ds_read_b64_tr_b16 a[150:151], v26 offset:22784
v_exp_f32 v175, v175
v_exp_f32 v55, v55
v_mfma_f32_32x32x16_bf16 v[80:95], a[156:159], a[60:63], v[80:95]
ds_read_b64_tr_b16 a[152:153], v26 offset:23552
ds_read_b64_tr_b16 a[154:155], v26 offset:23808
v_exp_f32 v176, v176
v_exp_f32 v56, v56
v_mfma_f32_32x32x16_bf16 v[96:111], a[160:163], a[60:63], v[96:111]
s_waitcnt lgkmcnt(6)
buffer_load_dwordx4 v22, s[12:15], s41 offen offset:2048 lds
ds_read_b64_tr_b16 a[156:157], v27 offset:20480
ds_read_b64_tr_b16 a[158:159], v27 offset:20736
v_mfma_f32_32x32x16_bf16 v[112:127], a[164:167], a[60:63], v[112:127]
ds_read_b64_tr_b16 a[160:161], v27 offset:21504
ds_read_b64_tr_b16 a[162:163], v27 offset:21760
v_exp_f32 v177, v177
v_exp_f32 v57, v57
v_mfma_f32_32x32x16_bf16 v[64:79], a[168:171], a[64:67], v[64:79]
s_waitcnt lgkmcnt(6)
ds_read_b64_tr_b16 a[164:165], v27 offset:22528
ds_read_b64_tr_b16 a[166:167], v27 offset:22784
v_exp_f32 v178, v178
v_exp_f32 v58, v58
v_mfma_f32_32x32x16_bf16 v[80:95], a[144:147], a[64:67], v[80:95]
buffer_load_dwordx4 v23, s[12:15], s41 offen offset:3072 lds
ds_read_b64_tr_b16 a[168:169], v27 offset:23552
ds_read_b64_tr_b16 a[170:171], v27 offset:23808
v_mfma_f32_32x32x16_bf16 v[96:111], a[148:151], a[64:67], v[96:111]
s_waitcnt lgkmcnt(6)
s_add_u32 m0, s35, 32768
ds_read_b64_tr_b16 a[144:145], v28 offset:20480
ds_read_b64_tr_b16 a[146:147], v28 offset:20736
v_exp_f32 v179, v179
v_exp_f32 v59, v59
v_mfma_f32_32x32x16_bf16 v[112:127], a[152:155], a[64:67], v[112:127]
s_add_u32 s41, s38, 887072
ds_read_b64_tr_b16 a[148:149], v28 offset:21504
ds_read_b64_tr_b16 a[150:151], v28 offset:21760
v_exp_f32 v180, v180
v_exp_f32 v60, v60
v_mfma_f32_32x32x16_bf16 v[64:79], a[156:159], a[68:71], v[64:79]
s_waitcnt lgkmcnt(6)
ds_read_b64_tr_b16 a[152:153], v28 offset:22528
ds_read_b64_tr_b16 a[154:155], v28 offset:22784
v_exp_f32 v181, v181
v_exp_f32 v61, v61
v_mfma_f32_32x32x16_bf16 v[80:95], a[160:163], a[68:71], v[80:95]
ds_read_b64_tr_b16 a[156:157], v28 offset:23552
ds_read_b64_tr_b16 a[158:159], v28 offset:23808
v_exp_f32 v182, v182
v_exp_f32 v62, v62
v_mfma_f32_32x32x16_bf16 v[96:111], a[164:167], a[68:71], v[96:111]
s_waitcnt lgkmcnt(6)
ds_read_b64_tr_b16 a[160:161], v29 offset:20480
ds_read_b64_tr_b16 a[162:163], v29 offset:20736
v_exp_f32 v183, v183
v_exp_f32 v63, v63
v_mfma_f32_32x32x16_bf16 v[112:127], a[168:171], a[68:71], v[112:127]
ds_read_b64_tr_b16 a[164:165], v29 offset:21504
ds_read_b64_tr_b16 a[166:167], v29 offset:21760
v_exp_f32 v184, v184
v_exp_f32 v244, v244
s_waitcnt vmcnt(4)
s_barrier
v_mfma_f32_32x32x16_bf16 v[64:79], a[144:147], a[72:75], v[64:79]
s_waitcnt lgkmcnt(6)
buffer_load_dwordx4 v20, s[12:15], s41 offen offset:0 lds
ds_read_b64_tr_b16 a[168:169], v29 offset:22528
ds_read_b64_tr_b16 a[170:171], v29 offset:22784
v_mfma_f32_32x32x16_bf16 v[80:95], a[148:151], a[72:75], v[80:95]
ds_read_b64_tr_b16 a[144:145], v29 offset:23552
ds_read_b64_tr_b16 a[146:147], v29 offset:23808
v_exp_f32 v185, v185
v_exp_f32 v245, v245
v_pk_add_f32 v[186:187], v[168:169], v[170:171] op_sel:[0,0] op_sel_hi:[1,1]
v_pk_add_f32 v[188:189], v[48:49], v[50:51] op_sel:[0,0] op_sel_hi:[1,1]
v_pk_add_f32 v[186:187], v[186:187], v[172:173] op_sel:[0,0] op_sel_hi:[1,1]
v_pk_add_f32 v[188:189], v[188:189], v[52:53] op_sel:[0,0] op_sel_hi:[1,1]
v_pk_add_f32 v[186:187], v[186:187], v[174:175] op_sel:[0,0] op_sel_hi:[1,1]
v_pk_add_f32 v[188:189], v[188:189], v[54:55] op_sel:[0,0] op_sel_hi:[1,1]
v_pk_add_f32 v[186:187], v[186:187], v[176:177] op_sel:[0,0] op_sel_hi:[1,1]
v_pk_add_f32 v[188:189], v[188:189], v[56:57] op_sel:[0,0] op_sel_hi:[1,1]
v_pk_add_f32 v[186:187], v[186:187], v[178:179] op_sel:[0,0] op_sel_hi:[1,1]
v_pk_add_f32 v[188:189], v[188:189], v[58:59] op_sel:[0,0] op_sel_hi:[1,1]
v_pk_add_f32 v[186:187], v[186:187], v[180:181] op_sel:[0,0] op_sel_hi:[1,1]
v_pk_add_f32 v[188:189], v[188:189], v[60:61] op_sel:[0,0] op_sel_hi:[1,1]
v_pk_add_f32 v[186:187], v[186:187], v[182:183] op_sel:[0,0] op_sel_hi:[1,1]
v_pk_add_f32 v[188:189], v[188:189], v[62:63] op_sel:[0,0] op_sel_hi:[1,1]
v_pk_add_f32 v[186:187], v[186:187], v[184:185] op_sel:[0,0] op_sel_hi:[1,1]
v_pk_add_f32 v[188:189], v[188:189], v[244:245] op_sel:[0,0] op_sel_hi:[1,1]
v_add_f32 v188, v188, v189
v_add_f32 v186, v186, v187
v_rcp_f32 v188, v188
v_rcp_f32 v186, v186
v_mul_f32 v188, v188, v14
v_mul_f32 v186, v186, v14
v_pk_mul_f32 v[48:49], v[48:49], v[188:189] op_sel:[0,0] op_sel_hi:[1,0]
v_pk_mul_f32 v[50:51], v[50:51], v[188:189] op_sel:[0,0] op_sel_hi:[1,0]
v_pk_mul_f32 v[52:53], v[52:53], v[188:189] op_sel:[0,0] op_sel_hi:[1,0]
v_pk_mul_f32 v[54:55], v[54:55], v[188:189] op_sel:[0,0] op_sel_hi:[1,0]
v_pk_mul_f32 v[56:57], v[56:57], v[188:189] op_sel:[0,0] op_sel_hi:[1,0]
v_pk_mul_f32 v[58:59], v[58:59], v[188:189] op_sel:[0,0] op_sel_hi:[1,0]
v_pk_mul_f32 v[60:61], v[60:61], v[188:189] op_sel:[0,0] op_sel_hi:[1,0]
v_pk_mul_f32 v[62:63], v[62:63], v[188:189] op_sel:[0,0] op_sel_hi:[1,0]
v_pk_mul_f32 v[244:245], v[244:245], v[188:189] op_sel:[0,0] op_sel_hi:[1,0]
v_pk_mul_f32 v[168:169], v[168:169], v[186:187] op_sel:[0,0] op_sel_hi:[1,0]
v_pk_mul_f32 v[170:171], v[170:171], v[186:187] op_sel:[0,0] op_sel_hi:[1,0]
v_pk_mul_f32 v[172:173], v[172:173], v[186:187] op_sel:[0,0] op_sel_hi:[1,0]
v_pk_mul_f32 v[174:175], v[174:175], v[186:187] op_sel:[0,0] op_sel_hi:[1,0]
v_pk_mul_f32 v[176:177], v[176:177], v[186:187] op_sel:[0,0] op_sel_hi:[1,0]
v_pk_mul_f32 v[178:179], v[178:179], v[186:187] op_sel:[0,0] op_sel_hi:[1,0]
v_pk_mul_f32 v[180:181], v[180:181], v[186:187] op_sel:[0,0] op_sel_hi:[1,0]
v_pk_mul_f32 v[182:183], v[182:183], v[186:187] op_sel:[0,0] op_sel_hi:[1,0]
v_pk_mul_f32 v[184:185], v[184:185], v[186:187] op_sel:[0,0] op_sel_hi:[1,0]
v_mfma_f32_32x32x16_bf16 v[96:111], a[152:155], a[72:75], v[96:111]
s_waitcnt lgkmcnt(6)
ds_read_b64_tr_b16 a[148:149], v26 offset:24576
ds_read_b64_tr_b16 a[150:151], v26 offset:24832
v_cvt_pk_bf16_f32 v190, v168, v169
v_cvt_pk_bf16_f32 v191, v170, v171
v_cvt_pk_bf16_f32 v192, v172, v173
v_cvt_pk_bf16_f32 v193, v174, v175
v_cvt_pk_bf16_f32 v194, v176, v177
v_mfma_f32_32x32x16_bf16 v[112:127], a[156:159], a[72:75], v[112:127]
buffer_load_dwordx4 v21, s[12:15], s41 offen offset:1024 lds
ds_read_b64_tr_b16 a[152:153], v26 offset:25600
ds_read_b64_tr_b16 a[154:155], v26 offset:25856
v_mfma_f32_32x32x16_bf16 v[64:79], a[160:163], a[76:79], v[64:79]
s_waitcnt lgkmcnt(6)
ds_read_b64_tr_b16 a[156:157], v26 offset:26624
ds_read_b64_tr_b16 a[158:159], v26 offset:26880
v_cvt_pk_bf16_f32 v195, v178, v179
v_cvt_pk_bf16_f32 v196, v180, v181
v_cvt_pk_bf16_f32 v197, v182, v183
v_cvt_pk_bf16_f32 v198, v184, v185
v_cvt_pk_bf16_f32 v199, v48, v49
v_mfma_f32_32x32x16_bf16 v[80:95], a[164:167], a[76:79], v[80:95]
ds_read_b64_tr_b16 a[160:161], v26 offset:27648
ds_read_b64_tr_b16 a[162:163], v26 offset:27904
v_cvt_pk_bf16_f32 v200, v50, v51
v_cvt_pk_bf16_f32 v201, v52, v53
v_cvt_pk_bf16_f32 v202, v54, v55
v_cvt_pk_bf16_f32 v203, v56, v57
v_cvt_pk_bf16_f32 v204, v58, v59
v_mfma_f32_32x32x16_bf16 v[96:111], a[168:171], a[76:79], v[96:111]
s_waitcnt lgkmcnt(6)
buffer_load_dwordx4 v22, s[12:15], s41 offen offset:2048 lds
ds_read_b64_tr_b16 a[164:165], v27 offset:24576
ds_read_b64_tr_b16 a[166:167], v27 offset:24832
v_cmp_le_u32 vcc, 1, v8
s_nop 1
s_andn2_b32 s7, 0xffff, vcc_lo
s_cbranch_scc1 L_spin_ak
L_back_ak:
v_mfma_f32_32x32x16_bf16 v[112:127], a[144:147], a[76:79], v[112:127]
ds_read_b64_tr_b16 a[168:169], v27 offset:25600
ds_read_b64_tr_b16 a[170:171], v27 offset:25856
v_cvt_pk_bf16_f32 v205, v60, v61
v_cvt_pk_bf16_f32 v206, v62, v63
v_cvt_pk_bf16_f32 v207, v244, v245
ds_write_b64 v12, v[190:191] offset:144
ds_write_b64 v12, v[192:193] offset:152
v_mfma_f32_32x32x16_bf16 v[64:79], a[148:151], a[80:83], v[64:79]
s_waitcnt lgkmcnt(8)
ds_read_b64_tr_b16 a[144:145], v27 offset:26624
ds_read_b64_tr_b16 a[146:147], v27 offset:26880
ds_write_b64 v12, v[194:195] offset:160
ds_write_b64 v12, v[196:197] offset:168
ds_write_b64 v12, v[198:199] offset:176
ds_write_b64 v12, v[200:201] offset:184
ds_write_b64 v12, v[202:203] offset:192
v_mfma_f32_32x32x16_bf16 v[80:95], a[152:155], a[80:83], v[80:95]
buffer_load_dwordx4 v23, s[12:15], s41 offen offset:3072 lds
ds_read_b64_tr_b16 a[148:149], v27 offset:27648
ds_read_b64_tr_b16 a[150:151], v27 offset:27904
v_mfma_f32_32x32x16_bf16 v[96:111], a[156:159], a[80:83], v[96:111]
s_waitcnt lgkmcnt(13)
s_add_u32 m0, s35, 20480
ds_read_b64_tr_b16 a[152:153], v28 offset:24576
ds_read_b64_tr_b16 a[154:155], v28 offset:24832
ds_write_b64 v12, v[204:205] offset:200
ds_write_b64 v12, v[206:207] offset:208
v_max3_f32 v186, v208, v209, v210
v_min3_f32 v187, v208, v209, v210
v_max3_f32 v186, v186, v211, v212
v_mfma_f32_32x32x16_bf16 v[112:127], a[160:163], a[80:83], v[112:127]
s_add_u32 s41, s38, 1550624
ds_read_b64_tr_b16 a[156:157], v28 offset:25600
ds_read_b64_tr_b16 a[158:159], v28 offset:25856
v_min3_f32 v187, v187, v211, v212
v_max3_f32 v186, v186, v213, v214
v_min3_f32 v187, v187, v213, v214
v_max3_f32 v186, v186, v215, v216
v_min3_f32 v187, v187, v215, v216
v_mfma_f32_32x32x16_bf16 v[64:79], a[164:167], a[84:87], v[64:79]
s_waitcnt lgkmcnt(13)
ds_read_b64_tr_b16 a[160:161], v28 offset:26624
ds_read_b64_tr_b16 a[162:163], v28 offset:26880
v_max3_f32 v186, v186, v217, v218
v_min3_f32 v187, v187, v217, v218
v_max3_f32 v186, v186, v219, v220
v_min3_f32 v187, v187, v219, v220
v_max3_f32 v186, v186, v221, v222
v_mfma_f32_32x32x16_bf16 v[80:95], a[168:171], a[84:87], v[80:95]
ds_read_b64_tr_b16 a[164:165], v28 offset:27648
ds_read_b64_tr_b16 a[166:167], v28 offset:27904
v_min3_f32 v187, v187, v221, v222
v_max3_f32 v186, v186, v223, v248
v_min3_f32 v187, v187, v223, v248
v_max_f32 v186, v186, v249
v_min_f32 v187, v187, v249
v_mfma_f32_32x32x16_bf16 v[96:111], a[144:147], a[84:87], v[96:111]
s_waitcnt lgkmcnt(8)
ds_read_b64_tr_b16 a[168:169], v29 offset:24576
ds_read_b64_tr_b16 a[170:171], v29 offset:24832
v_mul_f32 v186, v186, v30
v_mul_f32 v187, v187, v30
v_pk_fma_f32 v[168:169], v[208:209], v[30:31], v[186:187] op_sel:[0,0,0] op_sel_hi:[1,0,0] neg_lo:[0,0,1] neg_hi:[0,0,1]
v_pk_fma_f32 v[208:209], v[208:209], v[30:31], v[186:187] op_sel:[0,0,1] op_sel_hi:[1,0,1] neg_lo:[1,0,0] neg_hi:[1,0,0]
v_pk_fma_f32 v[170:171], v[210:211], v[30:31], v[186:187] op_sel:[0,0,0] op_sel_hi:[1,0,0] neg_lo:[0,0,1] neg_hi:[0,0,1]
v_pk_fma_f32 v[210:211], v[210:211], v[30:31], v[186:187] op_sel:[0,0,1] op_sel_hi:[1,0,1] neg_lo:[1,0,0] neg_hi:[1,0,0]
v_pk_fma_f32 v[172:173], v[212:213], v[30:31], v[186:187] op_sel:[0,0,0] op_sel_hi:[1,0,0] neg_lo:[0,0,1] neg_hi:[0,0,1]
v_pk_fma_f32 v[212:213], v[212:213], v[30:31], v[186:187] op_sel:[0,0,1] op_sel_hi:[1,0,1] neg_lo:[1,0,0] neg_hi:[1,0,0]
v_pk_fma_f32 v[174:175], v[214:215], v[30:31], v[186:187] op_sel:[0,0,0] op_sel_hi:[1,0,0] neg_lo:[0,0,1] neg_hi:[0,0,1]
v_pk_fma_f32 v[214:215], v[214:215], v[30:31], v[186:187] op_sel:[0,0,1] op_sel_hi:[1,0,1] neg_lo:[1,0,0] neg_hi:[1,0,0]
v_pk_fma_f32 v[176:177], v[216:217], v[30:31], v[186:187] op_sel:[0,0,0] op_sel_hi:[1,0,0] neg_lo:[0,0,1] neg_hi:[0,0,1]
v_pk_fma_f32 v[216:217], v[216:217], v[30:31], v[186:187] op_sel:[0,0,1] op_sel_hi:[1,0,1] neg_lo:[1,0,0] neg_hi:[1,0,0]
v_pk_fma_f32 v[178:179], v[218:219], v[30:31], v[186:187] op_sel:[0,0,0] op_sel_hi:[1,0,0] neg_lo:[0,0,1] neg_hi:[0,0,1]
v_pk_fma_f32 v[218:219], v[218:219], v[30:31], v[186:187] op_sel:[0,0,1] op_sel_hi:[1,0,1] neg_lo:[1,0,0] neg_hi:[1,0,0]
v_pk_fma_f32 v[180:181], v[220:221], v[30:31], v[186:187] op_sel:[0,0,0] op_sel_hi:[1,0,0] neg_lo:[0,0,1] neg_hi:[0,0,1]
v_pk_fma_f32 v[220:221], v[220:221], v[30:31], v[186:187] op_sel:[0,0,1] op_sel_hi:[1,0,1] neg_lo:[1,0,0] neg_hi:[1,0,0]
v_pk_fma_f32 v[182:183], v[222:223], v[30:31], v[186:187] op_sel:[0,0,0] op_sel_hi:[1,0,0] neg_lo:[0,0,1] neg_hi:[0,0,1]
v_pk_fma_f32 v[222:223], v[222:223], v[30:31], v[186:187] op_sel:[0,0,1] op_sel_hi:[1,0,1] neg_lo:[1,0,0] neg_hi:[1,0,0]
v_pk_fma_f32 v[184:185], v[248:249], v[30:31], v[186:187] op_sel:[0,0,0] op_sel_hi:[1,0,0] neg_lo:[0,0,1] neg_hi:[0,0,1]
v_pk_fma_f32 v[248:249], v[248:249], v[30:31], v[186:187] op_sel:[0,0,1] op_sel_hi:[1,0,1] neg_lo:[1,0,0] neg_hi:[1,0,0]
v_mfma_f32_32x32x16_bf16 v[112:127], a[148:151], a[84:87], v[112:127]
ds_read_b64_tr_b16 a[144:145], v29 offset:25600
ds_read_b64_tr_b16 a[146:147], v29 offset:25856
v_exp_f32 v168, v168
v_exp_f32 v208, v208
s_waitcnt vmcnt(4)
s_barrier
v_mfma_f32_32x32x16_bf16 v[64:79], a[152:155], a[88:91], v[64:79]
s_waitcnt lgkmcnt(6)
buffer_load_dwordx4 v20, s[12:15], s41 offen offset:0 lds
ds_read_b64_tr_b16 a[148:149], v29 offset:26624
ds_read_b64_tr_b16 a[150:151], v29 offset:26880
v_mfma_f32_32x32x16_bf16 v[80:95], a[156:159], a[88:91], v[80:95]
ds_read_b64_tr_b16 a[152:153], v29 offset:27648
ds_read_b64_tr_b16 a[154:155], v29 offset:27904
v_exp_f32 v169, v169
v_exp_f32 v209, v209
v_mfma_f32_32x32x16_bf16 v[96:111], a[160:163], a[88:91], v[96:111]
s_waitcnt lgkmcnt(6)
ds_read_b64_tr_b16 a[156:157], v26 offset:28672
ds_read_b64_tr_b16 a[158:159], v26 offset:28928
v_exp_f32 v170, v170
v_exp_f32 v210, v210
v_mfma_f32_32x32x16_bf16 v[112:127], a[164:167], a[88:91], v[112:127]
buffer_load_dwordx4 v21, s[12:15], s41 offen offset:1024 lds
ds_read_b64_tr_b16 a[160:161], v26 offset:29696
ds_read_b64_tr_b16 a[162:163], v26 offset:29952
v_mfma_f32_32x32x16_bf16 v[64:79], a[168:171], a[92:95], v[64:79]
s_waitcnt lgkmcnt(6)
ds_read_b64_tr_b16 a[164:165], v26 offset:30720
ds_read_b64_tr_b16 a[166:167], v26 offset:30976
v_exp_f32 v171, v171
v_exp_f32 v211, v211
v_mfma_f32_32x32x16_bf16 v[80:95], a[144:147], a[92:95], v[80:95]
ds_read_b64_tr_b16 a[168:169], v26 offset:31744
ds_read_b64_tr_b16 a[170:171], v26 offset:32000
v_exp_f32 v172, v172
v_exp_f32 v212, v212
v_mfma_f32_32x32x16_bf16 v[96:111], a[148:151], a[92:95], v[96:111]
s_waitcnt lgkmcnt(6)
buffer_load_dwordx4 v22, s[12:15], s41 offen offset:2048 lds
ds_read_b64_tr_b16 a[144:145], v27 offset:28672
ds_read_b64_tr_b16 a[146:147], v27 offset:28928
L_pad_a1_1:
s_cbranch_execz L_pad_a1_2
v_mfma_f32_32x32x16_bf16 v[112:127], a[152:155], a[92:95], v[112:127]
ds_read_b64_tr_b16 a[148:149], v27 offset:29696
ds_read_b64_tr_b16 a[150:151], v27 offset:29952
v_exp_f32 v173, v173
v_exp_f32 v213, v213
v_mfma_f32_32x32x16_bf16 v[64:79], a[156:159], a[96:99], v[64:79]
s_waitcnt lgkmcnt(6)
ds_read_b64_tr_b16 a[152:153], v27 offset:30720
ds_read_b64_tr_b16 a[154:155], v27 offset:30976
v_exp_f32 v174, v174
v_exp_f32 v214, v214
v_mfma_f32_32x32x16_bf16 v[80:95], a[160:163], a[96:99], v[80:95]
buffer_load_dwordx4 v23, s[12:15], s41 offen offset:3072 lds
ds_read_b64_tr_b16 a[156:157], v27 offset:31744
ds_read_b64_tr_b16 a[158:159], v27 offset:32000
v_mfma_f32_32x32x16_bf16 v[96:111], a[164:167], a[96:99], v[96:111]
s_waitcnt lgkmcnt(6)
s_mov_b32 m0, s62
ds_read_b64_tr_b16 a[160:161], v28 offset:28672
ds_read_b64_tr_b16 a[162:163], v28 offset:28928
v_exp_f32 v175, v175
v_exp_f32 v215, v215
v_mfma_f32_32x32x16_bf16 v[112:127], a[168:171], a[96:99], v[112:127]
s_add_u32 s41, s38, 442368
ds_read_b64_tr_b16 a[164:165], v28 offset:29696
ds_read_b64_tr_b16 a[166:167], v28 offset:29952
v_exp_f32 v176, v176
v_exp_f32 v216, v216
v_mfma_f32_32x32x16_bf16 v[64:79], a[144:147], a[100:103], v[64:79]
s_waitcnt lgkmcnt(6)
buffer_load_dwordx4 v20, s[12:15], s41 offen offset:0 lds
ds_read_b64_tr_b16 a[168:169], v28 offset:30720
ds_read_b64_tr_b16 a[170:171], v28 offset:30976
v_mfma_f32_32x32x16_bf16 v[80:95], a[148:151], a[100:103], v[80:95]
ds_read_b64_tr_b16 a[144:145], v28 offset:31744
ds_read_b64_tr_b16 a[146:147], v28 offset:32000
v_exp_f32 v177, v177
v_exp_f32 v217, v217
v_mfma_f32_32x32x16_bf16 v[96:111], a[152:155], a[100:103], v[96:111]
s_waitcnt lgkmcnt(6)
ds_read_b64_tr_b16 a[148:149], v29 offset:28672
ds_read_b64_tr_b16 a[150:151], v29 offset:28928
v_exp_f32 v178, v178
v_exp_f32 v218, v218
v_mfma_f32_32x32x16_bf16 v[112:127], a[156:159], a[100:103], v[112:127]
buffer_load_dwordx4 v21, s[12:15], s41 offen offset:1024 lds
ds_read_b64_tr_b16 a[152:153], v29 offset:29696
ds_read_b64_tr_b16 a[154:155], v29 offset:29952
s_waitcnt vmcnt(6)
s_barrier
v_mfma_f32_32x32x16_bf16 v[64:79], a[160:163], a[104:107], v[64:79]
s_waitcnt lgkmcnt(6)
ds_read_b64_tr_b16 a[156:157], v29 offset:30720
ds_read_b64_tr_b16 a[158:159], v29 offset:30976
v_exp_f32 v179, v179
v_exp_f32 v219, v219
v_exp_f32 v180, v180
v_mfma_f32_32x32x16_bf16 v[80:95], a[164:167], a[104:107], v[80:95]
ds_read_b64_tr_b16 a[160:161], v29 offset:31744
ds_read_b64_tr_b16 a[162:163], v29 offset:32000
v_exp_f32 v220, v220
v_exp_f32 v181, v181
v_exp_f32 v221, v221
v_mfma_f32_32x32x16_bf16 v[96:111], a[168:171], a[104:107], v[96:111]
s_waitcnt lgkmcnt(6)
buffer_load_dwordx4 v22, s[12:15], s41 offen offset:2048 lds
ds_read_b64_tr_b16 a[164:165], v26 offset:32768
ds_read_b64_tr_b16 a[166:167], v26 offset:33024
v_mfma_f32_32x32x16_bf16 v[112:127], a[144:147], a[104:107], v[112:127]
ds_read_b64_tr_b16 a[168:169], v26 offset:33792
ds_read_b64_tr_b16 a[170:171], v26 offset:34048
v_exp_f32 v182, v182
v_exp_f32 v222, v222
v_exp_f32 v183, v183
v_mfma_f32_32x32x16_bf16 v[64:79], a[148:151], a[108:111], v[64:79]
s_waitcnt lgkmcnt(6)
ds_read_b64_tr_b16 a[144:145], v26 offset:34816
ds_read_b64_tr_b16 a[146:147], v26 offset:35072
v_exp_f32 v223, v223
v_exp_f32 v184, v184
v_exp_f32 v248, v248
v_mfma_f32_32x32x16_bf16 v[80:95], a[152:155], a[108:111], v[80:95]
buffer_load_dwordx4 v23, s[12:15], s41 offen offset:3072 lds
ds_read_b64_tr_b16 a[148:149], v26 offset:35840
ds_read_b64_tr_b16 a[150:151], v26 offset:36096
v_mfma_f32_32x32x16_bf16 v[96:111], a[156:159], a[108:111], v[96:111]
s_waitcnt lgkmcnt(6)
s_add_u32 m0, s35, 19200
ds_read_b64_tr_b16 a[152:153], v27 offset:32768
ds_read_b64_tr_b16 a[154:155], v27 offset:33024
v_exp_f32 v185, v185
v_exp_f32 v249, v249
v_pk_add_f32 v[186:187], v[168:169], v[170:171] op_sel:[0,0] op_sel_hi:[1,1]
v_pk_add_f32 v[188:189], v[208:209], v[210:211] op_sel:[0,0] op_sel_hi:[1,1]
v_pk_add_f32 v[186:187], v[186:187], v[172:173] op_sel:[0,0] op_sel_hi:[1,1]
v_pk_add_f32 v[188:189], v[188:189], v[212:213] op_sel:[0,0] op_sel_hi:[1,1]
v_pk_add_f32 v[186:187], v[186:187], v[174:175] op_sel:[0,0] op_sel_hi:[1,1]
v_pk_add_f32 v[188:189], v[188:189], v[214:215] op_sel:[0,0] op_sel_hi:[1,1]
v_pk_add_f32 v[186:187], v[186:187], v[176:177] op_sel:[0,0] op_sel_hi:[1,1]
v_pk_add_f32 v[188:189], v[188:189], v[216:217] op_sel:[0,0] op_sel_hi:[1,1]
v_pk_add_f32 v[186:187], v[186:187], v[178:179] op_sel:[0,0] op_sel_hi:[1,1]
v_pk_add_f32 v[188:189], v[188:189], v[218:219] op_sel:[0,0] op_sel_hi:[1,1]
v_pk_add_f32 v[186:187], v[186:187], v[180:181] op_sel:[0,0] op_sel_hi:[1,1]
v_pk_add_f32 v[188:189], v[188:189], v[220:221] op_sel:[0,0] op_sel_hi:[1,1]
v_pk_add_f32 v[186:187], v[186:187], v[182:183] op_sel:[0,0] op_sel_hi:[1,1]
v_pk_add_f32 v[188:189], v[188:189], v[222:223] op_sel:[0,0] op_sel_hi:[1,1]
v_pk_add_f32 v[186:187], v[186:187], v[184:185] op_sel:[0,0] op_sel_hi:[1,1]
v_pk_add_f32 v[188:189], v[188:189], v[248:249] op_sel:[0,0] op_sel_hi:[1,1]
v_add_f32 v188, v188, v189
v_add_f32 v186, v186, v187
v_rcp_f32 v188, v188
v_rcp_f32 v186, v186
v_mul_f32 v188, v188, v14
v_mul_f32 v186, v186, v14
v_pk_mul_f32 v[208:209], v[208:209], v[188:189] op_sel:[0,0] op_sel_hi:[1,0]
v_pk_mul_f32 v[210:211], v[210:211], v[188:189] op_sel:[0,0] op_sel_hi:[1,0]
v_pk_mul_f32 v[212:213], v[212:213], v[188:189] op_sel:[0,0] op_sel_hi:[1,0]
v_pk_mul_f32 v[214:215], v[214:215], v[188:189] op_sel:[0,0] op_sel_hi:[1,0]
v_pk_mul_f32 v[216:217], v[216:217], v[188:189] op_sel:[0,0] op_sel_hi:[1,0]
v_pk_mul_f32 v[218:219], v[218:219], v[188:189] op_sel:[0,0] op_sel_hi:[1,0]
v_pk_mul_f32 v[220:221], v[220:221], v[188:189] op_sel:[0,0] op_sel_hi:[1,0]
v_pk_mul_f32 v[222:223], v[222:223], v[188:189] op_sel:[0,0] op_sel_hi:[1,0]
v_pk_mul_f32 v[248:249], v[248:249], v[188:189] op_sel:[0,0] op_sel_hi:[1,0]
v_pk_mul_f32 v[168:169], v[168:169], v[186:187] op_sel:[0,0] op_sel_hi:[1,0]
v_pk_mul_f32 v[170:171], v[170:171], v[186:187] op_sel:[0,0] op_sel_hi:[1,0]
v_pk_mul_f32 v[172:173], v[172:173], v[186:187] op_sel:[0,0] op_sel_hi:[1,0]
v_pk_mul_f32 v[174:175], v[174:175], v[186:187] op_sel:[0,0] op_sel_hi:[1,0]
v_pk_mul_f32 v[176:177], v[176:177], v[186:187] op_sel:[0,0] op_sel_hi:[1,0]
v_pk_mul_f32 v[178:179], v[178:179], v[186:187] op_sel:[0,0] op_sel_hi:[1,0]
v_pk_mul_f32 v[180:181], v[180:181], v[186:187] op_sel:[0,0] op_sel_hi:[1,0]
v_pk_mul_f32 v[182:183], v[182:183], v[186:187] op_sel:[0,0] op_sel_hi:[1,0]
v_pk_mul_f32 v[184:185], v[184:185], v[186:187] op_sel:[0,0] op_sel_hi:[1,0]
v_mfma_f32_32x32x16_bf16 v[112:127], a[160:163], a[108:111], v[112:127]
ds_read_b64_tr_b16 a[156:157], v27 offset:33792
ds_read_b64_tr_b16 a[158:159], v27 offset:34048
v_cvt_pk_bf16_f32 v190, v168, v169
v_cvt_pk_bf16_f32 v191, v170, v171
v_cvt_pk_bf16_f32 v192, v172, v173
v_cvt_pk_bf16_f32 v193, v174, v175
v_cvt_pk_bf16_f32 v194, v176, v177
v_cvt_pk_bf16_f32 v195, v178, v179
v_mfma_f32_32x32x16_bf16 v[64:79], a[164:167], a[112:115], v[64:79]
s_waitcnt lgkmcnt(6)
buffer_load_dwordx4 v20, s[12:15], s41 offen offset:256 lds
ds_read_b64_tr_b16 a[160:161], v27 offset:34816
ds_read_b64_tr_b16 a[162:163], v27 offset:35072
v_mfma_f32_32x32x16_bf16 v[80:95], a[168:171], a[112:115], v[80:95]
s_add_u32 m0, s35, 31744
ds_read_b64_tr_b16 a[164:165], v27 offset:35840
ds_read_b64_tr_b16 a[166:167], v27 offset:36096
v_cvt_pk_bf16_f32 v196, v180, v181
v_cvt_pk_bf16_f32 v197, v182, v183
v_cvt_pk_bf16_f32 v198, v184, v185
v_cvt_pk_bf16_f32 v199, v208, v209
v_cvt_pk_bf16_f32 v200, v210, v211
v_cvt_pk_bf16_f32 v201, v212, v213
v_mfma_f32_32x32x16_bf16 v[96:111], a[144:147], a[112:115], v[96:111]
s_waitcnt lgkmcnt(6)
s_add_u32 s41, s38, 1105920
ds_read_b64_tr_b16 a[168:169], v28 offset:32768
ds_read_b64_tr_b16 a[170:171], v28 offset:33024
v_cvt_pk_bf16_f32 v202, v214, v215
v_cvt_pk_bf16_f32 v203, v216, v217
v_cvt_pk_bf16_f32 v204, v218, v219
v_cvt_pk_bf16_f32 v205, v220, v221
v_cvt_pk_bf16_f32 v206, v222, v223
v_cvt_pk_bf16_f32 v207, v248, v249
v_mfma_f32_32x32x16_bf16 v[112:127], a[148:151], a[112:115], v[112:127]
ds_read_b64_tr_b16 a[144:145], v28 offset:33792
ds_read_b64_tr_b16 a[146:147], v28 offset:34048
ds_write_b64 v12, v[190:191] offset:288
ds_write_b64 v12, v[192:193] offset:296
ds_write_b64 v12, v[194:195] offset:304
ds_write_b64 v12, v[196:197] offset:312
ds_write_b64 v12, v[198:199] offset:320
ds_write_b64 v12, v[200:201] offset:328
v_mfma_f32_32x32x16_bf16 v[64:79], a[152:155], a[116:119], v[64:79]
s_waitcnt lgkmcnt(12)
ds_read_b64_tr_b16 a[148:149], v28 offset:34816
ds_read_b64_tr_b16 a[150:151], v28 offset:35072
ds_write_b64 v12, v[202:203] offset:336
ds_write_b64 v12, v[204:205] offset:344
ds_write_b64 v12, v[206:207] offset:352
v_max3_f32 v186, v224, v225, v226
v_min3_f32 v187, v224, v225, v226
v_max3_f32 v186, v186, v227, v228
v_mfma_f32_32x32x16_bf16 v[80:95], a[156:159], a[116:119], v[80:95]
ds_read_b64_tr_b16 a[152:153], v28 offset:35840
ds_read_b64_tr_b16 a[154:155], v28 offset:36096
v_min3_f32 v187, v187, v227, v228
v_max3_f32 v186, v186, v229, v230
v_min3_f32 v187, v187, v229, v230
v_max3_f32 v186, v186, v231, v232
v_min3_f32 v187, v187, v231, v232
v_max3_f32 v186, v186, v233, v234
v_mfma_f32_32x32x16_bf16 v[96:111], a[160:163], a[116:119], v[96:111]
s_waitcnt lgkmcnt(15)
ds_read_b64_tr_b16 a[156:157], v29 offset:32768
ds_read_b64_tr_b16 a[158:159], v29 offset:33024
v_min3_f32 v187, v187, v233, v234
v_max3_f32 v186, v186, v235, v236
v_min3_f32 v187, v187, v235, v236
v_max3_f32 v186, v186, v237, v238
v_min3_f32 v187, v187, v237, v238
v_max3_f32 v186, v186, v239, v252
v_mfma_f32_32x32x16_bf16 v[112:127], a[164:167], a[116:119], v[112:127]
ds_read_b64_tr_b16 a[160:161], v29 offset:33792
ds_read_b64_tr_b16 a[162:163], v29 offset:34048
v_min3_f32 v187, v187, v239, v252
v_max_f32 v186, v186, v253
v_min_f32 v187, v187, v253
v_mul_f32 v186, v186, v30
v_mul_f32 v187, v187, v30
v_pk_fma_f32 v[168:169], v[224:225], v[30:31], v[186:187] op_sel:[0,0,0] op_sel_hi:[1,0,0] neg_lo:[0,0,1] neg_hi:[0,0,1]
v_pk_fma_f32 v[224:225], v[224:225], v[30:31], v[186:187] op_sel:[0,0,1] op_sel_hi:[1,0,1] neg_lo:[1,0,0] neg_hi:[1,0,0]
v_pk_fma_f32 v[170:171], v[226:227], v[30:31], v[186:187] op_sel:[0,0,0] op_sel_hi:[1,0,0] neg_lo:[0,0,1] neg_hi:[0,0,1]
v_pk_fma_f32 v[226:227], v[226:227], v[30:31], v[186:187] op_sel:[0,0,1] op_sel_hi:[1,0,1] neg_lo:[1,0,0] neg_hi:[1,0,0]
v_pk_fma_f32 v[172:173], v[228:229], v[30:31], v[186:187] op_sel:[0,0,0] op_sel_hi:[1,0,0] neg_lo:[0,0,1] neg_hi:[0,0,1]
v_pk_fma_f32 v[228:229], v[228:229], v[30:31], v[186:187] op_sel:[0,0,1] op_sel_hi:[1,0,1] neg_lo:[1,0,0] neg_hi:[1,0,0]
v_pk_fma_f32 v[174:175], v[230:231], v[30:31], v[186:187] op_sel:[0,0,0] op_sel_hi:[1,0,0] neg_lo:[0,0,1] neg_hi:[0,0,1]
v_pk_fma_f32 v[230:231], v[230:231], v[30:31], v[186:187] op_sel:[0,0,1] op_sel_hi:[1,0,1] neg_lo:[1,0,0] neg_hi:[1,0,0]
v_pk_fma_f32 v[176:177], v[232:233], v[30:31], v[186:187] op_sel:[0,0,0] op_sel_hi:[1,0,0] neg_lo:[0,0,1] neg_hi:[0,0,1]
v_pk_fma_f32 v[232:233], v[232:233], v[30:31], v[186:187] op_sel:[0,0,1] op_sel_hi:[1,0,1] neg_lo:[1,0,0] neg_hi:[1,0,0]
v_pk_fma_f32 v[178:179], v[234:235], v[30:31], v[186:187] op_sel:[0,0,0] op_sel_hi:[1,0,0] neg_lo:[0,0,1] neg_hi:[0,0,1]
v_pk_fma_f32 v[234:235], v[234:235], v[30:31], v[186:187] op_sel:[0,0,1] op_sel_hi:[1,0,1] neg_lo:[1,0,0] neg_hi:[1,0,0]
v_pk_fma_f32 v[180:181], v[236:237], v[30:31], v[186:187] op_sel:[0,0,0] op_sel_hi:[1,0,0] neg_lo:[0,0,1] neg_hi:[0,0,1]
v_pk_fma_f32 v[236:237], v[236:237], v[30:31], v[186:187] op_sel:[0,0,1] op_sel_hi:[1,0,1] neg_lo:[1,0,0] neg_hi:[1,0,0]
v_pk_fma_f32 v[182:183], v[238:239], v[30:31], v[186:187] op_sel:[0,0,0] op_sel_hi:[1,0,0] neg_lo:[0,0,1] neg_hi:[0,0,1]
v_pk_fma_f32 v[238:239], v[238:239], v[30:31], v[186:187] op_sel:[0,0,1] op_sel_hi:[1,0,1] neg_lo:[1,0,0] neg_hi:[1,0,0]
v_pk_fma_f32 v[184:185], v[252:253], v[30:31], v[186:187] op_sel:[0,0,0] op_sel_hi:[1,0,0] neg_lo:[0,0,1] neg_hi:[0,0,1]
v_pk_fma_f32 v[252:253], v[252:253], v[30:31], v[186:187] op_sel:[0,0,1] op_sel_hi:[1,0,1] neg_lo:[1,0,0] neg_hi:[1,0,0]
s_waitcnt vmcnt(5)
s_barrier
v_mfma_f32_32x32x16_bf16 v[64:79], a[168:171], a[120:123], v[64:79]
s_waitcnt lgkmcnt(9)
ds_read_b64_tr_b16 a[164:165], v29 offset:34816
ds_read_b64_tr_b16 a[166:167], v29 offset:35072
v_exp_f32 v168, v168
v_exp_f32 v224, v224
v_mfma_f32_32x32x16_bf16 v[80:95], a[144:147], a[120:123], v[80:95]
ds_read_b64_tr_b16 a[168:169], v29 offset:35840
ds_read_b64_tr_b16 a[170:171], v29 offset:36096
v_exp_f32 v169, v169
v_exp_f32 v225, v225
v_mfma_f32_32x32x16_bf16 v[96:111], a[148:151], a[120:123], v[96:111]
s_waitcnt lgkmcnt(6)
ds_read_b64_tr_b16 a[144:145], v26 offset:20480
ds_read_b64_tr_b16 a[146:147], v26 offset:20736
v_exp_f32 v170, v170
v_exp_f32 v226, v226
v_mfma_f32_32x32x16_bf16 v[112:127], a[152:155], a[120:123], v[112:127]
ds_read_b64_tr_b16 a[148:149], v26 offset:21504
ds_read_b64_tr_b16 a[150:151], v26 offset:21760
v_exp_f32 v171, v171
v_exp_f32 v227, v227
v_exp_f32 v172, v172
v_mfma_f32_32x32x16_bf16 v[64:79], a[156:159], a[124:127], v[64:79]
s_waitcnt lgkmcnt(6)
ds_read_b64_tr_b16 a[152:153], v26 offset:22528
ds_read_b64_tr_b16 a[154:155], v26 offset:22784
v_exp_f32 v228, v228
v_exp_f32 v173, v173
v_mfma_f32_32x32x16_bf16 v[80:95], a[160:163], a[124:127], v[80:95]
ds_read_b64_tr_b16 a[156:157], v26 offset:23552
ds_read_b64_tr_b16 a[158:159], v26 offset:23808
v_exp_f32 v229, v229
v_exp_f32 v174, v174
v_mfma_f32_32x32x16_bf16 v[96:111], a[164:167], a[124:127], v[96:111]
s_waitcnt lgkmcnt(6)
ds_read_b64_tr_b16 a[160:161], v27 offset:20480
ds_read_b64_tr_b16 a[162:163], v27 offset:20736
v_exp_f32 v230, v230
v_exp_f32 v175, v175
v_mfma_f32_32x32x16_bf16 v[112:127], a[168:171], a[124:127], v[112:127]
ds_read_b64_tr_b16 a[164:165], v27 offset:21504
ds_read_b64_tr_b16 a[166:167], v27 offset:21760
v_exp_f32 v231, v231
v_exp_f32 v176, v176
v_mfma_f32_32x32x16_bf16 v[64:79], a[144:147], a[128:131], v[64:79]
s_waitcnt lgkmcnt(6)
ds_read_b64_tr_b16 a[168:169], v27 offset:22528
ds_read_b64_tr_b16 a[170:171], v27 offset:22784
v_exp_f32 v232, v232
v_exp_f32 v177, v177
v_mfma_f32_32x32x16_bf16 v[80:95], a[148:151], a[128:131], v[80:95]
ds_read_b64_tr_b16 a[144:145], v27 offset:23552
ds_read_b64_tr_b16 a[146:147], v27 offset:23808
v_exp_f32 v233, v233
v_exp_f32 v178, v178
v_mfma_f32_32x32x16_bf16 v[96:111], a[152:155], a[128:131], v[96:111]
s_waitcnt lgkmcnt(6)
ds_read_b64_tr_b16 a[148:149], v28 offset:20480
ds_read_b64_tr_b16 a[150:151], v28 offset:20736
v_exp_f32 v234, v234
v_exp_f32 v179, v179
v_mfma_f32_32x32x16_bf16 v[112:127], a[156:159], a[128:131], v[112:127]
ds_read_b64_tr_b16 a[152:153], v28 offset:21504
ds_read_b64_tr_b16 a[154:155], v28 offset:21760
v_exp_f32 v235, v235
v_exp_f32 v180, v180
v_exp_f32 v236, v236
v_mfma_f32_32x32x16_bf16 v[64:79], a[160:163], a[132:135], v[64:79]
s_waitcnt lgkmcnt(6)
ds_read_b64_tr_b16 a[156:157], v28 offset:22528
ds_read_b64_tr_b16 a[158:159], v28 offset:22784
v_exp_f32 v181, v181
v_exp_f32 v237, v237
v_mfma_f32_32x32x16_bf16 v[80:95], a[164:167], a[132:135], v[80:95]
ds_read_b64_tr_b16 a[160:161], v28 offset:23552
ds_read_b64_tr_b16 a[162:163], v28 offset:23808
v_exp_f32 v182, v182
v_exp_f32 v238, v238
v_mfma_f32_32x32x16_bf16 v[96:111], a[168:171], a[132:135], v[96:111]
s_waitcnt lgkmcnt(6)
ds_read_b64_tr_b16 a[164:165], v29 offset:20480
ds_read_b64_tr_b16 a[166:167], v29 offset:20736
v_exp_f32 v183, v183
v_exp_f32 v239, v239
v_mfma_f32_32x32x16_bf16 v[112:127], a[144:147], a[132:135], v[112:127]
ds_read_b64_tr_b16 a[168:169], v29 offset:21504
ds_read_b64_tr_b16 a[170:171], v29 offset:21760
v_exp_f32 v184, v184
v_exp_f32 v252, v252
v_exp_f32 v185, v185
s_waitcnt vmcnt(0)
s_barrier
v_mfma_f32_32x32x16_bf16 v[64:79], a[148:151], a[136:139], v[64:79]
s_waitcnt lgkmcnt(6)
buffer_load_dwordx4 v20, s[12:15], s41 offen offset:0 lds
ds_read_b64_tr_b16 a[144:145], v29 offset:22528
ds_read_b64_tr_b16 a[146:147], v29 offset:22784
v_mfma_f32_32x32x16_bf16 v[80:95], a[152:155], a[136:139], v[80:95]
ds_read_b64_tr_b16 a[148:149], v29 offset:23552
ds_read_b64_tr_b16 a[150:151], v29 offset:23808
v_exp_f32 v253, v253
v_pk_add_f32 v[186:187], v[168:169], v[170:171] op_sel:[0,0] op_sel_hi:[1,1]
v_pk_add_f32 v[188:189], v[224:225], v[226:227] op_sel:[0,0] op_sel_hi:[1,1]
v_pk_add_f32 v[186:187], v[186:187], v[172:173] op_sel:[0,0] op_sel_hi:[1,1]
v_pk_add_f32 v[188:189], v[188:189], v[228:229] op_sel:[0,0] op_sel_hi:[1,1]
v_pk_add_f32 v[186:187], v[186:187], v[174:175] op_sel:[0,0] op_sel_hi:[1,1]
v_pk_add_f32 v[188:189], v[188:189], v[230:231] op_sel:[0,0] op_sel_hi:[1,1]
v_pk_add_f32 v[186:187], v[186:187], v[176:177] op_sel:[0,0] op_sel_hi:[1,1]
v_pk_add_f32 v[188:189], v[188:189], v[232:233] op_sel:[0,0] op_sel_hi:[1,1]
v_pk_add_f32 v[186:187], v[186:187], v[178:179] op_sel:[0,0] op_sel_hi:[1,1]
v_pk_add_f32 v[188:189], v[188:189], v[234:235] op_sel:[0,0] op_sel_hi:[1,1]
v_pk_add_f32 v[186:187], v[186:187], v[180:181] op_sel:[0,0] op_sel_hi:[1,1]
v_pk_add_f32 v[188:189], v[188:189], v[236:237] op_sel:[0,0] op_sel_hi:[1,1]
v_pk_add_f32 v[186:187], v[186:187], v[182:183] op_sel:[0,0] op_sel_hi:[1,1]
v_pk_add_f32 v[188:189], v[188:189], v[238:239] op_sel:[0,0] op_sel_hi:[1,1]
v_pk_add_f32 v[186:187], v[186:187], v[184:185] op_sel:[0,0] op_sel_hi:[1,1]
v_pk_add_f32 v[188:189], v[188:189], v[252:253] op_sel:[0,0] op_sel_hi:[1,1]
v_add_f32 v188, v188, v189
v_add_f32 v186, v186, v187
v_rcp_f32 v188, v188
v_rcp_f32 v186, v186
v_mul_f32 v188, v188, v14
v_mul_f32 v186, v186, v14
v_pk_mul_f32 v[224:225], v[224:225], v[188:189] op_sel:[0,0] op_sel_hi:[1,0]
v_pk_mul_f32 v[226:227], v[226:227], v[188:189] op_sel:[0,0] op_sel_hi:[1,0]
v_pk_mul_f32 v[228:229], v[228:229], v[188:189] op_sel:[0,0] op_sel_hi:[1,0]
v_pk_mul_f32 v[230:231], v[230:231], v[188:189] op_sel:[0,0] op_sel_hi:[1,0]
v_pk_mul_f32 v[232:233], v[232:233], v[188:189] op_sel:[0,0] op_sel_hi:[1,0]
v_pk_mul_f32 v[234:235], v[234:235], v[188:189] op_sel:[0,0] op_sel_hi:[1,0]
v_pk_mul_f32 v[236:237], v[236:237], v[188:189] op_sel:[0,0] op_sel_hi:[1,0]
v_pk_mul_f32 v[238:239], v[238:239], v[188:189] op_sel:[0,0] op_sel_hi:[1,0]
v_pk_mul_f32 v[252:253], v[252:253], v[188:189] op_sel:[0,0] op_sel_hi:[1,0]
v_pk_mul_f32 v[168:169], v[168:169], v[186:187] op_sel:[0,0] op_sel_hi:[1,0]
v_pk_mul_f32 v[170:171], v[170:171], v[186:187] op_sel:[0,0] op_sel_hi:[1,0]
v_pk_mul_f32 v[172:173], v[172:173], v[186:187] op_sel:[0,0] op_sel_hi:[1,0]
v_pk_mul_f32 v[174:175], v[174:175], v[186:187] op_sel:[0,0] op_sel_hi:[1,0]
v_pk_mul_f32 v[176:177], v[176:177], v[186:187] op_sel:[0,0] op_sel_hi:[1,0]
v_pk_mul_f32 v[178:179], v[178:179], v[186:187] op_sel:[0,0] op_sel_hi:[1,0]
v_pk_mul_f32 v[180:181], v[180:181], v[186:187] op_sel:[0,0] op_sel_hi:[1,0]
v_pk_mul_f32 v[182:183], v[182:183], v[186:187] op_sel:[0,0] op_sel_hi:[1,0]
v_pk_mul_f32 v[184:185], v[184:185], v[186:187] op_sel:[0,0] op_sel_hi:[1,0]
v_mfma_f32_32x32x16_bf16 v[96:111], a[156:159], a[136:139], v[96:111]
s_waitcnt lgkmcnt(6)
ds_read_b64_tr_b16 a[152:153], v11 offset:0
ds_read_b64_tr_b16 a[154:155], v11 offset:256
v_cvt_pk_bf16_f32 v190, v168, v169
v_cvt_pk_bf16_f32 v191, v170, v171
v_cvt_pk_bf16_f32 v192, v172, v173
v_cvt_pk_bf16_f32 v193, v174, v175
v_cvt_pk_bf16_f32 v194, v176, v177
v_cvt_pk_bf16_f32 v195, v178, v179
v_mfma_f32_32x32x16_bf16 v[112:127], a[160:163], a[136:139], v[112:127]
buffer_load_dwordx4 v21, s[12:15], s41 offen offset:1024 lds
ds_read_b64_tr_b16 a[156:157], v11 offset:1024
ds_read_b64_tr_b16 a[158:159], v11 offset:1280
v_mfma_f32_32x32x16_bf16 v[64:79], a[164:167], a[140:143], v[64:79]
s_waitcnt lgkmcnt(6)
ds_read_b64_tr_b16 a[160:161], v11 offset:2048
ds_read_b64_tr_b16 a[162:163], v11 offset:2304
v_cvt_pk_bf16_f32 v196, v180, v181
v_cvt_pk_bf16_f32 v197, v182, v183
v_cvt_pk_bf16_f32 v198, v184, v185
v_cvt_pk_bf16_f32 v199, v224, v225
v_cvt_pk_bf16_f32 v200, v226, v227
v_cvt_pk_bf16_f32 v201, v228, v229
v_cvt_pk_bf16_f32 v202, v230, v231
v_mfma_f32_32x32x16_bf16 v[80:95], a[168:171], a[140:143], v[80:95]
ds_read_b64_tr_b16 a[164:165], v11 offset:3072
ds_read_b64_tr_b16 a[166:167], v11 offset:3328
v_cvt_pk_bf16_f32 v203, v232, v233
v_cvt_pk_bf16_f32 v204, v234, v235
v_cvt_pk_bf16_f32 v205, v236, v237
v_cvt_pk_bf16_f32 v206, v238, v239
v_cvt_pk_bf16_f32 v207, v252, v253
ds_write_b64 v12, v[190:191] offset:432
ds_write_b64 v12, v[192:193] offset:440
v_mfma_f32_32x32x16_bf16 v[96:111], a[144:147], a[140:143], v[96:111]
s_waitcnt lgkmcnt(10)
buffer_load_dwordx4 v22, s[12:15], s41 offen offset:2048 lds
ds_read_b64_tr_b16 a[168:169], v26 offset:19456
ds_read_b64_tr_b16 a[170:171], v26 offset:19712
v_mfma_f32_32x32x16_bf16 v[112:127], a[148:151], a[140:143], v[112:127]
ds_read_b64_tr_b16 a[144:145], v11 offset:4096
ds_read_b64_tr_b16 a[146:147], v11 offset:4352
ds_write_b64 v12, v[194:195] offset:448
ds_write_b64 v12, v[196:197] offset:456
ds_write_b64 v12, v[198:199] offset:464
ds_write_b64 v12, v[200:201] offset:472
ds_write_b64 v12, v[202:203] offset:480
ds_write_b64 v12, v[204:205] offset:488
ds_write_b64 v12, v[206:207] offset:496
s_waitcnt lgkmcnt(15)
v_mfma_f32_32x32x16_bf16 v[32:47], a[152:155], a[0:3], 0
ds_read_b64_tr_b16 a[148:149], v11 offset:5120
ds_read_b64_tr_b16 a[150:151], v11 offset:5376
v_bfe_u32 v3, v1, 2, 3
v_lshlrev_b32 v3, 2, v3
v_lshl_add_u32 v3, v2, 1, v3
v_mfma_f32_32x32x16_bf16 v[48:63], a[156:159], a[0:3], 0
s_waitcnt lgkmcnt(15)
ds_read_b64_tr_b16 a[152:153], v11 offset:6144
ds_read_b64_tr_b16 a[154:155], v11 offset:6400
v_and_b32 v5, 3, v1
v_lshlrev_b32 v5, 3, v5
s_mul_i32 s60, s32, 144
s_mul_i32 s61, s32, 80
v_mul_u32_u24 v192, 584, v3
v_mfma_f32_32x32x16_bf16 v[208:223], a[160:163], a[0:3], 0
buffer_load_dwordx4 v23, s[12:15], s41 offen offset:3072 lds
ds_read_b64_tr_b16 a[156:157], v11 offset:7168
ds_read_b64_tr_b16 a[158:159], v11 offset:7424
v_mfma_f32_32x32x16_bf16 v[224:239], a[164:167], a[0:3], 0
s_waitcnt lgkmcnt(13)
s_add_u32 m0, s35, 35584
ds_read_b64_tr_b16 a[160:161], v27 offset:19456
ds_read_b64_tr_b16 a[162:163], v27 offset:19712
v_cvt_pk_bf16_f32 v64, v64, v65
v_cvt_pk_bf16_f32 v66, v66, v67
v_cvt_pk_bf16_f32 v68, v68, v69
v_cvt_pk_bf16_f32 v70, v70, v71
v_cvt_pk_bf16_f32 v72, v72, v73
v_mfma_f32_32x32x16_bf16 v[240:255], a[168:171], a[0:3], 0
ds_read_b64_tr_b16 a[164:165], v11 offset:8192
ds_read_b64_tr_b16 a[166:167], v11 offset:8448
v_cvt_pk_bf16_f32 v74, v74, v75
v_cvt_pk_bf16_f32 v76, v76, v77
v_cvt_pk_bf16_f32 v78, v78, v79
v_cvt_pk_bf16_f32 v80, v80, v81
v_cvt_pk_bf16_f32 v82, v82, v83
v_mfma_f32_32x32x16_bf16 v[32:47], a[144:147], a[4:7], v[32:47]
s_waitcnt lgkmcnt(6)
buffer_load_dwordx4 v20, s[12:15], s41 offen offset:256 lds
ds_read_b64_tr_b16 a[168:169], v11 offset:9216
ds_read_b64_tr_b16 a[170:171], v11 offset:9472
v_mfma_f32_32x32x16_bf16 v[48:63], a[148:151], a[4:7], v[48:63]
s_mov_b32 m0, s62
ds_read_b64_tr_b16 a[144:145], v11 offset:10240
ds_read_b64_tr_b16 a[146:147], v11 offset:10496
v_cvt_pk_bf16_f32 v84, v84, v85
v_cvt_pk_bf16_f32 v86, v86, v87
v_cvt_pk_bf16_f32 v88, v88, v89
v_cvt_pk_bf16_f32 v90, v90, v91
v_cvt_pk_bf16_f32 v92, v92, v93
v_cvt_pk_bf16_f32 v94, v94, v95
v_cvt_pk_bf16_f32 v96, v96, v97
v_mfma_f32_32x32x16_bf16 v[208:223], a[152:155], a[4:7], v[208:223]
s_waitcnt lgkmcnt(6)
s_add_u32 s41, s38, 1769472
ds_read_b64_tr_b16 a[148:149], v11 offset:11264
ds_read_b64_tr_b16 a[150:151], v11 offset:11520
v_cvt_pk_bf16_f32 v98, v98, v99
v_cvt_pk_bf16_f32 v100, v100, v101
v_cvt_pk_bf16_f32 v102, v102, v103
v_cvt_pk_bf16_f32 v104, v104, v105
v_cvt_pk_bf16_f32 v106, v106, v107
v_mfma_f32_32x32x16_bf16 v[224:239], a[156:159], a[4:7], v[224:239]
ds_read_b64_tr_b16 a[152:153], v28 offset:19456
ds_read_b64_tr_b16 a[154:155], v28 offset:19712
v_cvt_pk_bf16_f32 v108, v108, v109
v_cvt_pk_bf16_f32 v110, v110, v111
v_cvt_pk_bf16_f32 v112, v112, v113
v_cvt_pk_bf16_f32 v114, v114, v115
v_cvt_pk_bf16_f32 v116, v116, v117
v_mfma_f32_32x32x16_bf16 v[240:255], a[160:163], a[4:7], v[240:255]
s_waitcnt lgkmcnt(6)
ds_read_b64_tr_b16 a[156:157], v11 offset:12288
ds_read_b64_tr_b16 a[158:159], v11 offset:12544
v_cvt_pk_bf16_f32 v118, v118, v119
v_cvt_pk_bf16_f32 v120, v120, v121
v_cvt_pk_bf16_f32 v122, v122, v123
v_cvt_pk_bf16_f32 v124, v124, v125
v_cvt_pk_bf16_f32 v126, v126, v127
s_waitcnt vmcnt(0)
s_barrier
v_mfma_f32_32x32x16_bf16 v[32:47], a[164:167], a[8:11], v[32:47]
ds_read_b64_tr_b16 a[160:161], v11 offset:13312
ds_read_b64_tr_b16 a[162:163], v11 offset:13568
v_add3_u32 v192, v192, v5, s60
v_mul_u32_u24 v193, 328, v3
v_add3_u32 v193, v193, v5, s61
v_mfma_f32_32x32x16_bf16 v[48:63], a[168:171], a[8:11], v[48:63]
s_waitcnt lgkmcnt(6)
ds_read_b64_tr_b16 a[164:165], v11 offset:14336
ds_read_b64_tr_b16 a[166:167], v11 offset:14592
ds_write_b32 v18, v164 offset:20480
ds_write_b32 v18, v165 offset:20484
ds_write_b32 v18, v166 offset:20496
v_mfma_f32_32x32x16_bf16 v[208:223], a[144:147], a[8:11], v[208:223]
ds_read_b64_tr_b16 a[168:169], v11 offset:15360
ds_read_b64_tr_b16 a[170:171], v11 offset:15616
ds_write_b32 v18, v167 offset:20500
v_mul_u32_u24 v4, 152, v2
v_add_u32 v4, v4, v18
ds_write_b32 v4, v13 offset:20516
v_mfma_f32_32x32x16_bf16 v[224:239], a[148:151], a[8:11], v[224:239]
s_waitcnt lgkmcnt(11)
ds_read_b64_tr_b16 a[144:145], v29 offset:19456
ds_read_b64_tr_b16 a[146:147], v29 offset:19712
ds_write_b32 v4, v13 offset:20556
ds_write_b32 v4, v13 offset:20596
ds_write_b32 v4, v13 offset:20636
v_mfma_f32_32x32x16_bf16 v[240:255], a[152:155], a[8:11], v[240:255]
ds_read_b64_tr_b16 a[148:149], v26 offset:31744
ds_read_b64_tr_b16 a[150:151], v26 offset:32000
ds_write_b32 v25, v64 offset:20512
ds_write_b32 v18, v66 offset:20520
ds_write_b32 v18, v68 offset:20532
v_mfma_f32_32x32x16_bf16 v[32:47], a[156:159], a[12:15], v[32:47]
s_waitcnt lgkmcnt(15)
ds_read_b64_tr_b16 a[152:153], v26 offset:32768
ds_read_b64_tr_b16 a[154:155], v26 offset:33024
ds_write_b32 v18, v70 offset:20536
ds_write_b32 v25, v72 offset:20548
ds_write_b32 v25, v74 offset:20552
v_mfma_f32_32x32x16_bf16 v[48:63], a[160:163], a[12:15], v[48:63]
ds_read_b64_tr_b16 a[156:157], v26 offset:33792
ds_read_b64_tr_b16 a[158:159], v26 offset:34048
ds_write_b32 v18, v76 offset:20568
ds_write_b32 v18, v78 offset:20572
ds_write_b32 v18, v80 offset:20584
v_mfma_f32_32x32x16_bf16 v[208:223], a[164:167], a[12:15], v[208:223]
s_waitcnt lgkmcnt(15)
ds_read_b64_tr_b16 a[160:161], v26 offset:34816
ds_read_b64_tr_b16 a[162:163], v26 offset:35072
ds_write_b32 v25, v82 offset:20588
ds_write_b32 v18, v84 offset:20604
ds_write_b32 v18, v86 offset:20608
v_mfma_f32_32x32x16_bf16 v[224:239], a[168:171], a[12:15], v[224:239]
ds_read_b64_tr_b16 a[164:165], v26 offset:35840
ds_read_b64_tr_b16 a[166:167], v26 offset:36096
ds_write_b32 v18, v88 offset:20620
ds_write_b32 v18, v90 offset:20624
ds_write_b32 v18, v92 offset:20640
v_mfma_f32_32x32x16_bf16 v[240:255], a[144:147], a[12:15], v[240:255]
s_waitcnt lgkmcnt(15)
ds_read_b64_tr_b16 a[168:169], v27 offset:31744
ds_read_b64_tr_b16 a[170:171], v27 offset:32000
ds_write_b32 v18, v94 offset:20644
ds_write_b32 v18, v96 offset:20656
ds_write_b32 v18, v98 offset:20660
v_mfma_f32_32x32x16_bf16 v[32:47], a[148:151], a[16:19], v[32:47]
L_pad_a2_1:
s_cbranch_execz L_pad_a2_2
ds_read_b64_tr_b16 a[144:145], v27 offset:32768
ds_read_b64_tr_b16 a[146:147], v27 offset:33024
ds_write_b32 v25, v100 offset:20672
ds_write_b32 v18, v102 offset:20680
ds_write_b32 v18, v104 offset:20692
v_mfma_f32_32x32x16_bf16 v[48:63], a[152:155], a[16:19], v[48:63]
s_waitcnt lgkmcnt(15)
ds_read_b64_tr_b16 a[148:149], v27 offset:33792
ds_read_b64_tr_b16 a[150:151], v27 offset:34048
ds_write_b32 v18, v106 offset:20696
ds_write_b32 v25, v108 offset:20708
ds_write_b32 v25, v110 offset:20712
v_mfma_f32_32x32x16_bf16 v[208:223], a[156:159], a[16:19], v[208:223]
ds_read_b64_tr_b16 a[152:153], v27 offset:34816
ds_read_b64_tr_b16 a[154:155], v27 offset:35072
ds_write_b32 v18, v112 offset:20728
ds_write_b32 v18, v114 offset:20732
ds_write_b32 v18, v116 offset:20744
v_mfma_f32_32x32x16_bf16 v[224:239], a[160:163], a[16:19], v[224:239]
s_waitcnt lgkmcnt(15)
ds_read_b64_tr_b16 a[156:157], v27 offset:35840
ds_read_b64_tr_b16 a[158:159], v27 offset:36096
ds_write_b32 v25, v118 offset:20748
ds_write_b32 v18, v120 offset:20764
ds_write_b32 v18, v122 offset:20768
v_mfma_f32_32x32x16_bf16 v[240:255], a[164:167], a[16:19], v[240:255]
ds_read_b64_tr_b16 a[160:161], v28 offset:31744
ds_read_b64_tr_b16 a[162:163], v28 offset:32000
ds_write_b32 v18, v124 offset:20780
ds_write_b32 v18, v126 offset:20784
v_and_b32 v3, 15, v1
v_mfma_f32_32x32x16_bf16 v[32:47], a[168:171], a[20:23], v[32:47]
s_waitcnt lgkmcnt(15)
ds_read_b64_tr_b16 a[164:165], v28 offset:32768
ds_read_b64_tr_b16 a[166:167], v28 offset:33024
v_lshrrev_b32 v5, 4, v1
v_lshl_add_u32 v194, v5, 2, v3
v_lshlrev_b32 v194, 4, v194
v_mfma_f32_32x32x16_bf16 v[48:63], a[144:147], a[20:23], v[48:63]
ds_read_b64_tr_b16 a[168:169], v28 offset:33792
ds_read_b64_tr_b16 a[170:171], v28 offset:34048
v_mov_b32 v6, 0x7f000000
v_cmp_gt_u32 vcc, 4, v3
s_nop 1
v_cndmask_b32 v195, v6, v194, vcc
v_mfma_f32_32x32x16_bf16 v[208:223], a[148:151], a[20:23], v[208:223]
s_waitcnt lgkmcnt(11)
ds_read_b64_tr_b16 a[144:145], v28 offset:34816
ds_read_b64_tr_b16 a[146:147], v28 offset:35072
v_cmp_eq_u32 vcc, 0, v5
s_nop 1
v_cndmask_b32 v196, v6, v19, vcc
v_cndmask_b32 v197, v6, v195, vcc
v_mfma_f32_32x32x16_bf16 v[224:239], a[152:155], a[20:23], v[224:239]
ds_read_b64_tr_b16 a[148:149], v28 offset:35840
ds_read_b64_tr_b16 a[150:151], v28 offset:36096
v_mfma_f32_32x32x16_bf16 v[240:255], a[156:159], a[20:23], v[240:255]
ds_read_b64_tr_b16 a[152:153], v29 offset:31744
ds_read_b64_tr_b16 a[154:155], v29 offset:32000
s_waitcnt lgkmcnt(0)
s_barrier
ds_read_b64_tr_b16 v[76:77], v193 offset:20480
ds_read_b64_tr_b16 v[78:79], v193 offset:20808
ds_read_b64_tr_b16 v[80:81], v193 offset:20512
ds_read_b64_tr_b16 v[82:83], v193 offset:20840
ds_read_b64_tr_b16 v[64:65], v192 offset:0
ds_read_b64_tr_b16 v[66:67], v192 offset:584
ds_read_b64_tr_b16 v[68:69], v192 offset:32
ds_read_b64_tr_b16 v[70:71], v192 offset:616
ds_read_b64_tr_b16 v[72:73], v192 offset:64
ds_read_b64_tr_b16 v[74:75], v192 offset:648
ds_read_b64_tr_b16 v[96:97], v193 offset:20520
ds_read_b64_tr_b16 v[98:99], v193 offset:20848
ds_read_b64_tr_b16 v[100:101], v193 offset:20552
ds_read_b64_tr_b16 v[102:103], v193 offset:20880
ds_read_b64_tr_b16 v[84:85], v192 offset:72
ds_read_b64_tr_b16 v[86:87], v192 offset:656
ds_read_b64_tr_b16 v[88:89], v192 offset:104
ds_read_b64_tr_b16 v[90:91], v192 offset:688
ds_read_b64_tr_b16 v[92:93], v192 offset:136
ds_read_b64_tr_b16 v[94:95], v192 offset:720
buffer_load_dwordx4 v20, s[12:15], s41 offen offset:0 lds
buffer_load_dwordx4 v21, s[12:15], s41 offen offset:1024 lds
s_waitcnt lgkmcnt(14)
v_mfma_f32_16x16x32_bf16 v[144:147], v[64:67], v[76:79], 0
v_add_u32 v192, 36864, v192
v_add_u32 v193, 36864, v193
v_mfma_f32_16x16x32_bf16 v[148:151], v[64:67], v[80:83], 0
ds_read_b64_tr_b16 v[116:117], v193 offset:20480
ds_read_b64_tr_b16 v[118:119], v193 offset:20808
s_waitcnt lgkmcnt(14)
v_mfma_f32_16x16x32_bf16 v[152:155], v[68:71], v[76:79], 0
ds_read_b64_tr_b16 v[120:121], v193 offset:20512
ds_read_b64_tr_b16 v[122:123], v193 offset:20840
v_mfma_f32_16x16x32_bf16 v[156:159], v[68:71], v[80:83], 0
ds_read_b64_tr_b16 v[104:105], v192 offset:0
ds_read_b64_tr_b16 v[106:107], v192 offset:584
buffer_load_dwordx4 v22, s[12:15], s41 offen offset:2048 lds
s_waitcnt lgkmcnt(15)
v_mfma_f32_16x16x32_bf16 v[160:163], v[72:75], v[76:79], 0
ds_read_b64_tr_b16 v[108:109], v192 offset:32
ds_read_b64_tr_b16 v[110:111], v192 offset:616
v_mfma_f32_16x16x32_bf16 v[164:167], v[72:75], v[80:83], 0
ds_read_b64_tr_b16 v[112:113], v192 offset:64
ds_read_b64_tr_b16 v[114:115], v192 offset:648
s_waitcnt lgkmcnt(14)
v_mfma_f32_16x16x32_bf16 v[168:171], v[84:87], v[96:99], 0
ds_read_b64_tr_b16 v[136:137], v193 offset:20520
ds_read_b64_tr_b16 v[138:139], v193 offset:20848
v_mfma_f32_16x16x32_bf16 v[172:175], v[84:87], v[100:103], 0
ds_read_b64_tr_b16 v[140:141], v193 offset:20552
ds_read_b64_tr_b16 v[142:143], v193 offset:20880
buffer_load_dwordx4 v23, s[12:15], s41 offen offset:3072 lds
s_waitcnt lgkmcnt(15)
v_mfma_f32_16x16x32_bf16 v[176:179], v[88:91], v[96:99], 0
ds_read_b64_tr_b16 v[124:125], v192 offset:72
ds_read_b64_tr_b16 v[126:127], v192 offset:656
v_mfma_f32_16x16x32_bf16 v[180:183], v[88:91], v[100:103], 0
ds_read_b64_tr_b16 v[128:129], v192 offset:104
ds_read_b64_tr_b16 v[130:131], v192 offset:688
s_waitcnt lgkmcnt(15)
v_mfma_f32_16x16x32_bf16 v[184:187], v[92:95], v[96:99], 0
ds_read_b64_tr_b16 v[132:133], v192 offset:136
ds_read_b64_tr_b16 v[134:135], v192 offset:720
v_mfma_f32_16x16x32_bf16 v[188:191], v[92:95], v[100:103], 0
s_add_u32 m0, s35, 19200
s_nop 0
buffer_load_dwordx4 v20, s[12:15], s41 offen offset:256 lds
s_waitcnt lgkmcnt(14)
v_mfma_f32_16x16x32_bf16 v[144:147], v[104:107], v[116:119], v[144:147]
v_add_u32 v192, 36864, v192
v_add_u32 v193, 36864, v193
v_mfma_f32_16x16x32_bf16 v[148:151], v[104:107], v[120:123], v[148:151]
ds_read_b64_tr_b16 v[76:77], v193 offset:20480
ds_read_b64_tr_b16 v[78:79], v193 offset:20808
s_waitcnt lgkmcnt(14)
v_mfma_f32_16x16x32_bf16 v[152:155], v[108:111], v[116:119], v[152:155]
ds_read_b64_tr_b16 v[80:81], v193 offset:20512
ds_read_b64_tr_b16 v[82:83], v193 offset:20840
v_mfma_f32_16x16x32_bf16 v[156:159], v[108:111], v[120:123], v[156:159]
ds_read_b64_tr_b16 v[64:65], v192 offset:0
ds_read_b64_tr_b16 v[66:67], v192 offset:584
s_waitcnt lgkmcnt(15)
v_mfma_f32_16x16x32_bf16 v[160:163], v[112:115], v[116:119], v[160:163]
ds_read_b64_tr_b16 v[68:69], v192 offset:32
ds_read_b64_tr_b16 v[70:71], v192 offset:616
v_mfma_f32_16x16x32_bf16 v[164:167], v[112:115], v[120:123], v[164:167]
ds_read_b64_tr_b16 v[72:73], v192 offset:64
ds_read_b64_tr_b16 v[74:75], v192 offset:648
s_waitcnt lgkmcnt(14)
v_mfma_f32_16x16x32_bf16 v[168:171], v[124:127], v[136:139], v[168:171]
ds_read_b64_tr_b16 v[96:97], v193 offset:20520
ds_read_b64_tr_b16 v[98:99], v193 offset:20848
v_mfma_f32_16x16x32_bf16 v[172:175], v[124:127], v[140:143], v[172:175]
ds_read_b64_tr_b16 v[100:101], v193 offset:20552
ds_read_b64_tr_b16 v[102:103], v193 offset:20880
s_waitcnt lgkmcnt(15)
v_mfma_f32_16x16x32_bf16 v[176:179], v[128:131], v[136:139], v[176:179]
ds_read_b64_tr_b16 v[84:85], v192 offset:72
ds_read_b64_tr_b16 v[86:87], v192 offset:656
v_mfma_f32_16x16x32_bf16 v[180:183], v[128:131], v[140:143], v[180:183]
ds_read_b64_tr_b16 v[88:89], v192 offset:104
ds_read_b64_tr_b16 v[90:91], v192 offset:688
s_waitcnt lgkmcnt(15)
v_mfma_f32_16x16x32_bf16 v[184:187], v[132:135], v[136:139], v[184:187]
ds_read_b64_tr_b16 v[92:93], v192 offset:136
ds_read_b64_tr_b16 v[94:95], v192 offset:720
v_mfma_f32_16x16x32_bf16 v[188:191], v[132:135], v[140:143], v[188:191]
s_waitcnt lgkmcnt(14)
v_mfma_f32_16x16x32_bf16 v[144:147], v[64:67], v[76:79], v[144:147]
v_add_u32 v192, 36864, v192
v_add_u32 v193, 36864, v193
v_mfma_f32_16x16x32_bf16 v[148:151], v[64:67], v[80:83], v[148:151]
ds_read_b64_tr_b16 v[116:117], v193 offset:20480
ds_read_b64_tr_b16 v[118:119], v193 offset:20808
s_waitcnt lgkmcnt(14)
v_mfma_f32_16x16x32_bf16 v[152:155], v[68:71], v[76:79], v[152:155]
ds_read_b64_tr_b16 v[120:121], v193 offset:20512
ds_read_b64_tr_b16 v[122:123], v193 offset:20840
v_mfma_f32_16x16x32_bf16 v[156:159], v[68:71], v[80:83], v[156:159]
ds_read_b64_tr_b16 v[104:105], v192 offset:0
ds_read_b64_tr_b16 v[106:107], v192 offset:584
s_waitcnt lgkmcnt(15)
v_mfma_f32_16x16x32_bf16 v[160:163], v[72:75], v[76:79], v[160:163]
ds_read_b64_tr_b16 v[108:109], v192 offset:32
ds_read_b64_tr_b16 v[110:111], v192 offset:616
v_mfma_f32_16x16x32_bf16 v[164:167], v[72:75], v[80:83], v[164:167]
ds_read_b64_tr_b16 v[112:113], v192 offset:64
ds_read_b64_tr_b16 v[114:115], v192 offset:648
s_waitcnt lgkmcnt(14)
v_mfma_f32_16x16x32_bf16 v[168:171], v[84:87], v[96:99], v[168:171]
ds_read_b64_tr_b16 v[136:137], v193 offset:20520
ds_read_b64_tr_b16 v[138:139], v193 offset:20848
v_mfma_f32_16x16x32_bf16 v[172:175], v[84:87], v[100:103], v[172:175]
ds_read_b64_tr_b16 v[140:141], v193 offset:20552
ds_read_b64_tr_b16 v[142:143], v193 offset:20880
s_waitcnt lgkmcnt(15)
v_mfma_f32_16x16x32_bf16 v[176:179], v[88:91], v[96:99], v[176:179]
ds_read_b64_tr_b16 v[124:125], v192 offset:72
ds_read_b64_tr_b16 v[126:127], v192 offset:656
v_mfma_f32_16x16x32_bf16 v[180:183], v[88:91], v[100:103], v[180:183]
ds_read_b64_tr_b16 v[128:129], v192 offset:104
ds_read_b64_tr_b16 v[130:131], v192 offset:688
s_waitcnt lgkmcnt(15)
v_mfma_f32_16x16x32_bf16 v[184:187], v[92:95], v[96:99], v[184:187]
ds_read_b64_tr_b16 v[132:133], v192 offset:136
ds_read_b64_tr_b16 v[134:135], v192 offset:720
v_mfma_f32_16x16x32_bf16 v[188:191], v[92:95], v[100:103], v[188:191]
s_waitcnt lgkmcnt(0)
s_waitcnt vmcnt(0)
s_barrier
v_mfma_f32_16x16x32_bf16 v[144:147], v[104:107], v[116:119], v[144:147]
v_mfma_f32_16x16x32_bf16 v[148:151], v[104:107], v[120:123], v[148:151]
s_add_u32 m0, s35, 0
s_add_u32 s41, s38, 0
buffer_load_dwordx4 v20, s[12:15], s41 offen offset:0 lds
v_mfma_f32_16x16x32_bf16 v[152:155], v[108:111], v[116:119], v[152:155]
v_mfma_f32_16x16x32_bf16 v[156:159], v[108:111], v[120:123], v[156:159]
buffer_load_dwordx4 v21, s[12:15], s41 offen offset:1024 lds
v_mfma_f32_16x16x32_bf16 v[160:163], v[112:115], v[116:119], v[160:163]
v_mfma_f32_16x16x32_bf16 v[164:167], v[112:115], v[120:123], v[164:167]
buffer_load_dwordx4 v22, s[12:15], s41 offen offset:2048 lds
v_mfma_f32_16x16x32_bf16 v[168:171], v[124:127], v[136:139], v[168:171]
v_mfma_f32_16x16x32_bf16 v[172:175], v[124:127], v[140:143], v[172:175]
buffer_load_dwordx4 v23, s[12:15], s41 offen offset:3072 lds
v_mfma_f32_16x16x32_bf16 v[176:179], v[128:131], v[136:139], v[176:179]
v_mfma_f32_16x16x32_bf16 v[180:183], v[128:131], v[140:143], v[180:183]
s_add_u32 m0, s35, 3840
s_nop 0
buffer_load_dwordx4 v20, s[12:15], s41 offen offset:256 lds
v_mfma_f32_16x16x32_bf16 v[184:187], v[132:135], v[136:139], v[184:187]
v_mfma_f32_16x16x32_bf16 v[188:191], v[132:135], v[140:143], v[188:191]
s_add_u32 m0, s35, 5120
s_add_u32 s41, s38, 663552
buffer_load_dwordx4 v20, s[12:15], s41 offen offset:0 lds
v_mfma_f32_32x32x16_bf16 v[32:47], a[160:163], a[24:27], v[32:47]
ds_read_b64_tr_b16 a[156:157], v29 offset:32768
ds_read_b64_tr_b16 a[158:159], v29 offset:33024
v_mfma_f32_32x32x16_bf16 v[48:63], a[164:167], a[24:27], v[48:63]
buffer_load_dwordx4 v21, s[12:15], s41 offen offset:1024 lds
ds_read_b64_tr_b16 a[160:161], v29 offset:33792
ds_read_b64_tr_b16 a[162:163], v29 offset:34048
v_mfma_f32_32x32x16_bf16 v[208:223], a[168:171], a[24:27], v[208:223]
ds_read_b64_tr_b16 a[164:165], v29 offset:34816
ds_read_b64_tr_b16 a[166:167], v29 offset:35072
v_and_b32 v3, 31, v1
v_min_u32 v3, 22, v3
v_add_u32 v3, s76, v3
v_mfma_f32_32x32x16_bf16 v[224:239], a[144:147], a[24:27], v[224:239]
buffer_load_dwordx4 v22, s[12:15], s41 offen offset:2048 lds
ds_read_b64_tr_b16 a[168:169], v29 offset:35840
ds_read_b64_tr_b16 a[170:171], v29 offset:36096
v_mfma_f32_32x32x16_bf16 v[240:255], a[148:151], a[24:27], v[240:255]
ds_read_b64_tr_b16 a[144:145], v11 offset:0
ds_read_b64_tr_b16 a[146:147], v11 offset:256
v_min_u32 v3, 89, v3
v_lshlrev_b32 v121, 3, v3
v_mul_u32_u24 v120, 184320, v2
v_mfma_f32_32x32x16_bf16 v[32:47], a[152:155], a[28:31], v[32:47]
s_waitcnt lgkmcnt(6)
buffer_load_dwordx4 v23, s[12:15], s41 offen offset:3072 lds
ds_read_b64_tr_b16 a[148:149], v11 offset:1024
ds_read_b64_tr_b16 a[150:151], v11 offset:1280
v_mfma_f32_32x32x16_bf16 v[48:63], a[156:159], a[28:31], v[48:63]
s_add_u32 m0, s35, 8960
ds_read_b64_tr_b16 a[152:153], v11 offset:2048
ds_read_b64_tr_b16 a[154:155], v11 offset:2304
v_lshl_add_u32 v120, v3, 4, v120
v_mfma_f32_32x32x16_bf16 v[208:223], a[160:163], a[28:31], v[208:223]
s_waitcnt lgkmcnt(6)
buffer_load_dwordx4 v20, s[12:15], s41 offen offset:256 lds
ds_read_b64_tr_b16 a[156:157], v11 offset:3072
ds_read_b64_tr_b16 a[158:159], v11 offset:3328
v_mfma_f32_32x32x16_bf16 v[224:239], a[164:167], a[28:31], v[224:239]
s_add_u32 m0, s35, 10240
ds_read_b64_tr_b16 a[160:161], v26 offset:19456
ds_read_b64_tr_b16 a[162:163], v26 offset:19712
v_mfma_f32_32x32x16_bf16 v[240:255], a[168:171], a[28:31], v[240:255]
s_waitcnt lgkmcnt(6)
s_add_u32 s41, s38, 1327104
buffer_load_dwordx4 v20, s[12:15], s41 offen offset:0 lds
ds_read_b64_tr_b16 a[164:165], v11 offset:4096
ds_read_b64_tr_b16 a[166:167], v11 offset:4352
v_mfma_f32_32x32x16_bf16 v[32:47], a[144:147], a[32:35], v[32:47]
ds_read_b64_tr_b16 a[168:169], v11 offset:5120
ds_read_b64_tr_b16 a[170:171], v11 offset:5376
v_mfma_f32_32x32x16_bf16 v[48:63], a[148:151], a[32:35], v[48:63]
s_waitcnt lgkmcnt(6)
buffer_load_dwordx4 v21, s[12:15], s41 offen offset:1024 lds
ds_read_b64_tr_b16 a[144:145], v11 offset:6144
ds_read_b64_tr_b16 a[146:147], v11 offset:6400
v_mfma_f32_32x32x16_bf16 v[208:223], a[152:155], a[32:35], v[208:223]
ds_read_b64_tr_b16 a[148:149], v11 offset:7168
ds_read_b64_tr_b16 a[150:151], v11 offset:7424
v_mfma_f32_32x32x16_bf16 v[224:239], a[156:159], a[32:35], v[224:239]
s_waitcnt lgkmcnt(6)
buffer_load_dwordx4 v22, s[12:15], s41 offen offset:2048 lds
ds_read_b64_tr_b16 a[152:153], v27 offset:19456
ds_read_b64_tr_b16 a[154:155], v27 offset:19712
v_mfma_f32_32x32x16_bf16 v[240:255], a[160:163], a[32:35], v[240:255]
ds_read_b64_tr_b16 a[156:157], v11 offset:8192
ds_read_b64_tr_b16 a[158:159], v11 offset:8448
v_mfma_f32_32x32x16_bf16 v[32:47], a[164:167], a[36:39], v[32:47]
s_waitcnt lgkmcnt(6)
buffer_load_dwordx4 v23, s[12:15], s41 offen offset:3072 lds
ds_read_b64_tr_b16 a[160:161], v11 offset:9216
ds_read_b64_tr_b16 a[162:163], v11 offset:9472
v_mfma_f32_32x32x16_bf16 v[48:63], a[168:171], a[36:39], v[48:63]
s_add_u32 m0, s35, 14080
ds_read_b64_tr_b16 a[164:165], v11 offset:10240
ds_read_b64_tr_b16 a[166:167], v11 offset:10496
v_mfma_f32_32x32x16_bf16 v[208:223], a[144:147], a[36:39], v[208:223]
s_waitcnt lgkmcnt(6)
buffer_load_dwordx4 v20, s[12:15], s41 offen offset:256 lds
ds_read_b64_tr_b16 a[168:169], v11 offset:11264
ds_read_b64_tr_b16 a[170:171], v11 offset:11520
v_mfma_f32_32x32x16_bf16 v[224:239], a[148:151], a[36:39], v[224:239]
s_add_u32 m0, s35, 20480
ds_read_b64_tr_b16 a[144:145], v28 offset:19456
ds_read_b64_tr_b16 a[146:147], v28 offset:19712
v_mfma_f32_32x32x16_bf16 v[240:255], a[152:155], a[36:39], v[240:255]
s_waitcnt lgkmcnt(6)
s_add_u32 s41, s38, 221184
buffer_load_dwordx4 v20, s[12:15], s41 offen offset:0 lds
ds_read_b64_tr_b16 a[148:149], v11 offset:12288
ds_read_b64_tr_b16 a[150:151], v11 offset:12544
s_waitcnt vmcnt(11)
s_barrier
v_mfma_f32_32x32x16_bf16 v[32:47], a[156:159], a[40:43], v[32:47]
ds_read_b64_tr_b16 a[152:153], v11 offset:13312
ds_read_b64_tr_b16 a[154:155], v11 offset:13568
v_min_u32 v144, -2, v144
v_min_u32 v145, -2, v145
v_min_u32 v146, -2, v146
v_mfma_f32_32x32x16_bf16 v[48:63], a[160:163], a[40:43], v[48:63]
s_waitcnt lgkmcnt(6)
buffer_load_dwordx4 v21, s[12:15], s41 offen offset:1024 lds
ds_read_b64_tr_b16 a[156:157], v11 offset:14336
ds_read_b64_tr_b16 a[158:159], v11 offset:14592
v_mfma_f32_32x32x16_bf16 v[208:223], a[164:167], a[40:43], v[208:223]
ds_read_b64_tr_b16 a[160:161], v11 offset:15360
ds_read_b64_tr_b16 a[162:163], v11 offset:15616
v_min_u32 v147, -2, v147
v_min_u32 v152, -2, v152
v_min_u32 v153, -2, v153
v_mfma_f32_32x32x16_bf16 v[224:239], a[168:171], a[40:43], v[224:239]
s_waitcnt lgkmcnt(6)
buffer_store_dwordx4 v[144:147], v19, s[20:23], s72 offen offset:0 sc1
ds_read_b64_tr_b16 a[164:165], v29 offset:19456
ds_read_b64_tr_b16 a[166:167], v29 offset:19712
v_mfma_f32_32x32x16_bf16 v[240:255], a[144:147], a[40:43], v[240:255]
ds_read_b64_tr_b16 a[168:169], v26 offset:0
ds_read_b64_tr_b16 a[170:171], v26 offset:256
v_min_u32 v154, -2, v154
v_min_u32 v155, -2, v155
v_min_u32 v160, -2, v160
v_mfma_f32_32x32x16_bf16 v[32:47], a[148:151], a[44:47], v[32:47]
s_waitcnt lgkmcnt(6)
buffer_store_dwordx4 v[152:155], v19, s[20:23], s72 offen offset:1024 sc1
ds_read_b64_tr_b16 a[144:145], v26 offset:1024
ds_read_b64_tr_b16 a[146:147], v26 offset:1280
v_mfma_f32_32x32x16_bf16 v[48:63], a[152:155], a[44:47], v[48:63]
ds_read_b64_tr_b16 a[148:149], v26 offset:2048
ds_read_b64_tr_b16 a[150:151], v26 offset:2304
v_min_u32 v161, -2, v161
v_min_u32 v162, -2, v162
v_min_u32 v163, -2, v163
v_min_u32 v148, -2, v148
v_mfma_f32_32x32x16_bf16 v[208:223], a[156:159], a[44:47], v[208:223]
s_waitcnt lgkmcnt(6)
buffer_store_dwordx4 v[160:163], v196, s[20:23], s72 offen offset:2048 sc1
ds_read_b64_tr_b16 a[152:153], v26 offset:3072
ds_read_b64_tr_b16 a[154:155], v26 offset:3328
v_mfma_f32_32x32x16_bf16 v[224:239], a[160:163], a[44:47], v[224:239]
ds_read_b64_tr_b16 a[156:157], v26 offset:4096
ds_read_b64_tr_b16 a[158:159], v26 offset:4352
v_min_u32 v149, -2, v149
v_min_u32 v150, -2, v150
v_min_u32 v151, -2, v151
v_min_u32 v156, -2, v156
v_mfma_f32_32x32x16_bf16 v[240:255], a[164:167], a[44:47], v[240:255]
s_waitcnt lgkmcnt(6)
buffer_store_dwordx4 v[148:151], v195, s[20:23], s72 offen offset:2304 sc1
ds_read_b64_tr_b16 a[160:161], v27 offset:0
ds_read_b64_tr_b16 a[162:163], v27 offset:256
v_mfma_f32_32x32x16_bf16 v[32:47], a[168:171], a[48:51], v[32:47]
ds_read_b64_tr_b16 a[164:165], v27 offset:1024
ds_read_b64_tr_b16 a[166:167], v27 offset:1280
v_min_u32 v157, -2, v157
v_min_u32 v158, -2, v158
v_min_u32 v159, -2, v159
v_min_u32 v164, -2, v164
v_mfma_f32_32x32x16_bf16 v[48:63], a[144:147], a[48:51], v[48:63]
s_waitcnt lgkmcnt(6)
buffer_store_dwordx4 v[156:159], v195, s[20:23], s72 offen offset:2560 sc1
ds_read_b64_tr_b16 a[168:169], v27 offset:2048
ds_read_b64_tr_b16 a[170:171], v27 offset:2304
v_mfma_f32_32x32x16_bf16 v[208:223], a[148:151], a[48:51], v[208:223]
ds_read_b64_tr_b16 a[144:145], v27 offset:3072
ds_read_b64_tr_b16 a[146:147], v27 offset:3328
v_min_u32 v165, -2, v165
v_min_u32 v166, -2, v166
v_min_u32 v167, -2, v167
v_min_u32 v168, -2, v168
v_mfma_f32_32x32x16_bf16 v[224:239], a[152:155], a[48:51], v[224:239]
s_waitcnt lgkmcnt(6)
buffer_store_dwordx4 v[164:167], v197, s[20:23], s72 offen offset:2816 sc1
ds_read_b64_tr_b16 a[148:149], v27 offset:4096
ds_read_b64_tr_b16 a[150:151], v27 offset:4352
v_mfma_f32_32x32x16_bf16 v[240:255], a[156:159], a[48:51], v[240:255]
ds_read_b64_tr_b16 a[152:153], v28 offset:0
ds_read_b64_tr_b16 a[154:155], v28 offset:256
v_min_u32 v169, -2, v169
v_min_u32 v170, -2, v170
v_min_u32 v171, -2, v171
v_min_u32 v176, -2, v176
v_min_u32 v177, -2, v177
v_mfma_f32_32x32x16_bf16 v[32:47], a[160:163], a[52:55], v[32:47]
s_waitcnt lgkmcnt(6)
buffer_store_dwordx4 v[168:171], v19, s[20:23], s73 offen offset:0 sc1
ds_read_b64_tr_b16 a[156:157], v28 offset:1024
ds_read_b64_tr_b16 a[158:159], v28 offset:1280
v_mfma_f32_32x32x16_bf16 v[48:63], a[164:167], a[52:55], v[48:63]
ds_read_b64_tr_b16 a[160:161], v28 offset:2048
ds_read_b64_tr_b16 a[162:163], v28 offset:2304
v_min_u32 v178, -2, v178
v_min_u32 v179, -2, v179
v_min_u32 v184, -2, v184
v_min_u32 v185, -2, v185
v_min_u32 v186, -2, v186
v_min_u32 v187, -2, v187
v_mfma_f32_32x32x16_bf16 v[208:223], a[168:171], a[52:55], v[208:223]
s_waitcnt lgkmcnt(6)
buffer_store_dwordx4 v[176:179], v19, s[20:23], s73 offen offset:1024 sc1
ds_read_b64_tr_b16 a[164:165], v28 offset:3072
ds_read_b64_tr_b16 a[166:167], v28 offset:3328
v_mfma_f32_32x32x16_bf16 v[224:239], a[144:147], a[52:55], v[224:239]
ds_read_b64_tr_b16 a[168:169], v28 offset:4096
ds_read_b64_tr_b16 a[170:171], v28 offset:4352
v_min_u32 v172, -2, v172
v_min_u32 v173, -2, v173
v_min_u32 v174, -2, v174
v_min_u32 v175, -2, v175
v_min_u32 v180, -2, v180
v_min_u32 v181, -2, v181
v_min_u32 v182, -2, v182
v_min_u32 v183, -2, v183
v_min_u32 v188, -2, v188
v_min_u32 v189, -2, v189
v_min_u32 v190, -2, v190
v_min_u32 v191, -2, v191
v_mfma_f32_32x32x16_bf16 v[240:255], a[148:151], a[52:55], v[240:255]
s_waitcnt lgkmcnt(6)
buffer_store_dwordx4 v[184:187], v196, s[20:23], s73 offen offset:2048 sc1
ds_read_b64_tr_b16 a[144:145], v29 offset:0
ds_read_b64_tr_b16 a[146:147], v29 offset:256
s_waitcnt vmcnt(16)
s_barrier
v_mfma_f32_32x32x16_bf16 v[32:47], a[152:155], a[56:59], v[32:47]
ds_read_b64_tr_b16 a[148:149], v29 offset:1024
ds_read_b64_tr_b16 a[150:151], v29 offset:1280
v_mfma_f32_32x32x16_bf16 v[48:63], a[156:159], a[56:59], v[48:63]
s_waitcnt lgkmcnt(6)
buffer_store_dwordx4 v[172:175], v195, s[20:23], s73 offen offset:2304 sc1
ds_read_b64_tr_b16 a[152:153], v29 offset:2048
ds_read_b64_tr_b16 a[154:155], v29 offset:2304
v_mfma_f32_32x32x16_bf16 v[208:223], a[160:163], a[56:59], v[208:223]
ds_read_b64_tr_b16 a[156:157], v29 offset:3072
ds_read_b64_tr_b16 a[158:159], v29 offset:3328
v_mfma_f32_32x32x16_bf16 v[224:239], a[164:167], a[56:59], v[224:239]
s_waitcnt lgkmcnt(6)
buffer_store_dwordx4 v[180:183], v195, s[20:23], s73 offen offset:2560 sc1
ds_read_b64_tr_b16 a[160:161], v29 offset:4096
ds_read_b64_tr_b16 a[162:163], v29 offset:4352
v_mfma_f32_32x32x16_bf16 v[240:255], a[168:171], a[56:59], v[240:255]
ds_read_b64_tr_b16 a[164:165], v26 offset:5120
ds_read_b64_tr_b16 a[166:167], v26 offset:5376
v_mfma_f32_32x32x16_bf16 v[32:47], a[144:147], a[60:63], v[32:47]
s_waitcnt lgkmcnt(6)
buffer_store_dwordx4 v[188:191], v197, s[20:23], s73 offen offset:2816 sc1
ds_read_b64_tr_b16 a[168:169], v26 offset:6144
ds_read_b64_tr_b16 a[170:171], v26 offset:6400
v_mfma_f32_32x32x16_bf16 v[48:63], a[148:151], a[60:63], v[48:63]
ds_read_b64_tr_b16 a[144:145], v26 offset:7168
ds_read_b64_tr_b16 a[146:147], v26 offset:7424
v_mfma_f32_32x32x16_bf16 v[208:223], a[152:155], a[60:63], v[208:223]
s_waitcnt lgkmcnt(6)
buffer_load_dwordx4 v22, s[12:15], s41 offen offset:2048 lds
ds_read_b64_tr_b16 a[148:149], v26 offset:8192
ds_read_b64_tr_b16 a[150:151], v26 offset:8448
v_mfma_f32_32x32x16_bf16 v[224:239], a[156:159], a[60:63], v[224:239]
ds_read_b64_tr_b16 a[152:153], v26 offset:9216
ds_read_b64_tr_b16 a[154:155], v26 offset:9472
v_mfma_f32_32x32x16_bf16 v[240:255], a[160:163], a[60:63], v[240:255]
s_waitcnt lgkmcnt(6)
buffer_load_dwordx4 v23, s[12:15], s41 offen offset:3072 lds
ds_read_b64_tr_b16 a[156:157], v27 offset:5120
ds_read_b64_tr_b16 a[158:159], v27 offset:5376
v_mfma_f32_32x32x16_bf16 v[32:47], a[164:167], a[64:67], v[32:47]
s_add_u32 m0, s35, 24320
ds_read_b64_tr_b16 a[160:161], v27 offset:6144
ds_read_b64_tr_b16 a[162:163], v27 offset:6400
v_mfma_f32_32x32x16_bf16 v[48:63], a[168:171], a[64:67], v[48:63]
s_waitcnt lgkmcnt(6)
buffer_load_dwordx4 v20, s[12:15], s41 offen offset:256 lds
ds_read_b64_tr_b16 a[164:165], v27 offset:7168
ds_read_b64_tr_b16 a[166:167], v27 offset:7424
v_mfma_f32_32x32x16_bf16 v[208:223], a[144:147], a[64:67], v[208:223]
s_add_u32 m0, s35, 25600
ds_read_b64_tr_b16 a[168:169], v27 offset:8192
ds_read_b64_tr_b16 a[170:171], v27 offset:8448
v_mfma_f32_32x32x16_bf16 v[224:239], a[148:151], a[64:67], v[224:239]
s_waitcnt lgkmcnt(6)
s_add_u32 s41, s38, 884736
buffer_load_dwordx4 v20, s[12:15], s41 offen offset:0 lds
ds_read_b64_tr_b16 a[144:145], v27 offset:9216
ds_read_b64_tr_b16 a[146:147], v27 offset:9472
v_mfma_f32_32x32x16_bf16 v[240:255], a[152:155], a[64:67], v[240:255]
ds_read_b64_tr_b16 a[148:149], v28 offset:5120
ds_read_b64_tr_b16 a[150:151], v28 offset:5376
v_mfma_f32_32x32x16_bf16 v[32:47], a[156:159], a[68:71], v[32:47]
s_waitcnt lgkmcnt(6)
buffer_load_dwordx4 v21, s[12:15], s41 offen offset:1024 lds
ds_read_b64_tr_b16 a[152:153], v28 offset:6144
ds_read_b64_tr_b16 a[154:155], v28 offset:6400
v_mfma_f32_32x32x16_bf16 v[48:63], a[160:163], a[68:71], v[48:63]
ds_read_b64_tr_b16 a[156:157], v28 offset:7168
ds_read_b64_tr_b16 a[158:159], v28 offset:7424
v_mfma_f32_32x32x16_bf16 v[208:223], a[164:167], a[68:71], v[208:223]
s_waitcnt lgkmcnt(6)
buffer_load_dwordx4 v22, s[12:15], s41 offen offset:2048 lds
ds_read_b64_tr_b16 a[160:161], v28 offset:8192
ds_read_b64_tr_b16 a[162:163], v28 offset:8448
v_mfma_f32_32x32x16_bf16 v[224:239], a[168:171], a[68:71], v[224:239]
ds_read_b64_tr_b16 a[164:165], v28 offset:9216
ds_read_b64_tr_b16 a[166:167], v28 offset:9472
v_mfma_f32_32x32x16_bf16 v[240:255], a[144:147], a[68:71], v[240:255]
s_waitcnt lgkmcnt(6)
buffer_load_dwordx4 v23, s[12:15], s41 offen offset:3072 lds
ds_read_b64_tr_b16 a[168:169], v29 offset:5120
ds_read_b64_tr_b16 a[170:171], v29 offset:5376
s_waitcnt vmcnt(21)
s_barrier
v_mfma_f32_32x32x16_bf16 v[32:47], a[148:151], a[72:75], v[32:47]
s_add_u32 m0, s35, 29440
ds_read_b64_tr_b16 a[144:145], v29 offset:6144
ds_read_b64_tr_b16 a[146:147], v29 offset:6400
s_mul_i32 s60, s32, 3280
s_add_u32 s60, s60, 147456
v_lshlrev_b32 v194, 3, v1
v_min_u32 v6, 51, v1
v_lshlrev_b32 v195, 3, v6
v_mfma_f32_32x32x16_bf16 v[48:63], a[152:155], a[72:75], v[48:63]
s_waitcnt lgkmcnt(6)
buffer_load_dwordx4 v20, s[12:15], s41 offen offset:256 lds
ds_read_b64_tr_b16 a[148:149], v29 offset:7168
ds_read_b64_tr_b16 a[150:151], v29 offset:7424
v_mfma_f32_32x32x16_bf16 v[208:223], a[156:159], a[72:75], v[208:223]
s_add_u32 m0, s35, 31744
ds_read_b64_tr_b16 a[152:153], v29 offset:8192
ds_read_b64_tr_b16 a[154:155], v29 offset:8448
v_and_b32 v4, 15, v1
v_lshrrev_b32 v5, 4, v1
v_mul_u32_u24 v196, 80, v4
v_mfma_f32_32x32x16_bf16 v[224:239], a[160:163], a[72:75], v[224:239]
s_waitcnt lgkmcnt(6)
s_add_u32 s41, s38, 1548288
buffer_load_dwordx4 v20, s[12:15], s41 offen offset:0 lds
ds_read_b64_tr_b16 a[156:157], v29 offset:9216
ds_read_b64_tr_b16 a[158:159], v29 offset:9472
v_mfma_f32_32x32x16_bf16 v[240:255], a[164:167], a[72:75], v[240:255]
ds_read_b64_tr_b16 a[160:161], v26 offset:10240
ds_read_b64_tr_b16 a[162:163], v26 offset:10496
v_add_u32 v197, 64, v196
v_lshl_add_u32 v196, v5, 3, v196
v_add_u32 v196, s60, v196
v_mfma_f32_32x32x16_bf16 v[32:47], a[168:171], a[76:79], v[32:47]
s_waitcnt lgkmcnt(6)
buffer_load_dwordx4 v21, s[12:15], s41 offen offset:1024 lds
ds_read_b64_tr_b16 a[164:165], v26 offset:11264
L_pad_a3_1:
s_cbranch_execz L_warm_a
ds_read_b64_tr_b16 a[166:167], v26 offset:11520
v_mfma_f32_32x32x16_bf16 v[48:63], a[144:147], a[76:79], v[48:63]
ds_read_b64_tr_b16 a[168:169], v26 offset:12288
ds_read_b64_tr_b16 a[170:171], v26 offset:12544
v_subrev_u32 v4, 16, v6
v_and_b32 v5, 3, v4
v_mul_u32_u24 v5, 80, v5
v_mfma_f32_32x32x16_bf16 v[208:223], a[148:151], a[76:79], v[208:223]
s_waitcnt lgkmcnt(6)
buffer_load_dwordx4 v22, s[12:15], s41 offen offset:2048 lds
ds_read_b64_tr_b16 a[144:145], v26 offset:13312
ds_read_b64_tr_b16 a[146:147], v26 offset:13568
v_mfma_f32_32x32x16_bf16 v[224:239], a[152:155], a[76:79], v[224:239]
ds_read_b64_tr_b16 a[148:149], v26 offset:14336
ds_read_b64_tr_b16 a[150:151], v26 offset:14592
v_lshrrev_b32 v4, 2, v4
v_lshl_add_u32 v5, v4, 3, v5
v_add_u32 v5, 1280, v5
v_mfma_f32_32x32x16_bf16 v[240:255], a[156:159], a[76:79], v[240:255]
s_waitcnt lgkmcnt(6)
buffer_load_dwordx4 v23, s[12:15], s41 offen offset:3072 lds
ds_read_b64_tr_b16 a[152:153], v27 offset:10240
ds_read_b64_tr_b16 a[154:155], v27 offset:10496
v_mfma_f32_32x32x16_bf16 v[32:47], a[160:163], a[80:83], v[32:47]
s_add_u32 m0, s35, 35584
ds_read_b64_tr_b16 a[156:157], v27 offset:11264
ds_read_b64_tr_b16 a[158:159], v27 offset:11520
v_cmp_gt_u32 vcc, 16, v1
s_nop 1
v_cndmask_b32 v197, v5, v197, vcc
v_add_u32 v197, s60, v197
v_mfma_f32_32x32x16_bf16 v[48:63], a[164:167], a[80:83], v[48:63]
s_waitcnt lgkmcnt(6)
buffer_load_dwordx4 v20, s[12:15], s41 offen offset:256 lds
ds_read_b64_tr_b16 a[160:161], v27 offset:12288
ds_read_b64_tr_b16 a[162:163], v27 offset:12544
v_mfma_f32_32x32x16_bf16 v[208:223], a[168:171], a[80:83], v[208:223]
s_add_u32 m0, s35, 0
ds_read_b64_tr_b16 a[164:165], v27 offset:13312
ds_read_b64_tr_b16 a[166:167], v27 offset:13568
v_min_u32 v6, 49, v1
v_mul_u32_u24 v198, 80, v6
v_add_u32 v198, 72, v198
v_mfma_f32_32x32x16_bf16 v[224:239], a[144:147], a[80:83], v[224:239]
s_waitcnt lgkmcnt(6)
s_add_u32 s41, s39, 0
ds_read_b64_tr_b16 a[168:169], v27 offset:14336
ds_read_b64_tr_b16 a[170:171], v27 offset:14592
v_lshlrev_b32 v4, 3, v6
v_add_u32 v4, 2880, v4
v_cmp_gt_u32 vcc, 40, v1
v_mfma_f32_32x32x16_bf16 v[240:255], a[148:151], a[80:83], v[240:255]
ds_read_b64_tr_b16 a[144:145], v28 offset:10240
ds_read_b64_tr_b16 a[146:147], v28 offset:10496
v_cndmask_b32 v198, v4, v198, vcc
v_add_u32 v198, s60, v198
v_mov_b32 v200, 0
v_mfma_f32_32x32x16_bf16 v[32:47], a[152:155], a[84:87], v[32:47]
s_waitcnt lgkmcnt(6)
ds_read_b64_tr_b16 a[148:149], v28 offset:11264
ds_read_b64_tr_b16 a[150:151], v28 offset:11520
v_mov_b32 v201, 0
ds_write_b64 v198, v[200:201]
v_mfma_f32_32x32x16_bf16 v[48:63], a[156:159], a[84:87], v[48:63]
ds_read_b64_tr_b16 a[152:153], v28 offset:12288
ds_read_b64_tr_b16 a[154:155], v28 offset:12544
v_mfma_f32_32x32x16_bf16 v[208:223], a[160:163], a[84:87], v[208:223]
s_waitcnt lgkmcnt(7)
ds_read_b64_tr_b16 a[156:157], v28 offset:13312
ds_read_b64_tr_b16 a[158:159], v28 offset:13568
v_mfma_f32_32x32x16_bf16 v[224:239], a[164:167], a[84:87], v[224:239]
s_add_u32 s63, s52, 0
buffer_load_dwordx4 v[64:67], v120, s[20:23], s63 offen sc1
ds_read_b64_tr_b16 a[160:161], v28 offset:14336
ds_read_b64_tr_b16 a[162:163], v28 offset:14592
v_mfma_f32_32x32x16_bf16 v[240:255], a[168:171], a[84:87], v[240:255]
s_waitcnt lgkmcnt(7)
s_add_u32 s63, s52, 23040
ds_read_b64_tr_b16 a[164:165], v29 offset:10240
ds_read_b64_tr_b16 a[166:167], v29 offset:10496
s_waitcnt vmcnt(11)
s_barrier
v_mfma_f32_32x32x16_bf16 v[32:47], a[144:147], a[88:91], v[32:47]
buffer_load_dwordx4 v[68:71], v120, s[20:23], s63 offen sc1
ds_read_b64_tr_b16 a[168:169], v29 offset:11264
ds_read_b64_tr_b16 a[170:171], v29 offset:11520
v_mfma_f32_32x32x16_bf16 v[48:63], a[148:151], a[88:91], v[48:63]
s_waitcnt lgkmcnt(6)
s_add_u32 s63, s52, 46080
ds_read_b64_tr_b16 a[144:145], v29 offset:12288
ds_read_b64_tr_b16 a[146:147], v29 offset:12544
v_mfma_f32_32x32x16_bf16 v[208:223], a[152:155], a[88:91], v[208:223]
buffer_load_dwordx4 v[72:75], v120, s[20:23], s63 offen sc1
ds_read_b64_tr_b16 a[148:149], v29 offset:13312
ds_read_b64_tr_b16 a[150:151], v29 offset:13568
v_mfma_f32_32x32x16_bf16 v[224:239], a[156:159], a[88:91], v[224:239]
s_waitcnt lgkmcnt(6)
s_add_u32 s63, s52, 69120
ds_read_b64_tr_b16 a[152:153], v29 offset:14336
ds_read_b64_tr_b16 a[154:155], v29 offset:14592
v_mfma_f32_32x32x16_bf16 v[240:255], a[160:163], a[88:91], v[240:255]
buffer_load_dwordx4 v[76:79], v120, s[20:23], s63 offen sc1
ds_read_b64_tr_b16 a[156:157], v26 offset:20480
ds_read_b64_tr_b16 a[158:159], v26 offset:20736
v_mfma_f32_32x32x16_bf16 v[32:47], a[164:167], a[92:95], v[32:47]
s_waitcnt lgkmcnt(6)
s_add_u32 s63, s52, 92160
ds_read_b64_tr_b16 a[160:161], v26 offset:21504
ds_read_b64_tr_b16 a[162:163], v26 offset:21760
v_mfma_f32_32x32x16_bf16 v[48:63], a[168:171], a[92:95], v[48:63]
buffer_load_dwordx4 v[80:83], v120, s[20:23], s63 offen sc1
ds_read_b64_tr_b16 a[164:165], v26 offset:22528
ds_read_b64_tr_b16 a[166:167], v26 offset:22784
v_mfma_f32_32x32x16_bf16 v[208:223], a[144:147], a[92:95], v[208:223]
s_waitcnt lgkmcnt(6)
s_add_u32 s63, s52, 115200
ds_read_b64_tr_b16 a[168:169], v26 offset:23552
ds_read_b64_tr_b16 a[170:171], v26 offset:23808
v_mfma_f32_32x32x16_bf16 v[224:239], a[148:151], a[92:95], v[224:239]
buffer_load_dwordx4 v[84:87], v120, s[20:23], s63 offen sc1
ds_read_b64_tr_b16 a[144:145], v26 offset:24576
ds_read_b64_tr_b16 a[146:147], v26 offset:24832
v_mfma_f32_32x32x16_bf16 v[240:255], a[152:155], a[92:95], v[240:255]
s_waitcnt lgkmcnt(6)
s_add_u32 s63, s52, 138240
ds_read_b64_tr_b16 a[148:149], v27 offset:20480
ds_read_b64_tr_b16 a[150:151], v27 offset:20736
v_mfma_f32_32x32x16_bf16 v[32:47], a[156:159], a[96:99], v[32:47]
buffer_load_dwordx4 v[88:91], v120, s[20:23], s63 offen sc1
ds_read_b64_tr_b16 a[152:153], v27 offset:21504
ds_read_b64_tr_b16 a[154:155], v27 offset:21760
v_mfma_f32_32x32x16_bf16 v[48:63], a[160:163], a[96:99], v[48:63]
s_waitcnt lgkmcnt(6)
s_add_u32 s63, s52, 161280
ds_read_b64_tr_b16 a[156:157], v27 offset:22528
ds_read_b64_tr_b16 a[158:159], v27 offset:22784
v_mfma_f32_32x32x16_bf16 v[208:223], a[164:167], a[96:99], v[208:223]
buffer_load_dwordx4 v[92:95], v120, s[20:23], s63 offen sc1
ds_read_b64_tr_b16 a[160:161], v27 offset:23552
ds_read_b64_tr_b16 a[162:163], v27 offset:23808
v_mfma_f32_32x32x16_bf16 v[224:239], a[168:171], a[96:99], v[224:239]
s_waitcnt lgkmcnt(6)
ds_read_b64_tr_b16 a[164:165], v27 offset:24576
ds_read_b64_tr_b16 a[166:167], v27 offset:24832
v_mfma_f32_32x32x16_bf16 v[240:255], a[144:147], a[96:99], v[240:255]
buffer_load_dwordx4 v15, s[16:19], s41 offen offset:0 lds
ds_read_b64_tr_b16 a[168:169], v28 offset:20480
ds_read_b64_tr_b16 a[170:171], v28 offset:20736
v_mfma_f32_32x32x16_bf16 v[32:47], a[148:151], a[100:103], v[32:47]
s_waitcnt lgkmcnt(6)
ds_read_b64_tr_b16 a[144:145], v28 offset:21504
ds_read_b64_tr_b16 a[146:147], v28 offset:21760
v_mfma_f32_32x32x16_bf16 v[48:63], a[152:155], a[100:103], v[48:63]
buffer_load_dwordx4 v16, s[16:19], s41 offen offset:1024 lds
ds_read_b64_tr_b16 a[148:149], v28 offset:22528
ds_read_b64_tr_b16 a[150:151], v28 offset:22784
v_mfma_f32_32x32x16_bf16 v[208:223], a[156:159], a[100:103], v[208:223]
s_waitcnt lgkmcnt(6)
ds_read_b64_tr_b16 a[152:153], v28 offset:23552
ds_read_b64_tr_b16 a[154:155], v28 offset:23808
v_mfma_f32_32x32x16_bf16 v[224:239], a[160:163], a[100:103], v[224:239]
buffer_load_dwordx4 v17, s[16:19], s41 offen offset:2048 lds
ds_read_b64_tr_b16 a[156:157], v28 offset:24576
ds_read_b64_tr_b16 a[158:159], v28 offset:24832
v_mfma_f32_32x32x16_bf16 v[240:255], a[164:167], a[100:103], v[240:255]
s_waitcnt lgkmcnt(6)
s_add_u32 m0, s35, 3072
ds_read_b64_tr_b16 a[160:161], v29 offset:20480
ds_read_b64_tr_b16 a[162:163], v29 offset:20736
s_waitcnt vmcnt(16)
s_barrier
v_mfma_f32_32x32x16_bf16 v[32:47], a[168:171], a[104:107], v[32:47]
s_add_u32 s41, s39, 55296
buffer_load_dwordx4 v15, s[16:19], s41 offen offset:0 lds
ds_read_b64_tr_b16 a[164:165], v29 offset:21504
ds_read_b64_tr_b16 a[166:167], v29 offset:21760
v_mfma_f32_32x32x16_bf16 v[48:63], a[144:147], a[104:107], v[48:63]
s_waitcnt lgkmcnt(6)
ds_read_b64_tr_b16 a[168:169], v29 offset:22528
ds_read_b64_tr_b16 a[170:171], v29 offset:22784
v_mfma_f32_32x32x16_bf16 v[208:223], a[148:151], a[104:107], v[208:223]
buffer_load_dwordx4 v16, s[16:19], s41 offen offset:1024 lds
ds_read_b64_tr_b16 a[144:145], v29 offset:23552
ds_read_b64_tr_b16 a[146:147], v29 offset:23808
v_mfma_f32_32x32x16_bf16 v[224:239], a[152:155], a[104:107], v[224:239]
s_waitcnt lgkmcnt(6)
ds_read_b64_tr_b16 a[148:149], v29 offset:24576
ds_read_b64_tr_b16 a[150:151], v29 offset:24832
v_mfma_f32_32x32x16_bf16 v[240:255], a[156:159], a[104:107], v[240:255]
buffer_load_dwordx4 v17, s[16:19], s41 offen offset:2048 lds
ds_read_b64_tr_b16 a[152:153], v26 offset:25600
ds_read_b64_tr_b16 a[154:155], v26 offset:25856
v_mfma_f32_32x32x16_bf16 v[32:47], a[160:163], a[108:111], v[32:47]
s_waitcnt lgkmcnt(6)
s_add_u32 m0, s35, 6144
ds_read_b64_tr_b16 a[156:157], v26 offset:26624
ds_read_b64_tr_b16 a[158:159], v26 offset:26880
v_mfma_f32_32x32x16_bf16 v[48:63], a[164:167], a[108:111], v[48:63]
s_add_u32 s41, s39, 110592
buffer_load_dwordx4 v15, s[16:19], s41 offen offset:0 lds
ds_read_b64_tr_b16 a[160:161], v26 offset:27648
ds_read_b64_tr_b16 a[162:163], v26 offset:27904
v_mfma_f32_32x32x16_bf16 v[208:223], a[168:171], a[108:111], v[208:223]
s_waitcnt lgkmcnt(6)
ds_read_b64_tr_b16 a[164:165], v26 offset:28672
ds_read_b64_tr_b16 a[166:167], v26 offset:28928
v_mfma_f32_32x32x16_bf16 v[224:239], a[144:147], a[108:111], v[224:239]
buffer_load_dwordx4 v16, s[16:19], s41 offen offset:1024 lds
ds_read_b64_tr_b16 a[168:169], v26 offset:29696
ds_read_b64_tr_b16 a[170:171], v26 offset:29952
v_mfma_f32_32x32x16_bf16 v[240:255], a[148:151], a[108:111], v[240:255]
s_waitcnt lgkmcnt(6)
ds_read_b64_tr_b16 a[144:145], v27 offset:25600
ds_read_b64_tr_b16 a[146:147], v27 offset:25856
v_mfma_f32_32x32x16_bf16 v[32:47], a[152:155], a[112:115], v[32:47]
buffer_load_dwordx4 v17, s[16:19], s41 offen offset:2048 lds
ds_read_b64_tr_b16 a[148:149], v27 offset:26624
ds_read_b64_tr_b16 a[150:151], v27 offset:26880
v_mfma_f32_32x32x16_bf16 v[48:63], a[156:159], a[112:115], v[48:63]
s_waitcnt lgkmcnt(6)
s_add_u32 m0, s35, 9216
ds_read_b64_tr_b16 a[152:153], v27 offset:27648
ds_read_b64_tr_b16 a[154:155], v27 offset:27904
v_mfma_f32_32x32x16_bf16 v[208:223], a[160:163], a[112:115], v[208:223]
s_add_u32 s41, s39, 256
buffer_load_dwordx4 v15, s[16:19], s41 offen offset:0 lds
ds_read_b64_tr_b16 a[156:157], v27 offset:28672
ds_read_b64_tr_b16 a[158:159], v27 offset:28928
v_mfma_f32_32x32x16_bf16 v[224:239], a[164:167], a[112:115], v[224:239]
s_waitcnt lgkmcnt(6)
ds_read_b64_tr_b16 a[160:161], v27 offset:29696
ds_read_b64_tr_b16 a[162:163], v27 offset:29952
s_waitcnt vmcnt(17)
v_max3_u32 v3, v64, v65, v66
s_waitcnt vmcnt(16)
v_max3_u32 v3, v3, v67, v68
v_max3_u32 v3, v3, v69, v70
s_waitcnt vmcnt(15)
v_max3_u32 v3, v3, v71, v72
v_max3_u32 v3, v3, v73, v74
s_waitcnt vmcnt(14)
v_max3_u32 v3, v3, v75, v76
v_mfma_f32_32x32x16_bf16 v[240:255], a[168:171], a[112:115], v[240:255]
buffer_load_dwordx4 v16, s[16:19], s41 offen offset:1024 lds
ds_read_b64_tr_b16 a[164:165], v28 offset:25600
ds_read_b64_tr_b16 a[166:167], v28 offset:25856
v_mfma_f32_32x32x16_bf16 v[32:47], a[144:147], a[116:119], v[32:47]
s_waitcnt lgkmcnt(6)
ds_read_b64_tr_b16 a[168:169], v28 offset:26624
ds_read_b64_tr_b16 a[170:171], v28 offset:26880
v_max3_u32 v3, v3, v77, v78
s_waitcnt vmcnt(14)
v_max3_u32 v3, v3, v79, v80
v_max3_u32 v3, v3, v81, v82
s_waitcnt vmcnt(13)
v_max3_u32 v3, v3, v83, v84
v_max3_u32 v3, v3, v85, v86
s_waitcnt vmcnt(12)
v_max3_u32 v3, v3, v87, v88
v_mfma_f32_32x32x16_bf16 v[48:63], a[148:151], a[116:119], v[48:63]
buffer_load_dwordx4 v17, s[16:19], s41 offen offset:2048 lds
ds_read_b64_tr_b16 a[144:145], v28 offset:27648
ds_read_b64_tr_b16 a[146:147], v28 offset:27904
v_mfma_f32_32x32x16_bf16 v[208:223], a[152:155], a[116:119], v[208:223]
s_waitcnt lgkmcnt(6)
s_add_u32 m0, s35, 12288
ds_read_b64_tr_b16 a[148:149], v28 offset:28672
ds_read_b64_tr_b16 a[150:151], v28 offset:28928
v_max3_u32 v3, v3, v89, v90
s_waitcnt vmcnt(12)
v_max3_u32 v3, v3, v91, v92
v_max3_u32 v3, v3, v93, v94
v_max_u32 v3, v3, v95
v_cmp_eq_u32 vcc, -1, v3
s_nop 4
s_cbranch_vccnz L_spin_h1
L_back_h1:
v_add_f32 v64, v64, v68
v_add_f32 v65, v65, v69
v_mfma_f32_32x32x16_bf16 v[224:239], a[156:159], a[116:119], v[224:239]
s_add_u32 s41, s39, 55552
buffer_load_dwordx4 v15, s[16:19], s41 offen offset:0 lds
ds_read_b64_tr_b16 a[152:153], v28 offset:29696
ds_read_b64_tr_b16 a[154:155], v28 offset:29952
v_mfma_f32_32x32x16_bf16 v[240:255], a[160:163], a[116:119], v[240:255]
s_waitcnt lgkmcnt(6)
ds_read_b64_tr_b16 a[156:157], v29 offset:25600
ds_read_b64_tr_b16 a[158:159], v29 offset:25856
v_add_f32 v66, v66, v70
v_add_f32 v67, v67, v71
v_add_f32 v64, v64, v72
v_add_f32 v65, v65, v73
v_add_f32 v66, v66, v74
v_add_f32 v67, v67, v75
v_add_f32 v64, v64, v76
s_barrier
v_mfma_f32_32x32x16_bf16 v[32:47], a[164:167], a[120:123], v[32:47]
buffer_load_dwordx4 v16, s[16:19], s41 offen offset:1024 lds
ds_read_b64_tr_b16 a[160:161], v29 offset:26624
ds_read_b64_tr_b16 a[162:163], v29 offset:26880
v_mfma_f32_32x32x16_bf16 v[48:63], a[168:171], a[120:123], v[48:63]
s_waitcnt lgkmcnt(6)
ds_read_b64_tr_b16 a[164:165], v29 offset:27648
ds_read_b64_tr_b16 a[166:167], v29 offset:27904
v_add_f32 v65, v65, v77
v_add_f32 v66, v66, v78
v_add_f32 v67, v67, v79
v_add_f32 v64, v64, v80
v_add_f32 v65, v65, v81
v_add_f32 v66, v66, v82
v_add_f32 v67, v67, v83
v_add_f32 v64, v64, v84
v_mfma_f32_32x32x16_bf16 v[208:223], a[144:147], a[120:123], v[208:223]
buffer_load_dwordx4 v17, s[16:19], s41 offen offset:2048 lds
ds_read_b64_tr_b16 a[168:169], v29 offset:28672
ds_read_b64_tr_b16 a[170:171], v29 offset:28928
v_mfma_f32_32x32x16_bf16 v[224:239], a[148:151], a[120:123], v[224:239]
s_waitcnt lgkmcnt(6)
s_add_u32 m0, s35, 15360
ds_read_b64_tr_b16 a[144:145], v29 offset:29696
ds_read_b64_tr_b16 a[146:147], v29 offset:29952
v_add_f32 v65, v65, v85
v_add_f32 v66, v66, v86
v_add_f32 v67, v67, v87
v_add_f32 v64, v64, v88
v_add_f32 v65, v65, v89
v_add_f32 v66, v66, v90
v_add_f32 v67, v67, v91
v_add_f32 v64, v64, v92
v_add_f32 v65, v65, v93
v_add_f32 v66, v66, v94
v_mfma_f32_32x32x16_bf16 v[240:255], a[152:155], a[120:123], v[240:255]
s_add_u32 s41, s39, 110848
buffer_load_dwordx4 v15, s[16:19], s41 offen offset:0 lds
ds_read_b64_tr_b16 a[148:149], v26 offset:31744
ds_read_b64_tr_b16 a[150:151], v26 offset:32000
v_mfma_f32_32x32x16_bf16 v[32:47], a[156:159], a[124:127], v[32:47]
s_waitcnt lgkmcnt(6)
ds_read_b64_tr_b16 a[152:153], v26 offset:32768
ds_read_b64_tr_b16 a[154:155], v26 offset:33024
v_add_f32 v67, v67, v95
v_mov_b32 v68, v64
v_mov_b32 v69, v65
v_mov_b32 v70, v66
v_mov_b32 v71, v67
v_permlane32_swap_b32 v64, v68
v_permlane32_swap_b32 v65, v69
v_mfma_f32_32x32x16_bf16 v[48:63], a[160:163], a[124:127], v[48:63]
buffer_load_dwordx4 v16, s[16:19], s41 offen offset:1024 lds
ds_read_b64_tr_b16 a[156:157], v26 offset:33792
ds_read_b64_tr_b16 a[158:159], v26 offset:34048
v_mfma_f32_32x32x16_bf16 v[208:223], a[164:167], a[124:127], v[208:223]
s_waitcnt lgkmcnt(6)
ds_read_b64_tr_b16 a[160:161], v26 offset:34816
ds_read_b64_tr_b16 a[162:163], v26 offset:35072
v_permlane32_swap_b32 v66, v70
v_permlane32_swap_b32 v67, v71
v_add_f32 v64, v64, v68
v_add_f32 v65, v65, v69
v_add_f32 v66, v66, v70
v_add_f32 v67, v67, v71
v_cvt_pk_bf16_f32 v64, v64, v65
v_cvt_pk_bf16_f32 v65, v66, v67
v_min_u32 v64, -2, v64
v_min_u32 v65, -2, v65
v_mfma_f32_32x32x16_bf16 v[224:239], a[168:171], a[124:127], v[224:239]
buffer_store_dwordx2 v[64:65], v121, s[20:23], s74 offen sc1
ds_read_b64_tr_b16 a[164:165], v26 offset:35840
ds_read_b64_tr_b16 a[166:167], v26 offset:36096
v_mfma_f32_32x32x16_bf16 v[240:255], a[144:147], a[124:127], v[240:255]
s_waitcnt lgkmcnt(6)
ds_read_b64_tr_b16 a[168:169], v27 offset:31744
ds_read_b64_tr_b16 a[170:171], v27 offset:32000
v_mfma_f32_32x32x16_bf16 v[32:47], a[148:151], a[128:131], v[32:47]
buffer_load_dwordx4 v17, s[16:19], s41 offen offset:2048 lds
ds_read_b64_tr_b16 a[144:145], v27 offset:32768
ds_read_b64_tr_b16 a[146:147], v27 offset:33024
v_mfma_f32_32x32x16_bf16 v[48:63], a[152:155], a[128:131], v[48:63]
s_waitcnt lgkmcnt(6)
s_add_u32 m0, s35, 18432
ds_read_b64_tr_b16 a[148:149], v27 offset:33792
ds_read_b64_tr_b16 a[150:151], v27 offset:34048
v_mfma_f32_32x32x16_bf16 v[208:223], a[156:159], a[128:131], v[208:223]
s_add_u32 s41, s39, 512
ds_read_b64_tr_b16 a[152:153], v27 offset:34816
ds_read_b64_tr_b16 a[154:155], v27 offset:35072
v_mfma_f32_32x32x16_bf16 v[224:239], a[160:163], a[128:131], v[224:239]
s_waitcnt lgkmcnt(6)
ds_read_b64_tr_b16 a[156:157], v27 offset:35840
ds_read_b64_tr_b16 a[158:159], v27 offset:36096
v_mfma_f32_32x32x16_bf16 v[240:255], a[164:167], a[128:131], v[240:255]
ds_read_b64_tr_b16 a[160:161], v28 offset:31744
ds_read_b64_tr_b16 a[162:163], v28 offset:32000
v_mfma_f32_32x32x16_bf16 v[32:47], a[168:171], a[132:135], v[32:47]
s_waitcnt lgkmcnt(6)
ds_read_b64_tr_b16 a[164:165], v28 offset:32768
ds_read_b64_tr_b16 a[166:167], v28 offset:33024
v_mfma_f32_32x32x16_bf16 v[48:63], a[144:147], a[132:135], v[48:63]
ds_read_b64_tr_b16 a[168:169], v28 offset:33792
ds_read_b64_tr_b16 a[170:171], v28 offset:34048
v_mfma_f32_32x32x16_bf16 v[208:223], a[148:151], a[132:135], v[208:223]
s_waitcnt lgkmcnt(6)
ds_read_b64_tr_b16 a[144:145], v28 offset:34816
ds_read_b64_tr_b16 a[146:147], v28 offset:35072
v_mfma_f32_32x32x16_bf16 v[224:239], a[152:155], a[132:135], v[224:239]
ds_read_b64_tr_b16 a[148:149], v28 offset:35840
ds_read_b64_tr_b16 a[150:151], v28 offset:36096
v_mfma_f32_32x32x16_bf16 v[240:255], a[156:159], a[132:135], v[240:255]
s_waitcnt lgkmcnt(6)
ds_read_b64_tr_b16 a[152:153], v29 offset:31744
ds_read_b64_tr_b16 a[154:155], v29 offset:32000
s_barrier
v_mfma_f32_32x32x16_bf16 v[32:47], a[160:163], a[136:139], v[32:47]
buffer_load_dwordx4 v15, s[16:19], s41 offen offset:0 lds
ds_read_b64_tr_b16 a[156:157], v29 offset:32768
ds_read_b64_tr_b16 a[158:159], v29 offset:33024
v_mfma_f32_32x32x16_bf16 v[48:63], a[164:167], a[136:139], v[48:63]
s_waitcnt lgkmcnt(6)
ds_read_b64_tr_b16 a[160:161], v29 offset:33792
ds_read_b64_tr_b16 a[162:163], v29 offset:34048
v_mfma_f32_32x32x16_bf16 v[208:223], a[168:171], a[136:139], v[208:223]
buffer_load_dwordx4 v16, s[16:19], s41 offen offset:1024 lds
ds_read_b64_tr_b16 a[164:165], v29 offset:34816
ds_read_b64_tr_b16 a[166:167], v29 offset:35072
v_mfma_f32_32x32x16_bf16 v[224:239], a[144:147], a[136:139], v[224:239]
s_waitcnt lgkmcnt(6)
ds_read_b64_tr_b16 a[168:169], v29 offset:35840
ds_read_b64_tr_b16 a[170:171], v29 offset:36096
v_mfma_f32_32x32x16_bf16 v[240:255], a[148:151], a[136:139], v[240:255]
buffer_load_dwordx4 v17, s[16:19], s41 offen offset:2048 lds
v_mfma_f32_32x32x16_bf16 v[32:47], a[152:155], a[140:143], v[32:47]
s_waitcnt lgkmcnt(4)
s_add_u32 m0, s35, 21504
v_mfma_f32_32x32x16_bf16 v[48:63], a[156:159], a[140:143], v[48:63]
s_add_u32 s41, s39, 55808
buffer_load_dwordx4 v15, s[16:19], s41 offen offset:0 lds
v_mfma_f32_32x32x16_bf16 v[208:223], a[160:163], a[140:143], v[208:223]
s_waitcnt lgkmcnt(0)
v_mfma_f32_32x32x16_bf16 v[224:239], a[164:167], a[140:143], v[224:239]
buffer_load_dwordx4 v16, s[16:19], s41 offen offset:1024 lds
v_mfma_f32_32x32x16_bf16 v[240:255], a[168:171], a[140:143], v[240:255]
s_nop 1
v_cvt_pk_bf16_f32 v128, v32, v33
v_cvt_pk_bf16_f32 v129, v34, v35
v_cvt_pk_bf16_f32 v130, v36, v37
v_cvt_pk_bf16_f32 v131, v38, v39
v_cvt_pk_bf16_f32 v132, v40, v41
v_cvt_pk_bf16_f32 v133, v42, v43
v_cvt_pk_bf16_f32 v134, v44, v45
v_cvt_pk_bf16_f32 v135, v46, v47
v_cvt_pk_bf16_f32 v136, v48, v49
v_cvt_pk_bf16_f32 v137, v50, v51
v_cvt_pk_bf16_f32 v138, v52, v53
v_cvt_pk_bf16_f32 v139, v54, v55
v_cvt_pk_bf16_f32 v140, v56, v57
v_cvt_pk_bf16_f32 v141, v58, v59
v_cvt_pk_bf16_f32 v142, v60, v61
v_cvt_pk_bf16_f32 v143, v62, v63
v_cvt_pk_bf16_f32 v144, v208, v209
v_cvt_pk_bf16_f32 v145, v210, v211
v_cvt_pk_bf16_f32 v146, v212, v213
v_cvt_pk_bf16_f32 v147, v214, v215
v_cvt_pk_bf16_f32 v148, v216, v217
v_cvt_pk_bf16_f32 v149, v218, v219
v_cvt_pk_bf16_f32 v150, v220, v221
v_cvt_pk_bf16_f32 v151, v222, v223
v_cvt_pk_bf16_f32 v152, v224, v225
v_cvt_pk_bf16_f32 v153, v226, v227
v_cvt_pk_bf16_f32 v154, v228, v229
v_cvt_pk_bf16_f32 v155, v230, v231
v_cvt_pk_bf16_f32 v156, v232, v233
v_cvt_pk_bf16_f32 v157, v234, v235
v_cvt_pk_bf16_f32 v158, v236, v237
v_cvt_pk_bf16_f32 v159, v238, v239
v_cvt_pk_bf16_f32 v160, v240, v241
v_cvt_pk_bf16_f32 v161, v242, v243
v_cvt_pk_bf16_f32 v162, v244, v245
v_cvt_pk_bf16_f32 v163, v246, v247
v_mfma_f32_32x32x16_bf16 v[240:255], a[220:223], v[128:131], 0
v_mov_b32 v82, 0
v_mov_b32 v83, 0
v_mov_b32 v102, 0
v_mfma_f32_32x32x16_bf16 v[240:255], a[224:227], v[132:135], v[240:255]
buffer_load_dwordx4 v17, s[16:19], s41 offen offset:2048 lds
v_mfma_f32_32x32x16_bf16 v[240:255], a[228:231], v[136:139], v[240:255]
s_add_u32 m0, s35, 24576
v_mov_b32 v103, 0
v_mov_b32 v122, 0
v_mov_b32 v123, 0
v_mfma_f32_32x32x16_bf16 v[240:255], a[232:235], v[140:143], v[240:255]
s_add_u32 s41, s39, 111104
buffer_load_dwordx4 v15, s[16:19], s41 offen offset:0 lds
v_mfma_f32_32x32x16_bf16 v[240:255], a[236:239], v[144:147], v[240:255]
v_mfma_f32_32x32x16_bf16 v[240:255], a[240:243], v[148:151], v[240:255]
buffer_load_dwordx4 v16, s[16:19], s41 offen offset:1024 lds
v_mfma_f32_32x32x16_bf16 v[240:255], a[244:247], v[152:155], v[240:255]
v_mfma_f32_32x32x16_bf16 v[240:255], a[248:251], v[156:159], v[240:255]
buffer_load_dwordx4 v17, s[16:19], s41 offen offset:2048 lds
s_barrier
v_mfma_f32_32x32x16_bf16 v[240:255], a[252:255], v[160:163], v[240:255]
s_add_u32 m0, s35, 27648
v_mfma_f32_32x32x16_bf16 v[32:47], a[172:175], v[128:131], 0
s_add_u32 s41, s39, 768
buffer_load_dwordx4 v15, s[16:19], s41 offen offset:0 lds
v_mfma_f32_32x32x16_bf16 v[32:47], a[176:179], v[132:135], v[32:47]
v_mfma_f32_32x32x16_bf16 v[32:47], a[180:183], v[136:139], v[32:47]
buffer_load_dwordx4 v16, s[16:19], s41 offen offset:1024 lds
v_mfma_f32_32x32x16_bf16 v[48:63], a[184:187], v[136:139], 0
v_mfma_f32_32x32x16_bf16 v[48:63], a[188:191], v[140:143], v[48:63]
buffer_load_dwordx4 v17, s[16:19], s41 offen offset:2048 lds
v_mfma_f32_32x32x16_bf16 v[48:63], a[192:195], v[144:147], v[48:63]
s_add_u32 m0, s35, 30720
v_mfma_f32_32x32x16_bf16 v[208:223], a[196:199], v[144:147], 0
s_add_u32 s41, s39, 56064
buffer_load_dwordx4 v15, s[16:19], s41 offen offset:0 lds
v_mfma_f32_32x32x16_bf16 v[208:223], a[200:203], v[148:151], v[208:223]
v_mfma_f32_32x32x16_bf16 v[208:223], a[204:207], v[152:155], v[208:223]
buffer_load_dwordx4 v16, s[16:19], s41 offen offset:1024 lds
v_mfma_f32_32x32x16_bf16 v[224:239], a[208:211], v[152:155], 0
v_mfma_f32_32x32x16_bf16 v[224:239], a[212:215], v[156:159], v[224:239]
buffer_load_dwordx4 v17, s[16:19], s41 offen offset:2048 lds
v_mfma_f32_32x32x16_bf16 v[224:239], a[216:219], v[160:163], v[224:239]
s_add_u32 m0, s35, 33792
v_mov_b32 v142, 0
v_mov_b32 v143, 0
v_max3_f32 v186, v32, v33, v34
v_min3_f32 v187, v32, v33, v34
v_max3_f32 v186, v186, v35, v36
v_min3_f32 v187, v187, v35, v36
v_max3_f32 v186, v186, v37, v38
v_min3_f32 v187, v187, v37, v38
v_max3_f32 v186, v186, v39, v40
v_min3_f32 v187, v187, v39, v40
v_max3_f32 v186, v186, v41, v42
v_min3_f32 v187, v187, v41, v42
v_max3_f32 v186, v186, v43, v44
v_min3_f32 v187, v187, v43, v44
v_max3_f32 v186, v186, v45, v46
v_min3_f32 v187, v187, v45, v46
v_max3_f32 v186, v186, v47, v240
v_min3_f32 v187, v187, v47, v240
v_max_f32 v186, v186, v241
v_min_f32 v187, v187, v241
v_mul_f32 v186, v186, v30
v_mul_f32 v187, v187, v30
v_pk_fma_f32 v[168:169], v[32:33], v[30:31], v[186:187] op_sel:[0,0,0] op_sel_hi:[1,0,0] neg_lo:[0,0,1] neg_hi:[0,0,1]
v_pk_fma_f32 v[32:33], v[32:33], v[30:31], v[186:187] op_sel:[0,0,1] op_sel_hi:[1,0,1] neg_lo:[1,0,0] neg_hi:[1,0,0]
v_pk_fma_f32 v[170:171], v[34:35], v[30:31], v[186:187] op_sel:[0,0,0] op_sel_hi:[1,0,0] neg_lo:[0,0,1] neg_hi:[0,0,1]
v_pk_fma_f32 v[34:35], v[34:35], v[30:31], v[186:187] op_sel:[0,0,1] op_sel_hi:[1,0,1] neg_lo:[1,0,0] neg_hi:[1,0,0]
v_pk_fma_f32 v[172:173], v[36:37], v[30:31], v[186:187] op_sel:[0,0,0] op_sel_hi:[1,0,0] neg_lo:[0,0,1] neg_hi:[0,0,1]
v_pk_fma_f32 v[36:37], v[36:37], v[30:31], v[186:187] op_sel:[0,0,1] op_sel_hi:[1,0,1] neg_lo:[1,0,0] neg_hi:[1,0,0]
v_pk_fma_f32 v[174:175], v[38:39], v[30:31], v[186:187] op_sel:[0,0,0] op_sel_hi:[1,0,0] neg_lo:[0,0,1] neg_hi:[0,0,1]
v_pk_fma_f32 v[38:39], v[38:39], v[30:31], v[186:187] op_sel:[0,0,1] op_sel_hi:[1,0,1] neg_lo:[1,0,0] neg_hi:[1,0,0]
v_pk_fma_f32 v[176:177], v[40:41], v[30:31], v[186:187] op_sel:[0,0,0] op_sel_hi:[1,0,0] neg_lo:[0,0,1] neg_hi:[0,0,1]
v_pk_fma_f32 v[40:41], v[40:41], v[30:31], v[186:187] op_sel:[0,0,1] op_sel_hi:[1,0,1] neg_lo:[1,0,0] neg_hi:[1,0,0]
v_pk_fma_f32 v[178:179], v[42:43], v[30:31], v[186:187] op_sel:[0,0,0] op_sel_hi:[1,0,0] neg_lo:[0,0,1] neg_hi:[0,0,1]
v_pk_fma_f32 v[42:43], v[42:43], v[30:31], v[186:187] op_sel:[0,0,1] op_sel_hi:[1,0,1] neg_lo:[1,0,0] neg_hi:[1,0,0]
v_pk_fma_f32 v[180:181], v[44:45], v[30:31], v[186:187] op_sel:[0,0,0] op_sel_hi:[1,0,0] neg_lo:[0,0,1] neg_hi:[0,0,1]
v_pk_fma_f32 v[44:45], v[44:45], v[30:31], v[186:187] op_sel:[0,0,1] op_sel_hi:[1,0,1] neg_lo:[1,0,0] neg_hi:[1,0,0]
v_pk_fma_f32 v[182:183], v[46:47], v[30:31], v[186:187] op_sel:[0,0,0] op_sel_hi:[1,0,0] neg_lo:[0,0,1] neg_hi:[0,0,1]
v_pk_fma_f32 v[46:47], v[46:47], v[30:31], v[186:187] op_sel:[0,0,1] op_sel_hi:[1,0,1] neg_lo:[1,0,0] neg_hi:[1,0,0]
v_pk_fma_f32 v[184:185], v[240:241], v[30:31], v[186:187] op_sel:[0,0,0] op_sel_hi:[1,0,0] neg_lo:[0,0,1] neg_hi:[0,0,1]
v_pk_fma_f32 v[240:241], v[240:241], v[30:31], v[186:187] op_sel:[0,0,1] op_sel_hi:[1,0,1] neg_lo:[1,0,0] neg_hi:[1,0,0]
s_add_u32 s41, s39, 111360
buffer_load_dwordx4 v15, s[16:19], s41 offen offset:0 lds
buffer_load_dwordx4 v16, s[16:19], s41 offen offset:1024 lds
v_exp_f32 v168, v168
v_exp_f32 v32, v32
v_exp_f32 v169, v169
v_exp_f32 v33, v33
v_exp_f32 v170, v170
v_exp_f32 v34, v34
v_exp_f32 v171, v171
v_exp_f32 v35, v35
v_exp_f32 v172, v172
v_exp_f32 v36, v36
v_exp_f32 v173, v173
v_exp_f32 v37, v37
v_exp_f32 v174, v174
v_exp_f32 v38, v38
v_exp_f32 v175, v175
v_exp_f32 v39, v39
v_exp_f32 v176, v176
v_exp_f32 v40, v40
v_exp_f32 v177, v177
v_exp_f32 v41, v41
v_exp_f32 v178, v178
v_exp_f32 v42, v42
v_exp_f32 v179, v179
v_exp_f32 v43, v43
v_exp_f32 v180, v180
L_pad_a0_2:
s_cbranch_execz L_warm_a
v_exp_f32 v44, v44
v_exp_f32 v181, v181
v_exp_f32 v45, v45
v_exp_f32 v182, v182
v_exp_f32 v46, v46
v_exp_f32 v183, v183
v_exp_f32 v47, v47
v_exp_f32 v184, v184
v_exp_f32 v240, v240
v_exp_f32 v185, v185
v_exp_f32 v241, v241
v_pk_add_f32 v[186:187], v[168:169], v[170:171] op_sel:[0,0] op_sel_hi:[1,1]
v_pk_add_f32 v[188:189], v[32:33], v[34:35] op_sel:[0,0] op_sel_hi:[1,1]
v_pk_add_f32 v[186:187], v[186:187], v[172:173] op_sel:[0,0] op_sel_hi:[1,1]
v_pk_add_f32 v[188:189], v[188:189], v[36:37] op_sel:[0,0] op_sel_hi:[1,1]
v_pk_add_f32 v[186:187], v[186:187], v[174:175] op_sel:[0,0] op_sel_hi:[1,1]
v_pk_add_f32 v[188:189], v[188:189], v[38:39] op_sel:[0,0] op_sel_hi:[1,1]
v_pk_add_f32 v[186:187], v[186:187], v[176:177] op_sel:[0,0] op_sel_hi:[1,1]
v_pk_add_f32 v[188:189], v[188:189], v[40:41] op_sel:[0,0] op_sel_hi:[1,1]
v_pk_add_f32 v[186:187], v[186:187], v[178:179] op_sel:[0,0] op_sel_hi:[1,1]
v_pk_add_f32 v[188:189], v[188:189], v[42:43] op_sel:[0,0] op_sel_hi:[1,1]
v_pk_add_f32 v[186:187], v[186:187], v[180:181] op_sel:[0,0] op_sel_hi:[1,1]
v_pk_add_f32 v[188:189], v[188:189], v[44:45] op_sel:[0,0] op_sel_hi:[1,1]
v_pk_add_f32 v[186:187], v[186:187], v[182:183] op_sel:[0,0] op_sel_hi:[1,1]
v_pk_add_f32 v[188:189], v[188:189], v[46:47] op_sel:[0,0] op_sel_hi:[1,1]
v_pk_add_f32 v[186:187], v[186:187], v[184:185] op_sel:[0,0] op_sel_hi:[1,1]
v_pk_add_f32 v[188:189], v[188:189], v[240:241] op_sel:[0,0] op_sel_hi:[1,1]
v_add_f32 v188, v188, v189
v_add_f32 v186, v186, v187
v_rcp_f32 v188, v188
v_mov_b32 v190, v186
v_mul_f32 v188, v188, v186
v_pk_mul_f32 v[32:33], v[32:33], v[188:189] op_sel:[0,0] op_sel_hi:[1,0]
v_pk_mul_f32 v[34:35], v[34:35], v[188:189] op_sel:[0,0] op_sel_hi:[1,0]
v_pk_mul_f32 v[36:37], v[36:37], v[188:189] op_sel:[0,0] op_sel_hi:[1,0]
v_pk_mul_f32 v[38:39], v[38:39], v[188:189] op_sel:[0,0] op_sel_hi:[1,0]
v_pk_mul_f32 v[40:41], v[40:41], v[188:189] op_sel:[0,0] op_sel_hi:[1,0]
v_pk_mul_f32 v[42:43], v[42:43], v[188:189] op_sel:[0,0] op_sel_hi:[1,0]
v_pk_mul_f32 v[44:45], v[44:45], v[188:189] op_sel:[0,0] op_sel_hi:[1,0]
v_pk_mul_f32 v[46:47], v[46:47], v[188:189] op_sel:[0,0] op_sel_hi:[1,0]
v_pk_mul_f32 v[240:241], v[240:241], v[188:189] op_sel:[0,0] op_sel_hi:[1,0]
buffer_load_dwordx4 v17, s[16:19], s41 offen offset:2048 lds
v_cvt_pk_bf16_f32 v64, v168, v169
v_cvt_pk_bf16_f32 v65, v170, v171
v_cvt_pk_bf16_f32 v66, v172, v173
v_cvt_pk_bf16_f32 v67, v174, v175
v_cvt_pk_bf16_f32 v68, v176, v177
v_cvt_pk_bf16_f32 v69, v178, v179
v_cvt_pk_bf16_f32 v70, v180, v181
v_cvt_pk_bf16_f32 v71, v182, v183
v_cvt_pk_bf16_f32 v72, v184, v185
v_cvt_pk_bf16_f32 v73, v32, v33
v_cvt_pk_bf16_f32 v74, v34, v35
v_cvt_pk_bf16_f32 v75, v36, v37
v_cvt_pk_bf16_f32 v76, v38, v39
v_cvt_pk_bf16_f32 v77, v40, v41
v_cvt_pk_bf16_f32 v78, v42, v43
v_cvt_pk_bf16_f32 v79, v44, v45
v_cvt_pk_bf16_f32 v80, v46, v47
v_cvt_pk_bf16_f32 v81, v240, v241
v_max3_f32 v186, v48, v49, v50
v_min3_f32 v187, v48, v49, v50
v_max3_f32 v186, v186, v51, v52
v_min3_f32 v187, v187, v51, v52
v_max3_f32 v186, v186, v53, v54
v_min3_f32 v187, v187, v53, v54
v_max3_f32 v186, v186, v55, v56
v_min3_f32 v187, v187, v55, v56
v_max3_f32 v186, v186, v57, v58
v_min3_f32 v187, v187, v57, v58
v_max3_f32 v186, v186, v59, v60
v_min3_f32 v187, v187, v59, v60
v_max3_f32 v186, v186, v61, v62
v_min3_f32 v187, v187, v61, v62
v_max3_f32 v186, v186, v63, v244
v_min3_f32 v187, v187, v63, v244
v_max_f32 v186, v186, v245
v_min_f32 v187, v187, v245
v_mul_f32 v186, v186, v30
v_mul_f32 v187, v187, v30
v_pk_fma_f32 v[168:169], v[48:49], v[30:31], v[186:187] op_sel:[0,0,0] op_sel_hi:[1,0,0] neg_lo:[0,0,1] neg_hi:[0,0,1]
v_pk_fma_f32 v[48:49], v[48:49], v[30:31], v[186:187] op_sel:[0,0,1] op_sel_hi:[1,0,1] neg_lo:[1,0,0] neg_hi:[1,0,0]
v_pk_fma_f32 v[170:171], v[50:51], v[30:31], v[186:187] op_sel:[0,0,0] op_sel_hi:[1,0,0] neg_lo:[0,0,1] neg_hi:[0,0,1]
v_pk_fma_f32 v[50:51], v[50:51], v[30:31], v[186:187] op_sel:[0,0,1] op_sel_hi:[1,0,1] neg_lo:[1,0,0] neg_hi:[1,0,0]
v_pk_fma_f32 v[172:173], v[52:53], v[30:31], v[186:187] op_sel:[0,0,0] op_sel_hi:[1,0,0] neg_lo:[0,0,1] neg_hi:[0,0,1]
v_pk_fma_f32 v[52:53], v[52:53], v[30:31], v[186:187] op_sel:[0,0,1] op_sel_hi:[1,0,1] neg_lo:[1,0,0] neg_hi:[1,0,0]
v_pk_fma_f32 v[174:175], v[54:55], v[30:31], v[186:187] op_sel:[0,0,0] op_sel_hi:[1,0,0] neg_lo:[0,0,1] neg_hi:[0,0,1]
v_pk_fma_f32 v[54:55], v[54:55], v[30:31], v[186:187] op_sel:[0,0,1] op_sel_hi:[1,0,1] neg_lo:[1,0,0] neg_hi:[1,0,0]
v_pk_fma_f32 v[176:177], v[56:57], v[30:31], v[186:187] op_sel:[0,0,0] op_sel_hi:[1,0,0] neg_lo:[0,0,1] neg_hi:[0,0,1]
v_pk_fma_f32 v[56:57], v[56:57], v[30:31], v[186:187] op_sel:[0,0,1] op_sel_hi:[1,0,1] neg_lo:[1,0,0] neg_hi:[1,0,0]
v_pk_fma_f32 v[178:179], v[58:59], v[30:31], v[186:187] op_sel:[0,0,0] op_sel_hi:[1,0,0] neg_lo:[0,0,1] neg_hi:[0,0,1]
v_pk_fma_f32 v[58:59], v[58:59], v[30:31], v[186:187] op_sel:[0,0,1] op_sel_hi:[1,0,1] neg_lo:[1,0,0] neg_hi:[1,0,0]
v_pk_fma_f32 v[180:181], v[60:61], v[30:31], v[186:187] op_sel:[0,0,0] op_sel_hi:[1,0,0] neg_lo:[0,0,1] neg_hi:[0,0,1]
v_pk_fma_f32 v[60:61], v[60:61], v[30:31], v[186:187] op_sel:[0,0,1] op_sel_hi:[1,0,1] neg_lo:[1,0,0] neg_hi:[1,0,0]
v_pk_fma_f32 v[182:183], v[62:63], v[30:31], v[186:187] op_sel:[0,0,0] op_sel_hi:[1,0,0] neg_lo:[0,0,1] neg_hi:[0,0,1]
v_pk_fma_f32 v[62:63], v[62:63], v[30:31], v[186:187] op_sel:[0,0,1] op_sel_hi:[1,0,1] neg_lo:[1,0,0] neg_hi:[1,0,0]
v_pk_fma_f32 v[184:185], v[244:245], v[30:31], v[186:187] op_sel:[0,0,0] op_sel_hi:[1,0,0] neg_lo:[0,0,1] neg_hi:[0,0,1]
v_pk_fma_f32 v[244:245], v[244:245], v[30:31], v[186:187] op_sel:[0,0,1] op_sel_hi:[1,0,1] neg_lo:[1,0,0] neg_hi:[1,0,0]
v_exp_f32 v168, v168
v_exp_f32 v48, v48
v_exp_f32 v169, v169
v_exp_f32 v49, v49
v_exp_f32 v170, v170
v_exp_f32 v50, v50
v_exp_f32 v171, v171
v_exp_f32 v51, v51
v_exp_f32 v172, v172
v_exp_f32 v52, v52
v_exp_f32 v173, v173
v_exp_f32 v53, v53
v_exp_f32 v174, v174
v_exp_f32 v54, v54
v_exp_f32 v175, v175
v_exp_f32 v55, v55
v_exp_f32 v176, v176
v_exp_f32 v56, v56
v_exp_f32 v177, v177
v_exp_f32 v57, v57
v_exp_f32 v178, v178
v_exp_f32 v58, v58
v_exp_f32 v179, v179
v_exp_f32 v59, v59
v_exp_f32 v180, v180
v_exp_f32 v60, v60
v_exp_f32 v181, v181
v_exp_f32 v61, v61
v_exp_f32 v182, v182
v_exp_f32 v62, v62
v_exp_f32 v183, v183
v_exp_f32 v63, v63
v_exp_f32 v184, v184
v_exp_f32 v244, v244
v_exp_f32 v185, v185
v_exp_f32 v245, v245
v_pk_add_f32 v[186:187], v[168:169], v[170:171] op_sel:[0,0] op_sel_hi:[1,1]
v_pk_add_f32 v[188:189], v[48:49], v[50:51] op_sel:[0,0] op_sel_hi:[1,1]
v_pk_add_f32 v[186:187], v[186:187], v[172:173] op_sel:[0,0] op_sel_hi:[1,1]
v_pk_add_f32 v[188:189], v[188:189], v[52:53] op_sel:[0,0] op_sel_hi:[1,1]
v_pk_add_f32 v[186:187], v[186:187], v[174:175] op_sel:[0,0] op_sel_hi:[1,1]
v_pk_add_f32 v[188:189], v[188:189], v[54:55] op_sel:[0,0] op_sel_hi:[1,1]
v_pk_add_f32 v[186:187], v[186:187], v[176:177] op_sel:[0,0] op_sel_hi:[1,1]
v_pk_add_f32 v[188:189], v[188:189], v[56:57] op_sel:[0,0] op_sel_hi:[1,1]
v_pk_add_f32 v[186:187], v[186:187], v[178:179] op_sel:[0,0] op_sel_hi:[1,1]
v_pk_add_f32 v[188:189], v[188:189], v[58:59] op_sel:[0,0] op_sel_hi:[1,1]
v_pk_add_f32 v[186:187], v[186:187], v[180:181] op_sel:[0,0] op_sel_hi:[1,1]
v_pk_add_f32 v[188:189], v[188:189], v[60:61] op_sel:[0,0] op_sel_hi:[1,1]
v_pk_add_f32 v[186:187], v[186:187], v[182:183] op_sel:[0,0] op_sel_hi:[1,1]
v_pk_add_f32 v[188:189], v[188:189], v[62:63] op_sel:[0,0] op_sel_hi:[1,1]
v_pk_add_f32 v[186:187], v[186:187], v[184:185] op_sel:[0,0] op_sel_hi:[1,1]
v_pk_add_f32 v[188:189], v[188:189], v[244:245] op_sel:[0,0] op_sel_hi:[1,1]
v_add_f32 v188, v188, v189
v_add_f32 v186, v186, v187
v_rcp_f32 v188, v188
v_mov_b32 v191, v186
v_mul_f32 v188, v188, v186
v_pk_mul_f32 v[48:49], v[48:49], v[188:189] op_sel:[0,0] op_sel_hi:[1,0]
v_pk_mul_f32 v[50:51], v[50:51], v[188:189] op_sel:[0,0] op_sel_hi:[1,0]
v_pk_mul_f32 v[52:53], v[52:53], v[188:189] op_sel:[0,0] op_sel_hi:[1,0]
v_pk_mul_f32 v[54:55], v[54:55], v[188:189] op_sel:[0,0] op_sel_hi:[1,0]
v_pk_mul_f32 v[56:57], v[56:57], v[188:189] op_sel:[0,0] op_sel_hi:[1,0]
v_pk_mul_f32 v[58:59], v[58:59], v[188:189] op_sel:[0,0] op_sel_hi:[1,0]
v_pk_mul_f32 v[60:61], v[60:61], v[188:189] op_sel:[0,0] op_sel_hi:[1,0]
v_pk_mul_f32 v[62:63], v[62:63], v[188:189] op_sel:[0,0] op_sel_hi:[1,0]
v_pk_mul_f32 v[244:245], v[244:245], v[188:189] op_sel:[0,0] op_sel_hi:[1,0]
v_cvt_pk_bf16_f32 v84, v168, v169
v_cvt_pk_bf16_f32 v85, v170, v171
v_cvt_pk_bf16_f32 v86, v172, v173
v_cvt_pk_bf16_f32 v87, v174, v175
v_cvt_pk_bf16_f32 v88, v176, v177
v_cvt_pk_bf16_f32 v89, v178, v179
v_cvt_pk_bf16_f32 v90, v180, v181
v_cvt_pk_bf16_f32 v91, v182, v183
v_cvt_pk_bf16_f32 v92, v184, v185
v_cvt_pk_bf16_f32 v93, v48, v49
v_cvt_pk_bf16_f32 v94, v50, v51
v_cvt_pk_bf16_f32 v95, v52, v53
v_cvt_pk_bf16_f32 v96, v54, v55
v_cvt_pk_bf16_f32 v97, v56, v57
v_cvt_pk_bf16_f32 v98, v58, v59
v_cvt_pk_bf16_f32 v99, v60, v61
v_cvt_pk_bf16_f32 v100, v62, v63
v_cvt_pk_bf16_f32 v101, v244, v245
buffer_load_dwordx2 v[144:145], v194, s[20:23], s75 offen offset:0 sc1
buffer_load_dwordx2 v[146:147], v194, s[20:23], s75 offen offset:512 sc1
buffer_load_dwordx2 v[148:149], v195, s[20:23], s75 offen offset:1024 sc1
buffer_load_dwordx2 v[150:151], v194, s[20:23], s75 offen offset:1440 sc1
buffer_load_dwordx2 v[152:153], v194, s[20:23], s75 offen offset:1952 sc1
buffer_load_dwordx2 v[154:155], v195, s[20:23], s75 offen offset:2464 sc1
v_max3_f32 v186, v208, v209, v210
v_min3_f32 v187, v208, v209, v210
v_max3_f32 v186, v186, v211, v212
v_min3_f32 v187, v187, v211, v212
v_max3_f32 v186, v186, v213, v214
v_min3_f32 v187, v187, v213, v214
v_max3_f32 v186, v186, v215, v216
v_min3_f32 v187, v187, v215, v216
v_max3_f32 v186, v186, v217, v218
v_min3_f32 v187, v187, v217, v218
v_max3_f32 v186, v186, v219, v220
v_min3_f32 v187, v187, v219, v220
v_max3_f32 v186, v186, v221, v222
v_min3_f32 v187, v187, v221, v222
v_max3_f32 v186, v186, v223, v248
v_min3_f32 v187, v187, v223, v248
v_max_f32 v186, v186, v249
v_min_f32 v187, v187, v249
v_mul_f32 v186, v186, v30
v_mul_f32 v187, v187, v30
v_pk_fma_f32 v[168:169], v[208:209], v[30:31], v[186:187] op_sel:[0,0,0] op_sel_hi:[1,0,0] neg_lo:[0,0,1] neg_hi:[0,0,1]
v_pk_fma_f32 v[208:209], v[208:209], v[30:31], v[186:187] op_sel:[0,0,1] op_sel_hi:[1,0,1] neg_lo:[1,0,0] neg_hi:[1,0,0]
v_pk_fma_f32 v[170:171], v[210:211], v[30:31], v[186:187] op_sel:[0,0,0] op_sel_hi:[1,0,0] neg_lo:[0,0,1] neg_hi:[0,0,1]
v_pk_fma_f32 v[210:211], v[210:211], v[30:31], v[186:187] op_sel:[0,0,1] op_sel_hi:[1,0,1] neg_lo:[1,0,0] neg_hi:[1,0,0]
v_pk_fma_f32 v[172:173], v[212:213], v[30:31], v[186:187] op_sel:[0,0,0] op_sel_hi:[1,0,0] neg_lo:[0,0,1] neg_hi:[0,0,1]
v_pk_fma_f32 v[212:213], v[212:213], v[30:31], v[186:187] op_sel:[0,0,1] op_sel_hi:[1,0,1] neg_lo:[1,0,0] neg_hi:[1,0,0]
v_pk_fma_f32 v[174:175], v[214:215], v[30:31], v[186:187] op_sel:[0,0,0] op_sel_hi:[1,0,0] neg_lo:[0,0,1] neg_hi:[0,0,1]
v_pk_fma_f32 v[214:215], v[214:215], v[30:31], v[186:187] op_sel:[0,0,1] op_sel_hi:[1,0,1] neg_lo:[1,0,0] neg_hi:[1,0,0]
v_pk_fma_f32 v[176:177], v[216:217], v[30:31], v[186:187] op_sel:[0,0,0] op_sel_hi:[1,0,0] neg_lo:[0,0,1] neg_hi:[0,0,1]
v_pk_fma_f32 v[216:217], v[216:217], v[30:31], v[186:187] op_sel:[0,0,1] op_sel_hi:[1,0,1] neg_lo:[1,0,0] neg_hi:[1,0,0]
v_pk_fma_f32 v[178:179], v[218:219], v[30:31], v[186:187] op_sel:[0,0,0] op_sel_hi:[1,0,0] neg_lo:[0,0,1] neg_hi:[0,0,1]
v_pk_fma_f32 v[218:219], v[218:219], v[30:31], v[186:187] op_sel:[0,0,1] op_sel_hi:[1,0,1] neg_lo:[1,0,0] neg_hi:[1,0,0]
v_pk_fma_f32 v[180:181], v[220:221], v[30:31], v[186:187] op_sel:[0,0,0] op_sel_hi:[1,0,0] neg_lo:[0,0,1] neg_hi:[0,0,1]
v_pk_fma_f32 v[220:221], v[220:221], v[30:31], v[186:187] op_sel:[0,0,1] op_sel_hi:[1,0,1] neg_lo:[1,0,0] neg_hi:[1,0,0]
v_pk_fma_f32 v[182:183], v[222:223], v[30:31], v[186:187] op_sel:[0,0,0] op_sel_hi:[1,0,0] neg_lo:[0,0,1] neg_hi:[0,0,1]
v_pk_fma_f32 v[222:223], v[222:223], v[30:31], v[186:187] op_sel:[0,0,1] op_sel_hi:[1,0,1] neg_lo:[1,0,0] neg_hi:[1,0,0]
v_pk_fma_f32 v[184:185], v[248:249], v[30:31], v[186:187] op_sel:[0,0,0] op_sel_hi:[1,0,0] neg_lo:[0,0,1] neg_hi:[0,0,1]
v_pk_fma_f32 v[248:249], v[248:249], v[30:31], v[186:187] op_sel:[0,0,1] op_sel_hi:[1,0,1] neg_lo:[1,0,0] neg_hi:[1,0,0]
v_exp_f32 v168, v168
v_exp_f32 v208, v208
v_exp_f32 v169, v169
v_exp_f32 v209, v209
v_exp_f32 v170, v170
v_exp_f32 v210, v210
v_exp_f32 v171, v171
v_exp_f32 v211, v211
v_exp_f32 v172, v172
v_exp_f32 v212, v212
v_exp_f32 v173, v173
v_exp_f32 v213, v213
v_exp_f32 v174, v174
v_exp_f32 v214, v214
v_exp_f32 v175, v175
v_exp_f32 v215, v215
v_exp_f32 v176, v176
v_exp_f32 v216, v216
v_exp_f32 v177, v177
v_exp_f32 v217, v217
v_exp_f32 v178, v178
v_exp_f32 v218, v218
v_exp_f32 v179, v179
v_exp_f32 v219, v219
v_exp_f32 v180, v180
v_exp_f32 v220, v220
v_exp_f32 v181, v181
v_exp_f32 v221, v221
v_exp_f32 v182, v182
v_exp_f32 v222, v222
v_exp_f32 v183, v183
v_exp_f32 v223, v223
v_exp_f32 v184, v184
v_exp_f32 v248, v248
v_exp_f32 v185, v185
v_exp_f32 v249, v249
v_pk_add_f32 v[186:187], v[168:169], v[170:171] op_sel:[0,0] op_sel_hi:[1,1]
v_pk_add_f32 v[188:189], v[208:209], v[210:211] op_sel:[0,0] op_sel_hi:[1,1]
v_pk_add_f32 v[186:187], v[186:187], v[172:173] op_sel:[0,0] op_sel_hi:[1,1]
v_pk_add_f32 v[188:189], v[188:189], v[212:213] op_sel:[0,0] op_sel_hi:[1,1]
v_pk_add_f32 v[186:187], v[186:187], v[174:175] op_sel:[0,0] op_sel_hi:[1,1]
v_pk_add_f32 v[188:189], v[188:189], v[214:215] op_sel:[0,0] op_sel_hi:[1,1]
v_pk_add_f32 v[186:187], v[186:187], v[176:177] op_sel:[0,0] op_sel_hi:[1,1]
v_pk_add_f32 v[188:189], v[188:189], v[216:217] op_sel:[0,0] op_sel_hi:[1,1]
v_pk_add_f32 v[186:187], v[186:187], v[178:179] op_sel:[0,0] op_sel_hi:[1,1]
v_pk_add_f32 v[188:189], v[188:189], v[218:219] op_sel:[0,0] op_sel_hi:[1,1]
v_pk_add_f32 v[186:187], v[186:187], v[180:181] op_sel:[0,0] op_sel_hi:[1,1]
v_pk_add_f32 v[188:189], v[188:189], v[220:221] op_sel:[0,0] op_sel_hi:[1,1]
v_pk_add_f32 v[186:187], v[186:187], v[182:183] op_sel:[0,0] op_sel_hi:[1,1]
v_pk_add_f32 v[188:189], v[188:189], v[222:223] op_sel:[0,0] op_sel_hi:[1,1]
v_pk_add_f32 v[186:187], v[186:187], v[184:185] op_sel:[0,0] op_sel_hi:[1,1]
v_pk_add_f32 v[188:189], v[188:189], v[248:249] op_sel:[0,0] op_sel_hi:[1,1]
v_add_f32 v188, v188, v189
v_add_f32 v186, v186, v187
v_rcp_f32 v188, v188
v_mov_b32 v192, v186
v_mul_f32 v188, v188, v186
v_pk_mul_f32 v[208:209], v[208:209], v[188:189] op_sel:[0,0] op_sel_hi:[1,0]
v_pk_mul_f32 v[210:211], v[210:211], v[188:189] op_sel:[0,0] op_sel_hi:[1,0]
v_pk_mul_f32 v[212:213], v[212:213], v[188:189] op_sel:[0,0] op_sel_hi:[1,0]
v_pk_mul_f32 v[214:215], v[214:215], v[188:189] op_sel:[0,0] op_sel_hi:[1,0]
v_pk_mul_f32 v[216:217], v[216:217], v[188:189] op_sel:[0,0] op_sel_hi:[1,0]
v_pk_mul_f32 v[218:219], v[218:219], v[188:189] op_sel:[0,0] op_sel_hi:[1,0]
v_pk_mul_f32 v[220:221], v[220:221], v[188:189] op_sel:[0,0] op_sel_hi:[1,0]
v_pk_mul_f32 v[222:223], v[222:223], v[188:189] op_sel:[0,0] op_sel_hi:[1,0]
v_pk_mul_f32 v[248:249], v[248:249], v[188:189] op_sel:[0,0] op_sel_hi:[1,0]
v_cvt_pk_bf16_f32 v104, v168, v169
v_cvt_pk_bf16_f32 v105, v170, v171
v_cvt_pk_bf16_f32 v106, v172, v173
v_cvt_pk_bf16_f32 v107, v174, v175
v_cvt_pk_bf16_f32 v108, v176, v177
v_cvt_pk_bf16_f32 v109, v178, v179
v_cvt_pk_bf16_f32 v110, v180, v181
v_cvt_pk_bf16_f32 v111, v182, v183
v_cvt_pk_bf16_f32 v112, v184, v185
v_cvt_pk_bf16_f32 v113, v208, v209
v_cvt_pk_bf16_f32 v114, v210, v211
v_cvt_pk_bf16_f32 v115, v212, v213
v_cvt_pk_bf16_f32 v116, v214, v215
v_cvt_pk_bf16_f32 v117, v216, v217
v_cvt_pk_bf16_f32 v118, v218, v219
v_cvt_pk_bf16_f32 v119, v220, v221
v_cvt_pk_bf16_f32 v120, v222, v223
v_cvt_pk_bf16_f32 v121, v248, v249
v_max3_f32 v186, v224, v225, v226
v_min3_f32 v187, v224, v225, v226
v_max3_f32 v186, v186, v227, v228
v_min3_f32 v187, v187, v227, v228
v_max3_f32 v186, v186, v229, v230
v_min3_f32 v187, v187, v229, v230
v_max3_f32 v186, v186, v231, v232
v_min3_f32 v187, v187, v231, v232
v_max3_f32 v186, v186, v233, v234
v_min3_f32 v187, v187, v233, v234
v_max3_f32 v186, v186, v235, v236
v_min3_f32 v187, v187, v235, v236
v_max3_f32 v186, v186, v237, v238
v_min3_f32 v187, v187, v237, v238
v_max3_f32 v186, v186, v239, v252
v_min3_f32 v187, v187, v239, v252
v_max_f32 v186, v186, v253
v_min_f32 v187, v187, v253
v_mul_f32 v186, v186, v30
v_mul_f32 v187, v187, v30
v_pk_fma_f32 v[168:169], v[224:225], v[30:31], v[186:187] op_sel:[0,0,0] op_sel_hi:[1,0,0] neg_lo:[0,0,1] neg_hi:[0,0,1]
v_pk_fma_f32 v[224:225], v[224:225], v[30:31], v[186:187] op_sel:[0,0,1] op_sel_hi:[1,0,1] neg_lo:[1,0,0] neg_hi:[1,0,0]
v_pk_fma_f32 v[170:171], v[226:227], v[30:31], v[186:187] op_sel:[0,0,0] op_sel_hi:[1,0,0] neg_lo:[0,0,1] neg_hi:[0,0,1]
v_pk_fma_f32 v[226:227], v[226:227], v[30:31], v[186:187] op_sel:[0,0,1] op_sel_hi:[1,0,1] neg_lo:[1,0,0] neg_hi:[1,0,0]
v_pk_fma_f32 v[172:173], v[228:229], v[30:31], v[186:187] op_sel:[0,0,0] op_sel_hi:[1,0,0] neg_lo:[0,0,1] neg_hi:[0,0,1]
v_pk_fma_f32 v[228:229], v[228:229], v[30:31], v[186:187] op_sel:[0,0,1] op_sel_hi:[1,0,1] neg_lo:[1,0,0] neg_hi:[1,0,0]
v_pk_fma_f32 v[174:175], v[230:231], v[30:31], v[186:187] op_sel:[0,0,0] op_sel_hi:[1,0,0] neg_lo:[0,0,1] neg_hi:[0,0,1]
v_pk_fma_f32 v[230:231], v[230:231], v[30:31], v[186:187] op_sel:[0,0,1] op_sel_hi:[1,0,1] neg_lo:[1,0,0] neg_hi:[1,0,0]
v_pk_fma_f32 v[176:177], v[232:233], v[30:31], v[186:187] op_sel:[0,0,0] op_sel_hi:[1,0,0] neg_lo:[0,0,1] neg_hi:[0,0,1]
v_pk_fma_f32 v[232:233], v[232:233], v[30:31], v[186:187] op_sel:[0,0,1] op_sel_hi:[1,0,1] neg_lo:[1,0,0] neg_hi:[1,0,0]
v_pk_fma_f32 v[178:179], v[234:235], v[30:31], v[186:187] op_sel:[0,0,0] op_sel_hi:[1,0,0] neg_lo:[0,0,1] neg_hi:[0,0,1]
v_pk_fma_f32 v[234:235], v[234:235], v[30:31], v[186:187] op_sel:[0,0,1] op_sel_hi:[1,0,1] neg_lo:[1,0,0] neg_hi:[1,0,0]
v_pk_fma_f32 v[180:181], v[236:237], v[30:31], v[186:187] op_sel:[0,0,0] op_sel_hi:[1,0,0] neg_lo:[0,0,1] neg_hi:[0,0,1]
v_pk_fma_f32 v[236:237], v[236:237], v[30:31], v[186:187] op_sel:[0,0,1] op_sel_hi:[1,0,1] neg_lo:[1,0,0] neg_hi:[1,0,0]
v_pk_fma_f32 v[182:183], v[238:239], v[30:31], v[186:187] op_sel:[0,0,0] op_sel_hi:[1,0,0] neg_lo:[0,0,1] neg_hi:[0,0,1]
v_pk_fma_f32 v[238:239], v[238:239], v[30:31], v[186:187] op_sel:[0,0,1] op_sel_hi:[1,0,1] neg_lo:[1,0,0] neg_hi:[1,0,0]
v_pk_fma_f32 v[184:185], v[252:253], v[30:31], v[186:187] op_sel:[0,0,0] op_sel_hi:[1,0,0] neg_lo:[0,0,1] neg_hi:[0,0,1]
v_pk_fma_f32 v[252:253], v[252:253], v[30:31], v[186:187] op_sel:[0,0,1] op_sel_hi:[1,0,1] neg_lo:[1,0,0] neg_hi:[1,0,0]
v_exp_f32 v168, v168
v_exp_f32 v224, v224
v_exp_f32 v169, v169
v_exp_f32 v225, v225
v_exp_f32 v170, v170
v_exp_f32 v226, v226
v_exp_f32 v171, v171
v_exp_f32 v227, v227
v_exp_f32 v172, v172
v_exp_f32 v228, v228
v_exp_f32 v173, v173
v_exp_f32 v229, v229
v_exp_f32 v174, v174
v_exp_f32 v230, v230
v_exp_f32 v175, v175
v_exp_f32 v231, v231
v_exp_f32 v176, v176
v_exp_f32 v232, v232
v_exp_f32 v177, v177
v_exp_f32 v233, v233
v_exp_f32 v178, v178
v_exp_f32 v234, v234
v_exp_f32 v179, v179
v_exp_f32 v235, v235
v_exp_f32 v180, v180
v_exp_f32 v236, v236
v_exp_f32 v181, v181
v_exp_f32 v237, v237
v_exp_f32 v182, v182
v_exp_f32 v238, v238
v_exp_f32 v183, v183
v_exp_f32 v239, v239
v_exp_f32 v184, v184
v_exp_f32 v252, v252
v_exp_f32 v185, v185
v_exp_f32 v253, v253
v_pk_add_f32 v[186:187], v[168:169], v[170:171] op_sel:[0,0] op_sel_hi:[1,1]
v_pk_add_f32 v[188:189], v[224:225], v[226:227] op_sel:[0,0] op_sel_hi:[1,1]
v_pk_add_f32 v[186:187], v[186:187], v[172:173] op_sel:[0,0] op_sel_hi:[1,1]
v_pk_add_f32 v[188:189], v[188:189], v[228:229] op_sel:[0,0] op_sel_hi:[1,1]
v_pk_add_f32 v[186:187], v[186:187], v[174:175] op_sel:[0,0] op_sel_hi:[1,1]
v_pk_add_f32 v[188:189], v[188:189], v[230:231] op_sel:[0,0] op_sel_hi:[1,1]
v_pk_add_f32 v[186:187], v[186:187], v[176:177] op_sel:[0,0] op_sel_hi:[1,1]
v_pk_add_f32 v[188:189], v[188:189], v[232:233] op_sel:[0,0] op_sel_hi:[1,1]
v_pk_add_f32 v[186:187], v[186:187], v[178:179] op_sel:[0,0] op_sel_hi:[1,1]
v_pk_add_f32 v[188:189], v[188:189], v[234:235] op_sel:[0,0] op_sel_hi:[1,1]
v_pk_add_f32 v[186:187], v[186:187], v[180:181] op_sel:[0,0] op_sel_hi:[1,1]
v_pk_add_f32 v[188:189], v[188:189], v[236:237] op_sel:[0,0] op_sel_hi:[1,1]
v_pk_add_f32 v[186:187], v[186:187], v[182:183] op_sel:[0,0] op_sel_hi:[1,1]
v_pk_add_f32 v[188:189], v[188:189], v[238:239] op_sel:[0,0] op_sel_hi:[1,1]
v_pk_add_f32 v[186:187], v[186:187], v[184:185] op_sel:[0,0] op_sel_hi:[1,1]
v_pk_add_f32 v[188:189], v[188:189], v[252:253] op_sel:[0,0] op_sel_hi:[1,1]
v_add_f32 v188, v188, v189
v_add_f32 v186, v186, v187
v_rcp_f32 v188, v188
v_mov_b32 v193, v186
v_mul_f32 v188, v188, v186
v_pk_mul_f32 v[224:225], v[224:225], v[188:189] op_sel:[0,0] op_sel_hi:[1,0]
v_pk_mul_f32 v[226:227], v[226:227], v[188:189] op_sel:[0,0] op_sel_hi:[1,0]
v_pk_mul_f32 v[228:229], v[228:229], v[188:189] op_sel:[0,0] op_sel_hi:[1,0]
v_pk_mul_f32 v[230:231], v[230:231], v[188:189] op_sel:[0,0] op_sel_hi:[1,0]
v_pk_mul_f32 v[232:233], v[232:233], v[188:189] op_sel:[0,0] op_sel_hi:[1,0]
v_pk_mul_f32 v[234:235], v[234:235], v[188:189] op_sel:[0,0] op_sel_hi:[1,0]
v_pk_mul_f32 v[236:237], v[236:237], v[188:189] op_sel:[0,0] op_sel_hi:[1,0]
v_pk_mul_f32 v[238:239], v[238:239], v[188:189] op_sel:[0,0] op_sel_hi:[1,0]
v_pk_mul_f32 v[252:253], v[252:253], v[188:189] op_sel:[0,0] op_sel_hi:[1,0]
v_cvt_pk_bf16_f32 v124, v168, v169
v_cvt_pk_bf16_f32 v125, v170, v171
v_cvt_pk_bf16_f32 v126, v172, v173
v_cvt_pk_bf16_f32 v127, v174, v175
v_cvt_pk_bf16_f32 v128, v176, v177
v_cvt_pk_bf16_f32 v129, v178, v179
v_cvt_pk_bf16_f32 v130, v180, v181
v_cvt_pk_bf16_f32 v131, v182, v183
v_cvt_pk_bf16_f32 v132, v184, v185
v_cvt_pk_bf16_f32 v133, v224, v225
v_cvt_pk_bf16_f32 v134, v226, v227
v_cvt_pk_bf16_f32 v135, v228, v229
v_cvt_pk_bf16_f32 v136, v230, v231
v_cvt_pk_bf16_f32 v137, v232, v233
v_cvt_pk_bf16_f32 v138, v234, v235
v_cvt_pk_bf16_f32 v139, v236, v237
v_cvt_pk_bf16_f32 v140, v238, v239
v_cvt_pk_bf16_f32 v141, v252, v253
s_waitcnt vmcnt(4)
v_max3_u32 v3, v144, v145, v146
s_waitcnt vmcnt(3)
v_max3_u32 v3, v3, v147, v148
s_waitcnt vmcnt(2)
v_max3_u32 v3, v3, v149, v150
s_waitcnt vmcnt(1)
v_max3_u32 v3, v3, v151, v152
s_waitcnt vmcnt(0)
v_max3_u32 v3, v3, v153, v154
v_max_u32 v3, v3, v155
v_cmp_eq_u32 vcc, -1, v3
s_nop 4
s_cbranch_vccnz L_spin_h2
L_back_h2:
ds_write_b64 v196, v[144:145] offset:0
ds_write_b64 v196, v[146:147] offset:32
ds_write_b64 v197, v[148:149] offset:0
ds_write_b64 v196, v[150:151] offset:1600
ds_write_b64 v196, v[152:153] offset:1632
ds_write_b64 v197, v[154:155] offset:1600
v_bfe_u32 v3, v1, 2, 1
v_bfe_u32 v4, v1, 3, 2
v_and_b32 v5, 3, v1
v_cmp_eq_u32 vcc, v3, v2
v_mul_u32_u24 v160, 1600, v3
v_mul_u32_u24 v6, 80, v5
v_add_u32 v160, v160, v6
v_add_u32 v160, 147456, v160
v_mul_u32_u24 v6, 320, v4
v_add_u32 v161, v160, v6
v_mov_b32 v166, 150656
v_cndmask_b32 v161, v166, v161, vcc
v_add_u32 v160, 1280, v160
v_cndmask_b32 v160, v166, v160, vcc
v_cmp_eq_u32 vcc, 0, v4
s_nop 1
v_cndmask_b32 v162, v166, v160, vcc
v_cmp_eq_u32 vcc, 1, v4
s_nop 1
v_cndmask_b32 v163, v166, v160, vcc
v_cmp_eq_u32 vcc, 2, v4
s_nop 1
v_cndmask_b32 v164, v166, v160, vcc
v_cmp_eq_u32 vcc, 3, v4
s_nop 1
v_cndmask_b32 v165, v166, v160, vcc
s_waitcnt lgkmcnt(0)
s_barrier
ds_read_b128 a[144:147], v162 offset:0
ds_read_b128 a[148:151], v162 offset:16
ds_read_b128 a[152:155], v162 offset:32
ds_read_b128 a[156:159], v162 offset:48
ds_read_b128 a[160:163], v162 offset:64
ds_read_b128 a[164:167], v163 offset:3280
s_waitcnt lgkmcnt(5)
v_mfma_f32_32x32x16_bf16 v[240:255], a[144:147], v[64:67], 0
s_add_u32 m0, s35, 0
ds_read_b128 a[168:171], v163 offset:3296
v_bfe_u32 v168, v1, 2, 2
v_lshlrev_b32 v168, 6, v168
v_bfe_u32 v6, v1, 4, 1
s_waitcnt lgkmcnt(5)
v_mfma_f32_32x32x16_bf16 v[240:255], a[148:151], v[68:71], v[240:255]
s_waitcnt lgkmcnt(3)
s_add_u32 s41, s39, 1024
ds_read_b128 a[144:147], v163 offset:3312
v_lshl_add_u32 v168, v6, 5, v168
v_and_b32 v6, 1, v1
v_lshl_add_u32 v168, v6, 4, v168
v_mfma_f32_32x32x16_bf16 v[240:255], a[152:155], v[72:75], v[240:255]
ds_read_b128 a[148:151], v163 offset:3328
v_bfe_u32 v6, v1, 1, 1
v_lshl_add_u32 v168, v6, 3, v168
v_mul_u32_u24 v6, 1152, v2
v_mfma_f32_32x32x16_bf16 v[240:255], a[156:159], v[76:79], v[240:255]
s_waitcnt lgkmcnt(3)
ds_read_b128 a[152:155], v163 offset:3344
v_add_u32 v168, v168, v6
v_bfe_u32 v6, v1, 3, 1
v_mul_u32_u24 v6, 1152, v6
v_mfma_f32_32x32x16_bf16 v[240:255], a[160:163], v[80:83], v[240:255]
ds_read_b128 a[156:159], v164 offset:6560
v_add_u32 v172, v168, v6
v_add_u32 v169, 36864, v168
v_add_u32 v173, 36864, v172
v_mfma_f32_32x32x16_bf16 v[240:255], a[164:167], v[84:87], v[240:255]
s_waitcnt lgkmcnt(3)
ds_read_b128 a[160:163], v164 offset:6576
v_add_u32 v170, 73728, v168
v_add_u32 v174, 73728, v172
v_add_u32 v171, 110592, v168
v_mfma_f32_32x32x16_bf16 v[240:255], a[168:171], v[88:91], v[240:255]
ds_read_b128 a[164:167], v164 offset:6592
v_add_u32 v175, 110592, v172
v_mfma_f32_32x32x16_bf16 v[240:255], a[144:147], v[92:95], v[240:255]
s_waitcnt lgkmcnt(3)
ds_read_b128 a[168:171], v164 offset:6608
v_mfma_f32_32x32x16_bf16 v[240:255], a[148:151], v[96:99], v[240:255]
ds_read_b128 a[144:147], v164 offset:6624
v_mfma_f32_32x32x16_bf16 v[240:255], a[152:155], v[100:103], v[240:255]
s_waitcnt lgkmcnt(3)
ds_read_b128 a[148:151], v165 offset:9840
v_mfma_f32_32x32x16_bf16 v[240:255], a[156:159], v[104:107], v[240:255]
ds_read_b128 a[152:155], v165 offset:9856
v_mfma_f32_32x32x16_bf16 v[240:255], a[160:163], v[108:111], v[240:255]
s_waitcnt lgkmcnt(3)
ds_read_b128 a[156:159], v165 offset:9872
v_mfma_f32_32x32x16_bf16 v[240:255], a[164:167], v[112:115], v[240:255]
ds_read_b128 a[160:163], v165 offset:9888
v_mfma_f32_32x32x16_bf16 v[240:255], a[168:171], v[116:119], v[240:255]
s_waitcnt lgkmcnt(3)
ds_read_b128 a[164:167], v165 offset:9904
v_mfma_f32_32x32x16_bf16 v[240:255], a[144:147], v[120:123], v[240:255]
ds_read_b128 a[168:171], v161 offset:0
v_mfma_f32_32x32x16_bf16 v[240:255], a[148:151], v[124:127], v[240:255]
s_waitcnt lgkmcnt(3)
ds_read_b128 a[144:147], v161 offset:16
v_mfma_f32_32x32x16_bf16 v[240:255], a[152:155], v[128:131], v[240:255]
ds_read_b128 a[148:151], v161 offset:32
v_mfma_f32_32x32x16_bf16 v[240:255], a[156:159], v[132:135], v[240:255]
s_waitcnt lgkmcnt(3)
ds_read_b128 a[152:155], v161 offset:48
v_mfma_f32_32x32x16_bf16 v[240:255], a[160:163], v[136:139], v[240:255]
ds_read_b128 a[156:159], v161 offset:64
v_mfma_f32_32x32x16_bf16 v[240:255], a[164:167], v[140:143], v[240:255]
s_waitcnt lgkmcnt(3)
ds_read_b128 a[160:163], v161 offset:3280
v_mfma_f32_32x32x16_bf16 v[32:47], a[168:171], v[64:67], 0
ds_read_b128 a[164:167], v161 offset:3296
v_mfma_f32_32x32x16_bf16 v[32:47], a[144:147], v[68:71], v[32:47]
s_waitcnt lgkmcnt(3)
ds_read_b128 a[168:171], v161 offset:3312
v_mfma_f32_32x32x16_bf16 v[32:47], a[148:151], v[72:75], v[32:47]
ds_read_b128 a[144:147], v161 offset:3328
s_nop 2
v_fmac_f32 v242, 0x358637bd, v190
v_rcp_f32 v242, v242
v_fmac_f32 v246, 0x358637bd, v191
v_mfma_f32_32x32x16_bf16 v[32:47], a[152:155], v[76:79], v[32:47]
s_waitcnt lgkmcnt(3)
ds_read_b128 a[148:151], v161 offset:3344
v_rcp_f32 v246, v246
v_fmac_f32 v250, 0x358637bd, v192
v_mfma_f32_32x32x16_bf16 v[32:47], a[156:159], v[80:83], v[32:47]
ds_read_b128 a[152:155], v161 offset:6560
v_rcp_f32 v250, v250
v_fmac_f32 v254, 0x358637bd, v193
v_mfma_f32_32x32x16_bf16 v[48:63], a[160:163], v[84:87], 0
s_waitcnt lgkmcnt(3)
ds_read_b128 a[156:159], v161 offset:6576
v_rcp_f32 v254, v254
v_mfma_f32_32x32x16_bf16 v[48:63], a[164:167], v[88:91], v[48:63]
ds_read_b128 a[160:163], v161 offset:6592
v_mfma_f32_32x32x16_bf16 v[48:63], a[168:171], v[92:95], v[48:63]
s_waitcnt lgkmcnt(3)
ds_read_b128 a[164:167], v161 offset:6608
v_mfma_f32_32x32x16_bf16 v[48:63], a[144:147], v[96:99], v[48:63]
ds_read_b128 a[168:171], v161 offset:6624
v_pk_mul_f32 v[32:33], v[32:33], v[242:243] op_sel:[0,0] op_sel_hi:[1,0]
v_pk_mul_f32 v[34:35], v[34:35], v[242:243] op_sel:[0,0] op_sel_hi:[1,0]
v_pk_mul_f32 v[36:37], v[36:37], v[242:243] op_sel:[0,0] op_sel_hi:[1,0]
v_pk_mul_f32 v[38:39], v[38:39], v[242:243] op_sel:[0,0] op_sel_hi:[1,0]
v_pk_mul_f32 v[40:41], v[40:41], v[242:243] op_sel:[0,0] op_sel_hi:[1,0]
v_pk_mul_f32 v[42:43], v[42:43], v[242:243] op_sel:[0,0] op_sel_hi:[1,0]
v_pk_mul_f32 v[44:45], v[44:45], v[242:243] op_sel:[0,0] op_sel_hi:[1,0]
v_pk_mul_f32 v[46:47], v[46:47], v[242:243] op_sel:[0,0] op_sel_hi:[1,0]
v_pk_mul_f32 v[240:241], v[240:241], v[242:243] op_sel:[0,0] op_sel_hi:[1,0]
v_mfma_f32_32x32x16_bf16 v[48:63], a[148:151], v[100:103], v[48:63]
s_waitcnt lgkmcnt(3)
ds_read_b128 a[144:147], v161 offset:9840
v_cvt_pk_bf16_f32 v176, v32, v33
v_cvt_pk_bf16_f32 v177, v34, v35
v_cvt_pk_bf16_f32 v178, v36, v37
v_mfma_f32_32x32x16_bf16 v[208:223], a[152:155], v[104:107], 0
ds_read_b128 a[148:151], v161 offset:9856
v_cvt_pk_bf16_f32 v179, v38, v39
v_cvt_pk_bf16_f32 v180, v40, v41
v_cvt_pk_bf16_f32 v181, v42, v43
v_mfma_f32_32x32x16_bf16 v[208:223], a[156:159], v[108:111], v[208:223]
s_waitcnt lgkmcnt(3)
ds_read_b128 a[152:155], v161 offset:9872
v_cvt_pk_bf16_f32 v182, v44, v45
v_cvt_pk_bf16_f32 v183, v46, v47
v_cvt_pk_bf16_f32 v184, v240, v241
L_pad_a1_2:
s_cbranch_execz L_warm_a
v_mfma_f32_32x32x16_bf16 v[208:223], a[160:163], v[112:115], v[208:223]
ds_read_b128 a[156:159], v161 offset:9888
v_mfma_f32_32x32x16_bf16 v[208:223], a[164:167], v[116:119], v[208:223]
s_waitcnt lgkmcnt(3)
ds_read_b128 a[160:163], v161 offset:9904
v_pk_mul_f32 v[48:49], v[48:49], v[246:247] op_sel:[0,0] op_sel_hi:[1,0]
v_pk_mul_f32 v[50:51], v[50:51], v[246:247] op_sel:[0,0] op_sel_hi:[1,0]
v_pk_mul_f32 v[52:53], v[52:53], v[246:247] op_sel:[0,0] op_sel_hi:[1,0]
v_pk_mul_f32 v[54:55], v[54:55], v[246:247] op_sel:[0,0] op_sel_hi:[1,0]
v_pk_mul_f32 v[56:57], v[56:57], v[246:247] op_sel:[0,0] op_sel_hi:[1,0]
v_pk_mul_f32 v[58:59], v[58:59], v[246:247] op_sel:[0,0] op_sel_hi:[1,0]
v_pk_mul_f32 v[60:61], v[60:61], v[246:247] op_sel:[0,0] op_sel_hi:[1,0]
v_pk_mul_f32 v[62:63], v[62:63], v[246:247] op_sel:[0,0] op_sel_hi:[1,0]
v_pk_mul_f32 v[244:245], v[244:245], v[246:247] op_sel:[0,0] op_sel_hi:[1,0]
v_mfma_f32_32x32x16_bf16 v[208:223], a[168:171], v[120:123], v[208:223]
ds_read_b64_tr_b16 a[164:165], v168 offset:0
ds_read_b64_tr_b16 a[166:167], v168 offset:256
v_cvt_pk_bf16_f32 v185, v48, v49
v_cvt_pk_bf16_f32 v186, v50, v51
v_cvt_pk_bf16_f32 v187, v52, v53
v_mfma_f32_32x32x16_bf16 v[224:239], a[144:147], v[124:127], 0
s_waitcnt lgkmcnt(4)
ds_read_b64_tr_b16 a[168:169], v169 offset:0
ds_read_b64_tr_b16 a[170:171], v169 offset:256
v_cvt_pk_bf16_f32 v188, v54, v55
v_cvt_pk_bf16_f32 v189, v56, v57
v_cvt_pk_bf16_f32 v190, v58, v59
v_mfma_f32_32x32x16_bf16 v[224:239], a[148:151], v[128:131], v[224:239]
ds_read_b64_tr_b16 a[144:145], v168 offset:512
ds_read_b64_tr_b16 a[146:147], v168 offset:768
v_cvt_pk_bf16_f32 v191, v60, v61
v_cvt_pk_bf16_f32 v192, v62, v63
v_cvt_pk_bf16_f32 v193, v244, v245
v_mfma_f32_32x32x16_bf16 v[224:239], a[152:155], v[132:135], v[224:239]
s_waitcnt lgkmcnt(6)
ds_read_b64_tr_b16 a[148:149], v169 offset:512
ds_read_b64_tr_b16 a[150:151], v169 offset:768
v_mfma_f32_32x32x16_bf16 v[224:239], a[156:159], v[136:139], v[224:239]
ds_read_b64_tr_b16 a[152:153], v172 offset:1024
ds_read_b64_tr_b16 a[154:155], v168 offset:2432
v_pk_mul_f32 v[208:209], v[208:209], v[250:251] op_sel:[0,0] op_sel_hi:[1,0]
v_pk_mul_f32 v[210:211], v[210:211], v[250:251] op_sel:[0,0] op_sel_hi:[1,0]
v_pk_mul_f32 v[212:213], v[212:213], v[250:251] op_sel:[0,0] op_sel_hi:[1,0]
v_pk_mul_f32 v[214:215], v[214:215], v[250:251] op_sel:[0,0] op_sel_hi:[1,0]
v_pk_mul_f32 v[216:217], v[216:217], v[250:251] op_sel:[0,0] op_sel_hi:[1,0]
v_pk_mul_f32 v[218:219], v[218:219], v[250:251] op_sel:[0,0] op_sel_hi:[1,0]
v_pk_mul_f32 v[220:221], v[220:221], v[250:251] op_sel:[0,0] op_sel_hi:[1,0]
v_pk_mul_f32 v[222:223], v[222:223], v[250:251] op_sel:[0,0] op_sel_hi:[1,0]
v_pk_mul_f32 v[248:249], v[248:249], v[250:251] op_sel:[0,0] op_sel_hi:[1,0]
v_mfma_f32_32x32x16_bf16 v[224:239], a[160:163], v[140:143], v[224:239]
ds_read_b64_tr_b16 a[156:157], v173 offset:1024
ds_read_b64_tr_b16 a[158:159], v169 offset:2432
v_cvt_pk_bf16_f32 v194, v208, v209
v_cvt_pk_bf16_f32 v195, v210, v211
v_cvt_pk_bf16_f32 v196, v212, v213
v_cvt_pk_bf16_f32 v197, v214, v215
v_cvt_pk_bf16_f32 v198, v216, v217
v_cvt_pk_bf16_f32 v199, v218, v219
v_cvt_pk_bf16_f32 v200, v220, v221
v_cvt_pk_bf16_f32 v201, v222, v223
v_cvt_pk_bf16_f32 v202, v248, v249
s_waitcnt lgkmcnt(10)
v_mfma_f32_32x32x16_bf16 v[64:79], a[164:167], v[176:179], 0
ds_read_b64_tr_b16 a[160:161], v168 offset:2688
ds_read_b64_tr_b16 a[162:163], v168 offset:2944
s_waitcnt lgkmcnt(10)
v_mfma_f32_32x32x16_bf16 v[80:95], a[168:171], v[176:179], 0
s_waitcnt lgkmcnt(6)
ds_read_b64_tr_b16 a[164:165], v169 offset:2688
ds_read_b64_tr_b16 a[166:167], v169 offset:2944
v_pk_mul_f32 v[224:225], v[224:225], v[254:255] op_sel:[0,0] op_sel_hi:[1,0]
v_pk_mul_f32 v[226:227], v[226:227], v[254:255] op_sel:[0,0] op_sel_hi:[1,0]
v_pk_mul_f32 v[228:229], v[228:229], v[254:255] op_sel:[0,0] op_sel_hi:[1,0]
v_pk_mul_f32 v[230:231], v[230:231], v[254:255] op_sel:[0,0] op_sel_hi:[1,0]
v_pk_mul_f32 v[232:233], v[232:233], v[254:255] op_sel:[0,0] op_sel_hi:[1,0]
v_pk_mul_f32 v[234:235], v[234:235], v[254:255] op_sel:[0,0] op_sel_hi:[1,0]
v_pk_mul_f32 v[236:237], v[236:237], v[254:255] op_sel:[0,0] op_sel_hi:[1,0]
v_pk_mul_f32 v[238:239], v[238:239], v[254:255] op_sel:[0,0] op_sel_hi:[1,0]
v_pk_mul_f32 v[252:253], v[252:253], v[254:255] op_sel:[0,0] op_sel_hi:[1,0]
v_mfma_f32_32x32x16_bf16 v[64:79], a[144:147], v[180:183], v[64:79]
ds_read_b64_tr_b16 a[168:169], v168 offset:3200
ds_read_b64_tr_b16 a[170:171], v168 offset:4608
v_cvt_pk_bf16_f32 v203, v224, v225
v_cvt_pk_bf16_f32 v204, v226, v227
v_cvt_pk_bf16_f32 v205, v228, v229
v_mfma_f32_32x32x16_bf16 v[80:95], a[148:151], v[180:183], v[80:95]
s_waitcnt lgkmcnt(6)
ds_read_b64_tr_b16 a[144:145], v169 offset:3200
ds_read_b64_tr_b16 a[146:147], v169 offset:4608
v_cvt_pk_bf16_f32 v206, v230, v231
v_cvt_pk_bf16_f32 v207, v232, v233
v_cvt_pk_bf16_f32 v144, v234, v235
v_mfma_f32_32x32x16_bf16 v[64:79], a[152:155], v[184:187], v[64:79]
ds_read_b64_tr_b16 a[148:149], v168 offset:4864
ds_read_b64_tr_b16 a[150:151], v168 offset:5120
v_cvt_pk_bf16_f32 v145, v236, v237
v_cvt_pk_bf16_f32 v146, v238, v239
v_cvt_pk_bf16_f32 v147, v252, v253
v_mfma_f32_32x32x16_bf16 v[80:95], a[156:159], v[184:187], v[80:95]
s_waitcnt lgkmcnt(6)
ds_read_b64_tr_b16 a[152:153], v169 offset:4864
ds_read_b64_tr_b16 a[154:155], v169 offset:5120
v_mfma_f32_32x32x16_bf16 v[64:79], a[160:163], v[188:191], v[64:79]
ds_read_b64_tr_b16 a[156:157], v168 offset:5376
ds_read_b64_tr_b16 a[158:159], v172 offset:5632
v_mfma_f32_32x32x16_bf16 v[80:95], a[164:167], v[188:191], v[80:95]
s_waitcnt lgkmcnt(6)
ds_read_b64_tr_b16 a[160:161], v169 offset:5376
ds_read_b64_tr_b16 a[162:163], v173 offset:5632
v_mfma_f32_32x32x16_bf16 v[64:79], a[168:171], v[192:195], v[64:79]
ds_read_b64_tr_b16 a[164:165], v168 offset:7040
ds_read_b64_tr_b16 a[166:167], v168 offset:7296
v_mfma_f32_32x32x16_bf16 v[80:95], a[144:147], v[192:195], v[80:95]
s_waitcnt lgkmcnt(6)
ds_read_b64_tr_b16 a[168:169], v169 offset:7040
ds_read_b64_tr_b16 a[170:171], v169 offset:7296
v_mfma_f32_32x32x16_bf16 v[64:79], a[148:151], v[196:199], v[64:79]
ds_read_b64_tr_b16 a[144:145], v168 offset:7552
ds_read_b64_tr_b16 a[146:147], v168 offset:7808
v_mfma_f32_32x32x16_bf16 v[80:95], a[152:155], v[196:199], v[80:95]
s_waitcnt lgkmcnt(6)
ds_read_b64_tr_b16 a[148:149], v169 offset:7552
ds_read_b64_tr_b16 a[150:151], v169 offset:7808
v_mfma_f32_32x32x16_bf16 v[64:79], a[156:159], v[200:203], v[64:79]
ds_read_b64_tr_b16 a[152:153], v170 offset:0
ds_read_b64_tr_b16 a[154:155], v170 offset:256
v_mfma_f32_32x32x16_bf16 v[80:95], a[160:163], v[200:203], v[80:95]
s_waitcnt lgkmcnt(6)
ds_read_b64_tr_b16 a[156:157], v171 offset:0
ds_read_b64_tr_b16 a[158:159], v171 offset:256
v_mfma_f32_32x32x16_bf16 v[64:79], a[164:167], v[204:207], v[64:79]
ds_read_b64_tr_b16 a[160:161], v170 offset:512
ds_read_b64_tr_b16 a[162:163], v170 offset:768
v_mfma_f32_32x32x16_bf16 v[80:95], a[168:171], v[204:207], v[80:95]
s_waitcnt lgkmcnt(6)
ds_read_b64_tr_b16 a[164:165], v171 offset:512
ds_read_b64_tr_b16 a[166:167], v171 offset:768
v_mfma_f32_32x32x16_bf16 v[64:79], a[144:147], v[144:147], v[64:79]
ds_read_b64_tr_b16 a[168:169], v174 offset:1024
ds_read_b64_tr_b16 a[170:171], v170 offset:2432
v_mfma_f32_32x32x16_bf16 v[80:95], a[148:151], v[144:147], v[80:95]
s_waitcnt lgkmcnt(6)
ds_read_b64_tr_b16 a[144:145], v175 offset:1024
ds_read_b64_tr_b16 a[146:147], v171 offset:2432
s_barrier
v_mfma_f32_32x32x16_bf16 v[96:111], a[152:155], v[176:179], 0
ds_read_b64_tr_b16 a[148:149], v170 offset:2688
ds_read_b64_tr_b16 a[150:151], v170 offset:2944
v_mfma_f32_32x32x16_bf16 v[112:127], a[156:159], v[176:179], 0
s_waitcnt lgkmcnt(6)
ds_read_b64_tr_b16 a[152:153], v171 offset:2688
ds_read_b64_tr_b16 a[154:155], v171 offset:2944
v_mfma_f32_32x32x16_bf16 v[96:111], a[160:163], v[180:183], v[96:111]
ds_read_b64_tr_b16 a[156:157], v170 offset:3200
ds_read_b64_tr_b16 a[158:159], v170 offset:4608
v_mfma_f32_32x32x16_bf16 v[112:127], a[164:167], v[180:183], v[112:127]
s_waitcnt lgkmcnt(6)
ds_read_b64_tr_b16 a[160:161], v171 offset:3200
ds_read_b64_tr_b16 a[162:163], v171 offset:4608
v_cvt_pk_bf16_f32 v128, v64, v65
v_cvt_pk_bf16_f32 v129, v66, v67
v_cvt_pk_bf16_f32 v130, v68, v69
v_mfma_f32_32x32x16_bf16 v[96:111], a[168:171], v[184:187], v[96:111]
ds_read_b64_tr_b16 a[164:165], v170 offset:4864
ds_read_b64_tr_b16 a[166:167], v170 offset:5120
v_cvt_pk_bf16_f32 v131, v70, v71
v_cvt_pk_bf16_f32 v132, v72, v73
v_cvt_pk_bf16_f32 v133, v74, v75
v_mfma_f32_32x32x16_bf16 v[112:127], a[144:147], v[184:187], v[112:127]
s_waitcnt lgkmcnt(6)
s_add_u32 s42, s40, 0
buffer_store_dwordx4 v[128:131], v19, s[20:23], s42 offen offset:0 sc1
ds_read_b64_tr_b16 a[168:169], v171 offset:4864
ds_read_b64_tr_b16 a[170:171], v171 offset:5120
v_mfma_f32_32x32x16_bf16 v[96:111], a[148:151], v[188:191], v[96:111]
ds_read_b64_tr_b16 a[144:145], v170 offset:5376
ds_read_b64_tr_b16 a[146:147], v174 offset:5632
v_cvt_pk_bf16_f32 v134, v76, v77
v_cvt_pk_bf16_f32 v135, v78, v79
v_cvt_pk_bf16_f32 v136, v80, v81
v_mfma_f32_32x32x16_bf16 v[112:127], a[152:155], v[188:191], v[112:127]
s_waitcnt lgkmcnt(6)
buffer_store_dwordx4 v[132:135], v19, s[20:23], s42 offen offset:1024 sc1
ds_read_b64_tr_b16 a[148:149], v171 offset:5376
ds_read_b64_tr_b16 a[150:151], v175 offset:5632
v_mfma_f32_32x32x16_bf16 v[96:111], a[156:159], v[192:195], v[96:111]
ds_read_b64_tr_b16 a[152:153], v170 offset:7040
ds_read_b64_tr_b16 a[154:155], v170 offset:7296
v_cvt_pk_bf16_f32 v137, v82, v83
v_cvt_pk_bf16_f32 v138, v84, v85
v_cvt_pk_bf16_f32 v139, v86, v87
v_mfma_f32_32x32x16_bf16 v[112:127], a[160:163], v[192:195], v[112:127]
s_waitcnt lgkmcnt(6)
buffer_store_dwordx4 v[136:139], v19, s[20:23], s42 offen offset:2048 sc1
ds_read_b64_tr_b16 a[156:157], v171 offset:7040
ds_read_b64_tr_b16 a[158:159], v171 offset:7296
v_mfma_f32_32x32x16_bf16 v[96:111], a[164:167], v[196:199], v[96:111]
ds_read_b64_tr_b16 a[160:161], v170 offset:7552
ds_read_b64_tr_b16 a[162:163], v170 offset:7808
v_cvt_pk_bf16_f32 v140, v88, v89
v_cvt_pk_bf16_f32 v141, v90, v91
v_cvt_pk_bf16_f32 v142, v92, v93
v_cvt_pk_bf16_f32 v143, v94, v95
v_mfma_f32_32x32x16_bf16 v[112:127], a[168:171], v[196:199], v[112:127]
s_waitcnt lgkmcnt(6)
buffer_store_dwordx4 v[140:143], v19, s[20:23], s42 offen offset:3072 sc1
ds_read_b64_tr_b16 a[164:165], v171 offset:7552
ds_read_b64_tr_b16 a[166:167], v171 offset:7808
v_mfma_f32_32x32x16_bf16 v[96:111], a[144:147], v[200:203], v[96:111]
ds_read_b64_tr_b16 a[168:169], v168 offset:9216
ds_read_b64_tr_b16 a[170:171], v168 offset:9472
v_mfma_f32_32x32x16_bf16 v[112:127], a[148:151], v[200:203], v[112:127]
s_waitcnt lgkmcnt(6)
ds_read_b64_tr_b16 a[144:145], v169 offset:9216
ds_read_b64_tr_b16 a[146:147], v169 offset:9472
v_mfma_f32_32x32x16_bf16 v[96:111], a[152:155], v[204:207], v[96:111]
ds_read_b64_tr_b16 a[148:149], v168 offset:9728
ds_read_b64_tr_b16 a[150:151], v168 offset:9984
v_mfma_f32_32x32x16_bf16 v[112:127], a[156:159], v[204:207], v[112:127]
s_waitcnt lgkmcnt(6)
ds_read_b64_tr_b16 a[152:153], v169 offset:9728
ds_read_b64_tr_b16 a[154:155], v169 offset:9984
v_mfma_f32_32x32x16_bf16 v[96:111], a[160:163], v[144:147], v[96:111]
ds_read_b64_tr_b16 a[156:157], v172 offset:10240
ds_read_b64_tr_b16 a[158:159], v168 offset:11648
v_mfma_f32_32x32x16_bf16 v[112:127], a[164:167], v[144:147], v[112:127]
s_waitcnt lgkmcnt(6)
ds_read_b64_tr_b16 a[160:161], v173 offset:10240
ds_read_b64_tr_b16 a[162:163], v169 offset:11648
v_mfma_f32_32x32x16_bf16 v[64:79], a[168:171], v[176:179], 0
ds_read_b64_tr_b16 a[164:165], v168 offset:11904
ds_read_b64_tr_b16 a[166:167], v168 offset:12160
v_mfma_f32_32x32x16_bf16 v[80:95], a[144:147], v[176:179], 0
s_waitcnt lgkmcnt(6)
ds_read_b64_tr_b16 a[168:169], v169 offset:11904
ds_read_b64_tr_b16 a[170:171], v169 offset:12160
v_mfma_f32_32x32x16_bf16 v[64:79], a[148:151], v[180:183], v[64:79]
ds_read_b64_tr_b16 a[144:145], v168 offset:12416
ds_read_b64_tr_b16 a[146:147], v168 offset:13824
v_mfma_f32_32x32x16_bf16 v[80:95], a[152:155], v[180:183], v[80:95]
s_waitcnt lgkmcnt(6)
ds_read_b64_tr_b16 a[148:149], v169 offset:12416
ds_read_b64_tr_b16 a[150:151], v169 offset:13824
v_cvt_pk_bf16_f32 v128, v96, v97
v_cvt_pk_bf16_f32 v129, v98, v99
v_cvt_pk_bf16_f32 v130, v100, v101
v_mfma_f32_32x32x16_bf16 v[64:79], a[156:159], v[184:187], v[64:79]
ds_read_b64_tr_b16 a[152:153], v168 offset:14080
ds_read_b64_tr_b16 a[154:155], v168 offset:14336
v_cvt_pk_bf16_f32 v131, v102, v103
v_cvt_pk_bf16_f32 v132, v104, v105
v_cvt_pk_bf16_f32 v133, v106, v107
v_mfma_f32_32x32x16_bf16 v[80:95], a[160:163], v[184:187], v[80:95]
s_waitcnt lgkmcnt(6)
s_add_u32 s42, s40, 4096
buffer_store_dwordx4 v[128:131], v19, s[20:23], s42 offen offset:0 sc1
ds_read_b64_tr_b16 a[156:157], v169 offset:14080
ds_read_b64_tr_b16 a[158:159], v169 offset:14336
v_mfma_f32_32x32x16_bf16 v[64:79], a[164:167], v[188:191], v[64:79]
ds_read_b64_tr_b16 a[160:161], v168 offset:14592
ds_read_b64_tr_b16 a[162:163], v172 offset:14848
v_cvt_pk_bf16_f32 v134, v108, v109
v_cvt_pk_bf16_f32 v135, v110, v111
v_cvt_pk_bf16_f32 v136, v112, v113
v_mfma_f32_32x32x16_bf16 v[80:95], a[168:171], v[188:191], v[80:95]
s_waitcnt lgkmcnt(6)
buffer_store_dwordx4 v[132:135], v19, s[20:23], s42 offen offset:1024 sc1
ds_read_b64_tr_b16 a[164:165], v169 offset:14592
ds_read_b64_tr_b16 a[166:167], v173 offset:14848
v_mfma_f32_32x32x16_bf16 v[64:79], a[144:147], v[192:195], v[64:79]
ds_read_b64_tr_b16 a[168:169], v168 offset:16256
ds_read_b64_tr_b16 a[170:171], v168 offset:16512
v_cvt_pk_bf16_f32 v137, v114, v115
v_cvt_pk_bf16_f32 v138, v116, v117
v_cvt_pk_bf16_f32 v139, v118, v119
v_mfma_f32_32x32x16_bf16 v[80:95], a[148:151], v[192:195], v[80:95]
s_waitcnt lgkmcnt(6)
buffer_store_dwordx4 v[136:139], v19, s[20:23], s42 offen offset:2048 sc1
ds_read_b64_tr_b16 a[144:145], v169 offset:16256
ds_read_b64_tr_b16 a[146:147], v169 offset:16512
v_mfma_f32_32x32x16_bf16 v[64:79], a[152:155], v[196:199], v[64:79]
ds_read_b64_tr_b16 a[148:149], v168 offset:16768
ds_read_b64_tr_b16 a[150:151], v168 offset:17024
v_cvt_pk_bf16_f32 v140, v120, v121
v_cvt_pk_bf16_f32 v141, v122, v123
v_cvt_pk_bf16_f32 v142, v124, v125
v_cvt_pk_bf16_f32 v143, v126, v127
v_mfma_f32_32x32x16_bf16 v[80:95], a[156:159], v[196:199], v[80:95]
s_waitcnt lgkmcnt(6)
buffer_store_dwordx4 v[140:143], v19, s[20:23], s42 offen offset:3072 sc1
ds_read_b64_tr_b16 a[152:153], v169 offset:16768
ds_read_b64_tr_b16 a[154:155], v169 offset:17024
v_mfma_f32_32x32x16_bf16 v[64:79], a[160:163], v[200:203], v[64:79]
ds_read_b64_tr_b16 a[156:157], v170 offset:9216
ds_read_b64_tr_b16 a[158:159], v170 offset:9472
v_mfma_f32_32x32x16_bf16 v[80:95], a[164:167], v[200:203], v[80:95]
s_waitcnt lgkmcnt(6)
ds_read_b64_tr_b16 a[160:161], v171 offset:9216
ds_read_b64_tr_b16 a[162:163], v171 offset:9472
v_mfma_f32_32x32x16_bf16 v[64:79], a[168:171], v[204:207], v[64:79]
ds_read_b64_tr_b16 a[164:165], v170 offset:9728
ds_read_b64_tr_b16 a[166:167], v170 offset:9984
v_mfma_f32_32x32x16_bf16 v[80:95], a[144:147], v[204:207], v[80:95]
s_waitcnt lgkmcnt(6)
ds_read_b64_tr_b16 a[168:169], v171 offset:9728
ds_read_b64_tr_b16 a[170:171], v171 offset:9984
v_mfma_f32_32x32x16_bf16 v[64:79], a[148:151], v[144:147], v[64:79]
ds_read_b64_tr_b16 a[144:145], v174 offset:10240
ds_read_b64_tr_b16 a[146:147], v170 offset:11648
v_mfma_f32_32x32x16_bf16 v[80:95], a[152:155], v[144:147], v[80:95]
s_waitcnt lgkmcnt(6)
ds_read_b64_tr_b16 a[148:149], v175 offset:10240
ds_read_b64_tr_b16 a[150:151], v171 offset:11648
s_barrier
v_mfma_f32_32x32x16_bf16 v[96:111], a[156:159], v[176:179], 0
buffer_load_dwordx4 v15, s[16:19], s41 offen offset:0 lds
ds_read_b64_tr_b16 a[152:153], v170 offset:11904
ds_read_b64_tr_b16 a[154:155], v170 offset:12160
v_mfma_f32_32x32x16_bf16 v[112:127], a[160:163], v[176:179], 0
s_waitcnt lgkmcnt(6)
ds_read_b64_tr_b16 a[156:157], v171 offset:11904
ds_read_b64_tr_b16 a[158:159], v171 offset:12160
v_mfma_f32_32x32x16_bf16 v[96:111], a[164:167], v[180:183], v[96:111]
buffer_load_dwordx4 v16, s[16:19], s41 offen offset:1024 lds
ds_read_b64_tr_b16 a[160:161], v170 offset:12416
ds_read_b64_tr_b16 a[162:163], v170 offset:13824
v_mfma_f32_32x32x16_bf16 v[112:127], a[168:171], v[180:183], v[112:127]
s_waitcnt lgkmcnt(6)
ds_read_b64_tr_b16 a[164:165], v171 offset:12416
ds_read_b64_tr_b16 a[166:167], v171 offset:13824
v_cvt_pk_bf16_f32 v128, v64, v65
v_cvt_pk_bf16_f32 v129, v66, v67
v_cvt_pk_bf16_f32 v130, v68, v69
v_mfma_f32_32x32x16_bf16 v[96:111], a[144:147], v[184:187], v[96:111]
buffer_load_dwordx4 v17, s[16:19], s41 offen offset:2048 lds
ds_read_b64_tr_b16 a[168:169], v170 offset:14080
ds_read_b64_tr_b16 a[170:171], v170 offset:14336
v_mfma_f32_32x32x16_bf16 v[112:127], a[148:151], v[184:187], v[112:127]
s_waitcnt lgkmcnt(6)
s_add_u32 m0, s35, 3072
ds_read_b64_tr_b16 a[144:145], v171 offset:14080
ds_read_b64_tr_b16 a[146:147], v171 offset:14336
v_cvt_pk_bf16_f32 v131, v70, v71
v_cvt_pk_bf16_f32 v132, v72, v73
v_cvt_pk_bf16_f32 v133, v74, v75
v_mfma_f32_32x32x16_bf16 v[96:111], a[152:155], v[188:191], v[96:111]
s_add_u32 s42, s40, 8192
buffer_store_dwordx4 v[128:131], v19, s[20:23], s42 offen offset:0 sc1
ds_read_b64_tr_b16 a[148:149], v170 offset:14592
ds_read_b64_tr_b16 a[150:151], v174 offset:14848
v_mfma_f32_32x32x16_bf16 v[112:127], a[156:159], v[188:191], v[112:127]
s_waitcnt lgkmcnt(6)
s_add_u32 s41, s39, 56320
ds_read_b64_tr_b16 a[152:153], v171 offset:14592
ds_read_b64_tr_b16 a[154:155], v175 offset:14848
v_cvt_pk_bf16_f32 v134, v76, v77
v_cvt_pk_bf16_f32 v135, v78, v79
v_cvt_pk_bf16_f32 v136, v80, v81
v_mfma_f32_32x32x16_bf16 v[96:111], a[160:163], v[192:195], v[96:111]
buffer_store_dwordx4 v[132:135], v19, s[20:23], s42 offen offset:1024 sc1
ds_read_b64_tr_b16 a[156:157], v170 offset:16256
ds_read_b64_tr_b16 a[158:159], v170 offset:16512
v_mfma_f32_32x32x16_bf16 v[112:127], a[164:167], v[192:195], v[112:127]
s_waitcnt lgkmcnt(6)
ds_read_b64_tr_b16 a[160:161], v171 offset:16256
ds_read_b64_tr_b16 a[162:163], v171 offset:16512
v_cvt_pk_bf16_f32 v137, v82, v83
v_cvt_pk_bf16_f32 v138, v84, v85
v_cvt_pk_bf16_f32 v139, v86, v87
v_mfma_f32_32x32x16_bf16 v[96:111], a[168:171], v[196:199], v[96:111]
buffer_store_dwordx4 v[136:139], v19, s[20:23], s42 offen offset:2048 sc1
ds_read_b64_tr_b16 a[164:165], v170 offset:16768
ds_read_b64_tr_b16 a[166:167], v170 offset:17024
v_mfma_f32_32x32x16_bf16 v[112:127], a[144:147], v[196:199], v[112:127]
s_waitcnt lgkmcnt(6)
ds_read_b64_tr_b16 a[168:169], v171 offset:16768
ds_read_b64_tr_b16 a[170:171], v171 offset:17024
v_cvt_pk_bf16_f32 v140, v88, v89
v_cvt_pk_bf16_f32 v141, v90, v91
v_cvt_pk_bf16_f32 v142, v92, v93
v_cvt_pk_bf16_f32 v143, v94, v95
v_mfma_f32_32x32x16_bf16 v[96:111], a[148:151], v[200:203], v[96:111]
buffer_store_dwordx4 v[140:143], v19, s[20:23], s42 offen offset:3072 sc1
ds_read_b64_tr_b16 a[144:145], v168 offset:18432
ds_read_b64_tr_b16 a[146:147], v168 offset:18688
v_mfma_f32_32x32x16_bf16 v[112:127], a[152:155], v[200:203], v[112:127]
s_waitcnt lgkmcnt(6)
ds_read_b64_tr_b16 a[148:149], v169 offset:18432
ds_read_b64_tr_b16 a[150:151], v169 offset:18688
v_mfma_f32_32x32x16_bf16 v[96:111], a[156:159], v[204:207], v[96:111]
buffer_load_dwordx4 v15, s[16:19], s41 offen offset:0 lds
ds_read_b64_tr_b16 a[152:153], v168 offset:18944
ds_read_b64_tr_b16 a[154:155], v168 offset:19200
v_mfma_f32_32x32x16_bf16 v[112:127], a[160:163], v[204:207], v[112:127]
s_waitcnt lgkmcnt(6)
ds_read_b64_tr_b16 a[156:157], v169 offset:18944
ds_read_b64_tr_b16 a[158:159], v169 offset:19200
v_mfma_f32_32x32x16_bf16 v[96:111], a[164:167], v[144:147], v[96:111]
buffer_load_dwordx4 v16, s[16:19], s41 offen offset:1024 lds
ds_read_b64_tr_b16 a[160:161], v172 offset:19456
ds_read_b64_tr_b16 a[162:163], v168 offset:20864
v_mfma_f32_32x32x16_bf16 v[112:127], a[168:171], v[144:147], v[112:127]
s_waitcnt lgkmcnt(6)
ds_read_b64_tr_b16 a[164:165], v173 offset:19456
ds_read_b64_tr_b16 a[166:167], v169 offset:20864
v_mfma_f32_32x32x16_bf16 v[64:79], a[144:147], v[176:179], 0
buffer_load_dwordx4 v17, s[16:19], s41 offen offset:2048 lds
ds_read_b64_tr_b16 a[168:169], v168 offset:21120
ds_read_b64_tr_b16 a[170:171], v168 offset:21376
v_mfma_f32_32x32x16_bf16 v[80:95], a[148:151], v[176:179], 0
s_waitcnt lgkmcnt(6)
s_add_u32 m0, s35, 6144
ds_read_b64_tr_b16 a[144:145], v169 offset:21120
ds_read_b64_tr_b16 a[146:147], v169 offset:21376
v_mfma_f32_32x32x16_bf16 v[64:79], a[152:155], v[180:183], v[64:79]
s_add_u32 s41, s39, 111616
buffer_load_dwordx4 v15, s[16:19], s41 offen offset:0 lds
ds_read_b64_tr_b16 a[148:149], v168 offset:21632
ds_read_b64_tr_b16 a[150:151], v168 offset:23040
v_mfma_f32_32x32x16_bf16 v[80:95], a[156:159], v[180:183], v[80:95]
s_waitcnt lgkmcnt(6)
ds_read_b64_tr_b16 a[152:153], v169 offset:21632
ds_read_b64_tr_b16 a[154:155], v169 offset:23040
v_cvt_pk_bf16_f32 v128, v96, v97
v_cvt_pk_bf16_f32 v129, v98, v99
v_cvt_pk_bf16_f32 v130, v100, v101
v_mfma_f32_32x32x16_bf16 v[64:79], a[160:163], v[184:187], v[64:79]
buffer_load_dwordx4 v16, s[16:19], s41 offen offset:1024 lds
ds_read_b64_tr_b16 a[156:157], v168 offset:23296
ds_read_b64_tr_b16 a[158:159], v168 offset:23552
v_mfma_f32_32x32x16_bf16 v[80:95], a[164:167], v[184:187], v[80:95]
s_waitcnt lgkmcnt(6)
ds_read_b64_tr_b16 a[160:161], v169 offset:23296
ds_read_b64_tr_b16 a[162:163], v169 offset:23552
v_cvt_pk_bf16_f32 v131, v102, v103
v_cvt_pk_bf16_f32 v132, v104, v105
v_cvt_pk_bf16_f32 v133, v106, v107
v_mfma_f32_32x32x16_bf16 v[64:79], a[168:171], v[188:191], v[64:79]
s_add_u32 s42, s40, 12288
buffer_store_dwordx4 v[128:131], v19, s[20:23], s42 offen offset:0 sc1
ds_read_b64_tr_b16 a[164:165], v168 offset:23808
ds_read_b64_tr_b16 a[166:167], v172 offset:24064
v_mfma_f32_32x32x16_bf16 v[80:95], a[144:147], v[188:191], v[80:95]
s_waitcnt lgkmcnt(6)
ds_read_b64_tr_b16 a[168:169], v169 offset:23808
ds_read_b64_tr_b16 a[170:171], v173 offset:24064
v_cvt_pk_bf16_f32 v134, v108, v109
v_cvt_pk_bf16_f32 v135, v110, v111
v_cvt_pk_bf16_f32 v136, v112, v113
v_mfma_f32_32x32x16_bf16 v[64:79], a[148:151], v[192:195], v[64:79]
buffer_store_dwordx4 v[132:135], v19, s[20:23], s42 offen offset:1024 sc1
ds_read_b64_tr_b16 a[144:145], v168 offset:25472
ds_read_b64_tr_b16 a[146:147], v168 offset:25728
v_mfma_f32_32x32x16_bf16 v[80:95], a[152:155], v[192:195], v[80:95]
s_waitcnt lgkmcnt(6)
ds_read_b64_tr_b16 a[148:149], v169 offset:25472
ds_read_b64_tr_b16 a[150:151], v169 offset:25728
v_cvt_pk_bf16_f32 v137, v114, v115
v_cvt_pk_bf16_f32 v138, v116, v117
v_cvt_pk_bf16_f32 v139, v118, v119
v_mfma_f32_32x32x16_bf16 v[64:79], a[156:159], v[196:199], v[64:79]
buffer_store_dwordx4 v[136:139], v19, s[20:23], s42 offen offset:2048 sc1
ds_read_b64_tr_b16 a[152:153], v168 offset:25984
ds_read_b64_tr_b16 a[154:155], v168 offset:26240
v_mfma_f32_32x32x16_bf16 v[80:95], a[160:163], v[196:199], v[80:95]
s_waitcnt lgkmcnt(6)
ds_read_b64_tr_b16 a[156:157], v169 offset:25984
ds_read_b64_tr_b16 a[158:159], v169 offset:26240
v_cvt_pk_bf16_f32 v140, v120, v121
v_cvt_pk_bf16_f32 v141, v122, v123
v_cvt_pk_bf16_f32 v142, v124, v125
v_cvt_pk_bf16_f32 v143, v126, v127
v_mfma_f32_32x32x16_bf16 v[64:79], a[164:167], v[200:203], v[64:79]
buffer_store_dwordx4 v[140:143], v19, s[20:23], s42 offen offset:3072 sc1
ds_read_b64_tr_b16 a[160:161], v170 offset:18432
ds_read_b64_tr_b16 a[162:163], v170 offset:18688
v_mfma_f32_32x32x16_bf16 v[80:95], a[168:171], v[200:203], v[80:95]
s_waitcnt lgkmcnt(6)
ds_read_b64_tr_b16 a[164:165], v171 offset:18432
ds_read_b64_tr_b16 a[166:167], v171 offset:18688
v_mfma_f32_32x32x16_bf16 v[64:79], a[144:147], v[204:207], v[64:79]
buffer_load_dwordx4 v17, s[16:19], s41 offen offset:2048 lds
ds_read_b64_tr_b16 a[168:169], v170 offset:18944
ds_read_b64_tr_b16 a[170:171], v170 offset:19200
v_mfma_f32_32x32x16_bf16 v[80:95], a[148:151], v[204:207], v[80:95]
s_waitcnt lgkmcnt(6)
ds_read_b64_tr_b16 a[144:145], v171 offset:18944
ds_read_b64_tr_b16 a[146:147], v171 offset:19200
v_mfma_f32_32x32x16_bf16 v[64:79], a[152:155], v[144:147], v[64:79]
ds_read_b64_tr_b16 a[148:149], v174 offset:19456
ds_read_b64_tr_b16 a[150:151], v170 offset:20864
v_mfma_f32_32x32x16_bf16 v[80:95], a[156:159], v[144:147], v[80:95]
s_waitcnt lgkmcnt(6)
ds_read_b64_tr_b16 a[152:153], v175 offset:19456
ds_read_b64_tr_b16 a[154:155], v171 offset:20864
s_barrier
v_mfma_f32_32x32x16_bf16 v[96:111], a[160:163], v[176:179], 0
ds_read_b64_tr_b16 a[156:157], v170 offset:21120
ds_read_b64_tr_b16 a[158:159], v170 offset:21376
v_mfma_f32_32x32x16_bf16 v[112:127], a[164:167], v[176:179], 0
s_waitcnt lgkmcnt(6)
ds_read_b64_tr_b16 a[160:161], v171 offset:21120
ds_read_b64_tr_b16 a[162:163], v171 offset:21376
v_mfma_f32_32x32x16_bf16 v[96:111], a[168:171], v[180:183], v[96:111]
ds_read_b64_tr_b16 a[164:165], v170 offset:21632
ds_read_b64_tr_b16 a[166:167], v170 offset:23040
v_mfma_f32_32x32x16_bf16 v[112:127], a[144:147], v[180:183], v[112:127]
s_waitcnt lgkmcnt(6)
ds_read_b64_tr_b16 a[168:169], v171 offset:21632
ds_read_b64_tr_b16 a[170:171], v171 offset:23040
v_cvt_pk_bf16_f32 v128, v64, v65
v_cvt_pk_bf16_f32 v129, v66, v67
v_cvt_pk_bf16_f32 v130, v68, v69
v_mfma_f32_32x32x16_bf16 v[96:111], a[148:151], v[184:187], v[96:111]
ds_read_b64_tr_b16 a[144:145], v170 offset:23296
ds_read_b64_tr_b16 a[146:147], v170 offset:23552
v_cvt_pk_bf16_f32 v131, v70, v71
v_cvt_pk_bf16_f32 v132, v72, v73
v_cvt_pk_bf16_f32 v133, v74, v75
v_mfma_f32_32x32x16_bf16 v[112:127], a[152:155], v[184:187], v[112:127]
s_waitcnt lgkmcnt(6)
s_add_u32 s42, s40, 16384
buffer_store_dwordx4 v[128:131], v19, s[20:23], s42 offen offset:0 sc1
ds_read_b64_tr_b16 a[148:149], v171 offset:23296
ds_read_b64_tr_b16 a[150:151], v171 offset:23552
v_mfma_f32_32x32x16_bf16 v[96:111], a[156:159], v[188:191], v[96:111]
ds_read_b64_tr_b16 a[152:153], v170 offset:23808
ds_read_b64_tr_b16 a[154:155], v174 offset:24064
v_cvt_pk_bf16_f32 v134, v76, v77
v_cvt_pk_bf16_f32 v135, v78, v79
v_cvt_pk_bf16_f32 v136, v80, v81
v_mfma_f32_32x32x16_bf16 v[112:127], a[160:163], v[188:191], v[112:127]
s_waitcnt lgkmcnt(6)
buffer_store_dwordx4 v[132:135], v19, s[20:23], s42 offen offset:1024 sc1
ds_read_b64_tr_b16 a[156:157], v171 offset:23808
ds_read_b64_tr_b16 a[158:159], v175 offset:24064
v_mfma_f32_32x32x16_bf16 v[96:111], a[164:167], v[192:195], v[96:111]
ds_read_b64_tr_b16 a[160:161], v170 offset:25472
ds_read_b64_tr_b16 a[162:163], v170 offset:25728
v_cvt_pk_bf16_f32 v137, v82, v83
L_pad_a2_2:
s_cbranch_execz L_warm_a
v_cvt_pk_bf16_f32 v138, v84, v85
v_cvt_pk_bf16_f32 v139, v86, v87
v_mfma_f32_32x32x16_bf16 v[112:127], a[168:171], v[192:195], v[112:127]
s_waitcnt lgkmcnt(6)
buffer_store_dwordx4 v[136:139], v19, s[20:23], s42 offen offset:2048 sc1
ds_read_b64_tr_b16 a[164:165], v171 offset:25472
ds_read_b64_tr_b16 a[166:167], v171 offset:25728
v_mfma_f32_32x32x16_bf16 v[96:111], a[144:147], v[196:199], v[96:111]
ds_read_b64_tr_b16 a[168:169], v170 offset:25984
ds_read_b64_tr_b16 a[170:171], v170 offset:26240
v_cvt_pk_bf16_f32 v140, v88, v89
v_cvt_pk_bf16_f32 v141, v90, v91
v_cvt_pk_bf16_f32 v142, v92, v93
v_cvt_pk_bf16_f32 v143, v94, v95
v_mfma_f32_32x32x16_bf16 v[112:127], a[148:151], v[196:199], v[112:127]
s_waitcnt lgkmcnt(6)
buffer_store_dwordx4 v[140:143], v19, s[20:23], s42 offen offset:3072 sc1
ds_read_b64_tr_b16 a[144:145], v171 offset:25984
ds_read_b64_tr_b16 a[146:147], v171 offset:26240
v_mfma_f32_32x32x16_bf16 v[96:111], a[152:155], v[200:203], v[96:111]
ds_read_b64_tr_b16 a[148:149], v168 offset:27648
ds_read_b64_tr_b16 a[150:151], v168 offset:27904
v_mfma_f32_32x32x16_bf16 v[112:127], a[156:159], v[200:203], v[112:127]
s_waitcnt lgkmcnt(6)
ds_read_b64_tr_b16 a[152:153], v169 offset:27648
ds_read_b64_tr_b16 a[154:155], v169 offset:27904
v_mfma_f32_32x32x16_bf16 v[96:111], a[160:163], v[204:207], v[96:111]
ds_read_b64_tr_b16 a[156:157], v168 offset:28160
ds_read_b64_tr_b16 a[158:159], v168 offset:28416
v_mfma_f32_32x32x16_bf16 v[112:127], a[164:167], v[204:207], v[112:127]
s_waitcnt lgkmcnt(6)
ds_read_b64_tr_b16 a[160:161], v169 offset:28160
ds_read_b64_tr_b16 a[162:163], v169 offset:28416
v_mfma_f32_32x32x16_bf16 v[96:111], a[168:171], v[144:147], v[96:111]
ds_read_b64_tr_b16 a[164:165], v172 offset:28672
ds_read_b64_tr_b16 a[166:167], v168 offset:30080
v_mfma_f32_32x32x16_bf16 v[112:127], a[144:147], v[144:147], v[112:127]
s_waitcnt lgkmcnt(6)
ds_read_b64_tr_b16 a[168:169], v173 offset:28672
ds_read_b64_tr_b16 a[170:171], v169 offset:30080
v_mfma_f32_32x32x16_bf16 v[64:79], a[148:151], v[176:179], 0
ds_read_b64_tr_b16 a[144:145], v168 offset:30336
ds_read_b64_tr_b16 a[146:147], v168 offset:30592
v_mfma_f32_32x32x16_bf16 v[80:95], a[152:155], v[176:179], 0
s_waitcnt lgkmcnt(6)
ds_read_b64_tr_b16 a[148:149], v169 offset:30336
ds_read_b64_tr_b16 a[150:151], v169 offset:30592
v_mfma_f32_32x32x16_bf16 v[64:79], a[156:159], v[180:183], v[64:79]
ds_read_b64_tr_b16 a[152:153], v168 offset:30848
ds_read_b64_tr_b16 a[154:155], v168 offset:32256
v_mfma_f32_32x32x16_bf16 v[80:95], a[160:163], v[180:183], v[80:95]
s_waitcnt lgkmcnt(6)
ds_read_b64_tr_b16 a[156:157], v169 offset:30848
ds_read_b64_tr_b16 a[158:159], v169 offset:32256
v_cvt_pk_bf16_f32 v128, v96, v97
v_cvt_pk_bf16_f32 v129, v98, v99
v_cvt_pk_bf16_f32 v130, v100, v101
v_mfma_f32_32x32x16_bf16 v[64:79], a[164:167], v[184:187], v[64:79]
ds_read_b64_tr_b16 a[160:161], v168 offset:32512
ds_read_b64_tr_b16 a[162:163], v168 offset:32768
v_cvt_pk_bf16_f32 v131, v102, v103
v_cvt_pk_bf16_f32 v132, v104, v105
v_cvt_pk_bf16_f32 v133, v106, v107
v_mfma_f32_32x32x16_bf16 v[80:95], a[168:171], v[184:187], v[80:95]
s_waitcnt lgkmcnt(6)
s_add_u32 s42, s40, 20480
buffer_store_dwordx4 v[128:131], v19, s[20:23], s42 offen offset:0 sc1
ds_read_b64_tr_b16 a[164:165], v169 offset:32512
ds_read_b64_tr_b16 a[166:167], v169 offset:32768
v_mfma_f32_32x32x16_bf16 v[64:79], a[144:147], v[188:191], v[64:79]
ds_read_b64_tr_b16 a[168:169], v168 offset:33024
ds_read_b64_tr_b16 a[170:171], v172 offset:33280
v_cvt_pk_bf16_f32 v134, v108, v109
v_cvt_pk_bf16_f32 v135, v110, v111
v_cvt_pk_bf16_f32 v136, v112, v113
v_mfma_f32_32x32x16_bf16 v[80:95], a[148:151], v[188:191], v[80:95]
s_waitcnt lgkmcnt(6)
buffer_store_dwordx4 v[132:135], v19, s[20:23], s42 offen offset:1024 sc1
ds_read_b64_tr_b16 a[144:145], v169 offset:33024
ds_read_b64_tr_b16 a[146:147], v173 offset:33280
v_mfma_f32_32x32x16_bf16 v[64:79], a[152:155], v[192:195], v[64:79]
ds_read_b64_tr_b16 a[148:149], v168 offset:34688
ds_read_b64_tr_b16 a[150:151], v168 offset:34944
v_cvt_pk_bf16_f32 v137, v114, v115
v_cvt_pk_bf16_f32 v138, v116, v117
v_cvt_pk_bf16_f32 v139, v118, v119
v_mfma_f32_32x32x16_bf16 v[80:95], a[156:159], v[192:195], v[80:95]
s_waitcnt lgkmcnt(6)
buffer_store_dwordx4 v[136:139], v19, s[20:23], s42 offen offset:2048 sc1
ds_read_b64_tr_b16 a[152:153], v169 offset:34688
ds_read_b64_tr_b16 a[154:155], v169 offset:34944
v_mfma_f32_32x32x16_bf16 v[64:79], a[160:163], v[196:199], v[64:79]
ds_read_b64_tr_b16 a[156:157], v168 offset:35200
ds_read_b64_tr_b16 a[158:159], v168 offset:35456
v_cvt_pk_bf16_f32 v140, v120, v121
v_cvt_pk_bf16_f32 v141, v122, v123
v_cvt_pk_bf16_f32 v142, v124, v125
v_cvt_pk_bf16_f32 v143, v126, v127
v_mfma_f32_32x32x16_bf16 v[80:95], a[164:167], v[196:199], v[80:95]
s_waitcnt lgkmcnt(6)
buffer_store_dwordx4 v[140:143], v19, s[20:23], s42 offen offset:3072 sc1
ds_read_b64_tr_b16 a[160:161], v169 offset:35200
ds_read_b64_tr_b16 a[162:163], v169 offset:35456
v_mfma_f32_32x32x16_bf16 v[64:79], a[168:171], v[200:203], v[64:79]
ds_read_b64_tr_b16 a[164:165], v170 offset:27648
ds_read_b64_tr_b16 a[166:167], v170 offset:27904
v_mfma_f32_32x32x16_bf16 v[80:95], a[144:147], v[200:203], v[80:95]
s_waitcnt lgkmcnt(6)
ds_read_b64_tr_b16 a[168:169], v171 offset:27648
ds_read_b64_tr_b16 a[170:171], v171 offset:27904
v_mfma_f32_32x32x16_bf16 v[64:79], a[148:151], v[204:207], v[64:79]
ds_read_b64_tr_b16 a[144:145], v170 offset:28160
ds_read_b64_tr_b16 a[146:147], v170 offset:28416
v_mfma_f32_32x32x16_bf16 v[80:95], a[152:155], v[204:207], v[80:95]
s_waitcnt lgkmcnt(6)
ds_read_b64_tr_b16 a[148:149], v171 offset:28160
ds_read_b64_tr_b16 a[150:151], v171 offset:28416
v_mfma_f32_32x32x16_bf16 v[64:79], a[156:159], v[144:147], v[64:79]
ds_read_b64_tr_b16 a[152:153], v174 offset:28672
ds_read_b64_tr_b16 a[154:155], v170 offset:30080
v_mfma_f32_32x32x16_bf16 v[80:95], a[160:163], v[144:147], v[80:95]
s_waitcnt lgkmcnt(6)
ds_read_b64_tr_b16 a[156:157], v175 offset:28672
ds_read_b64_tr_b16 a[158:159], v171 offset:30080
s_waitcnt vmcnt(8)
s_barrier
v_mfma_f32_32x32x16_bf16 v[96:111], a[164:167], v[176:179], 0
ds_read_b64_tr_b16 a[160:161], v170 offset:30336
ds_read_b64_tr_b16 a[162:163], v170 offset:30592
v_mfma_f32_32x32x16_bf16 v[112:127], a[168:171], v[176:179], 0
s_waitcnt lgkmcnt(6)
ds_read_b64_tr_b16 a[164:165], v171 offset:30336
ds_read_b64_tr_b16 a[166:167], v171 offset:30592
v_mfma_f32_32x32x16_bf16 v[96:111], a[144:147], v[180:183], v[96:111]
ds_read_b64_tr_b16 a[168:169], v170 offset:30848
ds_read_b64_tr_b16 a[170:171], v170 offset:32256
v_mfma_f32_32x32x16_bf16 v[112:127], a[148:151], v[180:183], v[112:127]
s_waitcnt lgkmcnt(6)
ds_read_b64_tr_b16 a[144:145], v171 offset:30848
ds_read_b64_tr_b16 a[146:147], v171 offset:32256
v_cvt_pk_bf16_f32 v128, v64, v65
v_cvt_pk_bf16_f32 v129, v66, v67
v_cvt_pk_bf16_f32 v130, v68, v69
v_mfma_f32_32x32x16_bf16 v[96:111], a[152:155], v[184:187], v[96:111]
ds_read_b64_tr_b16 a[148:149], v170 offset:32512
ds_read_b64_tr_b16 a[150:151], v170 offset:32768
v_cvt_pk_bf16_f32 v131, v70, v71
v_cvt_pk_bf16_f32 v132, v72, v73
v_cvt_pk_bf16_f32 v133, v74, v75
v_mfma_f32_32x32x16_bf16 v[112:127], a[156:159], v[184:187], v[112:127]
s_waitcnt lgkmcnt(6)
s_add_u32 s42, s40, 24576
buffer_store_dwordx4 v[128:131], v19, s[20:23], s42 offen offset:0 sc1
ds_read_b64_tr_b16 a[152:153], v171 offset:32512
ds_read_b64_tr_b16 a[154:155], v171 offset:32768
v_mfma_f32_32x32x16_bf16 v[96:111], a[160:163], v[188:191], v[96:111]
ds_read_b64_tr_b16 a[156:157], v170 offset:33024
ds_read_b64_tr_b16 a[158:159], v174 offset:33280
v_cvt_pk_bf16_f32 v134, v76, v77
v_cvt_pk_bf16_f32 v135, v78, v79
v_cvt_pk_bf16_f32 v136, v80, v81
v_mfma_f32_32x32x16_bf16 v[112:127], a[164:167], v[188:191], v[112:127]
s_waitcnt lgkmcnt(6)
buffer_store_dwordx4 v[132:135], v19, s[20:23], s42 offen offset:1024 sc1
ds_read_b64_tr_b16 a[160:161], v171 offset:33024
ds_read_b64_tr_b16 a[162:163], v175 offset:33280
v_mfma_f32_32x32x16_bf16 v[96:111], a[168:171], v[192:195], v[96:111]
ds_read_b64_tr_b16 a[164:165], v170 offset:34688
ds_read_b64_tr_b16 a[166:167], v170 offset:34944
v_cvt_pk_bf16_f32 v137, v82, v83
v_cvt_pk_bf16_f32 v138, v84, v85
v_cvt_pk_bf16_f32 v139, v86, v87
v_mfma_f32_32x32x16_bf16 v[112:127], a[144:147], v[192:195], v[112:127]
s_waitcnt lgkmcnt(6)
buffer_store_dwordx4 v[136:139], v19, s[20:23], s42 offen offset:2048 sc1
ds_read_b64_tr_b16 a[168:169], v171 offset:34688
ds_read_b64_tr_b16 a[170:171], v171 offset:34944
v_mfma_f32_32x32x16_bf16 v[96:111], a[148:151], v[196:199], v[96:111]
ds_read_b64_tr_b16 a[144:145], v170 offset:35200
ds_read_b64_tr_b16 a[146:147], v170 offset:35456
v_cvt_pk_bf16_f32 v140, v88, v89
v_cvt_pk_bf16_f32 v141, v90, v91
v_cvt_pk_bf16_f32 v142, v92, v93
v_cvt_pk_bf16_f32 v143, v94, v95
v_mfma_f32_32x32x16_bf16 v[112:127], a[152:155], v[196:199], v[112:127]
s_waitcnt lgkmcnt(6)
buffer_store_dwordx4 v[140:143], v19, s[20:23], s42 offen offset:3072 sc1
ds_read_b64_tr_b16 a[148:149], v171 offset:35200
ds_read_b64_tr_b16 a[150:151], v171 offset:35456
v_mfma_f32_32x32x16_bf16 v[96:111], a[156:159], v[200:203], v[96:111]
ds_read_b64_tr_b16 a[152:153], v168 offset:0
ds_read_b64_tr_b16 a[154:155], v168 offset:256
v_mfma_f32_32x32x16_bf16 v[112:127], a[160:163], v[200:203], v[112:127]
s_waitcnt lgkmcnt(6)
ds_read_b64_tr_b16 a[156:157], v169 offset:0
ds_read_b64_tr_b16 a[158:159], v169 offset:256
v_mfma_f32_32x32x16_bf16 v[96:111], a[164:167], v[204:207], v[96:111]
ds_read_b64_tr_b16 a[160:161], v168 offset:512
ds_read_b64_tr_b16 a[162:163], v168 offset:768
v_mfma_f32_32x32x16_bf16 v[112:127], a[168:171], v[204:207], v[112:127]
s_waitcnt lgkmcnt(6)
ds_read_b64_tr_b16 a[164:165], v169 offset:512
ds_read_b64_tr_b16 a[166:167], v169 offset:768
v_mfma_f32_32x32x16_bf16 v[96:111], a[144:147], v[144:147], v[96:111]
ds_read_b64_tr_b16 a[168:169], v172 offset:1024
ds_read_b64_tr_b16 a[170:171], v168 offset:2432
v_mfma_f32_32x32x16_bf16 v[112:127], a[148:151], v[144:147], v[112:127]
s_waitcnt lgkmcnt(6)
ds_read_b64_tr_b16 a[144:145], v173 offset:1024
ds_read_b64_tr_b16 a[146:147], v169 offset:2432
v_mfma_f32_32x32x16_bf16 v[64:79], a[152:155], v[176:179], 0
ds_read_b64_tr_b16 a[148:149], v168 offset:2688
ds_read_b64_tr_b16 a[150:151], v168 offset:2944
v_mfma_f32_32x32x16_bf16 v[80:95], a[156:159], v[176:179], 0
s_waitcnt lgkmcnt(6)
ds_read_b64_tr_b16 a[152:153], v169 offset:2688
ds_read_b64_tr_b16 a[154:155], v169 offset:2944
v_mfma_f32_32x32x16_bf16 v[64:79], a[160:163], v[180:183], v[64:79]
ds_read_b64_tr_b16 a[156:157], v168 offset:3200
ds_read_b64_tr_b16 a[158:159], v168 offset:4608
v_mfma_f32_32x32x16_bf16 v[80:95], a[164:167], v[180:183], v[80:95]
s_waitcnt lgkmcnt(6)
ds_read_b64_tr_b16 a[160:161], v169 offset:3200
ds_read_b64_tr_b16 a[162:163], v169 offset:4608
v_cvt_pk_bf16_f32 v128, v96, v97
v_cvt_pk_bf16_f32 v129, v98, v99
v_cvt_pk_bf16_f32 v130, v100, v101
v_mfma_f32_32x32x16_bf16 v[64:79], a[168:171], v[184:187], v[64:79]
ds_read_b64_tr_b16 a[164:165], v168 offset:4864
ds_read_b64_tr_b16 a[166:167], v168 offset:5120
v_cvt_pk_bf16_f32 v131, v102, v103
v_cvt_pk_bf16_f32 v132, v104, v105
v_cvt_pk_bf16_f32 v133, v106, v107
v_mfma_f32_32x32x16_bf16 v[80:95], a[144:147], v[184:187], v[80:95]
s_waitcnt lgkmcnt(6)
s_add_u32 s42, s40, 28672
buffer_store_dwordx4 v[128:131], v19, s[20:23], s42 offen offset:0 sc1
ds_read_b64_tr_b16 a[168:169], v169 offset:4864
ds_read_b64_tr_b16 a[170:171], v169 offset:5120
v_mfma_f32_32x32x16_bf16 v[64:79], a[148:151], v[188:191], v[64:79]
ds_read_b64_tr_b16 a[144:145], v168 offset:5376
ds_read_b64_tr_b16 a[146:147], v172 offset:5632
v_cvt_pk_bf16_f32 v134, v108, v109
v_cvt_pk_bf16_f32 v135, v110, v111
v_cvt_pk_bf16_f32 v136, v112, v113
v_mfma_f32_32x32x16_bf16 v[80:95], a[152:155], v[188:191], v[80:95]
s_waitcnt lgkmcnt(6)
buffer_store_dwordx4 v[132:135], v19, s[20:23], s42 offen offset:1024 sc1
ds_read_b64_tr_b16 a[148:149], v169 offset:5376
ds_read_b64_tr_b16 a[150:151], v173 offset:5632
v_mfma_f32_32x32x16_bf16 v[64:79], a[156:159], v[192:195], v[64:79]
ds_read_b64_tr_b16 a[152:153], v168 offset:7040
ds_read_b64_tr_b16 a[154:155], v168 offset:7296
v_cvt_pk_bf16_f32 v137, v114, v115
v_cvt_pk_bf16_f32 v138, v116, v117
v_cvt_pk_bf16_f32 v139, v118, v119
v_mfma_f32_32x32x16_bf16 v[80:95], a[160:163], v[192:195], v[80:95]
s_waitcnt lgkmcnt(6)
buffer_store_dwordx4 v[136:139], v19, s[20:23], s42 offen offset:2048 sc1
ds_read_b64_tr_b16 a[156:157], v169 offset:7040
ds_read_b64_tr_b16 a[158:159], v169 offset:7296
v_mfma_f32_32x32x16_bf16 v[64:79], a[164:167], v[196:199], v[64:79]
ds_read_b64_tr_b16 a[160:161], v168 offset:7552
ds_read_b64_tr_b16 a[162:163], v168 offset:7808
v_cvt_pk_bf16_f32 v140, v120, v121
v_cvt_pk_bf16_f32 v141, v122, v123
v_cvt_pk_bf16_f32 v142, v124, v125
v_cvt_pk_bf16_f32 v143, v126, v127
v_mfma_f32_32x32x16_bf16 v[80:95], a[168:171], v[196:199], v[80:95]
s_waitcnt lgkmcnt(6)
buffer_store_dwordx4 v[140:143], v19, s[20:23], s42 offen offset:3072 sc1
ds_read_b64_tr_b16 a[164:165], v169 offset:7552
ds_read_b64_tr_b16 a[166:167], v169 offset:7808
v_mfma_f32_32x32x16_bf16 v[64:79], a[144:147], v[200:203], v[64:79]
v_mfma_f32_32x32x16_bf16 v[80:95], a[148:151], v[200:203], v[80:95]
s_waitcnt lgkmcnt(4)
v_mfma_f32_32x32x16_bf16 v[64:79], a[152:155], v[204:207], v[64:79]
v_mfma_f32_32x32x16_bf16 v[80:95], a[156:159], v[204:207], v[80:95]
s_waitcnt lgkmcnt(0)
v_mfma_f32_32x32x16_bf16 v[64:79], a[160:163], v[144:147], v[64:79]
v_mfma_f32_32x32x16_bf16 v[80:95], a[164:167], v[144:147], v[80:95]
s_nop 10
v_cvt_pk_bf16_f32 v128, v64, v65
v_cvt_pk_bf16_f32 v129, v66, v67
v_cvt_pk_bf16_f32 v130, v68, v69
v_cvt_pk_bf16_f32 v131, v70, v71
s_add_u32 s42, s40, 32768
buffer_store_dwordx4 v[128:131], v19, s[20:23], s42 offen offset:0 sc1
v_cvt_pk_bf16_f32 v132, v72, v73
v_cvt_pk_bf16_f32 v133, v74, v75
v_cvt_pk_bf16_f32 v134, v76, v77
v_cvt_pk_bf16_f32 v135, v78, v79
buffer_store_dwordx4 v[132:135], v19, s[20:23], s42 offen offset:1024 sc1
v_cvt_pk_bf16_f32 v136, v80, v81
v_cvt_pk_bf16_f32 v137, v82, v83
v_cvt_pk_bf16_f32 v138, v84, v85
v_cvt_pk_bf16_f32 v139, v86, v87
buffer_store_dwordx4 v[136:139], v19, s[20:23], s42 offen offset:2048 sc1
v_cvt_pk_bf16_f32 v140, v88, v89
v_cvt_pk_bf16_f32 v141, v90, v91
v_cvt_pk_bf16_f32 v142, v92, v93
v_cvt_pk_bf16_f32 v143, v94, v95
buffer_store_dwordx4 v[140:143], v19, s[20:23], s42 offen offset:3072 sc1
s_waitcnt vmcnt(0)
s_barrier
v_mov_b32 v9, 3
buffer_store_dword v9, v7, s[20:23], s5 offen sc1
s_branch L_end
L_spin_fi:
s_mov_b32 s6, 0
L_spinl_fi:
s_sleep 2
buffer_load_dword v8, off, s[28:31], s1 sc1
s_add_u32 s6, s6, 1
s_waitcnt vmcnt(0)
v_cmp_le_u32 vcc, 1, v8
s_nop 4
s_andn2_b32 s7, 0x1, vcc_lo
s_cbranch_scc0 L_back_fi
s_cmp_lt_u32 s6, 0x40000
s_cbranch_scc1 L_spinl_fi
s_branch L_back_fi
L_spin_f0:
s_mov_b32 s6, 0
L_spinl_f0:
s_sleep 2
buffer_load_dword v8, v10, s[20:23], s4 offen sc1
s_add_u32 s6, s6, 1
s_waitcnt vmcnt(0)
v_cmp_le_u32 vcc, 1, v8
s_nop 4
s_andn2_b32 s7, 0xfff, vcc_lo
s_cbranch_scc0 L_back_f0
s_cmp_lt_u32 s6, 0x40000
s_cbranch_scc1 L_spinl_f0
s_branch L_back_f0
L_spin_f1:
s_mov_b32 s6, 0
L_spinl_f1:
s_sleep 2
buffer_load_dword v8, v10, s[20:23], s4 offen sc1
s_add_u32 s6, s6, 1
s_waitcnt vmcnt(0)
v_cmp_le_u32 vcc, 2, v8
s_nop 4
s_andn2_b32 s7, 0xfff, vcc_lo
s_cbranch_scc0 L_back_f1
s_cmp_lt_u32 s6, 0x40000
s_cbranch_scc1 L_spinl_f1
s_branch L_back_f1
L_spin_f2:
s_mov_b32 s6, 0
L_spinl_f2:
s_sleep 1
buffer_load_dword v8, v10, s[20:23], s4 offen sc1
s_add_u32 s6, s6, 1
s_waitcnt vmcnt(0)
v_cmp_le_u32 vcc, 3, v8
s_nop 4
s_andn2_b32 s7, 0xfff, vcc_lo
s_cbranch_scc0 L_back_f2
s_cmp_lt_u32 s6, 0x40000
s_cbranch_scc1 L_spinl_f2
s_branch L_back_f2
L_spin_f3:
s_mov_b32 s6, 0
L_spinl_f3:
s_sleep 1
buffer_load_dword v8, v10, s[20:23], s4 offen sc1
s_add_u32 s6, s6, 1
s_waitcnt vmcnt(0)
v_cmp_le_u32 vcc, 3, v8
s_nop 4
s_andn2_b32 s7, 0xf000, vcc_lo
s_cbranch_scc0 L_back_f3
s_cmp_lt_u32 s6, 0x40000
s_cbranch_scc1 L_spinl_f3
s_branch L_back_f3
L_spin_ai:
s_mov_b32 s6, 0
L_spinl_ai:
s_sleep 2
buffer_load_dword v8, off, s[28:31], s59 sc1
s_add_u32 s6, s6, 1
s_waitcnt vmcnt(0)
v_cmp_le_u32 vcc, 1, v8
s_nop 4
s_andn2_b32 s7, 0x1, vcc_lo
s_cbranch_scc0 L_back_ai
s_cmp_lt_u32 s6, 0x40000
s_cbranch_scc1 L_spinl_ai
s_branch L_back_ai
L_spin_aj:
s_mov_b32 s6, 0
L_spinl_aj:
s_sleep 2
buffer_load_dword v8, off, s[28:31], s58 sc1
s_add_u32 s6, s6, 1
s_waitcnt vmcnt(0)
v_cmp_le_u32 vcc, 1, v8
s_nop 4
s_andn2_b32 s7, 0x1, vcc_lo
s_cbranch_scc0 L_back_aj
s_cmp_lt_u32 s6, 0x40000
s_cbranch_scc1 L_spinl_aj
s_branch L_back_aj
L_spin_ak:
s_mov_b32 s6, 0
L_spinl_ak:
s_sleep 2
buffer_load_dword v8, v10, s[20:23], s54 offen sc1
s_add_u32 s6, s6, 1
s_waitcnt vmcnt(0)
v_cmp_le_u32 vcc, 1, v8
s_nop 4
s_andn2_b32 s7, 0xffff, vcc_lo
s_cbranch_scc0 L_back_ak
s_cmp_lt_u32 s6, 0x40000
s_cbranch_scc1 L_spinl_ak
s_branch L_back_ak
L_spin_h1:
s_mov_b32 s6, 0
L_spinl_h1:
s_sleep 1
s_add_u32 s7, s52, 0
buffer_load_dwordx4 v[64:67], v120, s[20:23], s7 offen sc1
s_add_u32 s7, s52, 23040
buffer_load_dwordx4 v[68:71], v120, s[20:23], s7 offen sc1
s_add_u32 s7, s52, 46080
buffer_load_dwordx4 v[72:75], v120, s[20:23], s7 offen sc1
s_add_u32 s7, s52, 69120
buffer_load_dwordx4 v[76:79], v120, s[20:23], s7 offen sc1
s_add_u32 s7, s52, 92160
buffer_load_dwordx4 v[80:83], v120, s[20:23], s7 offen sc1
s_add_u32 s7, s52, 115200
buffer_load_dwordx4 v[84:87], v120, s[20:23], s7 offen sc1
s_add_u32 s7, s52, 138240
buffer_load_dwordx4 v[88:91], v120, s[20:23], s7 offen sc1
s_add_u32 s7, s52, 161280
buffer_load_dwordx4 v[92:95], v120, s[20:23], s7 offen sc1
s_add_u32 s6, s6, 1
s_waitcnt vmcnt(0)
v_max3_u32 v3, v64, v65, v66
v_max3_u32 v3, v3, v67, v68
v_max3_u32 v3, v3, v69, v70
v_max3_u32 v3, v3, v71, v72
v_max3_u32 v3, v3, v73, v74
v_max3_u32 v3, v3, v75, v76
v_max3_u32 v3, v3, v77, v78
v_max3_u32 v3, v3, v79, v80
v_max3_u32 v3, v3, v81, v82
v_max3_u32 v3, v3, v83, v84
v_max3_u32 v3, v3, v85, v86
v_max3_u32 v3, v3, v87, v88
v_max3_u32 v3, v3, v89, v90
v_max3_u32 v3, v3, v91, v92
v_max3_u32 v3, v3, v93, v94
v_max_u32 v3, v3, v95
v_cmp_eq_u32 vcc, -1, v3
s_nop 4
s_cbranch_vccz L_back_h1
s_cmp_lt_u32 s6, 0x40000
s_cbranch_scc1 L_spinl_h1
s_branch L_back_h1
L_spin_h2:
s_mov_b32 s6, 0
L_spinl_h2:
s_sleep 1
buffer_load_dwordx2 v[144:145], v194, s[20:23], s75 offen offset:0 sc1
buffer_load_dwordx2 v[146:147], v194, s[20:23], s75 offen offset:512 sc1
buffer_load_dwordx2 v[148:149], v195, s[20:23], s75 offen offset:1024 sc1
buffer_load_dwordx2 v[150:151], v194, s[20:23], s75 offen offset:1440 sc1
buffer_load_dwordx2 v[152:153], v194, s[20:23], s75 offen offset:1952 sc1
buffer_load_dwordx2 v[154:155], v195, s[20:23], s75 offen offset:2464 sc1
s_add_u32 s6, s6, 1
s_waitcnt vmcnt(0)
v_max3_u32 v3, v144, v145, v146
v_max3_u32 v3, v3, v147, v148
v_max3_u32 v3, v3, v149, v150
v_max3_u32 v3, v3, v151, v152
v_max3_u32 v3, v3, v153, v154
v_max_u32 v3, v3, v155
v_cmp_eq_u32 vcc, -1, v3
s_nop 4
s_cbranch_vccz L_back_h2
s_cmp_lt_u32 s6, 0x40000
s_cbranch_scc1 L_spinl_h2
s_branch L_back_h2
L_end:
s_endpgm
.section .rodata,"a"
.p2align 6
.amdhsa_kernel recurrent_scan__linear_kernel_hedgehog__dense_activation_mish__prompt_kernel
  .amdhsa_next_free_vgpr 512
  .amdhsa_next_free_sgpr 102
  .amdhsa_accum_offset 256
  .amdhsa_group_segment_fixed_size 0
  .amdhsa_kernarg_size 88
  .amdhsa_user_sgpr_count 2
  .amdhsa_user_sgpr_kernarg_segment_ptr 1
  .amdhsa_system_sgpr_workgroup_id_x 1
  .amdhsa_float_denorm_mode_32 3
.end_amdhsa_kernel
```
